```python
import torch

def _softmax(x, axis=-1):
    return torch.softmax(x, dim=axis)
def _gelu(x):
    return torch.nn.functional.gelu(x, approximate="tanh")
def _silu(x):
    return torch.nn.functional.silu(x)
def _sigmoid(x):
    return torch.sigmoid(x)
def _layernorm(x, axis=-1, eps=1e-5):
    m = x.mean(dim=axis, keepdim=True)
    v = x.var(dim=axis, keepdim=True, unbiased=False)
    return (x - m) / torch.sqrt(v + eps)
def _scatter_add(tgt, idx, src, axis=0):
    return tgt.clone().index_add_(axis, idx, src)
def _segment_sum(src, seg, n):
    out = torch.zeros((n,) + src.shape[1:], dtype=src.dtype)
    return out.index_add_(0, seg, src)
def _pad(x, pw):
    flat = tuple(v for pair in reversed(pw) for v in pair)
    return torch.nn.functional.pad(x, flat)

kernel_name = 'interleave_layers__sliding_block__glu_gated_reglu__prompt'

def setup_inputs():

    _w = (lambda a: (lambda t: t.to(torch.bfloat16) if t.is_floating_point() else t)(torch.as_tensor(a)))
    def _A_setup():
        B, S, D = 1, 2048, 512
        return {
            "x": _w((lambda *s: torch.randn(*s, dtype=torch.bfloat16) * 0.05)(B, S, D)),
            "wqkv": _w((lambda *s: torch.randn(*s, dtype=torch.bfloat16) * 0.05)(D, 3 * D)),
            "wo": _w((lambda *s: torch.randn(*s, dtype=torch.bfloat16) * 0.05)(D, D)),
        }
    _A_in = _A_setup()

    def _B_setup():
        B, S, D, F = 1, 2048, 512, 1792
        return {
            "x": _w((lambda *s: torch.randn(*s, dtype=torch.bfloat16) * 0.05)(B, S, D)),
            "W_gate": _w((lambda *s: torch.randn(*s, dtype=torch.bfloat16) * 0.8)(D, F) * (2.0 / D) ** 0.5),
            "W_up": _w((lambda *s: torch.randn(*s, dtype=torch.bfloat16) * 0.8)(D, F) * (2.0 / D) ** 0.5),
            "W_down": _w((lambda *s: torch.randn(*s, dtype=torch.bfloat16) * 0.8)(F, D) * (1.0 / F) ** 0.5),
        }
    _B_in = _B_setup()

    return {
        "A_x": _A_in["x"],
        "A_wqkv": _A_in["wqkv"],
        "A_wo": _A_in["wo"],
        "B_x": _B_in["x"],
        "B_W_gate": _B_in["W_gate"],
        "B_W_up": _B_in["W_up"],
        "B_W_down": _B_in["W_down"],
    }

def reference(A_x, A_wqkv, A_wo, B_x, B_W_gate, B_W_up, B_W_down):
    def _A_ref(x, wqkv, wo):
        B, S, D = x.shape
        H = 32; Dh = D // H; W = 256
        qkv = (lambda x, *d: x.permute(*d))((x @ wqkv).reshape(B, S, 3, H, Dh), 2, 0, 3, 1, 4)
        q, k, v = qkv[0], qkv[1], qkv[2]
        scores = torch.einsum("bhqd,bhkd->bhqk", q, k) * (Dh ** -0.5)
        idx = torch.arange(S)
        mask = (idx[:, None] - idx[None, :] >= 0) & (idx[:, None] - idx[None, :] < W)
        scores = torch.where(mask[None, None], scores, -1e9)
        p = _softmax(scores, axis=-1)
        o = torch.einsum("bhqk,bhkd->bhqd", p, v)
        return (lambda x, *d: x.permute(*d))(o, 0, 2, 1, 3).reshape(B, S, D) @ wo

    def _B_ref(x, W_gate, W_up, W_down):
        gate = torch.einsum("bsd,df->bsf", x, W_gate)
        up = torch.einsum("bsd,df->bsf", x, W_up)
        gate = gate * (lambda x, dt: x.to(dt))(gate > 0, gate.dtype)
        h = gate * up
        return torch.einsum("bsf,fd->bsd", h, W_down)

    x = A_x
    x = x + _A_ref(_layernorm(x, axis=-1), A_wqkv, A_wo)
    x = x + _B_ref(_layernorm(x, axis=-1), B_W_gate, B_W_up, B_W_down)
    x = x + _A_ref(_layernorm(x, axis=-1), A_wqkv, A_wo)
    x = x + _B_ref(_layernorm(x, axis=-1), B_W_gate, B_W_up, B_W_down)
    return x
```

```asm
; @launch grid=(256,1,1) block=(256,1,1) lds=163840
.amdgcn_target "amdgcn-amd-amdhsa--gfx950"
.text
.globl interleave_layers__sliding_block__glu_gated_reglu__prompt_kernel
.p2align 8
.type interleave_layers__sliding_block__glu_gated_reglu__prompt_kernel,@function
interleave_layers__sliding_block__glu_gated_reglu__prompt_kernel:
    s_cmp_ge_u32 s2, 256
    s_cbranch_scc1 L_exit
    s_load_dwordx16 s[64:79], s[0:1], 0
    s_load_dwordx4 s[80:83], s[0:1], 64
    s_getpc_b64 s[4:5]
L_pc:
    v_lshrrev_b32 v2, 6, v0
    v_and_b32 v0, 63, v0
    v_readfirstlane_b32 s46, v2
    v_lshlrev_b32 v1, 4, v0
    s_and_b32 s44, s2, 7
    s_lshr_b32 s45, s2, 3
    s_and_b32 s47, s45, 3
    s_lshr_b32 s48, s45, 2
    s_lshl_b32 s84, s45, 2
    s_add_u32 s84, s84, s46
    s_lshl_b32 s84, s84, 10
    v_and_b32 v4, 7, v0
    v_lshlrev_b32 v3, 7, v4
    v_add_u32 v3, s84, v3
    v_min_u32 v3, L_end-L_pc-4, v3
    global_load_dword v251, v3, s[4:5]
    v_lshrrev_b32 v9, 3, v0
    v_xor_b32 v5, v4, v9
    v_lshlrev_b32 v92, 10, v9
    v_lshl_add_u32 v92, v5, 4, v92
    v_xor_b32 v93, 0x410, v92
    v_lshrrev_b32 v5, 4, v0
    v_mul_u32_u24 v5, 12288, v5
    v_lshl_add_u32 v5, v4, 4, v5
    v_and_b32 v6, 1, v9
    s_add_u32 s57, s48, 3
    s_and_b32 s57, s57, 7
    s_add_u32 s51, s48, 6
    s_and_b32 s51, s51, 7
    s_sub_u32 s85, s57, s48
    s_lshl_b32 s85, s85, 7
    s_add_u32 s85, s85, 1024
    v_mul_u32_u24 v104, s85, v6
    s_lshl_b32 s85, s48, 7
    v_add3_u32 v104, v104, v5, s85
    v_mul_u32_u24 v6, 3072, v6
    s_lshl_b32 s85, s51, 7
    v_add3_u32 v6, v6, v5, s85
    s_bitcmp1_b32 s46, 0
    s_cselect_b64 vcc, -1, 0
    s_cselect_b32 s94, 9216, 0
    s_mov_b32 s95, 3072
    s_mov_b32 s96, 6144
    s_mov_b32 s6, 1056
    s_mov_b32 s7, 2112
    s_cselect_b32 s95, 2048, s95
    s_cselect_b32 s96, 8192, s96
    s_cselect_b32 s3, 3168, 0
    s_cselect_b32 s6, 4224, s6
    s_cselect_b32 s7, 5312, s7
    v_cndmask_b32 v105, v104, v6, vcc
    s_lshr_b32 s85, s46, 1
    s_mul_i32 s86, s85, 49152
    s_mul_i32 s87, s85, 6336
    s_add_u32 s87, s87, 65536
    s_add_u32 s94, s94, s86
    s_add_u32 s3, s3, s87
    s_add_u32 s95, s95, s86
    s_add_u32 s6, s6, s87
    s_add_u32 s96, s96, s86
    s_add_u32 s7, s7, s87
    s_mul_i32 s86, s47, 4
    s_and_b32 s86, s86, 15
    s_mul_i32 s97, s86, 98304
    s_lshl_b32 s90, s86, 6
    s_lshl_b32 s91, s44, 4
    s_lshl_b32 s86, s47, 2
    s_add_u32 s91, s91, s86
    s_add_u32 s91, s91, s46
    s_lshl_b32 s91, s91, 14
    s_lshl_b32 s93, s85, 15
    s_and_b32 s86, s46, 1
    s_lshl_b32 s86, s86, 11
    s_add_u32 s93, s93, s86
    s_lshl_b32 s53, s44, 9
    s_lshl_b32 s92, s45, 4
    s_add_u32 s92, s92, s53
    v_mov_b32 v112, 0
    v_mov_b32 v113, 0
    v_mov_b32 v114, 0
    v_mov_b32 v115, 0
    s_waitcnt lgkmcnt(0)
    s_mov_b32 s16, s82
    s_mov_b32 s17, s83
    s_mov_b32 s18, 22544384
    s_mov_b32 s19, 0x20000
    s_cmp_lg_u32 s46, 0
    s_cbranch_scc1 L_c_1
    s_mov_b64 exec, 1
    buffer_store_dwordx4 v[112:115], off, s[16:19], s92 sc1
    s_add_u32 s92, s92, 4096
    buffer_store_dwordx4 v[112:115], off, s[16:19], s92 sc1
    s_mov_b64 exec, -1
L_c_1:
    s_mov_b32 s8, s64
    s_mov_b32 s9, s65
    s_mov_b32 s10, 2097152
    s_mov_b32 s11, 0x20000
    s_mov_b32 s12, s66
    s_mov_b32 s13, s67
    s_mov_b32 s14, 1572864
    s_mov_b32 s15, 0x20000
    s_mul_i32 s98, s48, 4096
    s_lshr_b32 s86, s98, 5
    s_add_u32 s90, s90, s86
    s_and_b32 s90, s90, 1023
    s_add_u32 s70, s90, s91
    s_add_u32 m0, s93, s98
    s_nop 0
    buffer_load_dwordx4 v92, s[8:11], s70 offen lds
    s_add_u32 s70, s90, s91
    s_add_u32 s70, s70, 8192
    s_add_u32 m0, s93, s98
    s_add_u32 m0, m0, 1024
    s_nop 0
    buffer_load_dwordx4 v93, s[8:11], s70 offen lds
    s_add_u32 s90, s90, 128
    s_and_b32 s90, s90, 1023
    s_add_u32 s98, s98, 4096
    s_and_b32 s98, s98, 0x7fff
    s_add_u32 s70, s90, s91
    s_add_u32 m0, s93, s98
    s_nop 0
    buffer_load_dwordx4 v92, s[8:11], s70 offen lds
    s_add_u32 s70, s90, s91
    s_add_u32 s70, s70, 8192
    s_add_u32 m0, s93, s98
    s_add_u32 m0, m0, 1024
    s_nop 0
    buffer_load_dwordx4 v93, s[8:11], s70 offen lds
    s_add_u32 s90, s90, 128
    s_and_b32 s90, s90, 1023
    s_add_u32 s98, s98, 4096
    s_and_b32 s98, s98, 0x7fff
    s_add_u32 s70, s90, s91
    s_add_u32 m0, s93, s98
    s_nop 0
    buffer_load_dwordx4 v92, s[8:11], s70 offen lds
    s_add_u32 s70, s90, s91
    s_add_u32 s70, s70, 8192
    s_add_u32 m0, s93, s98
    s_add_u32 m0, m0, 1024
    s_nop 0
    buffer_load_dwordx4 v93, s[8:11], s70 offen lds
    s_add_u32 s90, s90, 128
    s_and_b32 s90, s90, 1023
    s_add_u32 s98, s98, 4096
    s_and_b32 s98, s98, 0x7fff
    s_add_u32 s70, s90, s91
    s_add_u32 m0, s93, s98
    s_nop 0
    buffer_load_dwordx4 v92, s[8:11], s70 offen lds
    s_add_u32 s70, s90, s91
    s_add_u32 s70, s70, 8192
    s_add_u32 m0, s93, s98
    s_add_u32 m0, m0, 1024
    s_nop 0
    buffer_load_dwordx4 v93, s[8:11], s70 offen lds
    s_add_u32 m0, s3, 0
    s_add_u32 s70, s97, s94
    buffer_load_dwordx4 v104, s[12:15], s70 offen lds
    s_add_u32 m0, s6, 0
    s_add_u32 s70, s97, s95
    buffer_load_dwordx4 v105, s[12:15], s70 offen lds
    s_add_u32 m0, s7, 0
    s_add_u32 s70, s97, s96
    buffer_load_dwordx4 v105, s[12:15], s70 offen lds
    s_mov_b32 s63, s90
    s_mov_b32 s5, s91
    s_mov_b32 s4, s93
    s_mov_b32 s24, s80
    s_mov_b32 s25, s81
    s_mov_b32 s26, 256
    s_mov_b32 s27, 0x20000
    s_mov_b32 s20, s78
    s_mov_b32 s21, s79
    s_mov_b32 s22, 2097152
    s_mov_b32 s23, 0x20000
    s_mov_b32 s28, s68
    s_mov_b32 s29, s69
    s_mov_b32 s30, 524288
    s_mov_b32 s31, 0x20000
    s_mov_b32 s32, s72
    s_mov_b32 s33, s73
    s_mov_b32 s34, 1835008
    s_mov_b32 s35, 0x20000
    s_mov_b32 s36, s74
    s_mov_b32 s37, s75
    s_mov_b32 s38, 1835008
    s_mov_b32 s39, 0x20000
    s_mov_b32 s40, s76
    s_mov_b32 s41, s77
    s_mov_b32 s42, 1835008
    s_mov_b32 s43, 0x20000
    s_and_b32 s49, s45, 1
    s_lshr_b32 s85, s45, 1
    s_mul_i32 s85, s85, 224
    s_mul_i32 s86, s49, 96
    s_add_u32 s85, s85, s86
    s_mul_i32 s66, s46, 57344
    s_add_u32 s66, s66, s85
    v_mul_u32_u24 v24, 3584, v9
    v_lshl_add_u32 v24, v4, 4, v24
    s_lshl_b32 s84, s44, 3
    s_add_u32 s85, s84, s46
    s_sub_u32 s86, s84, s46
    s_add_u32 s86, s86, 7
    s_mul_i32 s59, s86, 151552
    s_mul_i32 s60, s85, 151552
    s_add_u32 s59, s59, 1048576
    s_add_u32 s60, s60, 1048576
    s_mov_b32 s55, 0x3f803f80
    s_getreg_b32 s56, hwreg(HW_REG_XCC_ID)
    s_and_b32 s56, s56, 15
    s_add_u32 s85, s84, s47
    s_sub_u32 s86, s84, s47
    s_add_u32 s86, s86, 7
    v_bfe_u32 v5, v0, 3, 1
    v_lshrrev_b32 v6, 4, v0
    s_lshl_b32 s87, s46, 3
    v_add_u32 v4, s87, v4
    v_lshlrev_b32 v17, 10, v4
    v_lshl_add_u32 v17, v6, 5, v17
    v_lshl_add_u32 v17, v5, 4, v17
    s_lshl_b32 s87, s48, 7
    s_lshl_b32 s88, s86, 15
    s_add_u32 s88, s88, s87
    s_lshl_b32 s89, s85, 15
    s_add_u32 s89, s89, s87
    s_mov_b32 s54, 200000
    s_lshl_b32 s90, s45, 4
    s_add_u32 s91, s53, s90
    s_lshl_b32 s92, s46, 2
    s_add_u32 s52, s91, s92
    s_max_i32 s71, s53, 512
    s_add_u32 s71, s71, s90
    s_add_u32 s71, s71, 3584
    s_mul_i32 s61, s86, 151552
    s_add_u32 s61, s61, 1048576
    s_mul_i32 s62, s85, 151552
    s_add_u32 s62, s62, 1048576
    s_lshl_b32 s65, s44, 19
    s_lshl_b32 s90, s45, 14
    s_add_u32 s65, s65, s90
    s_add_u32 s65, s65, 11534336
    s_lshl_b32 s72, s46, 10
    s_lshl_b32 s69, s46, 12
    s_lshl_b32 s68, s46, 17
    s_add_u32 s68, s68, s87
    s_mul_i32 s67, s46, 458752
    s_add_u32 s67, s67, s87
    s_add_u32 s82, s47, s48
    s_mul_i32 s75, s46, 28672
    s_add_u32 s75, s75, 32768
    s_lshl_b32 s90, s46, 13
    s_add_u32 s90, s90, 32768
    s_mul_i32 s81, s44, 1
    s_mul_i32 s80, s47, 0
    s_add_u32 s81, s81, s80
    s_mul_i32 s80, s81, 37
    s_lshr_b32 s80, s80, 8
    s_mul_i32 s80, s80, 7
    s_sub_u32 s81, s81, s80
    s_lshl_b32 s81, s81, 14
    s_mov_b32 s83, s81
    s_mul_i32 s80, s81, 14
    s_add_u32 s81, s81, s69
    s_add_u32 s80, s80, s66
    s_add_u32 s76, s82, 0
    s_and_b32 s76, s76, 3
    s_mul_i32 s76, s76, 2048
    s_add_u32 s76, s76, s90
    s_add_u32 s77, s82, 1
    s_and_b32 s77, s77, 3
    s_mul_i32 s77, s77, 2048
    s_add_u32 s77, s77, s90
    s_add_u32 s78, s82, 2
    s_and_b32 s78, s78, 3
    s_mul_i32 s78, s78, 2048
    s_add_u32 s78, s78, s90
    s_add_u32 s79, s82, 3
    s_and_b32 s79, s79, 3
    s_mul_i32 s79, s79, 2048
    s_add_u32 s79, s79, s90
    v_lshrrev_b32 v2, 5, v0
    v_bfe_u32 v3, v0, 4, 1
    v_bfe_u32 v8, v0, 2, 2
    v_and_b32 v7, 3, v0
    v_and_b32 v9, 15, v0
    v_lshl_add_u32 v9, v2, 4, v9
    v_lshlrev_b32 v9, 4, v9
    v_add_u32 v12, 114688, v9
    v_add_u32 v10, 114688, v1
    v_and_b32 v9, 31, v0
    v_lshlrev_b32 v19, 6, v9
    v_lshl_add_u32 v19, v2, 5, v19
    v_lshlrev_b32 v9, 3, v5
    v_xor_b32 v9, v9, v4
    v_lshlrev_b32 v13, 4, v9
    v_lshl_add_u32 v13, v2, 12, v13
    v_lshl_add_u32 v9, v3, 1, v5
    v_lshl_add_u32 v13, v9, 10, v13
    v_add_u32 v13, 131072, v13
    s_lshl_b32 s90, s46, 13
    s_add_u32 s90, s90, 131072
    v_add_u32 v14, s90, v1
    v_xor_b32 v15, 0x80, v14
    v_lshlrev_b32 v16, 4, v4
    v_lshl_add_u32 v16, v5, 9, v16
    v_lshl_add_u32 v16, v6, 10, v16
    v_lshlrev_b32 v18, 6, v4
    v_lshl_add_u32 v20, v5, 5, v18
    v_lshl_add_u32 v18, v3, 5, v18
    v_bfe_u32 v9, v0, 2, 3
    v_lshlrev_b32 v21, 6, v9
    v_lshl_add_u32 v21, v7, 2, v21
    s_lshl_b32 s90, s46, 4
    v_add_u32 v21, s90, v21
    v_and_b32 v9, 7, v0
    v_lshlrev_b32 v22, 4, v9
    s_lshl_b32 s90, s46, 7
    s_lshl_b32 s92, s47, 2
    s_add_u32 s90, s90, s92
    v_add_u32 v22, s90, v22
    v_lshrrev_b32 v8, 3, v0
    v_lshlrev_b32 v255, 10, v8
    v_lshl_add_u32 v255, v9, 4, v255
    v_bfe_u32 v9, v0, 1, 2
    v_and_b32 v7, 3, v8
    v_xor_b32 v9, v9, v7
    v_xor_b32 v9, 0, v9
    v_and_b32 v7, 1, v0
    v_lshlrev_b32 v7, 4, v7
    v_lshl_add_u32 v9, v9, 5, v7
    v_mul_u32_u24 v30, 3584, v8
    v_add_u32 v30, v30, v9
    v_lshl_add_u32 v25, v8, 7, v9
    v_add_u32 v25, s69, v25
    v_bfe_u32 v9, v0, 1, 2
    v_and_b32 v7, 3, v8
    v_xor_b32 v9, v9, v7
    v_xor_b32 v9, 1, v9
    v_and_b32 v7, 1, v0
    v_lshlrev_b32 v7, 4, v7
    v_lshl_add_u32 v9, v9, 5, v7
    v_mul_u32_u24 v31, 3584, v8
    v_add_u32 v31, v31, v9
    v_lshl_add_u32 v26, v8, 7, v9
    v_add_u32 v26, s69, v26
    v_and_b32 v9, 7, v0
    v_bfe_u32 v7, v0, 3, 2
    v_lshlrev_b32 v88, 10, v7
    v_and_b32 v7, 1, v7
    v_xor_b32 v7, v7, v9
    v_lshl_add_u32 v88, v7, 7, v88
    v_xor_b32 v7, v2, v9
    v_lshl_add_u32 v88, v7, 4, v88
    s_and_b32 s90, s46, 1
    s_lshl_b32 s90, s90, 15
    v_add_u32 v88, s90, v88
    v_xor_b32 v89, 32, v88
    v_xor_b32 v90, 64, v88
    v_xor_b32 v91, 96, v88
    v_xor_b32 v94, 0x8000, v88
    v_xor_b32 v95, 0x8000, v89
    v_xor_b32 v96, 0x8000, v90
    v_xor_b32 v97, 0x8000, v91
    v_and_b32 v7, 3, v0
    v_lshlrev_b32 v7, 3, v7
    v_lshl_add_u32 v7, v2, 9, v7
    v_bfe_u32 v8, v0, 2, 2
    v_mul_u32_u24 v100, 1056, v8
    v_lshl_add_u32 v100, v3, 7, v100
    s_lshl_b32 s90, s46, 5
    s_add_u32 s90, s90, 65536
    v_add3_u32 v100, v100, v7, s90
    v_mul_u32_u24 v101, 1088, v5
    v_and_b32 v8, 1, v8
    v_lshl_add_u32 v101, v8, 7, v101
    v_lshl_add_u32 v101, v3, 5, v101
    s_lshr_b32 s90, s46, 1
    s_lshl_b32 s90, s90, 6
    s_add_u32 s90, s90, 69760
    v_add3_u32 v101, v101, v7, s90
    v_add_u32 v102, 50688, v100
    v_add_u32 v103, 50688, v101
    s_sub_u32 s90, s44, 1
    s_max_i32 s90, s90, 0
    s_lshl_b32 s90, s90, 5
    s_lshl_b32 s92, s44, 5
    v_and_b32 v98, 7, v0
    v_lshlrev_b32 v98, 2, v98
    v_mov_b32 v253, s92
    v_mov_b32 v254, s90
    v_cmp_gt_u32 vcc, 32, v0
    s_nop 1
    v_cndmask_b32 v253, v254, v253, vcc
    v_add_u32 v98, v98, v253
    v_bfe_u32 v184, v0, 4, 1
    v_lshlrev_b32 v184, 2, v184
    v_and_b32 v185, 15, v0
    v_cmp_eq_u32 vcc, v184, v185
    v_mov_b32 v185, s55
    s_nop 0
    v_cndmask_b32 v184, 0, v185, vcc
    v_mov_b32 v185, v184
    v_mov_b32 v186, v184
    v_mov_b32 v187, v184
    s_add_u32 s63, s63, 128
    s_and_b32 s63, s63, 1023
    s_add_u32 s98, s98, 4096
    s_and_b32 s98, s98, 0x7fff
    s_add_u32 s70, s63, s5
    s_add_u32 m0, s4, s98
    s_nop 0
    buffer_load_dwordx4 v92, s[8:11], s70 offen lds
    s_add_u32 s70, s63, s5
    s_add_u32 s70, s70, 8192
    s_add_u32 m0, s4, s98
    s_add_u32 m0, m0, 1024
    s_nop 0
    buffer_load_dwordx4 v93, s[8:11], s70 offen lds
    s_add_u32 s63, s63, 128
    s_and_b32 s63, s63, 1023
    s_add_u32 s98, s98, 4096
    s_and_b32 s98, s98, 0x7fff
    s_add_u32 s70, s63, s5
    s_add_u32 m0, s4, s98
    s_nop 0
    buffer_load_dwordx4 v92, s[8:11], s70 offen lds
    s_add_u32 s70, s63, s5
    s_add_u32 s70, s70, 8192
    s_add_u32 m0, s4, s98
    s_add_u32 m0, m0, 1024
    s_nop 0
    buffer_load_dwordx4 v93, s[8:11], s70 offen lds
    s_add_u32 s63, s63, 128
    s_and_b32 s63, s63, 1023
    s_add_u32 s98, s98, 4096
    s_and_b32 s98, s98, 0x7fff
    s_add_u32 s70, s63, s5
    s_add_u32 m0, s4, s98
    s_nop 0
    buffer_load_dwordx4 v92, s[8:11], s70 offen lds
    s_add_u32 s70, s63, s5
    s_add_u32 s70, s70, 8192
    s_add_u32 m0, s4, s98
    s_add_u32 m0, m0, 1024
    s_nop 0
    buffer_load_dwordx4 v93, s[8:11], s70 offen lds
    s_add_u32 s63, s63, 128
    s_and_b32 s63, s63, 1023
    s_add_u32 s98, s98, 4096
    s_and_b32 s98, s98, 0x7fff
    s_add_u32 s70, s63, s5
    s_add_u32 m0, s4, s98
    s_nop 0
    buffer_load_dwordx4 v92, s[8:11], s70 offen lds
    s_add_u32 s70, s63, s5
    s_add_u32 s70, s70, 8192
    s_add_u32 m0, s4, s98
    s_add_u32 m0, m0, 1024
    s_nop 0
    buffer_load_dwordx4 v93, s[8:11], s70 offen lds
    s_add_u32 s97, s97, 98304
    s_cmp_eq_u32 s97, 1572864
    s_cselect_b32 s97, 0, s97
    s_add_u32 m0, s3, 12672
    s_add_u32 s70, s97, s94
    buffer_load_dwordx4 v104, s[12:15], s70 offen lds
    s_add_u32 m0, s6, 12672
    s_add_u32 s70, s97, s95
    buffer_load_dwordx4 v105, s[12:15], s70 offen lds
    s_add_u32 m0, s7, 12672
    s_add_u32 s70, s97, s96
    buffer_load_dwordx4 v105, s[12:15], s70 offen lds
    s_add_u32 s97, s97, 98304
    s_cmp_eq_u32 s97, 1572864
    s_cselect_b32 s97, 0, s97
    s_add_u32 m0, s3, 25344
    s_add_u32 s70, s97, s94
    buffer_load_dwordx4 v104, s[12:15], s70 offen lds
    s_add_u32 m0, s6, 25344
    s_add_u32 s70, s97, s95
    buffer_load_dwordx4 v105, s[12:15], s70 offen lds
    s_add_u32 m0, s7, 25344
    s_add_u32 s70, s97, s96
    buffer_load_dwordx4 v105, s[12:15], s70 offen lds
    s_add_u32 s97, s97, 98304
    s_cmp_eq_u32 s97, 1572864
    s_cselect_b32 s97, 0, s97
    s_add_u32 m0, s3, 38016
    s_add_u32 s70, s97, s94
    buffer_load_dwordx4 v104, s[12:15], s70 offen lds
    s_add_u32 m0, s6, 38016
    s_add_u32 s70, s97, s95
    buffer_load_dwordx4 v105, s[12:15], s70 offen lds
    s_add_u32 m0, s7, 38016
    s_add_u32 s70, s97, s96
    buffer_load_dwordx4 v105, s[12:15], s70 offen lds
    s_cmp_lg_u32 s46, 0
    s_cbranch_scc1 L_c_2
    s_waitcnt vmcnt(28)
    s_or_b32 s98, s56, 192
    v_mov_b32 v253, s98
    s_lshl_b32 s98, s44, 5
    s_add_u32 s98, s98, s45
    s_mov_b64 exec, 1
    buffer_store_byte v253, off, s[24:27], s98 sc1
    s_mov_b64 exec, -1
L_c_2:
    v_bfe_u32 v7, v0, 3, 1
    v_and_b32 v8, 7, v0
    v_xor_b32 v9, v7, v8
    v_lshlrev_b32 v9, 7, v9
    v_lshl_add_u32 v9, v7, 10, v9
    v_lshrrev_b32 v7, 4, v0
    v_xor_b32 v7, v7, v8
    v_lshl_add_u32 v9, v7, 4, v9
    v_add_u32 v106, s4, v9
    v_xor_b32 v107, 64, v106
    v_mov_b32 v116, s55
    v_mov_b32 v117, s55
    v_mov_b32 v118, s55
    v_mov_b32 v119, s55
    s_waitcnt vmcnt(9)
    ds_read_b128 v[128:131], v106 offset:0
    ds_read_b128 v[132:135], v107 offset:0
    ds_read_b128 v[136:139], v106 offset:4096
    ds_read_b128 v[140:143], v107 offset:4096
    ds_read_b128 v[144:147], v106 offset:8192
    ds_read_b128 v[148:151], v107 offset:8192
    ds_read_b128 v[152:155], v106 offset:12288
    ds_read_b128 v[156:159], v107 offset:12288
    ds_read_b128 v[160:163], v106 offset:16384
    s_waitcnt lgkmcnt(8)
    v_mfma_f32_16x16x32_bf16 v[120:123], v[116:119], v[128:131], 0
    v_mfma_f32_16x16x32_bf16 v[124:127], v[128:131], v[128:131], 0
    ds_read_b128 v[164:167], v107 offset:16384
    s_waitcnt lgkmcnt(8)
    v_mfma_f32_16x16x32_bf16 v[120:123], v[116:119], v[132:135], v[120:123]
    v_mfma_f32_16x16x32_bf16 v[124:127], v[132:135], v[132:135], v[124:127]
    ds_read_b128 v[168:171], v106 offset:20480
    s_waitcnt lgkmcnt(8)
    v_mfma_f32_16x16x32_bf16 v[120:123], v[116:119], v[136:139], v[120:123]
    v_mfma_f32_16x16x32_bf16 v[124:127], v[136:139], v[136:139], v[124:127]
    ds_read_b128 v[172:175], v107 offset:20480
    s_waitcnt lgkmcnt(8)
    v_mfma_f32_16x16x32_bf16 v[120:123], v[116:119], v[140:143], v[120:123]
    v_mfma_f32_16x16x32_bf16 v[124:127], v[140:143], v[140:143], v[124:127]
    ds_read_b128 v[128:131], v106 offset:24576
    s_waitcnt lgkmcnt(8)
    v_mfma_f32_16x16x32_bf16 v[120:123], v[116:119], v[144:147], v[120:123]
    v_mfma_f32_16x16x32_bf16 v[124:127], v[144:147], v[144:147], v[124:127]
    ds_read_b128 v[132:135], v107 offset:24576
    s_waitcnt lgkmcnt(8)
    v_mfma_f32_16x16x32_bf16 v[120:123], v[116:119], v[148:151], v[120:123]
    v_mfma_f32_16x16x32_bf16 v[124:127], v[148:151], v[148:151], v[124:127]
    s_add_u32 s97, s97, 98304
    s_cmp_eq_u32 s97, 1572864
    s_cselect_b32 s97, 0, s97
    s_add_u32 m0, s3, 50688
    s_add_u32 s70, s97, s94
    buffer_load_dwordx4 v104, s[12:15], s70 offen lds
    s_add_u32 m0, s6, 50688
    s_add_u32 s70, s97, s95
    buffer_load_dwordx4 v105, s[12:15], s70 offen lds
    s_add_u32 m0, s7, 50688
    s_add_u32 s70, s97, s96
    buffer_load_dwordx4 v105, s[12:15], s70 offen lds
    ds_read_b128 v[136:139], v106 offset:28672
    s_waitcnt lgkmcnt(8)
    v_mfma_f32_16x16x32_bf16 v[120:123], v[116:119], v[152:155], v[120:123]
    v_mfma_f32_16x16x32_bf16 v[124:127], v[152:155], v[152:155], v[124:127]
    ds_read_b128 v[140:143], v107 offset:28672
    s_waitcnt lgkmcnt(8)
    v_mfma_f32_16x16x32_bf16 v[120:123], v[116:119], v[156:159], v[120:123]
    v_mfma_f32_16x16x32_bf16 v[124:127], v[156:159], v[156:159], v[124:127]
    s_waitcnt lgkmcnt(7)
    v_mfma_f32_16x16x32_bf16 v[120:123], v[116:119], v[160:163], v[120:123]
    v_mfma_f32_16x16x32_bf16 v[124:127], v[160:163], v[160:163], v[124:127]
    s_waitcnt lgkmcnt(6)
    v_mfma_f32_16x16x32_bf16 v[120:123], v[116:119], v[164:167], v[120:123]
    v_mfma_f32_16x16x32_bf16 v[124:127], v[164:167], v[164:167], v[124:127]
    s_waitcnt lgkmcnt(5)
    v_mfma_f32_16x16x32_bf16 v[120:123], v[116:119], v[168:171], v[120:123]
    v_mfma_f32_16x16x32_bf16 v[124:127], v[168:171], v[168:171], v[124:127]
    s_waitcnt lgkmcnt(4)
    v_mfma_f32_16x16x32_bf16 v[120:123], v[116:119], v[172:175], v[120:123]
    v_mfma_f32_16x16x32_bf16 v[124:127], v[172:175], v[172:175], v[124:127]
    s_add_u32 s97, s97, 98304
    s_cmp_eq_u32 s97, 1572864
    s_cselect_b32 s97, 0, s97
    s_add_u32 m0, s3, 63360
    s_add_u32 s70, s97, s94
    buffer_load_dwordx4 v104, s[12:15], s70 offen lds
    s_add_u32 m0, s6, 63360
    s_add_u32 s70, s97, s95
    buffer_load_dwordx4 v105, s[12:15], s70 offen lds
    s_add_u32 m0, s7, 63360
    s_add_u32 s70, s97, s96
    buffer_load_dwordx4 v105, s[12:15], s70 offen lds
    s_waitcnt lgkmcnt(3)
    v_mfma_f32_16x16x32_bf16 v[120:123], v[116:119], v[128:131], v[120:123]
    v_mfma_f32_16x16x32_bf16 v[124:127], v[128:131], v[128:131], v[124:127]
    s_waitcnt lgkmcnt(2)
    v_mfma_f32_16x16x32_bf16 v[120:123], v[116:119], v[132:135], v[120:123]
    v_mfma_f32_16x16x32_bf16 v[124:127], v[132:135], v[132:135], v[124:127]
    s_waitcnt lgkmcnt(1)
    v_mfma_f32_16x16x32_bf16 v[120:123], v[116:119], v[136:139], v[120:123]
    v_mfma_f32_16x16x32_bf16 v[124:127], v[136:139], v[136:139], v[124:127]
    s_waitcnt lgkmcnt(0)
    v_mfma_f32_16x16x32_bf16 v[120:123], v[116:119], v[140:143], v[120:123]
    v_mfma_f32_16x16x32_bf16 v[124:127], v[140:143], v[140:143], v[124:127]
    v_and_b32 v106, 15, v0
    v_lshlrev_b32 v106, 3, v106
    s_lshl_b32 s70, s46, 7
    s_add_u32 s70, s70, 154624
    v_add_u32 v106, s70, v106
    s_mov_b32 vcc_lo, 0xaaaaaaaa
    s_mov_b32 vcc_hi, 0xaaaaaaaa
    s_nop 4
    v_cndmask_b32 v124, v124, v125, vcc
    v_cndmask_b32 v126, v126, v127, vcc
    s_mov_b32 vcc_lo, 0xcccccccc
    s_mov_b32 vcc_hi, 0xcccccccc
    v_cndmask_b32 v121, v124, v126, vcc
    s_mov_b32 exec_lo, 0x00f0000f
    s_mov_b32 exec_hi, 0xf0000f00
    ds_write_b64 v106, v[120:121]
    s_mov_b64 exec, -1
    s_waitcnt lgkmcnt(0)
    s_barrier
    ds_read_b64_tr_b16 v[112:113], v100 offset:0
    ds_read_b64_tr_b16 v[114:115], v100 offset:256
    ds_read_b128 v[64:67], v88 offset:0
    ds_read_b128 v[68:71], v94 offset:0
    ds_read_b64_tr_b16 v[116:117], v101 offset:0
    ds_read_b64_tr_b16 v[118:119], v101 offset:256
    s_waitcnt lgkmcnt(3)
    v_mfma_f32_32x32x16_bf16 v[128:143], v[112:115], v[64:67], 0
    ds_read_b64_tr_b16 v[120:121], v100 offset:6336
    ds_read_b64_tr_b16 v[122:123], v100 offset:6592
    ds_read_b128 v[72:75], v89 offset:0
    ds_read_b128 v[76:79], v95 offset:0
    s_waitcnt lgkmcnt(6)
    v_mfma_f32_32x32x16_bf16 v[160:175], v[112:115], v[68:71], 0
    ds_read_b64_tr_b16 v[124:125], v101 offset:6336
    ds_read_b64_tr_b16 v[126:127], v101 offset:6592
    s_waitcnt lgkmcnt(6)
    v_mfma_f32_32x32x16_bf16 v[144:159], v[64:67], v[116:119], 0
    v_mfma_f32_16x16x32_bf16 v[176:179], v[184:187], v[112:115], 0
    v_mfma_f32_16x16x32_bf16 v[180:183], v[184:187], v[116:119], 0
    s_waitcnt lgkmcnt(3)
    v_mfma_f32_32x32x16_bf16 v[128:143], v[120:123], v[72:75], v[128:143]
    s_waitcnt vmcnt(12)
    s_barrier
    ds_read_b64_tr_b16 v[112:113], v100 offset:12672
    ds_read_b64_tr_b16 v[114:115], v100 offset:12928
    ds_read_b128 v[64:67], v90 offset:0
    ds_read_b128 v[68:71], v96 offset:0
    v_and_b32 v108, 31, v0
    s_waitcnt lgkmcnt(6)
    v_mfma_f32_32x32x16_bf16 v[160:175], v[120:123], v[76:79], v[160:175]
    ds_read_b64_tr_b16 v[116:117], v101 offset:12672
    ds_read_b64_tr_b16 v[118:119], v101 offset:12928
    v_lshlrev_b32 v108, 3, v108
    s_waitcnt lgkmcnt(6)
    v_mfma_f32_32x32x16_bf16 v[144:159], v[72:75], v[124:127], v[144:159]
    s_add_u32 s97, s97, 98304
    s_cmp_eq_u32 s97, 1572864
    s_cselect_b32 s97, 0, s97
    s_add_u32 m0, s3, 76032
    s_add_u32 s70, s97, s94
    buffer_load_dwordx4 v104, s[12:15], s70 offen lds
    s_and_b32 s98, s46, 1
    v_mfma_f32_16x16x32_bf16 v[176:179], v[184:187], v[120:123], v[176:179]
    s_lshl_b32 s98, s98, 8
    v_mfma_f32_16x16x32_bf16 v[180:183], v[184:187], v[124:127], v[180:183]
    s_waitcnt lgkmcnt(3)
    v_mfma_f32_32x32x16_bf16 v[128:143], v[112:115], v[64:67], v[128:143]
    ds_read_b64_tr_b16 v[120:121], v100 offset:19008
    ds_read_b64_tr_b16 v[122:123], v100 offset:19264
    ds_read_b128 v[72:75], v91 offset:0
    ds_read_b128 v[76:79], v97 offset:0
    s_add_u32 s98, s98, 154624
    s_waitcnt lgkmcnt(6)
    v_mfma_f32_32x32x16_bf16 v[160:175], v[112:115], v[68:71], v[160:175]
    ds_read_b64_tr_b16 v[124:125], v101 offset:19008
    ds_read_b64_tr_b16 v[126:127], v101 offset:19264
    s_add_u32 m0, s6, 76032
    s_add_u32 s70, s97, s95
    buffer_load_dwordx4 v105, s[12:15], s70 offen lds
    v_add_u32 v108, s98, v108
    s_waitcnt lgkmcnt(6)
    v_mfma_f32_32x32x16_bf16 v[144:159], v[64:67], v[116:119], v[144:159]
    s_add_u32 m0, s7, 76032
    s_add_u32 s70, s97, s96
    buffer_load_dwordx4 v105, s[12:15], s70 offen lds
    v_xor_b32 v109, 0x100, v108
    v_mfma_f32_16x16x32_bf16 v[176:179], v[184:187], v[112:115], v[176:179]
    ds_read_b64 v[192:193], v108
    v_mfma_f32_16x16x32_bf16 v[180:183], v[184:187], v[116:119], v[180:183]
    s_waitcnt lgkmcnt(4)
    v_mfma_f32_32x32x16_bf16 v[128:143], v[120:123], v[72:75], v[128:143]
    s_waitcnt vmcnt(12)
    s_barrier
    ds_read_b64_tr_b16 v[112:113], v100 offset:25344
    ds_read_b64_tr_b16 v[114:115], v100 offset:25600
    ds_read_b128 v[64:67], v88 offset:4096
    ds_read_b128 v[68:71], v94 offset:4096
    ds_read_b64 v[194:195], v109
    s_waitcnt lgkmcnt(8)
    v_mfma_f32_32x32x16_bf16 v[160:175], v[120:123], v[76:79], v[160:175]
    ds_read_b64_tr_b16 v[116:117], v101 offset:25344
    ds_read_b64_tr_b16 v[118:119], v101 offset:25600
    s_waitcnt lgkmcnt(7)
    v_mul_f32 v192, 0x3b000000, v192
    v_mfma_f32_32x32x16_bf16 v[144:159], v[72:75], v[124:127], v[144:159]
    s_add_u32 s97, s97, 98304
    s_cmp_eq_u32 s97, 1572864
    s_cselect_b32 s97, 0, s97
    s_add_u32 m0, s3, 0
    s_add_u32 s70, s97, s94
    buffer_load_dwordx4 v104, s[12:15], s70 offen lds
    v_mul_f32 v193, 0x3b000000, v193
    v_mfma_f32_16x16x32_bf16 v[176:179], v[184:187], v[120:123], v[176:179]
    v_fma_f32 v193, -v192, v192, v193
    v_mfma_f32_16x16x32_bf16 v[180:183], v[184:187], v[124:127], v[180:183]
    s_waitcnt lgkmcnt(4)
    v_mfma_f32_32x32x16_bf16 v[128:143], v[112:115], v[64:67], v[128:143]
    ds_read_b64_tr_b16 v[120:121], v100 offset:31680
    ds_read_b64_tr_b16 v[122:123], v100 offset:31936
    ds_read_b128 v[72:75], v89 offset:4096
    ds_read_b128 v[76:79], v95 offset:4096
    v_max_f32 v193, 0, v193
    s_waitcnt lgkmcnt(7)
    v_mfma_f32_32x32x16_bf16 v[160:175], v[112:115], v[68:71], v[160:175]
    ds_read_b64_tr_b16 v[124:125], v101 offset:31680
    ds_read_b64_tr_b16 v[126:127], v101 offset:31936
    s_add_u32 m0, s6, 0
    s_add_u32 s70, s97, s95
    buffer_load_dwordx4 v105, s[12:15], s70 offen lds
    v_cvt_pk_bf16_f32 v208, -v192, -v192
    s_waitcnt lgkmcnt(6)
    v_mfma_f32_32x32x16_bf16 v[144:159], v[64:67], v[116:119], v[144:159]
    s_add_u32 m0, s7, 0
    s_add_u32 s70, s97, s96
    buffer_load_dwordx4 v105, s[12:15], s70 offen lds
    v_cvt_pk_bf16_f32 v108, v193, v193
    v_mfma_f32_16x16x32_bf16 v[176:179], v[184:187], v[112:115], v[176:179]
    v_and_b32 v108, 0xffff0000, v108
    v_mfma_f32_16x16x32_bf16 v[180:183], v[184:187], v[116:119], v[180:183]
    s_waitcnt lgkmcnt(3)
    v_mfma_f32_32x32x16_bf16 v[128:143], v[120:123], v[72:75], v[128:143]
    s_waitcnt vmcnt(12)
    s_barrier
    ds_read_b64_tr_b16 v[112:113], v100 offset:38016
    ds_read_b64_tr_b16 v[114:115], v100 offset:38272
    ds_read_b128 v[64:67], v90 offset:4096
    ds_read_b128 v[68:71], v96 offset:4096
    v_add_f32 v108, 0x3727c5ac, v108
    s_waitcnt lgkmcnt(6)
    v_mfma_f32_32x32x16_bf16 v[160:175], v[120:123], v[76:79], v[160:175]
    ds_read_b64_tr_b16 v[116:117], v101 offset:38016
    ds_read_b64_tr_b16 v[118:119], v101 offset:38272
    v_cvt_pk_bf16_f32 v108, v108, v108
    s_waitcnt lgkmcnt(6)
    v_mfma_f32_32x32x16_bf16 v[144:159], v[72:75], v[124:127], v[144:159]
    s_add_u32 s97, s97, 98304
    s_cmp_eq_u32 s97, 1572864
    s_cselect_b32 s97, 0, s97
    s_add_u32 m0, s3, 12672
    s_add_u32 s70, s97, s94
    buffer_load_dwordx4 v104, s[12:15], s70 offen lds
    v_and_b32 v108, 0xffff0000, v108
    v_mfma_f32_16x16x32_bf16 v[176:179], v[184:187], v[120:123], v[176:179]
    v_sqrt_f32 v108, v108
    v_mfma_f32_16x16x32_bf16 v[180:183], v[184:187], v[124:127], v[180:183]
    s_waitcnt lgkmcnt(3)
    v_mfma_f32_32x32x16_bf16 v[128:143], v[112:115], v[64:67], v[128:143]
    ds_read_b64_tr_b16 v[120:121], v100 offset:44352
    ds_read_b64_tr_b16 v[122:123], v100 offset:44608
    ds_read_b128 v[72:75], v91 offset:4096
    ds_read_b128 v[76:79], v97 offset:4096
    v_cvt_pk_bf16_f32 v108, v108, v108
    s_waitcnt lgkmcnt(6)
    v_mfma_f32_32x32x16_bf16 v[160:175], v[112:115], v[68:71], v[160:175]
    ds_read_b64_tr_b16 v[124:125], v101 offset:44352
    ds_read_b64_tr_b16 v[126:127], v101 offset:44608
    s_add_u32 m0, s6, 12672
    s_add_u32 s70, s97, s95
    buffer_load_dwordx4 v105, s[12:15], s70 offen lds
    v_and_b32 v108, 0xffff0000, v108
    s_waitcnt lgkmcnt(6)
    v_mfma_f32_32x32x16_bf16 v[144:159], v[64:67], v[116:119], v[144:159]
    s_add_u32 m0, s7, 12672
    s_add_u32 s70, s97, s96
    buffer_load_dwordx4 v105, s[12:15], s70 offen lds
    v_rcp_f32 v212, v108
    v_mfma_f32_16x16x32_bf16 v[176:179], v[184:187], v[112:115], v[176:179]
    v_mul_f32 v194, 0x3b000000, v194
    v_mfma_f32_16x16x32_bf16 v[180:183], v[184:187], v[116:119], v[180:183]
    s_waitcnt lgkmcnt(3)
    v_mfma_f32_32x32x16_bf16 v[128:143], v[120:123], v[72:75], v[128:143]
    s_waitcnt vmcnt(12)
    s_barrier
    ds_read_b64_tr_b16 v[112:113], v102 offset:0
    ds_read_b64_tr_b16 v[114:115], v102 offset:256
    ds_read_b128 v[64:67], v88 offset:8192
    ds_read_b128 v[68:71], v94 offset:8192
    v_mul_f32 v195, 0x3b000000, v195
    s_waitcnt lgkmcnt(6)
    v_mfma_f32_32x32x16_bf16 v[160:175], v[120:123], v[76:79], v[160:175]
    ds_read_b64_tr_b16 v[116:117], v103 offset:0
    ds_read_b64_tr_b16 v[118:119], v103 offset:256
    v_fma_f32 v195, -v194, v194, v195
    s_waitcnt lgkmcnt(6)
    v_mfma_f32_32x32x16_bf16 v[144:159], v[72:75], v[124:127], v[144:159]
    s_add_u32 s97, s97, 98304
    s_cmp_eq_u32 s97, 1572864
    s_cselect_b32 s97, 0, s97
    s_add_u32 m0, s3, 25344
    s_add_u32 s70, s97, s94
    buffer_load_dwordx4 v104, s[12:15], s70 offen lds
    v_max_f32 v195, 0, v195
    v_mfma_f32_16x16x32_bf16 v[176:179], v[184:187], v[120:123], v[176:179]
    v_cvt_pk_bf16_f32 v188, -v194, -v194
    v_mfma_f32_16x16x32_bf16 v[180:183], v[184:187], v[124:127], v[180:183]
    s_waitcnt lgkmcnt(3)
    v_mfma_f32_32x32x16_bf16 v[128:143], v[112:115], v[64:67], v[128:143]
    ds_read_b64_tr_b16 v[120:121], v102 offset:6336
    ds_read_b64_tr_b16 v[122:123], v102 offset:6592
    ds_read_b128 v[72:75], v89 offset:8192
    ds_read_b128 v[76:79], v95 offset:8192
    v_cvt_pk_bf16_f32 v109, v195, v195
    s_waitcnt lgkmcnt(6)
    v_mfma_f32_32x32x16_bf16 v[160:175], v[112:115], v[68:71], v[160:175]
    ds_read_b64_tr_b16 v[124:125], v103 offset:6336
    ds_read_b64_tr_b16 v[126:127], v103 offset:6592
    s_add_u32 m0, s6, 25344
    s_add_u32 s70, s97, s95
    buffer_load_dwordx4 v105, s[12:15], s70 offen lds
    v_and_b32 v109, 0xffff0000, v109
    s_waitcnt lgkmcnt(6)
    v_mfma_f32_32x32x16_bf16 v[144:159], v[64:67], v[116:119], v[144:159]
    s_cmp_lg_u32 s44, 0
    s_cbranch_scc1 L_c_3
    v_accvgpr_write_b32 a216, v112
    v_accvgpr_write_b32 a217, v113
    v_accvgpr_write_b32 a218, v114
    v_accvgpr_write_b32 a219, v115
    v_accvgpr_write_b32 a220, v116
    v_accvgpr_write_b32 a221, v117
    v_accvgpr_write_b32 a222, v118
    v_accvgpr_write_b32 a223, v119
L_c_3:
    s_add_u32 m0, s7, 25344
    s_add_u32 s70, s97, s96
    buffer_load_dwordx4 v105, s[12:15], s70 offen lds
    v_add_f32 v109, 0x3727c5ac, v109
    v_mfma_f32_16x16x32_bf16 v[176:179], v[184:187], v[112:115], v[176:179]
    v_cvt_pk_bf16_f32 v109, v109, v109
    v_mfma_f32_16x16x32_bf16 v[180:183], v[184:187], v[116:119], v[180:183]
    s_waitcnt lgkmcnt(3)
    v_mfma_f32_32x32x16_bf16 v[128:143], v[120:123], v[72:75], v[128:143]
    s_waitcnt vmcnt(12)
    s_barrier
    ds_read_b64_tr_b16 v[112:113], v102 offset:12672
    ds_read_b64_tr_b16 v[114:115], v102 offset:12928
    ds_read_b128 v[64:67], v90 offset:8192
    ds_read_b128 v[68:71], v96 offset:8192
    v_and_b32 v109, 0xffff0000, v109
    s_waitcnt lgkmcnt(6)
    v_mfma_f32_32x32x16_bf16 v[160:175], v[120:123], v[76:79], v[160:175]
    ds_read_b64_tr_b16 v[116:117], v103 offset:12672
    ds_read_b64_tr_b16 v[118:119], v103 offset:12928
    v_sqrt_f32 v109, v109
    s_waitcnt lgkmcnt(6)
    v_mfma_f32_32x32x16_bf16 v[144:159], v[72:75], v[124:127], v[144:159]
    s_cmp_lg_u32 s44, 1
    s_cbranch_scc1 L_c_4
    v_accvgpr_write_b32 a216, v120
    v_accvgpr_write_b32 a217, v121
    v_accvgpr_write_b32 a218, v122
    v_accvgpr_write_b32 a219, v123
    v_accvgpr_write_b32 a220, v124
    v_accvgpr_write_b32 a221, v125
    v_accvgpr_write_b32 a222, v126
    v_accvgpr_write_b32 a223, v127
L_c_4:
    s_add_u32 s97, s97, 98304
    s_cmp_eq_u32 s97, 1572864
    s_cselect_b32 s97, 0, s97
    s_add_u32 m0, s3, 38016
    s_add_u32 s70, s97, s94
    buffer_load_dwordx4 v104, s[12:15], s70 offen lds
    v_cvt_pk_bf16_f32 v109, v109, v109
    v_mfma_f32_16x16x32_bf16 v[176:179], v[184:187], v[120:123], v[176:179]
    v_and_b32 v109, 0xffff0000, v109
    v_mfma_f32_16x16x32_bf16 v[180:183], v[184:187], v[124:127], v[180:183]
    s_waitcnt lgkmcnt(3)
    v_mfma_f32_32x32x16_bf16 v[128:143], v[112:115], v[64:67], v[128:143]
    ds_read_b64_tr_b16 v[120:121], v102 offset:19008
    ds_read_b64_tr_b16 v[122:123], v102 offset:19264
    ds_read_b128 v[72:75], v91 offset:8192
    ds_read_b128 v[76:79], v97 offset:8192
    v_rcp_f32 v110, v109
    s_waitcnt lgkmcnt(6)
    v_mfma_f32_32x32x16_bf16 v[160:175], v[112:115], v[68:71], v[160:175]
    ds_read_b64_tr_b16 v[124:125], v103 offset:19008
    ds_read_b64_tr_b16 v[126:127], v103 offset:19264
    s_add_u32 m0, s6, 38016
    s_add_u32 s70, s97, s95
    buffer_load_dwordx4 v105, s[12:15], s70 offen lds
    v_mov_b32 v209, v208
    s_waitcnt lgkmcnt(6)
    v_mfma_f32_32x32x16_bf16 v[144:159], v[64:67], v[116:119], v[144:159]
    s_cmp_lg_u32 s44, 2
    s_cbranch_scc1 L_c_5
    v_accvgpr_write_b32 a216, v112
    v_accvgpr_write_b32 a217, v113
    v_accvgpr_write_b32 a218, v114
    v_accvgpr_write_b32 a219, v115
    v_accvgpr_write_b32 a220, v116
    v_accvgpr_write_b32 a221, v117
    v_accvgpr_write_b32 a222, v118
    v_accvgpr_write_b32 a223, v119
L_c_5:
    s_add_u32 m0, s7, 38016
    s_add_u32 s70, s97, s96
    buffer_load_dwordx4 v105, s[12:15], s70 offen lds
    v_mov_b32 v189, v188
    v_mfma_f32_16x16x32_bf16 v[176:179], v[184:187], v[112:115], v[176:179]
    v_mov_b32 v210, v208
    v_mfma_f32_16x16x32_bf16 v[180:183], v[184:187], v[116:119], v[180:183]
    s_waitcnt lgkmcnt(3)
    v_mfma_f32_32x32x16_bf16 v[128:143], v[120:123], v[72:75], v[128:143]
    s_waitcnt vmcnt(12)
    s_barrier
    ds_read_b64_tr_b16 v[112:113], v102 offset:25344
    ds_read_b64_tr_b16 v[114:115], v102 offset:25600
    ds_read_b128 v[64:67], v88 offset:12288
    ds_read_b128 v[68:71], v94 offset:12288
    v_mov_b32 v190, v188
    s_waitcnt lgkmcnt(6)
    v_mfma_f32_32x32x16_bf16 v[160:175], v[120:123], v[76:79], v[160:175]
    ds_read_b64_tr_b16 v[116:117], v103 offset:25344
    ds_read_b64_tr_b16 v[118:119], v103 offset:25600
    v_mov_b32 v211, v208
    s_waitcnt lgkmcnt(6)
    v_mfma_f32_32x32x16_bf16 v[144:159], v[72:75], v[124:127], v[144:159]
    s_cmp_lg_u32 s44, 3
    s_cbranch_scc1 L_c_6
    v_accvgpr_write_b32 a216, v120
    v_accvgpr_write_b32 a217, v121
    v_accvgpr_write_b32 a218, v122
    v_accvgpr_write_b32 a219, v123
    v_accvgpr_write_b32 a220, v124
    v_accvgpr_write_b32 a221, v125
    v_accvgpr_write_b32 a222, v126
    v_accvgpr_write_b32 a223, v127
L_c_6:
    s_add_u32 s97, s97, 98304
    s_cmp_eq_u32 s97, 1572864
    s_cselect_b32 s97, 0, s97
    s_add_u32 m0, s3, 50688
    s_add_u32 s70, s97, s94
    buffer_load_dwordx4 v104, s[12:15], s70 offen lds
    v_mov_b32 v191, v188
    v_mfma_f32_16x16x32_bf16 v[176:179], v[184:187], v[120:123], v[176:179]
    v_mul_f32 v213, 0x3eb8aa3b, v212
    v_mfma_f32_16x16x32_bf16 v[180:183], v[184:187], v[124:127], v[180:183]
    s_waitcnt lgkmcnt(3)
    v_mfma_f32_32x32x16_bf16 v[128:143], v[112:115], v[64:67], v[128:143]
    ds_read_b64_tr_b16 v[120:121], v102 offset:31680
    ds_read_b64_tr_b16 v[122:123], v102 offset:31936
    ds_read_b128 v[72:75], v89 offset:12288
    ds_read_b128 v[76:79], v95 offset:12288
    v_mul_f32 v111, 0x3eb8aa3b, v110
    s_waitcnt lgkmcnt(6)
    v_mfma_f32_32x32x16_bf16 v[160:175], v[112:115], v[68:71], v[160:175]
    ds_read_b64_tr_b16 v[124:125], v103 offset:31680
    ds_read_b64_tr_b16 v[126:127], v103 offset:31936
    s_add_u32 m0, s6, 50688
    s_add_u32 s70, s97, s95
    buffer_load_dwordx4 v105, s[12:15], s70 offen lds
    s_lshl_b32 s98, s46, 8
    s_waitcnt lgkmcnt(6)
    v_mfma_f32_32x32x16_bf16 v[144:159], v[64:67], v[116:119], v[144:159]
    s_cmp_lg_u32 s44, 4
    s_cbranch_scc1 L_c_7
    v_accvgpr_write_b32 a216, v112
    v_accvgpr_write_b32 a217, v113
    v_accvgpr_write_b32 a218, v114
    v_accvgpr_write_b32 a219, v115
    v_accvgpr_write_b32 a220, v116
    v_accvgpr_write_b32 a221, v117
    v_accvgpr_write_b32 a222, v118
    v_accvgpr_write_b32 a223, v119
L_c_7:
    s_add_u32 m0, s7, 50688
    s_add_u32 s70, s97, s96
    buffer_load_dwordx4 v105, s[12:15], s70 offen lds
    s_lshl_b32 s4, s45, 2
    s_add_u32 s4, s4, s46
    s_mul_i32 s4, s4, 4096
    v_lshlrev_b32 v253, 10, v0
    s_mov_b64 exec, 15
    s_sub_u32 s70, 384, s28
    s_and_b32 s70, s70, 0x380
    s_add_u32 s70, s70, s4
    buffer_load_dword v250, v253, s[28:31], s70 offen
    s_mov_b64 exec, -1
    s_add_u32 s98, s98, 155136
    v_mfma_f32_16x16x32_bf16 v[176:179], v[184:187], v[112:115], v[176:179]
    v_lshlrev_b32 v108, 2, v0
    v_mfma_f32_16x16x32_bf16 v[180:183], v[184:187], v[116:119], v[180:183]
    s_waitcnt lgkmcnt(3)
    v_mfma_f32_32x32x16_bf16 v[128:143], v[120:123], v[72:75], v[128:143]
    s_waitcnt vmcnt(13)
    s_barrier
    ds_read_b64_tr_b16 v[112:113], v100 offset:0
    ds_read_b64_tr_b16 v[114:115], v100 offset:256
    ds_read_b128 v[64:67], v90 offset:12288
    ds_read_b128 v[68:71], v96 offset:12288
    v_add_u32 v108, s98, v108
    s_waitcnt lgkmcnt(6)
    v_mfma_f32_32x32x16_bf16 v[160:175], v[120:123], v[76:79], v[160:175]
    ds_read_b64_tr_b16 v[116:117], v101 offset:0
    ds_read_b64_tr_b16 v[118:119], v101 offset:256
    ds_write_b32 v108, v212
    s_waitcnt lgkmcnt(7)
    v_mfma_f32_32x32x16_bf16 v[144:159], v[72:75], v[124:127], v[144:159]
    s_cmp_lg_u32 s44, 5
    s_cbranch_scc1 L_c_8
    v_accvgpr_write_b32 a216, v120
    v_accvgpr_write_b32 a217, v121
    v_accvgpr_write_b32 a218, v122
    v_accvgpr_write_b32 a219, v123
    v_accvgpr_write_b32 a220, v124
    v_accvgpr_write_b32 a221, v125
    v_accvgpr_write_b32 a222, v126
    v_accvgpr_write_b32 a223, v127
L_c_8:
    s_add_u32 s97, s97, 98304
    s_cmp_eq_u32 s97, 1572864
    s_cselect_b32 s97, 0, s97
    s_add_u32 m0, s3, 63360
    s_add_u32 s70, s97, s94
    buffer_load_dwordx4 v104, s[12:15], s70 offen lds
    v_lshrrev_b32 v109, 5, v0
    v_mfma_f32_16x16x32_bf16 v[176:179], v[184:187], v[120:123], v[176:179]
    v_lshlrev_b32 v109, 4, v109
    v_mfma_f32_16x16x32_bf16 v[180:183], v[184:187], v[124:127], v[180:183]
    s_waitcnt lgkmcnt(4)
    v_mfma_f32_32x32x16_bf16 v[128:143], v[112:115], v[64:67], v[128:143]
    ds_read_b64_tr_b16 v[120:121], v100 offset:6336
    ds_read_b64_tr_b16 v[122:123], v100 offset:6592
    ds_read_b128 v[72:75], v91 offset:12288
    ds_read_b128 v[76:79], v97 offset:12288
    v_add_u32 v109, s98, v109
    s_waitcnt lgkmcnt(7)
    v_mfma_f32_32x32x16_bf16 v[160:175], v[112:115], v[68:71], v[160:175]
    ds_read_b64_tr_b16 v[124:125], v101 offset:6336
    ds_read_b64_tr_b16 v[126:127], v101 offset:6592
    s_add_u32 m0, s6, 63360
    s_add_u32 s70, s97, s95
    buffer_load_dwordx4 v105, s[12:15], s70 offen lds
    ds_read_b128 v[192:195], v109 offset:0
    s_waitcnt lgkmcnt(8)
    v_mfma_f32_32x32x16_bf16 v[144:159], v[64:67], v[116:119], v[144:159]
    s_cmp_lg_u32 s44, 6
    s_cbranch_scc1 L_c_9
    v_accvgpr_write_b32 a216, v112
    v_accvgpr_write_b32 a217, v113
    v_accvgpr_write_b32 a218, v114
    v_accvgpr_write_b32 a219, v115
    v_accvgpr_write_b32 a220, v116
    v_accvgpr_write_b32 a221, v117
    v_accvgpr_write_b32 a222, v118
    v_accvgpr_write_b32 a223, v119
L_c_9:
    s_add_u32 m0, s7, 63360
    s_add_u32 s70, s97, s96
    buffer_load_dwordx4 v105, s[12:15], s70 offen lds
    ds_read_b128 v[196:199], v109 offset:32
    v_mfma_f32_16x16x32_bf16 v[176:179], v[184:187], v[112:115], v[176:179]
    ds_read_b128 v[200:203], v109 offset:64
    v_mfma_f32_16x16x32_bf16 v[180:183], v[184:187], v[116:119], v[180:183]
    s_waitcnt lgkmcnt(6)
    v_mfma_f32_32x32x16_bf16 v[128:143], v[120:123], v[72:75], v[128:143]
    s_waitcnt vmcnt(13)
    s_barrier
    ds_read_b64_tr_b16 v[112:113], v100 offset:12672
    ds_read_b64_tr_b16 v[114:115], v100 offset:12928
    ds_read_b128 v[64:67], v88 offset:16384
    ds_read_b128 v[68:71], v94 offset:16384
    ds_read_b128 v[204:207], v109 offset:96
    s_waitcnt lgkmcnt(10)
    v_mfma_f32_32x32x16_bf16 v[160:175], v[120:123], v[76:79], v[160:175]
    ds_read_b64_tr_b16 v[116:117], v101 offset:12672
    ds_read_b64_tr_b16 v[118:119], v101 offset:12928
    v_mov_b32 v81, 0
    s_waitcnt lgkmcnt(10)
    v_mfma_f32_32x32x16_bf16 v[144:159], v[72:75], v[124:127], v[144:159]
    s_cmp_lg_u32 s44, 7
    s_cbranch_scc1 L_c_10
    v_accvgpr_write_b32 a216, v120
    v_accvgpr_write_b32 a217, v121
    v_accvgpr_write_b32 a218, v122
    v_accvgpr_write_b32 a219, v123
    v_accvgpr_write_b32 a220, v124
    v_accvgpr_write_b32 a221, v125
    v_accvgpr_write_b32 a222, v126
    v_accvgpr_write_b32 a223, v127
L_c_10:
    s_add_u32 s97, s97, 98304
    s_cmp_eq_u32 s97, 1572864
    s_cselect_b32 s97, 0, s97
    s_add_u32 m0, s3, 76032
    s_add_u32 s70, s97, s94
    buffer_load_dwordx4 v104, s[12:15], s70 offen lds
    v_mov_b32 v82, 0
    v_mfma_f32_16x16x32_bf16 v[176:179], v[184:187], v[120:123], v[176:179]
    v_mov_b32 v83, 0
    v_mfma_f32_16x16x32_bf16 v[180:183], v[184:187], v[124:127], v[180:183]
    s_waitcnt lgkmcnt(4)
    v_mfma_f32_32x32x16_bf16 v[128:143], v[112:115], v[64:67], v[128:143]
    ds_read_b64_tr_b16 v[120:121], v100 offset:19008
    ds_read_b64_tr_b16 v[122:123], v100 offset:19264
    ds_read_b128 v[72:75], v89 offset:16384
    ds_read_b128 v[76:79], v95 offset:16384
    v_mov_b32 v85, 0
    s_waitcnt lgkmcnt(7)
    v_mfma_f32_32x32x16_bf16 v[160:175], v[112:115], v[68:71], v[160:175]
    ds_read_b64_tr_b16 v[124:125], v101 offset:19008
    ds_read_b64_tr_b16 v[126:127], v101 offset:19264
    s_add_u32 m0, s6, 76032
    s_add_u32 s70, s97, s95
    buffer_load_dwordx4 v105, s[12:15], s70 offen lds
    v_mov_b32 v86, 0
    s_waitcnt lgkmcnt(6)
    v_mfma_f32_32x32x16_bf16 v[144:159], v[64:67], v[116:119], v[144:159]
    s_add_u32 m0, s7, 76032
    s_add_u32 s70, s97, s96
    buffer_load_dwordx4 v105, s[12:15], s70 offen lds
    v_mov_b32 v87, 0
    v_mfma_f32_16x16x32_bf16 v[176:179], v[184:187], v[112:115], v[176:179]
    s_lshl_b32 s92, s45, 14
    v_mfma_f32_16x16x32_bf16 v[180:183], v[184:187], v[116:119], v[180:183]
    s_waitcnt lgkmcnt(3)
    v_mfma_f32_32x32x16_bf16 v[128:143], v[120:123], v[72:75], v[128:143]
    s_waitcnt vmcnt(13)
    s_barrier
    ds_read_b64_tr_b16 v[112:113], v100 offset:25344
    ds_read_b64_tr_b16 v[114:115], v100 offset:25600
    ds_read_b128 v[64:67], v90 offset:16384
    ds_read_b128 v[68:71], v96 offset:16384
    s_sub_u32 s86, s65, s92
    s_waitcnt lgkmcnt(6)
    v_mfma_f32_32x32x16_bf16 v[160:175], v[120:123], v[76:79], v[160:175]
    ds_read_b64_tr_b16 v[116:117], v101 offset:25344
    ds_read_b64_tr_b16 v[118:119], v101 offset:25600
    s_lshl_b32 s92, s47, 11
    s_waitcnt lgkmcnt(6)
    v_mfma_f32_32x32x16_bf16 v[144:159], v[72:75], v[124:127], v[144:159]
    s_add_u32 s97, s97, 98304
    s_cmp_eq_u32 s97, 1572864
    s_cselect_b32 s97, 0, s97
    s_add_u32 m0, s3, 0
    s_add_u32 s70, s97, s94
    buffer_load_dwordx4 v104, s[12:15], s70 offen lds
    s_add_u32 s91, s86, s92
    v_mfma_f32_16x16x32_bf16 v[176:179], v[184:187], v[120:123], v[176:179]
    s_and_b32 s92, s46, 1
    v_mfma_f32_16x16x32_bf16 v[180:183], v[184:187], v[124:127], v[180:183]
    s_waitcnt lgkmcnt(3)
    v_mfma_f32_32x32x16_bf16 v[128:143], v[112:115], v[64:67], v[128:143]
    ds_read_b64_tr_b16 v[120:121], v100 offset:31680
    ds_read_b64_tr_b16 v[122:123], v100 offset:31936
    ds_read_b128 v[72:75], v91 offset:16384
    ds_read_b128 v[76:79], v97 offset:16384
    s_lshl_b32 s92, s92, 10
    s_waitcnt lgkmcnt(6)
    v_mfma_f32_32x32x16_bf16 v[160:175], v[112:115], v[68:71], v[160:175]
    ds_read_b64_tr_b16 v[124:125], v101 offset:31680
    ds_read_b64_tr_b16 v[126:127], v101 offset:31936
    s_add_u32 m0, s6, 0
    s_add_u32 s70, s97, s95
    buffer_load_dwordx4 v105, s[12:15], s70 offen lds
    s_add_u32 s91, s91, s92
    s_waitcnt lgkmcnt(6)
    v_mfma_f32_32x32x16_bf16 v[144:159], v[64:67], v[116:119], v[144:159]
    s_add_u32 m0, s7, 0
    s_add_u32 s70, s97, s96
    buffer_load_dwordx4 v105, s[12:15], s70 offen lds
    buffer_load_dwordx4 v[2:5], v17, s[8:11], s88 offen
    buffer_load_dwordx4 v[6:9], v17, s[8:11], s89 offen
    s_lshl_b32 s92, s46, 14
    v_mfma_f32_16x16x32_bf16 v[176:179], v[184:187], v[112:115], v[176:179]
    s_add_u32 s90, s91, s92
    v_mfma_f32_16x16x32_bf16 v[180:183], v[184:187], v[116:119], v[180:183]
    s_waitcnt lgkmcnt(3)
    v_mfma_f32_32x32x16_bf16 v[128:143], v[120:123], v[72:75], v[128:143]
    s_waitcnt vmcnt(15)
    s_barrier
    ds_read_b64_tr_b16 v[112:113], v100 offset:38016
    ds_read_b64_tr_b16 v[114:115], v100 offset:38272
    ds_read_b128 v[64:67], v88 offset:20480
    ds_read_b128 v[68:71], v94 offset:20480
    s_and_b32 s92, s92, 0x8000
    s_waitcnt lgkmcnt(6)
    v_mfma_f32_32x32x16_bf16 v[160:175], v[120:123], v[76:79], v[160:175]
    ds_read_b64_tr_b16 v[116:117], v101 offset:38016
    ds_read_b64_tr_b16 v[118:119], v101 offset:38272
    s_add_u32 s91, s91, s92
    s_waitcnt lgkmcnt(6)
    v_mfma_f32_32x32x16_bf16 v[144:159], v[72:75], v[124:127], v[144:159]
    s_add_u32 s97, s97, 98304
    s_cmp_eq_u32 s97, 1572864
    s_cselect_b32 s97, 0, s97
    s_add_u32 m0, s3, 12672
    s_add_u32 s70, s97, s94
    buffer_load_dwordx4 v104, s[12:15], s70 offen lds
    buffer_load_dword v99, v98, s[24:27], 0 offen sc1
    s_lshl_b32 s92, s51, 16
    v_mfma_f32_16x16x32_bf16 v[176:179], v[184:187], v[120:123], v[176:179]
    s_add_u32 s91, s91, s92
    v_mfma_f32_16x16x32_bf16 v[180:183], v[184:187], v[124:127], v[180:183]
    s_waitcnt lgkmcnt(3)
    v_mfma_f32_32x32x16_bf16 v[128:143], v[112:115], v[64:67], v[128:143]
    ds_read_b64_tr_b16 v[120:121], v100 offset:44352
    ds_read_b64_tr_b16 v[122:123], v100 offset:44608
    ds_read_b128 v[72:75], v89 offset:20480
    ds_read_b128 v[76:79], v95 offset:20480
    s_add_u32 s91, s91, 8192
    s_waitcnt lgkmcnt(6)
    v_mfma_f32_32x32x16_bf16 v[160:175], v[112:115], v[68:71], v[160:175]
    ds_read_b64_tr_b16 v[124:125], v101 offset:44352
    ds_read_b64_tr_b16 v[126:127], v101 offset:44608
    s_add_u32 m0, s6, 12672
    s_add_u32 s70, s97, s95
    buffer_load_dwordx4 v105, s[12:15], s70 offen lds
    s_lshl_b32 s92, s57, 16
    s_waitcnt lgkmcnt(6)
    v_mfma_f32_32x32x16_bf16 v[144:159], v[64:67], v[116:119], v[144:159]
    s_add_u32 m0, s7, 12672
    s_add_u32 s70, s97, s96
    buffer_load_dwordx4 v105, s[12:15], s70 offen lds
    s_add_u32 s70, s66, 1605632
    buffer_load_dwordx4 a[128:131], v24, s[32:35], s70 offen
    s_add_u32 s90, s90, s92
    v_mfma_f32_16x16x32_bf16 v[176:179], v[184:187], v[112:115], v[176:179]
    s_lshl_b32 s86, s44, 2
    v_mfma_f32_16x16x32_bf16 v[180:183], v[184:187], v[116:119], v[180:183]
    s_waitcnt lgkmcnt(3)
    v_mfma_f32_32x32x16_bf16 v[128:143], v[120:123], v[72:75], v[128:143]
    s_waitcnt vmcnt(17)
    s_barrier
    ds_read_b64_tr_b16 v[112:113], v102 offset:0
    ds_read_b64_tr_b16 v[114:115], v102 offset:256
    ds_read_b128 v[64:67], v90 offset:20480
    ds_read_b128 v[68:71], v96 offset:20480
    s_add_u32 s86, s86, s47
    s_waitcnt lgkmcnt(6)
    v_mfma_f32_32x32x16_bf16 v[160:175], v[120:123], v[76:79], v[160:175]
    ds_read_b64_tr_b16 v[116:117], v103 offset:0
    ds_read_b64_tr_b16 v[118:119], v103 offset:256
    s_lshl_b32 s86, s86, 1
    s_waitcnt lgkmcnt(6)
    v_mfma_f32_32x32x16_bf16 v[144:159], v[72:75], v[124:127], v[144:159]
    s_add_u32 s74, s82, 0
    s_and_b32 s74, s74, 3
    s_mul_i32 s74, s74, 32768
    s_add_u32 s74, s74, s68
    s_add_u32 s70, s74, 0
    buffer_load_dwordx4 v[32:35], v255, s[28:31], s70 offen
    s_and_b32 s92, s46, 1
    v_mfma_f32_16x16x32_bf16 v[176:179], v[184:187], v[120:123], v[176:179]
    s_add_u32 s86, s86, s92
    v_mfma_f32_16x16x32_bf16 v[180:183], v[184:187], v[124:127], v[180:183]
    s_waitcnt lgkmcnt(3)
    v_mfma_f32_32x32x16_bf16 v[128:143], v[112:115], v[64:67], v[128:143]
    ds_read_b64_tr_b16 v[120:121], v102 offset:6336
    ds_read_b64_tr_b16 v[122:123], v102 offset:6592
    ds_read_b128 v[72:75], v91 offset:20480
    ds_read_b128 v[76:79], v97 offset:20480
    s_mul_i32 s85, s86, 151552
    s_waitcnt lgkmcnt(6)
    v_mfma_f32_32x32x16_bf16 v[160:175], v[112:115], v[68:71], v[160:175]
    ds_read_b64_tr_b16 v[124:125], v103 offset:6336
    ds_read_b64_tr_b16 v[126:127], v103 offset:6592
    s_xor_b32 s86, s86, 1
    s_waitcnt lgkmcnt(6)
    v_mfma_f32_32x32x16_bf16 v[144:159], v[64:67], v[116:119], v[144:159]
    s_add_u32 s70, s66, 1634304
    buffer_load_dwordx4 a[132:135], v24, s[32:35], s70 offen
    s_mul_i32 s99, s86, 151552
    v_mfma_f32_16x16x32_bf16 v[176:179], v[184:187], v[112:115], v[176:179]
    s_add_u32 s92, s72, 1048576
    v_mfma_f32_16x16x32_bf16 v[180:183], v[184:187], v[116:119], v[180:183]
    s_waitcnt lgkmcnt(3)
    v_mfma_f32_32x32x16_bf16 v[128:143], v[120:123], v[72:75], v[128:143]
    s_waitcnt vmcnt(15)
    s_barrier
    ds_read_b64_tr_b16 v[112:113], v102 offset:12672
    ds_read_b64_tr_b16 v[114:115], v102 offset:12928
    ds_read_b128 v[64:67], v88 offset:24576
    ds_read_b128 v[68:71], v94 offset:24576
    s_add_u32 s85, s85, s92
    s_waitcnt lgkmcnt(6)
    v_mfma_f32_32x32x16_bf16 v[160:175], v[120:123], v[76:79], v[160:175]
    ds_read_b64_tr_b16 v[116:117], v103 offset:12672
    ds_read_b64_tr_b16 v[118:119], v103 offset:12928
    s_add_u32 s99, s99, s92
    s_waitcnt lgkmcnt(6)
    v_mfma_f32_32x32x16_bf16 v[144:159], v[72:75], v[124:127], v[144:159]
    s_add_u32 s70, s74, 8192
    buffer_load_dwordx4 v[36:39], v255, s[28:31], s70 offen
    v_mov_b32 v106, s48
    v_mfma_f32_16x16x32_bf16 v[176:179], v[184:187], v[120:123], v[176:179]
    v_mov_b32 v107, s57
    v_mfma_f32_16x16x32_bf16 v[180:183], v[184:187], v[124:127], v[180:183]
    s_waitcnt lgkmcnt(3)
    v_mfma_f32_32x32x16_bf16 v[128:143], v[112:115], v[64:67], v[128:143]
    ds_read_b64_tr_b16 v[120:121], v102 offset:19008
    ds_read_b64_tr_b16 v[122:123], v102 offset:19264
    ds_read_b128 v[72:75], v89 offset:24576
    ds_read_b128 v[76:79], v95 offset:24576
    v_bfe_u32 v108, v0, 4, 2
    s_waitcnt lgkmcnt(6)
    v_mfma_f32_32x32x16_bf16 v[160:175], v[112:115], v[68:71], v[160:175]
    ds_read_b64_tr_b16 v[124:125], v103 offset:19008
    ds_read_b64_tr_b16 v[126:127], v103 offset:19264
    v_cmp_eq_u32 vcc, 1, v108
    s_waitcnt lgkmcnt(6)
    v_mfma_f32_32x32x16_bf16 v[144:159], v[64:67], v[116:119], v[144:159]
    s_add_u32 s70, s66, 1605632
    buffer_load_dwordx4 a[136:139], v24, s[36:39], s70 offen
    v_cndmask_b32 v106, v106, v107, vcc
    v_mfma_f32_16x16x32_bf16 v[176:179], v[184:187], v[112:115], v[176:179]
    v_lshlrev_b32 v106, 11, v106
    v_mfma_f32_16x16x32_bf16 v[180:183], v[184:187], v[116:119], v[180:183]
    s_waitcnt lgkmcnt(3)
    v_mfma_f32_32x32x16_bf16 v[128:143], v[120:123], v[72:75], v[128:143]
    s_waitcnt vmcnt(14)
    s_barrier
    ds_read_b64_tr_b16 v[112:113], v102 offset:25344
    ds_read_b64_tr_b16 v[114:115], v102 offset:25600
    ds_read_b128 v[64:67], v90 offset:24576
    ds_read_b128 v[68:71], v96 offset:24576
    v_lshl_add_u32 v106, v0, 2, v106
    s_waitcnt lgkmcnt(6)
    v_mfma_f32_32x32x16_bf16 v[160:175], v[120:123], v[76:79], v[160:175]
    ds_read_b64_tr_b16 v[116:117], v103 offset:25344
    ds_read_b64_tr_b16 v[118:119], v103 offset:25600
    v_lshlrev_b32 v107, 2, v0
    s_waitcnt lgkmcnt(6)
    v_mfma_f32_32x32x16_bf16 v[144:159], v[72:75], v[124:127], v[144:159]
    s_add_u32 s70, s74, 16384
    buffer_load_dwordx4 v[40:43], v255, s[28:31], s70 offen
    s_mul_i32 s86, s44, 1212416
    v_mfma_f32_16x16x32_bf16 v[176:179], v[184:187], v[120:123], v[176:179]
    s_lshl_b32 s92, s46, 9
    v_mfma_f32_16x16x32_bf16 v[180:183], v[184:187], v[124:127], v[180:183]
    s_waitcnt lgkmcnt(3)
    v_mfma_f32_32x32x16_bf16 v[128:143], v[112:115], v[64:67], v[128:143]
    ds_read_b64_tr_b16 v[120:121], v102 offset:31680
    ds_read_b64_tr_b16 v[122:123], v102 offset:31936
    ds_read_b128 v[72:75], v91 offset:24576
    ds_read_b128 v[76:79], v97 offset:24576
    s_add_u32 s86, s86, s92
    s_waitcnt lgkmcnt(6)
    v_mfma_f32_32x32x16_bf16 v[160:175], v[112:115], v[68:71], v[160:175]
    ds_read_b64_tr_b16 v[124:125], v103 offset:31680
    ds_read_b64_tr_b16 v[126:127], v103 offset:31936
    s_add_u32 s86, s86, 1146880
    s_waitcnt lgkmcnt(6)
    v_mfma_f32_32x32x16_bf16 v[144:159], v[64:67], v[116:119], v[144:159]
    s_add_u32 s70, s66, 1634304
    buffer_load_dwordx4 a[140:143], v24, s[36:39], s70 offen
    s_lshl_b32 s92, s51, 11
    v_mfma_f32_16x16x32_bf16 v[176:179], v[184:187], v[112:115], v[176:179]
    s_add_u32 s92, s92, s86
    v_mfma_f32_16x16x32_bf16 v[180:183], v[184:187], v[116:119], v[180:183]
    s_waitcnt lgkmcnt(3)
    v_mfma_f32_32x32x16_bf16 v[128:143], v[120:123], v[72:75], v[128:143]
    s_waitcnt vmcnt(13)
    s_barrier
    ds_read_b64_tr_b16 v[112:113], v100 offset:0
    ds_read_b64_tr_b16 v[114:115], v100 offset:256
    ds_read_b128 v[64:67], v88 offset:28672
    ds_read_b128 v[68:71], v94 offset:28672
    s_waitcnt lgkmcnt(6)
    v_mfma_f32_32x32x16_bf16 v[160:175], v[120:123], v[76:79], v[160:175]
    ds_read_b64_tr_b16 v[116:117], v101 offset:0
    ds_read_b64_tr_b16 v[118:119], v101 offset:256
    s_waitcnt lgkmcnt(6)
    v_mfma_f32_32x32x16_bf16 v[144:159], v[72:75], v[124:127], v[144:159]
    s_add_u32 s70, s74, 24576
    buffer_load_dwordx4 v[44:47], v255, s[28:31], s70 offen
    v_mfma_f32_16x16x32_bf16 v[176:179], v[184:187], v[120:123], v[176:179]
    v_mfma_f32_16x16x32_bf16 v[180:183], v[184:187], v[124:127], v[180:183]
    s_waitcnt lgkmcnt(3)
    v_mfma_f32_32x32x16_bf16 v[128:143], v[112:115], v[64:67], v[128:143]
    ds_read_b64_tr_b16 v[120:121], v100 offset:6336
    ds_read_b64_tr_b16 v[122:123], v100 offset:6592
    ds_read_b128 v[72:75], v89 offset:28672
    ds_read_b128 v[76:79], v95 offset:28672
    s_waitcnt lgkmcnt(6)
    v_mfma_f32_32x32x16_bf16 v[160:175], v[112:115], v[68:71], v[160:175]
    ds_read_b64_tr_b16 v[124:125], v101 offset:6336
    ds_read_b64_tr_b16 v[126:127], v101 offset:6592
    s_waitcnt lgkmcnt(6)
    v_mfma_f32_32x32x16_bf16 v[144:159], v[64:67], v[116:119], v[144:159]
    s_add_u32 s74, s82, 1
    s_and_b32 s74, s74, 3
    s_mul_i32 s74, s74, 32768
    s_add_u32 s74, s74, s68
    s_add_u32 s70, s74, 0
    buffer_load_dwordx4 v[48:51], v255, s[28:31], s70 offen
    s_add_u32 s70, s74, 8192
    buffer_load_dwordx4 v[52:55], v255, s[28:31], s70 offen
    s_add_u32 s70, s74, 16384
    buffer_load_dwordx4 v[56:59], v255, s[28:31], s70 offen
    v_mfma_f32_16x16x32_bf16 v[176:179], v[184:187], v[112:115], v[176:179]
    v_mfma_f32_16x16x32_bf16 v[180:183], v[184:187], v[116:119], v[180:183]
    s_waitcnt lgkmcnt(3)
    v_mfma_f32_32x32x16_bf16 v[128:143], v[120:123], v[72:75], v[128:143]
    s_waitcnt vmcnt(11)
    s_barrier
    ds_read_b64_tr_b16 v[112:113], v100 offset:12672
    ds_read_b64_tr_b16 v[114:115], v100 offset:12928
    ds_read_b128 v[64:67], v90 offset:28672
    ds_read_b128 v[68:71], v96 offset:28672
    s_waitcnt lgkmcnt(6)
    v_mfma_f32_32x32x16_bf16 v[160:175], v[120:123], v[76:79], v[160:175]
    ds_read_b64_tr_b16 v[116:117], v101 offset:12672
    ds_read_b64_tr_b16 v[118:119], v101 offset:12928
    s_waitcnt lgkmcnt(6)
    v_mfma_f32_32x32x16_bf16 v[144:159], v[72:75], v[124:127], v[144:159]
    s_add_u32 s70, s74, 24576
    buffer_load_dwordx4 v[60:63], v255, s[28:31], s70 offen
    s_add_u32 s74, s82, 2
    s_and_b32 s74, s74, 3
    s_mul_i32 s74, s74, 32768
    s_add_u32 s74, s74, s68
    s_add_u32 s70, s74, 0
    buffer_load_dwordx4 a[224:227], v255, s[28:31], s70 offen
    s_add_u32 s70, s74, 8192
    buffer_load_dwordx4 a[228:231], v255, s[28:31], s70 offen
    v_mfma_f32_16x16x32_bf16 v[176:179], v[184:187], v[120:123], v[176:179]
    v_mfma_f32_16x16x32_bf16 v[180:183], v[184:187], v[124:127], v[180:183]
    s_waitcnt lgkmcnt(3)
    v_mfma_f32_32x32x16_bf16 v[128:143], v[112:115], v[64:67], v[128:143]
    ds_read_b64_tr_b16 v[120:121], v100 offset:19008
    ds_read_b64_tr_b16 v[122:123], v100 offset:19264
    ds_read_b128 v[72:75], v91 offset:28672
    ds_read_b128 v[76:79], v97 offset:28672
    s_waitcnt lgkmcnt(6)
    v_mfma_f32_32x32x16_bf16 v[160:175], v[112:115], v[68:71], v[160:175]
    ds_read_b64_tr_b16 v[124:125], v101 offset:19008
    ds_read_b64_tr_b16 v[126:127], v101 offset:19264
    s_waitcnt lgkmcnt(6)
    v_mfma_f32_32x32x16_bf16 v[144:159], v[64:67], v[116:119], v[144:159]
    s_add_u32 s70, s74, 16384
    buffer_load_dwordx4 a[232:235], v255, s[28:31], s70 offen
    s_add_u32 s70, s74, 24576
    buffer_load_dwordx4 a[236:239], v255, s[28:31], s70 offen
    s_add_u32 s74, s82, 3
    s_and_b32 s74, s74, 3
    s_mul_i32 s74, s74, 32768
    s_add_u32 s74, s74, s68
    s_add_u32 s70, s74, 0
    buffer_load_dwordx4 a[240:243], v255, s[28:31], s70 offen
    v_mfma_f32_16x16x32_bf16 v[176:179], v[184:187], v[112:115], v[176:179]
    v_mfma_f32_16x16x32_bf16 v[180:183], v[184:187], v[116:119], v[180:183]
    s_waitcnt lgkmcnt(4)
    v_mfma_f32_16x16x32_bf16 v[176:179], v[184:187], v[120:123], v[176:179]
    s_waitcnt lgkmcnt(0)
    v_mfma_f32_16x16x32_bf16 v[180:183], v[184:187], v[124:127], v[180:183]
    v_mfma_f32_32x32x16_bf16 v[128:143], v[120:123], v[72:75], v[128:143]
    s_add_u32 s70, s74, 8192
    buffer_load_dwordx4 a[244:247], v255, s[28:31], s70 offen
    s_add_u32 s70, s74, 16384
    buffer_load_dwordx4 a[248:251], v255, s[28:31], s70 offen
    s_add_u32 s70, s74, 24576
    buffer_load_dwordx4 a[252:255], v255, s[28:31], s70 offen
    v_cvt_pk_bf16_f32 v177, v176, v176
    v_and_b32 v177, 0xffff0000, v177
    v_sub_f32 v177, v176, v177
    v_cvt_pk_bf16_f32 v176, v176, v177
    v_mov_b32 v80, v176
    v_mfma_f32_32x32x16_bf16 v[160:175], v[120:123], v[76:79], v[160:175]
    v_cvt_pk_bf16_f32 v181, v180, v180
    v_and_b32 v181, 0xffff0000, v181
    v_sub_f32 v181, v180, v181
    v_cvt_pk_bf16_f32 v180, v180, v181
    v_mov_b32 v84, v180
    v_mfma_f32_32x32x16_bf16 v[144:159], v[72:75], v[124:127], v[144:159]
    v_mfma_f32_32x32x16_bf16 v[128:143], v[80:83], v[208:211], v[128:143]
    v_mfma_f32_32x32x16_bf16 v[160:175], v[80:83], v[188:191], v[160:175]
    v_mfma_f32_32x32x16_bf16 v[144:159], v[208:211], v[84:87], v[144:159]
    s_mov_b32 s93, 0x40404040
    v_and_b32 v254, s93, v99
    v_cmp_ne_u32 vcc, s93, v254
    s_nop 1
    s_cbranch_vccnz L_poll_11
L_ok_12:
    s_mul_i32 s93, s56, 0x01010101
    v_and_b32 v253, 0x0f0f0f0f, v99
    v_cmp_ne_u32 vcc, s93, v253
    s_nop 1
    s_cmp_lg_u32 vcc_lo, 0
    s_cselect_b32 s50, 1, 0
    s_cmp_lg_u32 s47, 0
    s_cbranch_scc1 L_c_13
    buffer_store_dword v176, v106, s[16:19], s86 offen sc1
    buffer_store_dword v180, v107, s[16:19], s92 offen offset:256 sc1
L_c_13:
    s_xor_b32 s93, s90, 1024
    s_add_u32 s96, s91, 16384
    s_lshl_b32 s94, s57, 12
    s_lshl_b32 s95, s48, 12
    s_add_u32 s95, s95, 32768
    v_mul_f32 v136, v136, v212
    v_mul_f32 v137, v137, v212
    v_mul_f32 v138, v138, v212
    v_mul_f32 v139, v139, v212
    v_mul_f32 v140, v140, v212
    v_mul_f32 v141, v141, v212
    v_mul_f32 v142, v142, v212
    v_mul_f32 v143, v143, v212
    v_cvt_pk_bf16_f32 v136, v136, v137
    v_cvt_pk_bf16_f32 v137, v138, v139
    v_cvt_pk_bf16_f32 v138, v140, v141
    v_cvt_pk_bf16_f32 v139, v142, v143
    s_add_u32 s97, s85, s94
    buffer_store_dwordx4 v[136:139], v1, s[16:19], s90 offen sc1
    v_mul_f32 v128, v128, v213
    v_mul_f32 v129, v129, v213
    v_mul_f32 v130, v130, v213
    v_mul_f32 v131, v131, v213
    v_mul_f32 v132, v132, v213
    v_mul_f32 v133, v133, v213
    v_mul_f32 v134, v134, v213
    v_mul_f32 v135, v135, v213
    v_cvt_pk_bf16_f32 v128, v128, v129
    v_cvt_pk_bf16_f32 v129, v130, v131
    v_cvt_pk_bf16_f32 v130, v132, v133
    v_cvt_pk_bf16_f32 v131, v134, v135
    s_add_u32 s97, s85, s95
    buffer_store_dwordx4 v[128:131], v1, s[16:19], s97 offen sc1
    v_mul_f32 v168, v168, v110
    v_mul_f32 v169, v169, v110
    v_mul_f32 v170, v170, v110
    v_mul_f32 v171, v171, v110
    v_mul_f32 v172, v172, v110
    v_mul_f32 v173, v173, v110
    v_mul_f32 v174, v174, v110
    v_mul_f32 v175, v175, v110
    v_cvt_pk_bf16_f32 v168, v168, v169
    v_cvt_pk_bf16_f32 v169, v170, v171
    v_cvt_pk_bf16_f32 v170, v172, v173
    v_cvt_pk_bf16_f32 v171, v174, v175
    s_add_u32 s97, s99, s94
    buffer_store_dwordx4 v[168:171], v1, s[16:19], s93 offen sc1
    v_mul_f32 v160, v160, v111
    v_mul_f32 v161, v161, v111
    v_mul_f32 v162, v162, v111
    v_mul_f32 v163, v163, v111
    v_mul_f32 v164, v164, v111
    v_mul_f32 v165, v165, v111
    v_mul_f32 v166, v166, v111
    v_mul_f32 v167, v167, v111
    v_cvt_pk_bf16_f32 v160, v160, v161
    v_cvt_pk_bf16_f32 v161, v162, v163
    v_cvt_pk_bf16_f32 v162, v164, v165
    v_cvt_pk_bf16_f32 v163, v166, v167
    s_add_u32 s97, s99, s95
    buffer_store_dwordx4 v[160:163], v1, s[16:19], s97 offen sc1
    v_mul_f32 v144, v144, v192
    v_mul_f32 v145, v145, v193
    v_mul_f32 v146, v146, v194
    v_mul_f32 v147, v147, v195
    v_mul_f32 v148, v148, v196
    v_mul_f32 v149, v149, v197
    v_mul_f32 v150, v150, v198
    v_mul_f32 v151, v151, v199
    v_mul_f32 v152, v152, v200
    v_mul_f32 v153, v153, v201
    v_mul_f32 v154, v154, v202
    v_mul_f32 v155, v155, v203
    v_mul_f32 v156, v156, v204
    v_mul_f32 v157, v157, v205
    v_mul_f32 v158, v158, v206
    v_mul_f32 v159, v159, v207
    v_cvt_pk_bf16_f32 v144, v144, v145
    v_cvt_pk_bf16_f32 v145, v146, v147
    v_cvt_pk_bf16_f32 v146, v148, v149
    v_cvt_pk_bf16_f32 v147, v150, v151
    v_cvt_pk_bf16_f32 v148, v152, v153
    v_cvt_pk_bf16_f32 v149, v154, v155
    v_cvt_pk_bf16_f32 v150, v156, v157
    v_cvt_pk_bf16_f32 v151, v158, v159
    v_permlane16_swap_b32 v144, v148
    v_permlane16_swap_b32 v145, v149
    v_permlane16_swap_b32 v146, v150
    v_permlane16_swap_b32 v147, v151
    s_and_b32 s94, s72, 1024
    s_sub_u32 s97, s85, s94
    s_lshl_b32 s94, s51, 12
    s_add_u32 s97, s97, s94
    s_add_u32 s97, s97, 65536
    buffer_store_dwordx4 v[144:147], v1, s[16:19], s91 offen sc1
    buffer_store_dwordx4 v[148:151], v1, s[16:19], s96 offen sc1
    v_lshrrev_b32 v125, 5, v0
    v_bfe_u32 v126, v0, 2, 2
    v_lshl_add_u32 v126, v125, 2, v126
    v_lshlrev_b32 v126, 7, v126
    v_bfe_u32 v125, v0, 4, 1
    v_lshl_add_u32 v126, v125, 5, v126
    v_lshlrev_b32 v125, 6, v125
    v_and_b32 v127, 3, v0
    v_lshl_add_u32 v126, v127, 3, v126
    v_bfe_u32 v127, v0, 3, 1
    v_lshl_add_u32 v126, v127, 6, v126
    v_sub_u32 v127, v14, v1
    v_add_u32 v126, v126, v127
    v_xor_b32 v127, 64, v126
    v_xor_b32 v125, v125, v14
    s_add_u32 s97, s69, 32768
    v_subrev_u32 v125, s97, v125
    v_subrev_u32 v126, s97, v126
    v_subrev_u32 v127, s97, v127
    v_and_b32 v253, 31, v0
    v_lshrrev_b32 v254, 5, v0
    v_lshlrev_b32 v235, 2, v254
    v_sub_u32 v235, v253, v235
    v_mov_b32 v11, 0xf149f2ca
    v_cmp_le_i32_e64 s[94:95], 0, v235
    v_cmp_le_i32_e64 s[96:97], 1, v235
    s_nop 0
    v_cndmask_b32_e64 v220, v11, 0, s[94:95]
    v_cmp_le_i32_e64 s[94:95], 2, v235
    v_cndmask_b32_e64 v221, v11, 0, s[96:97]
    v_cmp_le_i32_e64 s[96:97], 3, v235
    v_cndmask_b32_e64 v222, v11, 0, s[94:95]
    v_cmp_le_i32_e64 s[94:95], 8, v235
    v_cndmask_b32_e64 v223, v11, 0, s[96:97]
    v_cmp_le_i32_e64 s[96:97], 9, v235
    v_cndmask_b32_e64 v224, v11, 0, s[94:95]
    v_cmp_le_i32_e64 s[94:95], 10, v235
    v_cndmask_b32_e64 v225, v11, 0, s[96:97]
    v_cmp_le_i32_e64 s[96:97], 11, v235
    v_cndmask_b32_e64 v226, v11, 0, s[94:95]
    v_cmp_le_i32_e64 s[94:95], 16, v235
    v_cndmask_b32_e64 v227, v11, 0, s[96:97]
    v_cmp_le_i32_e64 s[96:97], 17, v235
    v_cndmask_b32_e64 v228, v11, 0, s[94:95]
    v_cmp_le_i32_e64 s[94:95], 18, v235
    v_cndmask_b32_e64 v229, v11, 0, s[96:97]
    v_cmp_le_i32_e64 s[96:97], 19, v235
    v_cndmask_b32_e64 v230, v11, 0, s[94:95]
    v_cmp_le_i32_e64 s[94:95], 24, v235
    v_cndmask_b32_e64 v231, v11, 0, s[96:97]
    v_cmp_le_i32_e64 s[96:97], 25, v235
    v_cndmask_b32_e64 v232, v11, 0, s[94:95]
    v_cmp_le_i32_e64 s[94:95], 26, v235
    v_cndmask_b32_e64 v233, v11, 0, s[96:97]
    v_cmp_le_i32_e64 s[96:97], 27, v235
    v_cndmask_b32_e64 v234, v11, 0, s[94:95]
    s_nop 0
    v_cndmask_b32_e64 v235, v11, 0, s[96:97]
    v_sub_f32 v236, v11, v220
    v_sub_f32 v237, v11, v221
    v_sub_f32 v238, v11, v222
    v_sub_f32 v239, v11, v223
    v_sub_f32 v240, v11, v224
    v_sub_f32 v241, v11, v225
    v_sub_f32 v242, v11, v226
    v_sub_f32 v243, v11, v227
    v_sub_f32 v244, v11, v228
    v_sub_f32 v245, v11, v229
    v_sub_f32 v246, v11, v230
    v_sub_f32 v247, v11, v231
    v_sub_f32 v248, v11, v232
    v_sub_f32 v249, v11, v233
    v_sub_f32 v250, v11, v234
    v_sub_f32 v251, v11, v235
    s_sub_u32 s87, 7168, s72
    v_add_u32 v216, 114688, v1
    v_add_u32 v217, s87, v216
    v_add_u32 v216, s72, v216
    v_and_b32 v218, 15, v0
    v_lshlrev_b32 v218, 4, v218
    v_lshrrev_b32 v253, 5, v0
    v_lshl_add_u32 v218, v253, 9, v218
    v_bfe_u32 v253, v0, 4, 1
    v_lshl_add_u32 v218, v253, 14, v218
    v_add_u32 v218, 131072, v218
    v_add_u32 v219, s87, v218
    v_add_u32 v218, s72, v218
    v_and_b32 v214, 3, v0
    v_lshlrev_b32 v214, 2, v214
    s_mov_b32 s63, 0
    s_cmp_eq_u32 s44, 0
    s_cselect_b32 s87, 0, s55
    s_lshl_b32 s86, s46, 11
    s_add_u32 s86, s86, 147456
    v_add_u32 v72, s86, v1
    v_mov_b32 v64, s55
    v_mov_b32 v68, s87
    v_mov_b32 v65, s55
    v_mov_b32 v69, s87
    v_mov_b32 v66, s55
    v_mov_b32 v70, s87
    v_mov_b32 v67, s55
    v_mov_b32 v71, s87
    s_barrier
    ds_write_b128 v72, v[64:67] offset:8192
    ds_write_b128 v72, v[64:67] offset:9216
    ds_write_b128 v72, v[68:71]
    ds_write_b128 v72, v[68:71] offset:1024
    s_cmp_lg_u32 s44, 0
    s_cbranch_scc1 L_c_14
    v_subrev_u32 v72, 32768, v72
    ds_write_b128 v72, v[68:71] offset:0
    ds_write_b128 v72, v[68:71] offset:16384
    ds_write_b128 v72, v[68:71] offset:1024
    ds_write_b128 v72, v[68:71] offset:17408
L_c_14:
    v_and_b32 v73, 15, v0
    v_lshlrev_b32 v73, 2, v73
    v_lshrrev_b32 v214, 4, v0
    v_min_u32 v214, 2, v214
    v_mul_u32_u24 v214, 5, v214
    v_add_u32 v214, s48, v214
    v_and_b32 v214, 7, v214
    v_lshl_add_u32 v214, v214, 6, v73
    s_lshl_b32 s93, s45, 4
    s_sub_u32 s97, s71, s93
    s_lshl_b32 s93, s49, 6
    v_add_u32 v73, s93, v73
    v_lshlrev_b32 v74, 2, v0
    v_cmp_gt_u32 vcc, 32, v0
    s_nop 1
    v_cndmask_b32 v73, v74, v73, vcc
    s_lshl_b32 s88, s45, 10
    s_add_u32 s89, s88, s60
    s_add_u32 s90, s89, 606208
    s_add_u32 s93, s89, 65536
    s_add_u32 s94, s90, 65536
    s_add_u32 s95, s89, 32768
    s_add_u32 s89, s65, s72
    s_add_u32 s90, s89, 4096
    s_add_u32 s93, s89, 8192
    s_add_u32 s94, s89, 12288
    s_add_u32 s96, s88, s59
    s_add_u32 s96, s96, 32768
    s_mul_i32 s92, s44, 1212416
    s_lshr_b32 s88, s88, 1
    s_add_u32 s92, s92, s88
    s_add_u32 s92, s92, 1146880
    v_mov_b32 v252, 1
    s_waitcnt vmcnt(0)
    s_mov_b64 exec, 1
    s_cmp_lg_u32 s50, 0
    s_cbranch_scc1 L_pub_15
    buffer_store_dword v252, off, s[16:19], s52
L_pur_16:
    s_mov_b64 exec, -1
    v_mov_b32 v252, 2
    s_add_u32 s99, s52, 4096
    s_mov_b64 exec, 1
    buffer_store_dword v252, off, s[16:19], s99 sc1
    s_mov_b64 exec, -1
    buffer_load_dword v215, v214, s[16:19], s53 offen sc1
    ds_write_b128 v125, v[32:35]
    ds_write_b128 v125, v[36:39] offset:1024
    ds_read_b64_tr_b16 v[32:33], v126
    ds_read_b64_tr_b16 v[34:35], v126 offset:1024
    ds_read_b64_tr_b16 v[36:37], v127
    ds_read_b64_tr_b16 v[38:39], v127 offset:1024
    ds_write_b128 v125, v[40:43]
    ds_write_b128 v125, v[44:47] offset:1024
    ds_read_b64_tr_b16 v[40:41], v126
    ds_read_b64_tr_b16 v[42:43], v126 offset:1024
    ds_read_b64_tr_b16 v[44:45], v127
    ds_read_b64_tr_b16 v[46:47], v127 offset:1024
    ds_write_b128 v125, v[48:51]
    ds_write_b128 v125, v[52:55] offset:1024
    ds_read_b64_tr_b16 v[48:49], v126
    ds_read_b64_tr_b16 v[50:51], v126 offset:1024
    ds_read_b64_tr_b16 v[52:53], v127
    ds_read_b64_tr_b16 v[54:55], v127 offset:1024
    ds_write_b128 v125, v[56:59]
    ds_write_b128 v125, v[60:63] offset:1024
    ds_read_b64_tr_b16 v[56:57], v126
    ds_read_b64_tr_b16 v[58:59], v126 offset:1024
    ds_read_b64_tr_b16 v[60:61], v127
    ds_read_b64_tr_b16 v[62:63], v127 offset:1024
    ds_write_b128 v125, a[224:227]
    ds_write_b128 v125, a[228:231] offset:1024
    ds_read_b64_tr_b16 a[224:225], v126
    ds_read_b64_tr_b16 a[226:227], v126 offset:1024
    ds_read_b64_tr_b16 a[228:229], v127
    ds_read_b64_tr_b16 a[230:231], v127 offset:1024
    ds_write_b128 v125, a[232:235]
    ds_write_b128 v125, a[236:239] offset:1024
    ds_read_b64_tr_b16 a[232:233], v126
    ds_read_b64_tr_b16 a[234:235], v126 offset:1024
    ds_read_b64_tr_b16 a[236:237], v127
    ds_read_b64_tr_b16 a[238:239], v127 offset:1024
    ds_write_b128 v125, a[240:243]
    ds_write_b128 v125, a[244:247] offset:1024
    ds_read_b64_tr_b16 a[240:241], v126
    ds_read_b64_tr_b16 a[242:243], v126 offset:1024
    ds_read_b64_tr_b16 a[244:245], v127
    ds_read_b64_tr_b16 a[246:247], v127 offset:1024
    ds_write_b128 v125, a[248:251]
    ds_write_b128 v125, a[252:255] offset:1024
    ds_read_b64_tr_b16 a[248:249], v126
    ds_read_b64_tr_b16 a[250:251], v126 offset:1024
    ds_read_b64_tr_b16 a[252:253], v127
    ds_read_b64_tr_b16 a[254:255], v127 offset:1024
    s_waitcnt vmcnt(0)
    v_cmp_gt_u32 vcc, 1, v215
    s_nop 1
    s_cbranch_vccnz L_poll_17
L_ok_18:
    s_cmp_lg_u32 s50, 0
    s_cbranch_scc1 L_acq_19
L_acr_20:
    buffer_load_dwordx4 v[128:131], v1, s[16:19], s96 offen sc1
    s_add_u32 m0, s72, 126976
    s_nop 0
    buffer_load_dwordx4 v1, s[16:19], s90 offen sc1 lds
    s_add_u32 m0, s72, 143360
    s_nop 0
    buffer_load_dwordx4 v1, s[16:19], s94 offen sc1 lds
    s_add_u32 m0, s72, 122880
    s_nop 0
    buffer_load_dwordx4 v1, s[16:19], s89 offen sc1 lds
    s_add_u32 m0, s72, 139264
    s_nop 0
    buffer_load_dwordx4 v1, s[16:19], s93 offen sc1 lds
    buffer_load_dwordx4 v[160:163], v1, s[16:19], s95 offen sc1
    v_mov_b32 v28, v74
    v_mov_b32 v29, v73
    s_mov_b32 s51, s92
    buffer_load_dword v215, v214, s[16:19], s97 offen sc1
    s_add_u32 s4, s47, 1
    s_and_b32 s4, s4, 3
    s_lshl_b32 s96, s4, 14
    s_lshl_b32 s95, s44, 10
    s_and_b32 s5, s44, 4
    s_mul_i32 s5, s5, 3072
    s_add_u32 s5, s5, s95
    s_add_u32 s95, s95, s96
    s_add_u32 s95, s95, 4096
    s_add_u32 s96, s96, 12288
    s_cmp_eq_u32 s4, 3
    s_cselect_b32 s95, s5, s95
    s_cselect_b32 s96, 32768, s96
    s_lshl_b32 s5, s44, 9
    s_add_u32 s96, s96, s5
    s_mul_i32 s5, s46, 49152
    s_add_u32 s5, s5, 19922944
    s_add_u32 s95, s95, s5
    s_add_u32 s96, s96, s5
    s_add_u32 s5, s48, 6
    s_and_b32 s5, s5, 7
    s_mul_i32 s5, s5, 196608
    s_add_u32 s96, s96, s5
    s_sub_u32 s96, s96, 114688
    s_mul_i32 s4, s48, 196608
    s_mul_i32 s5, s57, 196608
    s_sub_u32 s5, s5, s4
    v_bfe_i32 v121, v0, 4, 1
    v_and_b32 v121, s5, v121
    v_add3_u32 v121, v121, s4, v1
    s_and_b32 s4, s46, 1
    s_lshl_b32 s4, s4, 4
    s_lshl_b32 s4, 0xffff, s4
    s_mov_b32 s5, s4
    buffer_store_dwordx4 a[216:219], v121, s[16:19], s95 offen sc1
    s_mov_b64 exec, s[4:5]
    buffer_store_dwordx4 a[220:223], v12, s[16:19], s96 offen sc1
    s_mov_b64 exec, -1
    s_waitcnt vmcnt(2)
    s_cmp_eq_u32 s44, 0
    s_cbranch_scc1 L_c_21
    v_cmp_gt_u32 vcc, 2, v215
    s_nop 1
    s_cbranch_vccnz L_poll_22
L_ok_23:
    s_cmp_lg_u32 s50, 0
    s_cbranch_scc1 L_acq_24
L_acr_25:
    s_add_u32 s89, s65, s72
    s_sub_u32 s90, s89, 520192
    s_add_u32 m0, s72, 118784
    s_nop 0
    buffer_load_dwordx4 v1, s[16:19], s90 offen sc1 lds
    s_sub_u32 s90, s89, 512000
    s_add_u32 m0, s72, 135168
    s_nop 0
    buffer_load_dwordx4 v1, s[16:19], s90 offen sc1 lds
    s_sub_u32 s90, s89, 524288
    s_add_u32 m0, s72, 114688
    s_nop 0
    buffer_load_dwordx4 v1, s[16:19], s90 offen sc1 lds
    s_sub_u32 s90, s89, 516096
    s_add_u32 m0, s72, 131072
    s_nop 0
    buffer_load_dwordx4 v1, s[16:19], s90 offen sc1 lds
L_c_21:
    buffer_load_dword v28, v28, s[16:19], s51 offen sc1
    buffer_load_dword v29, v29, s[16:19], s51 offen offset:256 sc1
    s_lshl_b32 s92, s44, 3
    s_add_u32 s92, s92, s48
    s_mul_i32 s92, s92, 151552
    s_lshl_b32 s93, s47, 2
    s_add_u32 s93, s93, s46
    s_mul_i32 s93, s93, 256
    s_add_u32 s92, s92, s93
    s_add_u32 s92, s92, 1196032
    v_lshlrev_b32 v253, 7, v0
    s_mov_b64 exec, 3
    buffer_load_dword v124, v253, s[16:19], s92 offen
    s_sub_u32 s92, s92, 81920
    buffer_load_dword v124, v253, s[16:19], s92 offen
    s_mov_b64 exec, -1
    s_getpc_b64 s[92:93]
L_ct_26:
    s_lshl_b32 s70, s45, 2
    s_add_u32 s70, s70, s46
    s_lshl_b32 s70, s70, 9
    v_and_b32 v253, 3, v0
    v_lshlrev_b32 v253, 7, v253
    v_add_u32 v253, s70, v253
    v_min_u32 v253, L_end-L_ct_26-4, v253
    global_load_dword v124, v253, s[92:93]
    s_lshl_b32 s88, s45, 10
    s_add_u32 s88, s88, 32768
    s_add_u32 s86, s88, s59
    s_add_u32 s87, s88, s60
    s_waitcnt lgkmcnt(0)
    s_barrier
    ds_read_b128 v[112:115], v217 offset:8192
    ds_read_b128 v[116:119], v217 offset:7168
    ds_read_b128 v[144:147], v219 offset:8192
    ds_read_b128 v[148:151], v219 offset:8448
    s_waitcnt lgkmcnt(3)
    v_mfma_f32_32x32x16_bf16 v[64:79], v[112:115], v[128:131], v[220:235]
    s_waitcnt lgkmcnt(2)
    v_mfma_f32_32x32x16_bf16 v[80:95], v[116:119], v[128:131], 0
    ds_read_b128 v[112:115], v217 offset:6144
    ds_read_b128 v[152:155], v219 offset:7168
    s_nop 1
    v_exp_f32 v64, v64
    v_exp_f32 v65, v65
    v_exp_f32 v66, v66
    v_exp_f32 v67, v67
    ds_read_b128 v[156:159], v219 offset:7424
    v_exp_f32 v68, v68
    v_exp_f32 v69, v69
    v_exp_f32 v70, v70
    v_exp_f32 v71, v71
    s_add_u32 s70, s80, 0
    s_add_u32 m0, s81, 0
    s_nop 0
    buffer_load_dwordx4 v30, s[32:35], s70 offen lds
    v_cvt_pk_bf16_f32 v96, v64, v65
    v_cvt_pk_bf16_f32 v97, v66, v67
    v_cvt_pk_bf16_f32 v98, v68, v69
    v_cvt_pk_bf16_f32 v99, v70, v71
    v_exp_f32 v72, v72
    v_exp_f32 v73, v73
    v_exp_f32 v74, v74
    v_exp_f32 v75, v75
    s_waitcnt lgkmcnt(4)
    v_mfma_f32_32x32x16_bf16 v[176:191], v[144:147], v[96:99], 0
    v_exp_f32 v76, v76
    v_exp_f32 v77, v77
    v_exp_f32 v78, v78
    v_exp_f32 v79, v79
    v_cvt_pk_bf16_f32 v100, v72, v73
    v_cvt_pk_bf16_f32 v101, v74, v75
    v_cvt_pk_bf16_f32 v102, v76, v77
    v_cvt_pk_bf16_f32 v103, v78, v79
    s_waitcnt lgkmcnt(2)
    v_mfma_f32_32x32x16_bf16 v[64:79], v[112:115], v[128:131], 0
    ds_read_b128 v[116:119], v217 offset:5120
    ds_read_b128 v[144:147], v219 offset:6144
    v_exp_f32 v80, v80
    v_exp_f32 v81, v81
    v_exp_f32 v82, v82
    v_exp_f32 v83, v83
    v_mfma_f32_32x32x16_bf16 v[176:191], v[148:151], v[100:103], v[176:191]
    ds_read_b128 v[148:151], v219 offset:6400
    v_exp_f32 v84, v84
    v_exp_f32 v85, v85
    v_exp_f32 v86, v86
    v_exp_f32 v87, v87
    s_add_u32 s70, s80, 28672
    s_add_u32 m0, s81, 1024
    s_nop 0
    buffer_load_dwordx4 v30, s[32:35], s70 offen lds
    v_cvt_pk_bf16_f32 v104, v80, v81
    v_cvt_pk_bf16_f32 v105, v82, v83
    v_cvt_pk_bf16_f32 v106, v84, v85
    v_cvt_pk_bf16_f32 v107, v86, v87
    v_exp_f32 v88, v88
    v_exp_f32 v89, v89
    v_exp_f32 v90, v90
    v_exp_f32 v91, v91
    s_waitcnt lgkmcnt(4)
    v_mfma_f32_32x32x16_bf16 v[176:191], v[152:155], v[104:107], v[176:191]
    v_exp_f32 v92, v92
    v_exp_f32 v93, v93
    v_exp_f32 v94, v94
    v_exp_f32 v95, v95
    v_cvt_pk_bf16_f32 v108, v88, v89
    v_cvt_pk_bf16_f32 v109, v90, v91
    v_cvt_pk_bf16_f32 v110, v92, v93
    v_cvt_pk_bf16_f32 v111, v94, v95
    s_waitcnt lgkmcnt(2)
    v_mfma_f32_32x32x16_bf16 v[80:95], v[116:119], v[128:131], 0
    ds_read_b128 v[112:115], v217 offset:4096
    ds_read_b128 v[152:155], v219 offset:5120
    v_exp_f32 v64, v64
    v_exp_f32 v65, v65
    v_exp_f32 v66, v66
    v_exp_f32 v67, v67
    v_mfma_f32_32x32x16_bf16 v[176:191], v[156:159], v[108:111], v[176:191]
    ds_read_b128 v[156:159], v219 offset:5376
    v_exp_f32 v68, v68
    v_exp_f32 v69, v69
    v_exp_f32 v70, v70
    v_exp_f32 v71, v71
    s_add_u32 s70, s80, 0
    s_add_u32 m0, s81, 2048
    s_nop 0
    buffer_load_dwordx4 v31, s[36:39], s70 offen lds
    v_cvt_pk_bf16_f32 v96, v64, v65
    v_cvt_pk_bf16_f32 v97, v66, v67
    v_cvt_pk_bf16_f32 v98, v68, v69
    v_cvt_pk_bf16_f32 v99, v70, v71
    v_exp_f32 v72, v72
    v_exp_f32 v73, v73
    v_exp_f32 v74, v74
    v_exp_f32 v75, v75
    s_waitcnt lgkmcnt(4)
    v_mfma_f32_32x32x16_bf16 v[176:191], v[144:147], v[96:99], v[176:191]
    v_exp_f32 v76, v76
    v_exp_f32 v77, v77
    v_exp_f32 v78, v78
    v_exp_f32 v79, v79
    v_cvt_pk_bf16_f32 v100, v72, v73
    v_cvt_pk_bf16_f32 v101, v74, v75
    v_cvt_pk_bf16_f32 v102, v76, v77
    v_cvt_pk_bf16_f32 v103, v78, v79
    s_waitcnt lgkmcnt(2)
    v_mfma_f32_32x32x16_bf16 v[64:79], v[112:115], v[128:131], 0
    ds_read_b128 v[144:147], v219 offset:4096
    v_exp_f32 v80, v80
    v_exp_f32 v81, v81
    v_exp_f32 v82, v82
    v_exp_f32 v83, v83
    v_mfma_f32_32x32x16_bf16 v[176:191], v[148:151], v[100:103], v[176:191]
    ds_read_b128 v[148:151], v219 offset:4352
    v_exp_f32 v84, v84
    v_exp_f32 v85, v85
    v_exp_f32 v86, v86
    v_exp_f32 v87, v87
    s_add_u32 s70, s80, 28672
    s_add_u32 m0, s81, 3072
    s_nop 0
    buffer_load_dwordx4 v31, s[36:39], s70 offen lds
    v_cvt_pk_bf16_f32 v104, v80, v81
    v_cvt_pk_bf16_f32 v105, v82, v83
    v_cvt_pk_bf16_f32 v106, v84, v85
    v_cvt_pk_bf16_f32 v107, v86, v87
    v_exp_f32 v88, v88
    v_exp_f32 v89, v89
    v_exp_f32 v90, v90
    v_exp_f32 v91, v91
    s_waitcnt lgkmcnt(3)
    v_mfma_f32_32x32x16_bf16 v[176:191], v[152:155], v[104:107], v[176:191]
    v_exp_f32 v92, v92
    v_exp_f32 v93, v93
    v_exp_f32 v94, v94
    v_exp_f32 v95, v95
    v_cvt_pk_bf16_f32 v108, v88, v89
    v_cvt_pk_bf16_f32 v109, v90, v91
    v_cvt_pk_bf16_f32 v110, v92, v93
    v_cvt_pk_bf16_f32 v111, v94, v95
    s_waitcnt vmcnt(9)
    s_barrier
    ds_read_b128 v[116:119], v217 offset:3072
    ds_read_b128 v[112:115], v217 offset:2048
    ds_read_b128 v[152:155], v219 offset:3072
    v_exp_f32 v64, v64
    v_exp_f32 v65, v65
    v_exp_f32 v66, v66
    v_exp_f32 v67, v67
    s_waitcnt lgkmcnt(5)
    v_mfma_f32_32x32x16_bf16 v[176:191], v[156:159], v[108:111], v[176:191]
    ds_read_b128 v[156:159], v219 offset:3328
    v_exp_f32 v68, v68
    v_exp_f32 v69, v69
    v_exp_f32 v70, v70
    v_exp_f32 v71, v71
    s_waitcnt lgkmcnt(3)
    v_mfma_f32_32x32x16_bf16 v[80:95], v[116:119], v[128:131], 0
    s_add_u32 s81, s81, 16384
    s_add_u32 s80, s80, 229376
    s_cmp_ge_u32 s81, 114688
    s_cselect_b32 s70, 114688, 0
    s_sub_u32 s81, s81, s70
    s_mul_i32 s70, s70, 14
    s_sub_u32 s80, s80, s70
    s_add_u32 s70, s80, 0
    s_add_u32 m0, s81, 0
    s_nop 0
    buffer_load_dwordx4 v30, s[32:35], s70 offen lds
    v_cvt_pk_bf16_f32 v96, v64, v65
    v_cvt_pk_bf16_f32 v97, v66, v67
    v_cvt_pk_bf16_f32 v98, v68, v69
    v_cvt_pk_bf16_f32 v99, v70, v71
    v_exp_f32 v72, v72
    v_exp_f32 v73, v73
    v_exp_f32 v74, v74
    v_exp_f32 v75, v75
    v_mfma_f32_32x32x16_bf16 v[176:191], v[144:147], v[96:99], v[176:191]
    v_exp_f32 v76, v76
    v_exp_f32 v77, v77
    v_exp_f32 v78, v78
    v_exp_f32 v79, v79
    v_cvt_pk_bf16_f32 v100, v72, v73
    v_cvt_pk_bf16_f32 v101, v74, v75
    v_cvt_pk_bf16_f32 v102, v76, v77
    v_cvt_pk_bf16_f32 v103, v78, v79
    s_waitcnt lgkmcnt(2)
    v_mfma_f32_32x32x16_bf16 v[64:79], v[112:115], v[128:131], 0
    ds_read_b128 v[116:119], v217 offset:1024
    ds_read_b128 v[144:147], v219 offset:2048
    v_exp_f32 v80, v80
    v_exp_f32 v81, v81
    v_exp_f32 v82, v82
    v_exp_f32 v83, v83
    v_mfma_f32_32x32x16_bf16 v[176:191], v[148:151], v[100:103], v[176:191]
    ds_read_b128 v[148:151], v219 offset:2304
    v_exp_f32 v84, v84
    v_exp_f32 v85, v85
    v_exp_f32 v86, v86
    v_exp_f32 v87, v87
    s_add_u32 s70, s80, 28672
    s_add_u32 m0, s81, 1024
    s_nop 0
    buffer_load_dwordx4 v30, s[32:35], s70 offen lds
    v_cvt_pk_bf16_f32 v104, v80, v81
    v_cvt_pk_bf16_f32 v105, v82, v83
    v_cvt_pk_bf16_f32 v106, v84, v85
    v_cvt_pk_bf16_f32 v107, v86, v87
    v_exp_f32 v88, v88
    v_exp_f32 v89, v89
    v_exp_f32 v90, v90
    v_exp_f32 v91, v91
    s_waitcnt lgkmcnt(4)
    v_mfma_f32_32x32x16_bf16 v[176:191], v[152:155], v[104:107], v[176:191]
    v_exp_f32 v92, v92
    v_exp_f32 v93, v93
    v_exp_f32 v94, v94
    v_exp_f32 v95, v95
    v_cvt_pk_bf16_f32 v108, v88, v89
    v_cvt_pk_bf16_f32 v109, v90, v91
    v_cvt_pk_bf16_f32 v110, v92, v93
    v_cvt_pk_bf16_f32 v111, v94, v95
    s_waitcnt lgkmcnt(2)
    v_mfma_f32_32x32x16_bf16 v[80:95], v[116:119], v[128:131], 0
    ds_read_b128 v[112:115], v217 offset:0
    ds_read_b128 v[152:155], v219 offset:1024
    v_exp_f32 v64, v64
    v_exp_f32 v65, v65
    v_exp_f32 v66, v66
    v_exp_f32 v67, v67
    v_mfma_f32_32x32x16_bf16 v[176:191], v[156:159], v[108:111], v[176:191]
    ds_read_b128 v[156:159], v219 offset:1280
    v_exp_f32 v68, v68
    v_exp_f32 v69, v69
    v_exp_f32 v70, v70
    v_exp_f32 v71, v71
    s_add_u32 s70, s80, 0
    s_add_u32 m0, s81, 2048
    s_nop 0
    buffer_load_dwordx4 v31, s[36:39], s70 offen lds
    v_cvt_pk_bf16_f32 v96, v64, v65
    v_cvt_pk_bf16_f32 v97, v66, v67
    v_cvt_pk_bf16_f32 v98, v68, v69
    v_cvt_pk_bf16_f32 v99, v70, v71
    v_exp_f32 v72, v72
    v_exp_f32 v73, v73
    v_exp_f32 v74, v74
    v_exp_f32 v75, v75
    s_waitcnt lgkmcnt(4)
    v_mfma_f32_32x32x16_bf16 v[176:191], v[144:147], v[96:99], v[176:191]
    v_exp_f32 v76, v76
    v_exp_f32 v77, v77
    v_exp_f32 v78, v78
    v_exp_f32 v79, v79
    v_cvt_pk_bf16_f32 v100, v72, v73
    v_cvt_pk_bf16_f32 v101, v74, v75
    v_cvt_pk_bf16_f32 v102, v76, v77
    v_cvt_pk_bf16_f32 v103, v78, v79
    s_waitcnt lgkmcnt(2)
    v_mfma_f32_32x32x16_bf16 v[64:79], v[112:115], v[128:131], v[236:251]
    ds_read_b128 v[116:119], v216 offset:8192
    ds_read_b128 v[144:147], v219 offset:0
    v_exp_f32 v80, v80
    v_exp_f32 v81, v81
    v_exp_f32 v82, v82
    v_exp_f32 v83, v83
    v_mfma_f32_32x32x16_bf16 v[176:191], v[148:151], v[100:103], v[176:191]
    ds_read_b128 v[148:151], v219 offset:256
    v_exp_f32 v84, v84
    v_exp_f32 v85, v85
    v_exp_f32 v86, v86
    v_exp_f32 v87, v87
    s_add_u32 s70, s80, 28672
    s_add_u32 m0, s81, 3072
    s_nop 0
    buffer_load_dwordx4 v31, s[36:39], s70 offen lds
    v_cvt_pk_bf16_f32 v104, v80, v81
    v_cvt_pk_bf16_f32 v105, v82, v83
    v_cvt_pk_bf16_f32 v106, v84, v85
    v_cvt_pk_bf16_f32 v107, v86, v87
    v_exp_f32 v88, v88
    v_exp_f32 v89, v89
    v_exp_f32 v90, v90
    v_exp_f32 v91, v91
    s_waitcnt lgkmcnt(4)
    v_mfma_f32_32x32x16_bf16 v[176:191], v[152:155], v[104:107], v[176:191]
    v_exp_f32 v92, v92
    v_exp_f32 v93, v93
    v_exp_f32 v94, v94
    v_exp_f32 v95, v95
    v_cvt_pk_bf16_f32 v108, v88, v89
    v_cvt_pk_bf16_f32 v109, v90, v91
    v_cvt_pk_bf16_f32 v110, v92, v93
    v_cvt_pk_bf16_f32 v111, v94, v95
    s_waitcnt lgkmcnt(2)
    v_mfma_f32_32x32x16_bf16 v[80:95], v[116:119], v[160:163], v[220:235]
    ds_read_b128 v[112:115], v216 offset:7168
    ds_read_b128 v[152:155], v218 offset:8192
    v_exp_f32 v64, v64
    v_exp_f32 v65, v65
    v_exp_f32 v66, v66
    v_exp_f32 v67, v67
    v_mfma_f32_32x32x16_bf16 v[176:191], v[156:159], v[108:111], v[176:191]
    ds_read_b128 v[156:159], v218 offset:8448
    v_exp_f32 v68, v68
    v_exp_f32 v69, v69
    v_exp_f32 v70, v70
    v_exp_f32 v71, v71
    v_cvt_pk_bf16_f32 v96, v64, v65
    v_cvt_pk_bf16_f32 v97, v66, v67
    v_cvt_pk_bf16_f32 v98, v68, v69
    v_cvt_pk_bf16_f32 v99, v70, v71
    v_exp_f32 v72, v72
    v_exp_f32 v73, v73
    v_exp_f32 v74, v74
    v_exp_f32 v75, v75
    s_waitcnt lgkmcnt(4)
    v_mfma_f32_32x32x16_bf16 v[176:191], v[144:147], v[96:99], v[176:191]
    v_exp_f32 v76, v76
    v_exp_f32 v77, v77
    v_exp_f32 v78, v78
    v_exp_f32 v79, v79
    v_cvt_pk_bf16_f32 v100, v72, v73
    v_cvt_pk_bf16_f32 v101, v74, v75
    v_cvt_pk_bf16_f32 v102, v76, v77
    v_cvt_pk_bf16_f32 v103, v78, v79
    s_waitcnt lgkmcnt(2)
    v_mfma_f32_32x32x16_bf16 v[64:79], v[112:115], v[160:163], 0
    ds_read_b128 v[116:119], v216 offset:6144
    ds_read_b128 v[144:147], v218 offset:7168
    v_exp_f32 v80, v80
    v_exp_f32 v81, v81
    v_exp_f32 v82, v82
    v_exp_f32 v83, v83
    v_mfma_f32_32x32x16_bf16 v[176:191], v[148:151], v[100:103], v[176:191]
    ds_read_b128 v[148:151], v218 offset:7424
    v_exp_f32 v84, v84
    v_exp_f32 v85, v85
    v_exp_f32 v86, v86
    v_exp_f32 v87, v87
    v_cvt_pk_bf16_f32 v104, v80, v81
    v_cvt_pk_bf16_f32 v105, v82, v83
    v_cvt_pk_bf16_f32 v106, v84, v85
    v_cvt_pk_bf16_f32 v107, v86, v87
    v_exp_f32 v88, v88
    v_exp_f32 v89, v89
    v_exp_f32 v90, v90
    v_exp_f32 v91, v91
    s_waitcnt lgkmcnt(4)
    v_mfma_f32_32x32x16_bf16 v[192:207], v[152:155], v[104:107], 0
    v_exp_f32 v92, v92
    v_exp_f32 v93, v93
    v_exp_f32 v94, v94
    v_exp_f32 v95, v95
    v_cvt_pk_bf16_f32 v108, v88, v89
    v_cvt_pk_bf16_f32 v109, v90, v91
    v_cvt_pk_bf16_f32 v110, v92, v93
    v_cvt_pk_bf16_f32 v111, v94, v95
    v_rcp_f32 v185, v184
    s_nop 0
    v_mul_f32 v176, v176, v185
    v_mul_f32 v177, v177, v185
    v_mul_f32 v178, v178, v185
    v_mul_f32 v179, v179, v185
    v_mul_f32 v180, v180, v185
    v_mul_f32 v181, v181, v185
    v_mul_f32 v182, v182, v185
    v_mul_f32 v183, v183, v185
    v_cvt_pk_bf16_f32 v188, v176, v177
    v_cvt_pk_bf16_f32 v189, v178, v179
    v_cvt_pk_bf16_f32 v190, v180, v181
    v_cvt_pk_bf16_f32 v191, v182, v183
    buffer_store_dwordx4 v[188:191], v1, s[16:19], s86 offen
    v_mov_b32 v186, 0
    v_dot2c_f32_bf16 v186, s55, v188
    v_dot2c_f32_bf16 v186, s55, v189
    v_dot2c_f32_bf16 v186, s55, v190
    v_dot2c_f32_bf16 v186, s55, v191
    s_nop 2
    v_fma_f32 v186, v186, 0, v184
    v_subrev_u32 v186, 0x30800000, v186
    v_cmp_le_u32 vcc, 0x28000000, v186
    s_nop 1
    s_cmp_lg_u64 vcc, 0
    s_cselect_b32 s63, 1, s63
    s_waitcnt lgkmcnt(2)
    v_mfma_f32_32x32x16_bf16 v[80:95], v[116:119], v[160:163], 0
    ds_read_b128 v[112:115], v216 offset:5120
    ds_read_b128 v[152:155], v218 offset:6144
    v_exp_f32 v64, v64
    v_exp_f32 v65, v65
    v_exp_f32 v66, v66
    v_exp_f32 v67, v67
    v_mfma_f32_32x32x16_bf16 v[192:207], v[156:159], v[108:111], v[192:207]
    ds_read_b128 v[156:159], v218 offset:6400
    v_exp_f32 v68, v68
    v_exp_f32 v69, v69
    v_exp_f32 v70, v70
    v_exp_f32 v71, v71
    s_add_u32 s81, s81, 16384
    s_add_u32 s80, s80, 229376
    s_cmp_ge_u32 s81, 114688
    s_cselect_b32 s70, 114688, 0
    s_sub_u32 s81, s81, s70
    s_mul_i32 s70, s70, 14
    s_sub_u32 s80, s80, s70
    s_add_u32 s70, s80, 0
    s_add_u32 m0, s81, 0
    s_nop 0
    buffer_load_dwordx4 v30, s[32:35], s70 offen lds
    v_cvt_pk_bf16_f32 v96, v64, v65
    v_cvt_pk_bf16_f32 v97, v66, v67
    v_cvt_pk_bf16_f32 v98, v68, v69
    v_cvt_pk_bf16_f32 v99, v70, v71
    v_exp_f32 v72, v72
    v_exp_f32 v73, v73
    v_exp_f32 v74, v74
    v_exp_f32 v75, v75
    s_waitcnt lgkmcnt(4)
    v_mfma_f32_32x32x16_bf16 v[192:207], v[144:147], v[96:99], v[192:207]
    v_exp_f32 v76, v76
    v_exp_f32 v77, v77
    v_exp_f32 v78, v78
    v_exp_f32 v79, v79
    v_cvt_pk_bf16_f32 v100, v72, v73
    v_cvt_pk_bf16_f32 v101, v74, v75
    v_cvt_pk_bf16_f32 v102, v76, v77
    v_cvt_pk_bf16_f32 v103, v78, v79
    s_waitcnt lgkmcnt(2)
    v_mfma_f32_32x32x16_bf16 v[64:79], v[112:115], v[160:163], 0
    ds_read_b128 v[116:119], v216 offset:4096
    ds_read_b128 v[144:147], v218 offset:5120
    v_exp_f32 v80, v80
    v_exp_f32 v81, v81
    v_exp_f32 v82, v82
    v_exp_f32 v83, v83
    v_mfma_f32_32x32x16_bf16 v[192:207], v[148:151], v[100:103], v[192:207]
    ds_read_b128 v[148:151], v218 offset:5376
    v_exp_f32 v84, v84
    v_exp_f32 v85, v85
    v_exp_f32 v86, v86
    v_exp_f32 v87, v87
    s_add_u32 s70, s80, 28672
    s_add_u32 m0, s81, 1024
    s_nop 0
    buffer_load_dwordx4 v30, s[32:35], s70 offen lds
    v_cvt_pk_bf16_f32 v104, v80, v81
    v_cvt_pk_bf16_f32 v105, v82, v83
    v_cvt_pk_bf16_f32 v106, v84, v85
    v_cvt_pk_bf16_f32 v107, v86, v87
    v_exp_f32 v88, v88
    v_exp_f32 v89, v89
    v_exp_f32 v90, v90
    v_exp_f32 v91, v91
    s_waitcnt lgkmcnt(4)
    v_mfma_f32_32x32x16_bf16 v[192:207], v[152:155], v[104:107], v[192:207]
    v_exp_f32 v92, v92
    v_exp_f32 v93, v93
    v_exp_f32 v94, v94
    v_exp_f32 v95, v95
    v_cvt_pk_bf16_f32 v108, v88, v89
    v_cvt_pk_bf16_f32 v109, v90, v91
    v_cvt_pk_bf16_f32 v110, v92, v93
    v_cvt_pk_bf16_f32 v111, v94, v95
    s_waitcnt lgkmcnt(2)
    v_mfma_f32_32x32x16_bf16 v[80:95], v[116:119], v[160:163], 0
    ds_read_b128 v[112:115], v216 offset:3072
    ds_read_b128 v[152:155], v218 offset:4096
    v_exp_f32 v64, v64
    v_exp_f32 v65, v65
    v_exp_f32 v66, v66
    v_exp_f32 v67, v67
    v_mfma_f32_32x32x16_bf16 v[192:207], v[156:159], v[108:111], v[192:207]
    ds_read_b128 v[156:159], v218 offset:4352
    v_exp_f32 v68, v68
    v_exp_f32 v69, v69
    v_exp_f32 v70, v70
    v_exp_f32 v71, v71
    s_add_u32 s70, s80, 0
    s_add_u32 m0, s81, 2048
    s_nop 0
    buffer_load_dwordx4 v31, s[36:39], s70 offen lds
    v_cvt_pk_bf16_f32 v96, v64, v65
    v_cvt_pk_bf16_f32 v97, v66, v67
    v_cvt_pk_bf16_f32 v98, v68, v69
    v_cvt_pk_bf16_f32 v99, v70, v71
    v_exp_f32 v72, v72
    v_exp_f32 v73, v73
    v_exp_f32 v74, v74
    v_exp_f32 v75, v75
    s_waitcnt lgkmcnt(4)
    v_mfma_f32_32x32x16_bf16 v[192:207], v[144:147], v[96:99], v[192:207]
    v_exp_f32 v76, v76
    v_exp_f32 v77, v77
    v_exp_f32 v78, v78
    v_exp_f32 v79, v79
    v_cvt_pk_bf16_f32 v100, v72, v73
    v_cvt_pk_bf16_f32 v101, v74, v75
    v_cvt_pk_bf16_f32 v102, v76, v77
    v_cvt_pk_bf16_f32 v103, v78, v79
    s_waitcnt lgkmcnt(2)
    v_mfma_f32_32x32x16_bf16 v[64:79], v[112:115], v[160:163], 0
    ds_read_b128 v[116:119], v216 offset:2048
    ds_read_b128 v[144:147], v218 offset:3072
    v_exp_f32 v80, v80
    v_exp_f32 v81, v81
    v_exp_f32 v82, v82
    v_exp_f32 v83, v83
    v_mfma_f32_32x32x16_bf16 v[192:207], v[148:151], v[100:103], v[192:207]
    ds_read_b128 v[148:151], v218 offset:3328
    v_exp_f32 v84, v84
    v_exp_f32 v85, v85
    v_exp_f32 v86, v86
    v_exp_f32 v87, v87
    s_add_u32 s70, s80, 28672
    s_add_u32 m0, s81, 3072
    s_nop 0
    buffer_load_dwordx4 v31, s[36:39], s70 offen lds
    v_cvt_pk_bf16_f32 v104, v80, v81
    v_cvt_pk_bf16_f32 v105, v82, v83
    v_cvt_pk_bf16_f32 v106, v84, v85
    v_cvt_pk_bf16_f32 v107, v86, v87
    v_exp_f32 v88, v88
    v_exp_f32 v89, v89
    v_exp_f32 v90, v90
    v_exp_f32 v91, v91
    s_waitcnt lgkmcnt(4)
    v_mfma_f32_32x32x16_bf16 v[192:207], v[152:155], v[104:107], v[192:207]
    v_exp_f32 v92, v92
    v_exp_f32 v93, v93
    v_exp_f32 v94, v94
    v_exp_f32 v95, v95
    v_cvt_pk_bf16_f32 v108, v88, v89
    v_cvt_pk_bf16_f32 v109, v90, v91
    v_cvt_pk_bf16_f32 v110, v92, v93
    v_cvt_pk_bf16_f32 v111, v94, v95
    s_cmp_lg_u32 s63, 0
    s_cbranch_scc1 L_c_27
    v_mov_b32 v252, 4
    s_waitcnt vmcnt(4)
    s_mov_b64 exec, 1
    s_cmp_lg_u32 s50, 0
    s_cbranch_scc1 L_pub_28
    buffer_store_dword v252, off, s[16:19], s52
L_pur_29:
    s_mov_b64 exec, -1
L_c_27:
    s_waitcnt lgkmcnt(2)
    v_mfma_f32_32x32x16_bf16 v[80:95], v[116:119], v[160:163], 0
    ds_read_b128 v[112:115], v216 offset:1024
    ds_read_b128 v[152:155], v218 offset:2048
    v_exp_f32 v64, v64
    v_exp_f32 v65, v65
    v_exp_f32 v66, v66
    v_exp_f32 v67, v67
    v_mfma_f32_32x32x16_bf16 v[192:207], v[156:159], v[108:111], v[192:207]
    ds_read_b128 v[156:159], v218 offset:2304
    v_exp_f32 v68, v68
    v_exp_f32 v69, v69
    v_exp_f32 v70, v70
    v_exp_f32 v71, v71
    s_add_u32 s81, s81, 16384
    s_add_u32 s80, s80, 229376
    s_cmp_ge_u32 s81, 114688
    s_cselect_b32 s70, 114688, 0
    s_sub_u32 s81, s81, s70
    s_mul_i32 s70, s70, 14
    s_sub_u32 s80, s80, s70
    s_add_u32 s70, s80, 0
    s_add_u32 m0, s81, 0
    s_nop 0
    buffer_load_dwordx4 v30, s[32:35], s70 offen lds
    v_cvt_pk_bf16_f32 v96, v64, v65
    v_cvt_pk_bf16_f32 v97, v66, v67
    v_cvt_pk_bf16_f32 v98, v68, v69
    v_cvt_pk_bf16_f32 v99, v70, v71
    v_exp_f32 v72, v72
    v_exp_f32 v73, v73
    v_exp_f32 v74, v74
    v_exp_f32 v75, v75
    s_waitcnt lgkmcnt(4)
    v_mfma_f32_32x32x16_bf16 v[192:207], v[144:147], v[96:99], v[192:207]
    v_exp_f32 v76, v76
    v_exp_f32 v77, v77
    v_exp_f32 v78, v78
    v_exp_f32 v79, v79
    v_cvt_pk_bf16_f32 v100, v72, v73
    v_cvt_pk_bf16_f32 v101, v74, v75
    v_cvt_pk_bf16_f32 v102, v76, v77
    v_cvt_pk_bf16_f32 v103, v78, v79
    s_waitcnt lgkmcnt(2)
    v_mfma_f32_32x32x16_bf16 v[64:79], v[112:115], v[160:163], 0
    ds_read_b128 v[116:119], v216 offset:0
    ds_read_b128 v[144:147], v218 offset:1024
    v_exp_f32 v80, v80
    v_exp_f32 v81, v81
    v_exp_f32 v82, v82
    v_exp_f32 v83, v83
    v_mfma_f32_32x32x16_bf16 v[192:207], v[148:151], v[100:103], v[192:207]
    ds_read_b128 v[148:151], v218 offset:1280
    v_exp_f32 v84, v84
    v_exp_f32 v85, v85
    v_exp_f32 v86, v86
    v_exp_f32 v87, v87
    v_cvt_pk_bf16_f32 v104, v80, v81
    v_cvt_pk_bf16_f32 v105, v82, v83
    v_cvt_pk_bf16_f32 v106, v84, v85
    v_cvt_pk_bf16_f32 v107, v86, v87
    v_exp_f32 v88, v88
    v_exp_f32 v89, v89
    v_exp_f32 v90, v90
    v_exp_f32 v91, v91
    s_waitcnt lgkmcnt(4)
    v_mfma_f32_32x32x16_bf16 v[192:207], v[152:155], v[104:107], v[192:207]
    v_exp_f32 v92, v92
    v_exp_f32 v93, v93
    v_exp_f32 v94, v94
    v_exp_f32 v95, v95
    v_cvt_pk_bf16_f32 v108, v88, v89
    v_cvt_pk_bf16_f32 v109, v90, v91
    v_cvt_pk_bf16_f32 v110, v92, v93
    v_cvt_pk_bf16_f32 v111, v94, v95
    buffer_load_dword v120, v22, s[16:19], s53 offen sc1
    s_waitcnt lgkmcnt(2)
    v_mfma_f32_32x32x16_bf16 v[80:95], v[116:119], v[160:163], v[236:251]
    ds_read_b128 v[152:155], v218 offset:0
    v_exp_f32 v64, v64
    v_exp_f32 v65, v65
    v_exp_f32 v66, v66
    v_exp_f32 v67, v67
    v_mfma_f32_32x32x16_bf16 v[192:207], v[156:159], v[108:111], v[192:207]
    ds_read_b128 v[156:159], v218 offset:256
    v_exp_f32 v68, v68
    v_exp_f32 v69, v69
    v_exp_f32 v70, v70
    v_exp_f32 v71, v71
    s_add_u32 s70, s80, 28672
    s_add_u32 m0, s81, 1024
    s_nop 0
    buffer_load_dwordx4 v30, s[32:35], s70 offen lds
    v_cvt_pk_bf16_f32 v96, v64, v65
    v_cvt_pk_bf16_f32 v97, v66, v67
    v_cvt_pk_bf16_f32 v98, v68, v69
    v_cvt_pk_bf16_f32 v99, v70, v71
    v_exp_f32 v72, v72
    v_exp_f32 v73, v73
    v_exp_f32 v74, v74
    v_exp_f32 v75, v75
    s_waitcnt lgkmcnt(3)
    v_mfma_f32_32x32x16_bf16 v[192:207], v[144:147], v[96:99], v[192:207]
    v_exp_f32 v76, v76
    v_exp_f32 v77, v77
    v_exp_f32 v78, v78
    v_exp_f32 v79, v79
    v_cvt_pk_bf16_f32 v100, v72, v73
    v_cvt_pk_bf16_f32 v101, v74, v75
    v_cvt_pk_bf16_f32 v102, v76, v77
    v_cvt_pk_bf16_f32 v103, v78, v79
    v_exp_f32 v80, v80
    v_exp_f32 v81, v81
    v_exp_f32 v82, v82
    v_exp_f32 v83, v83
    s_waitcnt lgkmcnt(2)
    v_mfma_f32_32x32x16_bf16 v[192:207], v[148:151], v[100:103], v[192:207]
    v_exp_f32 v84, v84
    v_exp_f32 v85, v85
    v_exp_f32 v86, v86
    v_exp_f32 v87, v87
    s_add_u32 s70, s80, 0
    s_add_u32 m0, s81, 2048
    s_nop 0
    buffer_load_dwordx4 v31, s[36:39], s70 offen lds
    v_cvt_pk_bf16_f32 v104, v80, v81
    v_cvt_pk_bf16_f32 v105, v82, v83
    v_cvt_pk_bf16_f32 v106, v84, v85
    v_cvt_pk_bf16_f32 v107, v86, v87
    v_exp_f32 v88, v88
    v_exp_f32 v89, v89
    v_exp_f32 v90, v90
    v_exp_f32 v91, v91
    s_waitcnt lgkmcnt(1)
    v_mfma_f32_32x32x16_bf16 v[192:207], v[152:155], v[104:107], v[192:207]
    v_exp_f32 v92, v92
    v_exp_f32 v93, v93
    v_exp_f32 v94, v94
    v_exp_f32 v95, v95
    v_cvt_pk_bf16_f32 v108, v88, v89
    v_cvt_pk_bf16_f32 v109, v90, v91
    v_cvt_pk_bf16_f32 v110, v92, v93
    v_cvt_pk_bf16_f32 v111, v94, v95
    s_mov_b32 s91, s63
    s_waitcnt vmcnt(2)
    s_cmp_lg_u32 s63, 0
    s_cbranch_scc1 L_c_30
    v_cmp_gt_u32 vcc, 4, v120
    s_nop 1
    s_cbranch_vccnz L_poll_31
L_ok_32:
    s_cmp_lg_u32 s50, 0
    s_cbranch_scc1 L_acq_33
L_acr_34:
    s_add_u32 s92, s61, s76
    buffer_load_dwordx4 v[132:135], v1, s[16:19], s92 offen offset:0 sc1
    buffer_load_dwordx4 v[136:139], v1, s[16:19], s92 offen offset:1024 sc1
    s_add_u32 s92, s61, s77
    buffer_load_dwordx4 v[140:143], v1, s[16:19], s92 offen offset:0 sc1
    buffer_load_dwordx4 v[164:167], v1, s[16:19], s92 offen offset:1024 sc1
    s_add_u32 s92, s61, s78
    buffer_load_dwordx4 v[168:171], v1, s[16:19], s92 offen offset:0 sc1
    buffer_load_dwordx4 v[172:175], v1, s[16:19], s92 offen offset:1024 sc1
    s_add_u32 s92, s61, s79
    buffer_load_dwordx4 v[208:211], v1, s[16:19], s92 offen offset:0 sc1
    buffer_load_dwordx4 v[212:215], v1, s[16:19], s92 offen offset:1024 sc1
L_c_30:
    s_waitcnt lgkmcnt(0)
    v_mfma_f32_32x32x16_bf16 v[192:207], v[156:159], v[108:111], v[192:207]
    s_nop 11
    v_rcp_f32 v201, v200
    s_nop 0
    v_mul_f32 v192, v192, v201
    v_mul_f32 v193, v193, v201
    v_mul_f32 v194, v194, v201
    v_mul_f32 v195, v195, v201
    v_mul_f32 v196, v196, v201
    v_mul_f32 v197, v197, v201
    v_mul_f32 v198, v198, v201
    v_mul_f32 v199, v199, v201
    v_cvt_pk_bf16_f32 v204, v192, v193
    v_cvt_pk_bf16_f32 v205, v194, v195
    v_cvt_pk_bf16_f32 v206, v196, v197
    v_cvt_pk_bf16_f32 v207, v198, v199
    buffer_store_dwordx4 v[204:207], v1, s[16:19], s87 offen
    v_mov_b32 v202, 0
    v_dot2c_f32_bf16 v202, s55, v204
    v_dot2c_f32_bf16 v202, s55, v205
    v_dot2c_f32_bf16 v202, s55, v206
    v_dot2c_f32_bf16 v202, s55, v207
    s_nop 2
    v_fma_f32 v202, v202, 0, v200
    v_subrev_u32 v202, 0x30800000, v202
    v_cmp_le_u32 vcc, 0x28000000, v202
    s_nop 1
    s_cmp_lg_u64 vcc, 0
    s_cselect_b32 s63, 1, s63
    s_add_u32 s70, s80, 28672
    s_add_u32 m0, s81, 3072
    s_nop 0
    buffer_load_dwordx4 v31, s[36:39], s70 offen lds
    s_add_u32 s81, s81, 16384
    s_add_u32 s80, s80, 229376
    s_cmp_ge_u32 s81, 114688
    s_cselect_b32 s70, 114688, 0
    s_sub_u32 s81, s81, s70
    s_mul_i32 s70, s70, 14
    s_sub_u32 s80, s80, s70
    s_add_u32 s70, s80, 0
    s_add_u32 m0, s81, 0
    s_nop 0
    buffer_load_dwordx4 v30, s[32:35], s70 offen lds
    s_add_u32 s70, s80, 28672
    s_add_u32 m0, s81, 1024
    s_nop 0
    buffer_load_dwordx4 v30, s[32:35], s70 offen lds
    s_add_u32 s70, s80, 0
    s_add_u32 m0, s81, 2048
    s_nop 0
    buffer_load_dwordx4 v31, s[36:39], s70 offen lds
    s_add_u32 s70, s80, 28672
    s_add_u32 m0, s81, 3072
    s_nop 0
    buffer_load_dwordx4 v31, s[36:39], s70 offen lds
    s_cmp_lg_u32 s63, 0
    s_cbranch_scc1 L_fb0
L_fbr0:
    s_barrier
    s_cmp_lg_u32 s46, 0
    s_cbranch_scc1 L_c_35
    s_or_b32 s98, s56, 224
    v_mov_b32 v253, s98
    s_lshl_b32 s98, s44, 5
    s_add_u32 s98, s98, s45
    s_mov_b64 exec, 1
    buffer_store_byte v253, off, s[24:27], s98 sc1
    s_mov_b64 exec, -1
L_c_35:
    v_add_u32 v25, 0x10000, v25
    v_add_u32 v26, 0x10000, v26
    ds_write_b128 v25, a[128:131] offset:49152
    ds_write_b128 v25, a[132:135] offset:50176
    ds_write_b128 v26, a[136:139] offset:51200
    ds_write_b128 v26, a[140:143] offset:52224
    v_mov_b32 v252, 5
    s_waitcnt vmcnt(5)
    s_mov_b64 exec, 1
    s_cmp_lg_u32 s50, 0
    s_cbranch_scc1 L_pub_36
    buffer_store_dword v252, off, s[16:19], s52
L_pur_37:
    s_mov_b64 exec, -1
    s_add_u32 s81, s81, 16384
    s_add_u32 s80, s80, 229376
    s_cmp_ge_u32 s81, 114688
    s_cselect_b32 s70, 114688, 0
    s_sub_u32 s81, s81, s70
    s_mul_i32 s70, s70, 14
    s_sub_u32 s80, s80, s70
    s_add_u32 s70, s80, 0
    s_add_u32 m0, s81, 0
    s_nop 0
    buffer_load_dwordx4 v30, s[32:35], s70 offen lds
    s_add_u32 s70, s80, 28672
    s_add_u32 m0, s81, 1024
    s_nop 0
    buffer_load_dwordx4 v30, s[32:35], s70 offen lds
    s_add_u32 s70, s80, 0
    s_add_u32 m0, s81, 2048
    s_nop 0
    buffer_load_dwordx4 v31, s[36:39], s70 offen lds
    v_mfma_f32_32x32x16_bf16 v[64:79], v[32:35], v[132:135], 0
    v_mfma_f32_32x32x16_bf16 v[64:79], v[40:43], v[136:139], v[64:79]
    v_mfma_f32_32x32x16_bf16 v[64:79], v[48:51], v[140:143], v[64:79]
    v_mfma_f32_32x32x16_bf16 v[64:79], v[56:59], v[164:167], v[64:79]
    v_mfma_f32_32x32x16_bf16 v[64:79], a[224:227], v[168:171], v[64:79]
    v_mfma_f32_32x32x16_bf16 v[64:79], a[232:235], v[172:175], v[64:79]
    v_mfma_f32_32x32x16_bf16 v[64:79], a[240:243], v[208:211], v[64:79]
    v_mfma_f32_32x32x16_bf16 v[64:79], a[248:251], v[212:215], v[64:79]
    v_mfma_f32_32x32x16_bf16 v[80:95], v[36:39], v[132:135], 0
    v_mfma_f32_32x32x16_bf16 v[80:95], v[44:47], v[136:139], v[80:95]
    ds_write_b128 v14, v[64:67] offset:0
    v_mfma_f32_32x32x16_bf16 v[80:95], v[52:55], v[140:143], v[80:95]
    v_mfma_f32_32x32x16_bf16 v[80:95], v[60:63], v[164:167], v[80:95]
    ds_write_b128 v15, v[68:71] offset:1024
    v_mfma_f32_32x32x16_bf16 v[80:95], a[228:231], v[168:171], v[80:95]
    v_mfma_f32_32x32x16_bf16 v[80:95], a[236:239], v[172:175], v[80:95]
    ds_write_b128 v14, v[72:75] offset:2048
    v_mfma_f32_32x32x16_bf16 v[80:95], a[244:247], v[208:211], v[80:95]
    v_mfma_f32_32x32x16_bf16 v[80:95], a[252:255], v[212:215], v[80:95]
    ds_write_b128 v15, v[76:79] offset:3072
    buffer_load_dword v128, v22, s[16:19], s53 offen sc1
    s_nop 9
    ds_write_b128 v14, v[80:83] offset:4096
    ds_write_b128 v15, v[84:87] offset:5120
    ds_write_b128 v14, v[88:91] offset:6144
    ds_write_b128 v15, v[92:95] offset:7168
    s_waitcnt lgkmcnt(0)
    s_barrier
    ds_read_b128 v[64:67], v13 offset:0
    ds_read_b128 v[68:71], v13 offset:512
    ds_read_b128 v[72:75], v13 offset:8192
    ds_read_b128 v[76:79], v13 offset:8704
    ds_read_b128 v[80:83], v13 offset:16384
    ds_read_b128 v[84:87], v13 offset:16896
    ds_read_b128 v[88:91], v13 offset:24576
    ds_read_b128 v[92:95], v13 offset:25088
    s_waitcnt vmcnt(0)
    v_cmp_gt_u32 vcc, 5, v128
    s_nop 1
    s_cbranch_vccnz L_poll_38
L_ok_39:
    s_cmp_lg_u32 s50, 0
    s_cbranch_scc1 L_acq_40
L_acr_41:
    s_add_u32 s92, s62, s76
    buffer_load_dwordx4 v[144:147], v1, s[16:19], s92 offen offset:0 sc1
    buffer_load_dwordx4 v[148:151], v1, s[16:19], s92 offen offset:1024 sc1
    s_waitcnt lgkmcnt(5)
    v_pk_add_f32 v[64:65], v[64:65], v[72:73]
    v_pk_add_f32 v[66:67], v[66:67], v[74:75]
    s_waitcnt lgkmcnt(4)
    v_pk_add_f32 v[68:69], v[68:69], v[76:77]
    v_pk_add_f32 v[70:71], v[70:71], v[78:79]
    s_waitcnt lgkmcnt(1)
    v_pk_add_f32 v[80:81], v[80:81], v[88:89]
    s_add_u32 s92, s62, s77
    buffer_load_dwordx4 v[152:155], v1, s[16:19], s92 offen offset:0 sc1
    v_pk_add_f32 v[82:83], v[82:83], v[90:91]
    s_waitcnt lgkmcnt(0)
    v_pk_add_f32 v[84:85], v[84:85], v[92:93]
    v_pk_add_f32 v[86:87], v[86:87], v[94:95]
    v_lshlrev_b32 v72, 16, v2
    v_and_b32 v73, 0xffff0000, v2
    buffer_load_dwordx4 v[156:159], v1, s[16:19], s92 offen offset:1024 sc1
    v_lshlrev_b32 v74, 16, v3
    v_and_b32 v75, 0xffff0000, v3
    v_lshlrev_b32 v76, 16, v4
    v_and_b32 v77, 0xffff0000, v4
    v_lshlrev_b32 v78, 16, v5
    s_add_u32 s92, s62, s78
    buffer_load_dwordx4 v[176:179], v1, s[16:19], s92 offen offset:0 sc1
    v_and_b32 v79, 0xffff0000, v5
    v_pk_add_f32 v[64:65], v[64:65], v[80:81]
    v_pk_add_f32 v[66:67], v[66:67], v[82:83]
    v_pk_add_f32 v[68:69], v[68:69], v[84:85]
    v_pk_add_f32 v[70:71], v[70:71], v[86:87]
    buffer_load_dwordx4 v[180:183], v1, s[16:19], s92 offen offset:1024 sc1
    v_pk_add_f32 v[64:65], v[64:65], v[72:73]
    v_pk_add_f32 v[66:67], v[66:67], v[74:75]
    v_pk_add_f32 v[68:69], v[68:69], v[76:77]
    v_pk_add_f32 v[70:71], v[70:71], v[78:79]
    v_cvt_pk_bf16_f32 v2, v64, v65
    s_add_u32 s92, s62, s79
    buffer_load_dwordx4 v[184:187], v1, s[16:19], s92 offen offset:0 sc1
    v_cvt_pk_bf16_f32 v3, v66, v67
    v_cvt_pk_bf16_f32 v4, v68, v69
    v_cvt_pk_bf16_f32 v5, v70, v71
    s_lshl_b32 s87, s48, 12
    s_add_u32 s86, s61, s87
    buffer_load_dwordx4 v[220:223], v1, s[16:19], s92 offen offset:1024 sc1
    buffer_store_dwordx4 v[2:5], v16, s[16:19], s86 offen sc1
    v_mov_b32 v64, 0
    v_mov_b32 v65, 0
    v_dot2c_f32_bf16 v64, s55, v2
    v_dot2c_f32_bf16 v65, v2, v2
    v_dot2c_f32_bf16 v64, s55, v3
    v_dot2c_f32_bf16 v65, v3, v3
    v_dot2c_f32_bf16 v64, s55, v4
    v_dot2c_f32_bf16 v65, v4, v4
    v_dot2c_f32_bf16 v64, s55, v5
    v_dot2c_f32_bf16 v65, v5, v5
    s_lshl_b32 s87, s48, 2
    s_add_u32 s86, s61, s87
    s_add_u32 s86, s86, 149504
    v_add_f32_dpp v64, v64, v64 row_ror:8 row_mask:0xf bank_mask:0xf
    v_add_f32_dpp v65, v65, v65 row_ror:8 row_mask:0xf bank_mask:0xf
    s_nop 1
    v_permlane16_swap_b32 v64, v65
    v_add_f32 v64, v64, v65
    v_mov_b32 v65, v64
    s_nop 1
    v_permlane32_swap_b32 v64, v65
    v_add_f32 v64, v64, v65
    buffer_store_dword v64, v18, s[16:19], s86 offen offset:0
    s_add_u32 s70, s80, 28672
    s_add_u32 m0, s81, 3072
    s_nop 0
    buffer_load_dwordx4 v31, s[36:39], s70 offen lds
    s_add_u32 s81, s81, 16384
    s_add_u32 s80, s80, 229376
    s_cmp_ge_u32 s81, 114688
    s_cselect_b32 s70, 114688, 0
    s_sub_u32 s81, s81, s70
    s_mul_i32 s70, s70, 14
    s_sub_u32 s80, s80, s70
    s_add_u32 s70, s80, 0
    s_add_u32 m0, s81, 0
    s_nop 0
    buffer_load_dwordx4 v30, s[32:35], s70 offen lds
    s_add_u32 s70, s80, 28672
    s_add_u32 m0, s81, 1024
    s_nop 0
    buffer_load_dwordx4 v30, s[32:35], s70 offen lds
    s_add_u32 s70, s80, 0
    s_add_u32 m0, s81, 2048
    s_nop 0
    buffer_load_dwordx4 v31, s[36:39], s70 offen lds
    s_add_u32 s70, s80, 28672
    s_add_u32 m0, s81, 3072
    s_nop 0
    buffer_load_dwordx4 v31, s[36:39], s70 offen lds
    s_lshl_b32 s93, s45, 2
    s_add_u32 s93, s93, s46
    s_mul_i32 s93, s93, 14336
    v_lshlrev_b32 v253, 10, v0
    s_mov_b64 exec, 16383
    s_sub_u32 s70, 384, s40
    s_and_b32 s70, s70, 0x380
    s_add_u32 s70, s70, s93
    buffer_load_dword v129, v253, s[40:43], s70 offen
    s_mov_b64 exec, -1
    v_lshrrev_b32 v253, 5, v0
    v_lshlrev_b32 v163, 10, v253
    v_bfe_u32 v253, v0, 4, 1
    v_lshl_add_u32 v163, v253, 11, v163
    v_bfe_u32 v254, v0, 2, 2
    v_lshl_add_u32 v163, v254, 7, v163
    v_xor_b32 v253, v253, v254
    v_lshl_add_u32 v163, v253, 5, v163
    v_and_b32 v253, 3, v0
    v_lshl_add_u32 v160, v253, 3, v163
    v_xor_b32 v161, 32, v160
    v_xor_b32 v162, 64, v160
    v_xor_b32 v163, 96, v160
    s_waitcnt vmcnt(15)
    v_mfma_f32_32x32x16_bf16 v[96:111], v[32:35], v[144:147], 0
    s_waitcnt vmcnt(14)
    v_mfma_f32_32x32x16_bf16 v[96:111], v[40:43], v[148:151], v[96:111]
    s_waitcnt vmcnt(13)
    v_mfma_f32_32x32x16_bf16 v[96:111], v[48:51], v[152:155], v[96:111]
    s_waitcnt vmcnt(12)
    v_mfma_f32_32x32x16_bf16 v[96:111], v[56:59], v[156:159], v[96:111]
    s_waitcnt vmcnt(11)
    v_mfma_f32_32x32x16_bf16 v[96:111], a[224:227], v[176:179], v[96:111]
    s_waitcnt vmcnt(10)
    v_mfma_f32_32x32x16_bf16 v[96:111], a[232:235], v[180:183], v[96:111]
    s_waitcnt vmcnt(9)
    v_mfma_f32_32x32x16_bf16 v[96:111], a[240:243], v[184:187], v[96:111]
    s_waitcnt vmcnt(8)
    v_mfma_f32_32x32x16_bf16 v[96:111], a[248:251], v[220:223], v[96:111]
    s_barrier
    v_mfma_f32_32x32x16_bf16 v[112:127], v[36:39], v[144:147], 0
    v_mfma_f32_32x32x16_bf16 v[112:127], v[44:47], v[148:151], v[112:127]
    ds_write_b128 v14, v[96:99] offset:0
    v_mfma_f32_32x32x16_bf16 v[112:127], v[52:55], v[152:155], v[112:127]
    v_mfma_f32_32x32x16_bf16 v[112:127], v[60:63], v[156:159], v[112:127]
    ds_write_b128 v15, v[100:103] offset:1024
    v_mfma_f32_32x32x16_bf16 v[112:127], a[228:231], v[176:179], v[112:127]
    v_mfma_f32_32x32x16_bf16 v[112:127], a[236:239], v[180:183], v[112:127]
    ds_write_b128 v14, v[104:107] offset:2048
    v_mov_b32 v252, 6
    s_waitcnt vmcnt(6)
    s_mov_b64 exec, 1
    s_cmp_lg_u32 s50, 0
    s_cbranch_scc1 L_pub_42
    buffer_store_dword v252, off, s[16:19], s52
L_pur_43:
    s_mov_b64 exec, -1
    v_mfma_f32_32x32x16_bf16 v[112:127], a[244:247], v[184:187], v[112:127]
    v_mfma_f32_32x32x16_bf16 v[112:127], a[252:255], v[220:223], v[112:127]
    ds_write_b128 v15, v[108:111] offset:3072
    s_nop 10
    ds_write_b128 v14, v[112:115] offset:4096
    ds_write_b128 v15, v[116:119] offset:5120
    ds_write_b128 v14, v[120:123] offset:6144
    ds_write_b128 v15, v[124:127] offset:7168
    s_waitcnt lgkmcnt(0)
    s_barrier
    ds_read_b128 v[96:99], v13 offset:0
    ds_read_b128 v[100:103], v13 offset:512
    ds_read_b128 v[104:107], v13 offset:8192
    ds_read_b128 v[108:111], v13 offset:8704
    ds_read_b128 v[112:115], v13 offset:16384
    ds_read_b128 v[116:119], v13 offset:16896
    ds_read_b128 v[120:123], v13 offset:24576
    ds_read_b128 v[124:127], v13 offset:25088
    s_lshr_b32 s57, s45, 1
    s_mul_i32 s57, s57, 7168
    s_add_u32 s57, s57, 32768
    s_mul_i32 s88, s49, 3072
    s_add_u32 s57, s57, s88
    v_bfe_u32 v136, v0, 4, 1
    v_lshlrev_b32 v136, 2, v136
    v_and_b32 v137, 15, v0
    v_cmp_eq_u32 vcc, v136, v137
    v_mov_b32 v137, s55
    s_nop 0
    v_cndmask_b32 v136, 0, v137, vcc
    v_mov_b32 v137, v136
    v_mov_b32 v138, v136
    v_mov_b32 v139, v136
    s_lshl_b32 s90, s46, 5
    v_xor_b32 v140, s90, v160
    v_add_u32 v141, 0x10000, v140
    v_add_u32 v146, s83, v140
    ds_read_b64_tr_b16 v[64:65], v146 offset:0
    ds_read_b64_tr_b16 v[66:67], v146 offset:512
    ds_read_b64_tr_b16 v[68:69], v146 offset:4096
    ds_read_b64_tr_b16 v[70:71], v146 offset:4608
    ds_read_b64_tr_b16 v[72:73], v146 offset:8192
    ds_read_b64_tr_b16 v[74:75], v146 offset:8704
    ds_read_b64_tr_b16 v[76:77], v146 offset:12288
    ds_read_b64_tr_b16 v[78:79], v146 offset:12800
    s_add_u32 s83, s83, 16384
    s_cmp_eq_u32 s83, 114688
    s_cselect_b32 s83, 0, s83
    v_add_u32 v147, s83, v140
    ds_read_b64_tr_b16 v[80:81], v147 offset:0
    ds_read_b64_tr_b16 v[82:83], v147 offset:512
    ds_read_b64_tr_b16 v[84:85], v147 offset:4096
    ds_read_b64_tr_b16 v[86:87], v147 offset:4608
    ds_read_b64_tr_b16 v[88:89], v147 offset:8192
    ds_read_b64_tr_b16 v[90:91], v147 offset:8704
    s_waitcnt lgkmcnt(12)
    v_mfma_f32_16x16x32_bf16 v[132:135], v[136:139], v[64:67], 0
    ds_read_b64_tr_b16 v[92:93], v147 offset:12288
    ds_read_b64_tr_b16 v[94:95], v147 offset:12800
    v_pk_add_f32 v[96:97], v[96:97], v[104:105]
    v_pk_add_f32 v[98:99], v[98:99], v[106:107]
    v_pk_add_f32 v[100:101], v[100:101], v[108:109]
    v_and_b32 v142, 7, v0
    v_lshlrev_b32 v142, 5, v142
    s_and_b32 s51, s45, 28
    buffer_load_dword v143, v142, s[24:27], s51 offen sc1
    s_waitcnt lgkmcnt(12)
    v_mfma_f32_16x16x32_bf16 v[132:135], v[136:139], v[68:71], v[132:135]
    s_add_u32 s83, s83, 16384
    s_cmp_eq_u32 s83, 114688
    s_cselect_b32 s83, 0, s83
    v_add_u32 v146, s83, v140
    ds_read_b64_tr_b16 v[64:65], v146 offset:0
    ds_read_b64_tr_b16 v[66:67], v146 offset:512
    v_pk_add_f32 v[102:103], v[102:103], v[110:111]
    v_pk_add_f32 v[112:113], v[112:113], v[120:121]
    v_pk_add_f32 v[114:115], v[114:115], v[122:123]
    s_waitcnt lgkmcnt(12)
    v_mfma_f32_16x16x32_bf16 v[132:135], v[136:139], v[72:75], v[132:135]
    ds_read_b64_tr_b16 v[68:69], v146 offset:4096
    ds_read_b64_tr_b16 v[70:71], v146 offset:4608
    v_pk_add_f32 v[116:117], v[116:117], v[124:125]
    v_pk_add_f32 v[118:119], v[118:119], v[126:127]
    v_lshlrev_b32 v104, 16, v6
    s_waitcnt lgkmcnt(12)
    v_mfma_f32_16x16x32_bf16 v[132:135], v[136:139], v[76:79], v[132:135]
    ds_read_b64_tr_b16 v[72:73], v146 offset:8192
    ds_read_b64_tr_b16 v[74:75], v146 offset:8704
    v_and_b32 v105, 0xffff0000, v6
    v_lshlrev_b32 v106, 16, v7
    v_and_b32 v107, 0xffff0000, v7
    s_waitcnt lgkmcnt(12)
    v_mfma_f32_16x16x32_bf16 v[132:135], v[136:139], v[80:83], v[132:135]
    ds_read_b64_tr_b16 v[76:77], v146 offset:12288
    ds_read_b64_tr_b16 v[78:79], v146 offset:12800
    v_lshlrev_b32 v108, 16, v8
    v_and_b32 v109, 0xffff0000, v8
    v_lshlrev_b32 v110, 16, v9
    s_waitcnt lgkmcnt(12)
    v_mfma_f32_16x16x32_bf16 v[132:135], v[136:139], v[84:87], v[132:135]
    s_add_u32 s83, s83, 16384
    s_cmp_eq_u32 s83, 114688
    s_cselect_b32 s83, 0, s83
    v_add_u32 v147, s83, v140
    ds_read_b64_tr_b16 v[80:81], v147 offset:0
    ds_read_b64_tr_b16 v[82:83], v147 offset:512
    v_and_b32 v111, 0xffff0000, v9
    v_pk_add_f32 v[96:97], v[96:97], v[112:113]
    v_pk_add_f32 v[98:99], v[98:99], v[114:115]
    s_waitcnt lgkmcnt(12)
    v_mfma_f32_16x16x32_bf16 v[132:135], v[136:139], v[88:91], v[132:135]
    ds_read_b64_tr_b16 v[84:85], v147 offset:4096
    ds_read_b64_tr_b16 v[86:87], v147 offset:4608
    v_pk_add_f32 v[100:101], v[100:101], v[116:117]
    v_pk_add_f32 v[102:103], v[102:103], v[118:119]
    v_pk_add_f32 v[96:97], v[96:97], v[104:105]
    s_waitcnt lgkmcnt(12)
    v_mfma_f32_16x16x32_bf16 v[132:135], v[136:139], v[92:95], v[132:135]
    ds_read_b64_tr_b16 v[88:89], v147 offset:8192
    ds_read_b64_tr_b16 v[90:91], v147 offset:8704
    v_pk_add_f32 v[98:99], v[98:99], v[106:107]
    v_pk_add_f32 v[100:101], v[100:101], v[108:109]
    v_pk_add_f32 v[102:103], v[102:103], v[110:111]
    s_waitcnt lgkmcnt(12)
    v_mfma_f32_16x16x32_bf16 v[132:135], v[136:139], v[64:67], v[132:135]
    ds_read_b64_tr_b16 v[92:93], v147 offset:12288
    ds_read_b64_tr_b16 v[94:95], v147 offset:12800
    v_cvt_pk_bf16_f32 v6, v96, v97
    v_cvt_pk_bf16_f32 v7, v98, v99
    v_cvt_pk_bf16_f32 v8, v100, v101
    s_waitcnt lgkmcnt(12)
    v_mfma_f32_16x16x32_bf16 v[132:135], v[136:139], v[68:71], v[132:135]
    s_add_u32 s83, s83, 16384
    s_cmp_eq_u32 s83, 114688
    s_cselect_b32 s83, 0, s83
    v_add_u32 v146, s83, v140
    ds_read_b64_tr_b16 v[64:65], v146 offset:0
    ds_read_b64_tr_b16 v[66:67], v146 offset:512
    v_cvt_pk_bf16_f32 v9, v102, v103
    s_lshl_b32 s87, s48, 12
    s_add_u32 s86, s62, s87
    s_waitcnt lgkmcnt(12)
    v_mfma_f32_16x16x32_bf16 v[132:135], v[136:139], v[72:75], v[132:135]
    ds_read_b64_tr_b16 v[68:69], v146 offset:4096
    ds_read_b64_tr_b16 v[70:71], v146 offset:4608
    buffer_store_dwordx4 v[6:9], v16, s[16:19], s86 offen sc1
    v_mov_b32 v96, 0
    v_mov_b32 v97, 0
    s_waitcnt lgkmcnt(12)
    v_mfma_f32_16x16x32_bf16 v[132:135], v[136:139], v[76:79], v[132:135]
    ds_read_b64_tr_b16 v[72:73], v146 offset:8192
    ds_read_b64_tr_b16 v[74:75], v146 offset:8704
    v_dot2c_f32_bf16 v96, s55, v6
    v_dot2c_f32_bf16 v97, v6, v6
    v_dot2c_f32_bf16 v96, s55, v7
    s_waitcnt lgkmcnt(12)
    v_mfma_f32_16x16x32_bf16 v[132:135], v[136:139], v[80:83], v[132:135]
    ds_read_b64_tr_b16 v[76:77], v146 offset:12288
    ds_read_b64_tr_b16 v[78:79], v146 offset:12800
    v_dot2c_f32_bf16 v97, v7, v7
    v_dot2c_f32_bf16 v96, s55, v8
    v_dot2c_f32_bf16 v97, v8, v8
    s_waitcnt lgkmcnt(12)
    v_mfma_f32_16x16x32_bf16 v[132:135], v[136:139], v[84:87], v[132:135]
    ds_read_b64_tr_b16 v[80:81], v141 offset:49152
    ds_read_b64_tr_b16 v[82:83], v141 offset:49664
    v_dot2c_f32_bf16 v96, s55, v9
    v_dot2c_f32_bf16 v97, v9, v9
    s_lshl_b32 s87, s48, 2
    s_waitcnt lgkmcnt(12)
    v_mfma_f32_16x16x32_bf16 v[132:135], v[136:139], v[88:91], v[132:135]
    ds_read_b64_tr_b16 v[84:85], v141 offset:53248
    ds_read_b64_tr_b16 v[86:87], v141 offset:53760
    s_add_u32 s86, s62, s87
    s_add_u32 s86, s86, 149504
    v_add_f32_dpp v96, v96, v96 row_ror:8 row_mask:0xf bank_mask:0xf
    s_waitcnt lgkmcnt(12)
    v_mfma_f32_16x16x32_bf16 v[132:135], v[136:139], v[92:95], v[132:135]
    ds_read_b64_tr_b16 v[88:89], v141 offset:57344
    ds_read_b64_tr_b16 v[90:91], v141 offset:57856
    v_add_f32_dpp v97, v97, v97 row_ror:8 row_mask:0xf bank_mask:0xf
    s_nop 1
    v_permlane16_swap_b32 v96, v97
    v_add_f32 v96, v96, v97
    s_waitcnt lgkmcnt(12)
    v_mfma_f32_16x16x32_bf16 v[132:135], v[136:139], v[64:67], v[132:135]
    ds_read_b64_tr_b16 v[92:93], v141 offset:61440
    ds_read_b64_tr_b16 v[94:95], v141 offset:61952
    v_mov_b32 v97, v96
    s_nop 1
    v_permlane32_swap_b32 v96, v97
    v_add_f32 v96, v96, v97
    buffer_load_dword v128, v21, s[16:19], s53 offen sc1
    s_waitcnt lgkmcnt(12)
    v_mfma_f32_16x16x32_bf16 v[132:135], v[136:139], v[68:71], v[132:135]
    s_waitcnt vmcnt(5)
    s_barrier
    s_add_u32 s83, s83, 16384
    s_cmp_eq_u32 s83, 114688
    s_cselect_b32 s83, 0, s83
    v_add_u32 v147, s83, v140
    ds_read_b64_tr_b16 v[64:65], v147 offset:0
    ds_read_b64_tr_b16 v[66:67], v147 offset:512
    buffer_store_dword v96, v18, s[16:19], s86 offen offset:0
    s_waitcnt lgkmcnt(12)
    v_mfma_f32_16x16x32_bf16 v[132:135], v[136:139], v[72:75], v[132:135]
    ds_read_b64_tr_b16 v[68:69], v147 offset:4096
    ds_read_b64_tr_b16 v[70:71], v147 offset:4608
    s_waitcnt lgkmcnt(12)
    v_mfma_f32_16x16x32_bf16 v[132:135], v[136:139], v[76:79], v[132:135]
    ds_read_b64_tr_b16 v[72:73], v147 offset:8192
    ds_read_b64_tr_b16 v[74:75], v147 offset:8704
    s_waitcnt lgkmcnt(12)
    v_mfma_f32_16x16x32_bf16 v[132:135], v[136:139], v[80:83], v[132:135]
    ds_read_b64_tr_b16 v[76:77], v147 offset:12288
    ds_read_b64_tr_b16 v[78:79], v147 offset:12800
    s_waitcnt lgkmcnt(12)
    v_mfma_f32_16x16x32_bf16 v[132:135], v[136:139], v[84:87], v[132:135]
    s_add_u32 s83, s83, 16384
    s_cmp_eq_u32 s83, 114688
    s_cselect_b32 s83, 0, s83
    v_add_u32 v146, s83, v140
    ds_read_b64_tr_b16 v[80:81], v146 offset:0
    ds_read_b64_tr_b16 v[82:83], v146 offset:512
    s_waitcnt lgkmcnt(12)
    v_mfma_f32_16x16x32_bf16 v[132:135], v[136:139], v[88:91], v[132:135]
    ds_read_b64_tr_b16 v[84:85], v146 offset:4096
    ds_read_b64_tr_b16 v[86:87], v146 offset:4608
    s_waitcnt lgkmcnt(12)
    v_mfma_f32_16x16x32_bf16 v[132:135], v[136:139], v[92:95], v[132:135]
    ds_read_b64_tr_b16 v[88:89], v146 offset:8192
    ds_read_b64_tr_b16 v[90:91], v146 offset:8704
    s_waitcnt lgkmcnt(12)
    v_mfma_f32_16x16x32_bf16 v[132:135], v[136:139], v[64:67], v[132:135]
    ds_read_b64_tr_b16 v[92:93], v146 offset:12288
    ds_read_b64_tr_b16 v[94:95], v146 offset:12800
    s_waitcnt lgkmcnt(12)
    v_mfma_f32_16x16x32_bf16 v[132:135], v[136:139], v[68:71], v[132:135]
    s_waitcnt lgkmcnt(10)
    v_mfma_f32_16x16x32_bf16 v[132:135], v[136:139], v[72:75], v[132:135]
    s_waitcnt lgkmcnt(8)
    v_mfma_f32_16x16x32_bf16 v[132:135], v[136:139], v[76:79], v[132:135]
    s_waitcnt lgkmcnt(6)
    v_mfma_f32_16x16x32_bf16 v[132:135], v[136:139], v[80:83], v[132:135]
    s_waitcnt lgkmcnt(4)
    v_mfma_f32_16x16x32_bf16 v[132:135], v[136:139], v[84:87], v[132:135]
    s_waitcnt lgkmcnt(2)
    v_mfma_f32_16x16x32_bf16 v[132:135], v[136:139], v[88:91], v[132:135]
    s_waitcnt lgkmcnt(0)
    v_mfma_f32_16x16x32_bf16 v[132:135], v[136:139], v[92:95], v[132:135]
    s_bfe_u32 s83, s44, 65538
    s_mul_i32 s83, s83, 3072
    s_waitcnt vmcnt(1)
    v_cmp_gt_u32 vcc, 6, v128
    s_nop 1
    s_cbranch_vccnz L_poll_44
L_ok_45:
    s_cmp_lg_u32 s50, 0
    s_cbranch_scc1 L_acq_46
L_acr_47:
    s_mov_b32 s64, s59
    buffer_load_dwordx4 a[128:131], v1, s[16:19], s64 offen offset:0 sc1
    buffer_load_dwordx4 a[132:135], v1, s[16:19], s64 offen offset:1024 sc1
    v_mov_b32 v27, v132
    v_cvt_pk_bf16_f32 v133, v27, v27
    v_and_b32 v133, 0xffff0000, v133
    s_add_u32 s88, s59, 149504
    buffer_load_dwordx4 v[164:167], v19, s[16:19], s88 offen sc1
    buffer_load_dwordx4 v[168:171], v19, s[16:19], s88 offen offset:16 sc1
    v_sub_f32 v133, v27, v133
    v_cvt_pk_bf16_f32 v27, v27, v133
    v_lshrrev_b32 v185, 5, v0
    buffer_load_dwordx4 a[136:139], v1, s[16:19], s64 offen offset:2048 sc1
    v_bfe_u32 v186, v0, 2, 2
    v_lshl_add_u32 v186, v185, 2, v186
    v_lshlrev_b32 v186, 7, v186
    buffer_load_dwordx4 a[140:143], v1, s[16:19], s64 offen offset:3072 sc1
    v_bfe_u32 v185, v0, 4, 1
    v_lshl_add_u32 v186, v185, 5, v186
    v_lshlrev_b32 v185, 6, v185
    s_add_u32 s64, s64, 4096
    buffer_load_dwordx4 a[144:147], v1, s[16:19], s64 offen offset:0 sc1
    v_and_b32 v187, 3, v0
    v_lshl_add_u32 v186, v187, 3, v186
    v_bfe_u32 v187, v0, 3, 1
    buffer_load_dwordx4 a[148:151], v1, s[16:19], s64 offen offset:1024 sc1
    v_lshl_add_u32 v186, v187, 6, v186
    v_sub_u32 v187, v14, v1
    v_add_u32 v186, v186, v187
    buffer_load_dwordx4 a[152:155], v1, s[16:19], s64 offen offset:2048 sc1
    v_xor_b32 v187, 64, v186
    v_xor_b32 v185, v185, v14
    v_bfe_u32 v185, v0, 4, 1
    buffer_load_dwordx4 a[156:159], v1, s[16:19], s64 offen offset:3072 sc1
    v_lshlrev_b32 v185, 6, v185
    v_xor_b32 v255, v255, v185
    v_lshlrev_b32 v253, 2, v0
    v_add_u32 v253, 135168, v253
    s_lshl_b32 s86, s46, 13
    v_add_u32 v253, s86, v253
    ds_write_b32 v253, v27
    s_and_b32 s91, s45, 3
    s_lshl_b32 s91, s91, 3
    s_lshl_b32 s91, 0x20, s91
    v_and_b32 v254, s91, v143
    v_cmp_ne_u32 vcc, s91, v254
    s_nop 1
    s_cbranch_vccnz L_poll_48
L_ok_49:
    s_cmp_lg_u32 s50, 0
    s_cbranch_scc1 L_acq_50
L_acr_51:
    v_mov_b32 v252, 7
    s_waitcnt vmcnt(10)
    s_mov_b64 exec, 1
    s_cmp_lg_u32 s50, 0
    s_cbranch_scc1 L_pub_52
    buffer_store_dword v252, off, s[16:19], s52
L_pur_53:
    s_mov_b64 exec, -1
    s_cmp_lg_u32 s49, 0
    s_cbranch_scc1 L_ge0
    ds_read_b64_tr_b16 v[128:129], v160 offset:0
    ds_read_b64_tr_b16 v[130:131], v160 offset:512
    ds_read_b64_tr_b16 v[132:133], v161 offset:0
    ds_read_b64_tr_b16 v[134:135], v161 offset:512
    ds_read_b64_tr_b16 v[136:137], v162 offset:0
    ds_read_b64_tr_b16 v[138:139], v162 offset:512
    ds_read_b64_tr_b16 v[140:141], v163 offset:0
    ds_read_b64_tr_b16 v[142:143], v163 offset:512
    ds_read_b64_tr_b16 v[144:145], v160 offset:4096
    ds_read_b64_tr_b16 v[146:147], v160 offset:4608
    ds_read_b64_tr_b16 v[148:149], v161 offset:4096
    ds_read_b64_tr_b16 v[150:151], v161 offset:4608
    ds_read_b64_tr_b16 v[152:153], v162 offset:4096
    ds_read_b64_tr_b16 v[154:155], v162 offset:4608
    ds_read_b64_tr_b16 v[156:157], v163 offset:4096
    ds_read_b64_tr_b16 v[158:159], v163 offset:4608
    s_waitcnt vmcnt(10) lgkmcnt(8)
    v_mfma_f32_32x32x16_bf16 v[64:79], v[128:131], a[128:131], 0
    ds_read_b64_tr_b16 v[128:129], v160 offset:8192
    ds_read_b64_tr_b16 v[130:131], v160 offset:8704
    s_add_u32 s64, s64, 4096
    buffer_load_dwordx4 a[160:163], v1, s[16:19], s64 offen offset:0 sc1
    v_mfma_f32_32x32x16_bf16 v[80:95], v[132:135], a[128:131], 0
    ds_read_b64_tr_b16 v[132:133], v161 offset:8192
    ds_read_b64_tr_b16 v[134:135], v161 offset:8704
    buffer_load_dwordx4 a[164:167], v1, s[16:19], s64 offen offset:1024 sc1
    v_mfma_f32_32x32x16_bf16 v[96:111], v[136:139], a[128:131], 0
    ds_read_b64_tr_b16 v[136:137], v162 offset:8192
    ds_read_b64_tr_b16 v[138:139], v162 offset:8704
    v_mfma_f32_32x32x16_bf16 v[112:127], v[140:143], a[128:131], 0
    ds_read_b64_tr_b16 v[140:141], v163 offset:8192
    ds_read_b64_tr_b16 v[142:143], v163 offset:8704
    s_waitcnt vmcnt(11) lgkmcnt(8)
    v_mfma_f32_32x32x16_bf16 v[64:79], v[144:147], a[132:135], v[64:79]
    ds_read_b64_tr_b16 v[144:145], v160 offset:12288
    ds_read_b64_tr_b16 v[146:147], v160 offset:12800
    buffer_load_dwordx4 a[168:171], v1, s[16:19], s64 offen offset:2048 sc1
    v_mfma_f32_32x32x16_bf16 v[80:95], v[148:151], a[132:135], v[80:95]
    ds_read_b64_tr_b16 v[148:149], v161 offset:12288
    ds_read_b64_tr_b16 v[150:151], v161 offset:12800
    buffer_load_dwordx4 a[172:175], v1, s[16:19], s64 offen offset:3072 sc1
    v_mfma_f32_32x32x16_bf16 v[96:111], v[152:155], a[132:135], v[96:111]
    ds_read_b64_tr_b16 v[152:153], v162 offset:12288
    ds_read_b64_tr_b16 v[154:155], v162 offset:12800
    v_mfma_f32_32x32x16_bf16 v[112:127], v[156:159], a[132:135], v[112:127]
    ds_read_b64_tr_b16 v[156:157], v163 offset:12288
    ds_read_b64_tr_b16 v[158:159], v163 offset:12800
    s_waitcnt vmcnt(10) lgkmcnt(8)
    v_mfma_f32_32x32x16_bf16 v[64:79], v[128:131], a[136:139], v[64:79]
    ds_read_b64_tr_b16 v[128:129], v160 offset:16384
    ds_read_b64_tr_b16 v[130:131], v160 offset:16896
    s_add_u32 s64, s64, 4096
    buffer_load_dwordx4 a[176:179], v1, s[16:19], s64 offen offset:0 sc1
    v_mfma_f32_32x32x16_bf16 v[80:95], v[132:135], a[136:139], v[80:95]
    ds_read_b64_tr_b16 v[132:133], v161 offset:16384
    ds_read_b64_tr_b16 v[134:135], v161 offset:16896
    buffer_load_dwordx4 a[180:183], v1, s[16:19], s64 offen offset:1024 sc1
    v_mfma_f32_32x32x16_bf16 v[96:111], v[136:139], a[136:139], v[96:111]
    ds_read_b64_tr_b16 v[136:137], v162 offset:16384
    ds_read_b64_tr_b16 v[138:139], v162 offset:16896
    v_mfma_f32_32x32x16_bf16 v[112:127], v[140:143], a[136:139], v[112:127]
    ds_read_b64_tr_b16 v[140:141], v163 offset:16384
    ds_read_b64_tr_b16 v[142:143], v163 offset:16896
    s_waitcnt vmcnt(11) lgkmcnt(8)
    v_mfma_f32_32x32x16_bf16 v[64:79], v[144:147], a[140:143], v[64:79]
    ds_read_b64_tr_b16 v[144:145], v160 offset:20480
    ds_read_b64_tr_b16 v[146:147], v160 offset:20992
    buffer_load_dwordx4 a[184:187], v1, s[16:19], s64 offen offset:2048 sc1
    v_mfma_f32_32x32x16_bf16 v[80:95], v[148:151], a[140:143], v[80:95]
    ds_read_b64_tr_b16 v[148:149], v161 offset:20480
    ds_read_b64_tr_b16 v[150:151], v161 offset:20992
    buffer_load_dwordx4 a[188:191], v1, s[16:19], s64 offen offset:3072 sc1
    v_mfma_f32_32x32x16_bf16 v[96:111], v[152:155], a[140:143], v[96:111]
    ds_read_b64_tr_b16 v[152:153], v162 offset:20480
    ds_read_b64_tr_b16 v[154:155], v162 offset:20992
    v_mfma_f32_32x32x16_bf16 v[112:127], v[156:159], a[140:143], v[112:127]
    ds_read_b64_tr_b16 v[156:157], v163 offset:20480
    ds_read_b64_tr_b16 v[158:159], v163 offset:20992
    s_waitcnt vmcnt(12) lgkmcnt(8)
    v_mfma_f32_32x32x16_bf16 v[64:79], v[128:131], a[144:147], v[64:79]
    ds_read_b64_tr_b16 v[128:129], v160 offset:24576
    ds_read_b64_tr_b16 v[130:131], v160 offset:25088
    s_add_u32 s64, s64, 4096
    buffer_load_dwordx4 a[192:195], v1, s[16:19], s64 offen offset:0 sc1
    v_mfma_f32_32x32x16_bf16 v[80:95], v[132:135], a[144:147], v[80:95]
    ds_read_b64_tr_b16 v[132:133], v161 offset:24576
    ds_read_b64_tr_b16 v[134:135], v161 offset:25088
    buffer_load_dwordx4 a[196:199], v1, s[16:19], s64 offen offset:1024 sc1
    v_mfma_f32_32x32x16_bf16 v[96:111], v[136:139], a[144:147], v[96:111]
    ds_read_b64_tr_b16 v[136:137], v162 offset:24576
    ds_read_b64_tr_b16 v[138:139], v162 offset:25088
    v_mfma_f32_32x32x16_bf16 v[112:127], v[140:143], a[144:147], v[112:127]
    ds_read_b64_tr_b16 v[140:141], v163 offset:24576
    ds_read_b64_tr_b16 v[142:143], v163 offset:25088
    s_waitcnt vmcnt(13) lgkmcnt(8)
    v_mfma_f32_32x32x16_bf16 v[64:79], v[144:147], a[148:151], v[64:79]
    ds_read_b64_tr_b16 v[144:145], v160 offset:28672
    ds_read_b64_tr_b16 v[146:147], v160 offset:29184
    buffer_load_dwordx4 a[200:203], v1, s[16:19], s64 offen offset:2048 sc1
    v_mfma_f32_32x32x16_bf16 v[80:95], v[148:151], a[148:151], v[80:95]
    ds_read_b64_tr_b16 v[148:149], v161 offset:28672
    ds_read_b64_tr_b16 v[150:151], v161 offset:29184
    buffer_load_dwordx4 a[204:207], v1, s[16:19], s64 offen offset:3072 sc1
    v_mfma_f32_32x32x16_bf16 v[96:111], v[152:155], a[148:151], v[96:111]
    ds_read_b64_tr_b16 v[152:153], v162 offset:28672
    ds_read_b64_tr_b16 v[154:155], v162 offset:29184
    v_mfma_f32_32x32x16_bf16 v[112:127], v[156:159], a[148:151], v[112:127]
    ds_read_b64_tr_b16 v[156:157], v163 offset:28672
    ds_read_b64_tr_b16 v[158:159], v163 offset:29184
    s_waitcnt vmcnt(14) lgkmcnt(8)
    v_mfma_f32_32x32x16_bf16 v[64:79], v[128:131], a[152:155], v[64:79]
    ds_read_b64_tr_b16 v[128:129], v160 offset:32768
    ds_read_b64_tr_b16 v[130:131], v160 offset:33280
    s_add_u32 s64, s64, 4096
    buffer_load_dwordx4 a[208:211], v1, s[16:19], s64 offen offset:0 sc1
    v_mfma_f32_32x32x16_bf16 v[80:95], v[132:135], a[152:155], v[80:95]
    ds_read_b64_tr_b16 v[132:133], v161 offset:32768
    ds_read_b64_tr_b16 v[134:135], v161 offset:33280
    buffer_load_dwordx4 a[212:215], v1, s[16:19], s64 offen offset:1024 sc1
    v_mfma_f32_32x32x16_bf16 v[96:111], v[136:139], a[152:155], v[96:111]
    ds_read_b64_tr_b16 v[136:137], v162 offset:32768
    ds_read_b64_tr_b16 v[138:139], v162 offset:33280
    v_mfma_f32_32x32x16_bf16 v[112:127], v[140:143], a[152:155], v[112:127]
    ds_read_b64_tr_b16 v[140:141], v163 offset:32768
    ds_read_b64_tr_b16 v[142:143], v163 offset:33280
    s_waitcnt vmcnt(15) lgkmcnt(8)
    v_mfma_f32_32x32x16_bf16 v[64:79], v[144:147], a[156:159], v[64:79]
    ds_read_b64_tr_b16 v[144:145], v160 offset:36864
    ds_read_b64_tr_b16 v[146:147], v160 offset:37376
    buffer_load_dwordx4 a[216:219], v1, s[16:19], s64 offen offset:2048 sc1
    v_mfma_f32_32x32x16_bf16 v[80:95], v[148:151], a[156:159], v[80:95]
    ds_read_b64_tr_b16 v[148:149], v161 offset:36864
    ds_read_b64_tr_b16 v[150:151], v161 offset:37376
    buffer_load_dwordx4 a[220:223], v1, s[16:19], s64 offen offset:3072 sc1
    v_mfma_f32_32x32x16_bf16 v[96:111], v[152:155], a[156:159], v[96:111]
    ds_read_b64_tr_b16 v[152:153], v162 offset:36864
    ds_read_b64_tr_b16 v[154:155], v162 offset:37376
    v_mfma_f32_32x32x16_bf16 v[112:127], v[156:159], a[156:159], v[112:127]
    ds_read_b64_tr_b16 v[156:157], v163 offset:36864
    ds_read_b64_tr_b16 v[158:159], v163 offset:37376
    s_waitcnt vmcnt(15) lgkmcnt(8)
    v_mfma_f32_32x32x16_bf16 v[64:79], v[128:131], a[160:163], v[64:79]
    ds_read_b64_tr_b16 v[128:129], v160 offset:40960
    ds_read_b64_tr_b16 v[130:131], v160 offset:41472
    s_add_u32 s64, s64, 4096
    buffer_load_dwordx4 v[188:191], v1, s[16:19], s64 offen offset:0 sc1
    v_mfma_f32_32x32x16_bf16 v[80:95], v[132:135], a[160:163], v[80:95]
    ds_read_b64_tr_b16 v[132:133], v161 offset:40960
    ds_read_b64_tr_b16 v[134:135], v161 offset:41472
    buffer_load_dwordx4 v[192:195], v1, s[16:19], s64 offen offset:1024 sc1
    v_mfma_f32_32x32x16_bf16 v[96:111], v[136:139], a[160:163], v[96:111]
    ds_read_b64_tr_b16 v[136:137], v162 offset:40960
    ds_read_b64_tr_b16 v[138:139], v162 offset:41472
    v_mfma_f32_32x32x16_bf16 v[112:127], v[140:143], a[160:163], v[112:127]
    ds_read_b64_tr_b16 v[140:141], v163 offset:40960
    ds_read_b64_tr_b16 v[142:143], v163 offset:41472
    s_waitcnt vmcnt(16) lgkmcnt(8)
    v_mfma_f32_32x32x16_bf16 v[64:79], v[144:147], a[164:167], v[64:79]
    ds_read_b64_tr_b16 v[144:145], v160 offset:45056
    ds_read_b64_tr_b16 v[146:147], v160 offset:45568
    buffer_load_dwordx4 v[196:199], v1, s[16:19], s64 offen offset:2048 sc1
    v_mfma_f32_32x32x16_bf16 v[80:95], v[148:151], a[164:167], v[80:95]
    ds_read_b64_tr_b16 v[148:149], v161 offset:45056
    ds_read_b64_tr_b16 v[150:151], v161 offset:45568
    buffer_load_dwordx4 v[200:203], v1, s[16:19], s64 offen offset:3072 sc1
    v_mfma_f32_32x32x16_bf16 v[96:111], v[152:155], a[164:167], v[96:111]
    ds_read_b64_tr_b16 v[152:153], v162 offset:45056
    ds_read_b64_tr_b16 v[154:155], v162 offset:45568
    v_mfma_f32_32x32x16_bf16 v[112:127], v[156:159], a[164:167], v[112:127]
    ds_read_b64_tr_b16 v[156:157], v163 offset:45056
    ds_read_b64_tr_b16 v[158:159], v163 offset:45568
    buffer_load_dword v184, v21, s[16:19], s53 offen sc1
    s_waitcnt vmcnt(18) lgkmcnt(8)
    v_mfma_f32_32x32x16_bf16 v[64:79], v[128:131], a[168:171], v[64:79]
    ds_read_b64_tr_b16 v[128:129], v160 offset:49152
    ds_read_b64_tr_b16 v[130:131], v160 offset:49664
    s_add_u32 s64, s64, 4096
    buffer_load_dwordx4 v[204:207], v1, s[16:19], s64 offen offset:0 sc1
    v_mfma_f32_32x32x16_bf16 v[80:95], v[132:135], a[168:171], v[80:95]
    ds_read_b64_tr_b16 v[132:133], v161 offset:49152
    ds_read_b64_tr_b16 v[134:135], v161 offset:49664
    buffer_load_dwordx4 v[208:211], v1, s[16:19], s64 offen offset:1024 sc1
    v_mfma_f32_32x32x16_bf16 v[96:111], v[136:139], a[168:171], v[96:111]
    ds_read_b64_tr_b16 v[136:137], v162 offset:49152
    ds_read_b64_tr_b16 v[138:139], v162 offset:49664
    s_add_u32 s73, s82, 0
    s_and_b32 s73, s73, 3
    s_mul_i32 s73, s73, 114688
    s_add_u32 s73, s73, s67
    s_lshl_b32 s70, s83, 4
    s_add_u32 s73, s73, s70
    s_add_u32 s70, s73, 0
    buffer_load_dwordx4 a[0:3], v255, s[40:43], s70 offen
    v_mfma_f32_32x32x16_bf16 v[112:127], v[140:143], a[168:171], v[112:127]
    ds_read_b64_tr_b16 v[140:141], v163 offset:49152
    ds_read_b64_tr_b16 v[142:143], v163 offset:49664
    s_waitcnt vmcnt(20) lgkmcnt(8)
    v_mfma_f32_32x32x16_bf16 v[64:79], v[144:147], a[172:175], v[64:79]
    ds_read_b64_tr_b16 v[144:145], v160 offset:53248
    ds_read_b64_tr_b16 v[146:147], v160 offset:53760
    buffer_load_dwordx4 v[212:215], v1, s[16:19], s64 offen offset:2048 sc1
    v_mfma_f32_32x32x16_bf16 v[80:95], v[148:151], a[172:175], v[80:95]
    ds_read_b64_tr_b16 v[148:149], v161 offset:53248
    ds_read_b64_tr_b16 v[150:151], v161 offset:53760
    buffer_load_dwordx4 v[216:219], v1, s[16:19], s64 offen offset:3072 sc1
    v_mfma_f32_32x32x16_bf16 v[96:111], v[152:155], a[172:175], v[96:111]
    ds_read_b64_tr_b16 v[152:153], v162 offset:53248
    ds_read_b64_tr_b16 v[154:155], v162 offset:53760
    s_add_u32 s70, s73, 8192
    buffer_load_dwordx4 a[4:7], v255, s[40:43], s70 offen
    v_mfma_f32_32x32x16_bf16 v[112:127], v[156:159], a[172:175], v[112:127]
    ds_read_b64_tr_b16 v[156:157], v163 offset:53248
    ds_read_b64_tr_b16 v[158:159], v163 offset:53760
    s_waitcnt vmcnt(22) lgkmcnt(8)
    v_mfma_f32_32x32x16_bf16 v[64:79], v[128:131], a[176:179], v[64:79]
    ds_read_b64_tr_b16 v[128:129], v160 offset:57344
    ds_read_b64_tr_b16 v[130:131], v160 offset:57856
    v_mfma_f32_32x32x16_bf16 v[80:95], v[132:135], a[176:179], v[80:95]
    ds_read_b64_tr_b16 v[132:133], v161 offset:57344
    ds_read_b64_tr_b16 v[134:135], v161 offset:57856
    v_mfma_f32_32x32x16_bf16 v[96:111], v[136:139], a[176:179], v[96:111]
    ds_read_b64_tr_b16 v[136:137], v162 offset:57344
    ds_read_b64_tr_b16 v[138:139], v162 offset:57856
    s_add_u32 s70, s73, 16384
    buffer_load_dwordx4 a[8:11], v255, s[40:43], s70 offen
    v_mfma_f32_32x32x16_bf16 v[112:127], v[140:143], a[176:179], v[112:127]
    ds_read_b64_tr_b16 v[140:141], v163 offset:57344
    ds_read_b64_tr_b16 v[142:143], v163 offset:57856
    s_waitcnt vmcnt(22) lgkmcnt(8)
    v_mfma_f32_32x32x16_bf16 v[64:79], v[144:147], a[180:183], v[64:79]
    ds_read_b64_tr_b16 v[144:145], v160 offset:61440
    ds_read_b64_tr_b16 v[146:147], v160 offset:61952
    v_mfma_f32_32x32x16_bf16 v[80:95], v[148:151], a[180:183], v[80:95]
    ds_read_b64_tr_b16 v[148:149], v161 offset:61440
    ds_read_b64_tr_b16 v[150:151], v161 offset:61952
    v_mfma_f32_32x32x16_bf16 v[96:111], v[152:155], a[180:183], v[96:111]
    ds_read_b64_tr_b16 v[152:153], v162 offset:61440
    ds_read_b64_tr_b16 v[154:155], v162 offset:61952
    s_add_u32 s70, s73, 24576
    buffer_load_dwordx4 a[12:15], v255, s[40:43], s70 offen
    v_mfma_f32_32x32x16_bf16 v[112:127], v[156:159], a[180:183], v[112:127]
    ds_read_b64_tr_b16 v[156:157], v163 offset:61440
    ds_read_b64_tr_b16 v[158:159], v163 offset:61952
    s_waitcnt vmcnt(22) lgkmcnt(8)
    v_mfma_f32_32x32x16_bf16 v[64:79], v[128:131], a[184:187], v[64:79]
    v_add_u32 v160, 0x10000, v160
    ds_read_b64_tr_b16 v[128:129], v160 offset:0
    ds_read_b64_tr_b16 v[130:131], v160 offset:512
    v_mfma_f32_32x32x16_bf16 v[80:95], v[132:135], a[184:187], v[80:95]
    v_add_u32 v161, 0x10000, v161
    ds_read_b64_tr_b16 v[132:133], v161 offset:0
    ds_read_b64_tr_b16 v[134:135], v161 offset:512
    v_add_f32 v164, v164, v165
    v_add_f32 v166, v166, v167
    v_mfma_f32_32x32x16_bf16 v[96:111], v[136:139], a[184:187], v[96:111]
    v_add_u32 v162, 0x10000, v162
    ds_read_b64_tr_b16 v[136:137], v162 offset:0
    ds_read_b64_tr_b16 v[138:139], v162 offset:512
    s_add_u32 s70, s73, 32768
    buffer_load_dwordx4 a[16:19], v255, s[40:43], s70 offen
    v_mfma_f32_32x32x16_bf16 v[112:127], v[140:143], a[184:187], v[112:127]
    v_add_u32 v163, 0x10000, v163
    ds_read_b64_tr_b16 v[140:141], v163 offset:0
    ds_read_b64_tr_b16 v[142:143], v163 offset:512
    s_waitcnt vmcnt(22) lgkmcnt(8)
    v_mfma_f32_32x32x16_bf16 v[64:79], v[144:147], a[188:191], v[64:79]
    ds_read_b64_tr_b16 v[144:145], v160 offset:4096
    ds_read_b64_tr_b16 v[146:147], v160 offset:4608
    v_mfma_f32_32x32x16_bf16 v[80:95], v[148:151], a[188:191], v[80:95]
    ds_read_b64_tr_b16 v[148:149], v161 offset:4096
    ds_read_b64_tr_b16 v[150:151], v161 offset:4608
    v_add_f32 v168, v168, v169
    v_add_f32 v170, v170, v171
    v_mfma_f32_32x32x16_bf16 v[96:111], v[152:155], a[188:191], v[96:111]
    ds_read_b64_tr_b16 v[152:153], v162 offset:4096
    ds_read_b64_tr_b16 v[154:155], v162 offset:4608
    s_add_u32 s70, s73, 40960
    buffer_load_dwordx4 a[20:23], v255, s[40:43], s70 offen
    v_mfma_f32_32x32x16_bf16 v[112:127], v[156:159], a[188:191], v[112:127]
    ds_read_b64_tr_b16 v[156:157], v163 offset:4096
    ds_read_b64_tr_b16 v[158:159], v163 offset:4608
    s_waitcnt vmcnt(22) lgkmcnt(8)
    v_mfma_f32_32x32x16_bf16 v[64:79], v[128:131], a[192:195], v[64:79]
    ds_read_b64_tr_b16 v[128:129], v160 offset:8192
    ds_read_b64_tr_b16 v[130:131], v160 offset:8704
    s_waitcnt vmcnt(10)
    v_cmp_gt_u32 vcc, 7, v184
    s_nop 1
    s_cbranch_vccnz L_poll_54
L_ok_55:
    s_cmp_lg_u32 s50, 0
    s_cbranch_scc1 L_acq_56
L_acr_57:
    s_mov_b32 s64, s60
    buffer_load_dwordx4 v[220:223], v1, s[16:19], s64 offen offset:0 sc1
    v_mfma_f32_32x32x16_bf16 v[80:95], v[132:135], a[192:195], v[80:95]
    ds_read_b64_tr_b16 v[132:133], v161 offset:8192
    ds_read_b64_tr_b16 v[134:135], v161 offset:8704
    v_add_f32 v164, v164, v166
    v_add_f32 v168, v168, v170
    v_mfma_f32_32x32x16_bf16 v[96:111], v[136:139], a[192:195], v[96:111]
    ds_read_b64_tr_b16 v[136:137], v162 offset:8192
    ds_read_b64_tr_b16 v[138:139], v162 offset:8704
    s_add_u32 s70, s73, 49152
    buffer_load_dwordx4 a[24:27], v255, s[40:43], s70 offen
    v_mfma_f32_32x32x16_bf16 v[112:127], v[140:143], a[192:195], v[112:127]
    ds_read_b64_tr_b16 v[140:141], v163 offset:8192
    ds_read_b64_tr_b16 v[142:143], v163 offset:8704
    s_waitcnt lgkmcnt(8)
    v_mfma_f32_32x32x16_bf16 v[64:79], v[144:147], a[196:199], v[64:79]
    ds_read_b64_tr_b16 v[144:145], v160 offset:12288
    ds_read_b64_tr_b16 v[146:147], v160 offset:12800
    buffer_load_dwordx4 v[224:227], v1, s[16:19], s64 offen offset:1024 sc1
    v_mfma_f32_32x32x16_bf16 v[80:95], v[148:151], a[196:199], v[80:95]
    ds_read_b64_tr_b16 v[148:149], v161 offset:12288
    ds_read_b64_tr_b16 v[150:151], v161 offset:12800
    v_add_f32 v164, v164, v168
    v_mov_b32 v165, v164
    v_mfma_f32_32x32x16_bf16 v[96:111], v[152:155], a[196:199], v[96:111]
    ds_read_b64_tr_b16 v[152:153], v162 offset:12288
    ds_read_b64_tr_b16 v[154:155], v162 offset:12800
    s_add_u32 s70, s73, 57344
    buffer_load_dwordx4 a[28:31], v255, s[40:43], s70 offen
    v_mfma_f32_32x32x16_bf16 v[112:127], v[156:159], a[196:199], v[112:127]
    ds_read_b64_tr_b16 v[156:157], v163 offset:12288
    ds_read_b64_tr_b16 v[158:159], v163 offset:12800
    s_waitcnt lgkmcnt(8)
    v_mfma_f32_32x32x16_bf16 v[64:79], v[128:131], a[200:203], v[64:79]
    ds_read_b64_tr_b16 v[128:129], v160 offset:16384
    ds_read_b64_tr_b16 v[130:131], v160 offset:16896
    buffer_load_dwordx4 v[228:231], v1, s[16:19], s64 offen offset:2048 sc1
    v_mfma_f32_32x32x16_bf16 v[80:95], v[132:135], a[200:203], v[80:95]
    ds_read_b64_tr_b16 v[132:133], v161 offset:16384
    ds_read_b64_tr_b16 v[134:135], v161 offset:16896
    v_permlane32_swap_b32 v164, v165
    v_mul_f32 v164, 0x3b000000, v164
    v_mfma_f32_32x32x16_bf16 v[96:111], v[136:139], a[200:203], v[96:111]
    ds_read_b64_tr_b16 v[136:137], v162 offset:16384
    ds_read_b64_tr_b16 v[138:139], v162 offset:16896
    s_add_u32 s73, s73, 65536
    s_sub_u32 s70, s73, s67
    s_cmp_eq_u32 s70, 458752
    s_cmov_b32 s73, s67
    s_add_u32 s70, s73, 0
    buffer_load_dwordx4 a[32:35], v255, s[40:43], s70 offen
    v_mfma_f32_32x32x16_bf16 v[112:127], v[140:143], a[200:203], v[112:127]
    ds_read_b64_tr_b16 v[140:141], v163 offset:16384
    ds_read_b64_tr_b16 v[142:143], v163 offset:16896
    s_waitcnt lgkmcnt(8)
    v_mfma_f32_32x32x16_bf16 v[64:79], v[144:147], a[204:207], v[64:79]
    ds_read_b64_tr_b16 v[144:145], v160 offset:20480
    ds_read_b64_tr_b16 v[146:147], v160 offset:20992
    buffer_load_dwordx4 v[232:235], v1, s[16:19], s64 offen offset:3072 sc1
    v_mfma_f32_32x32x16_bf16 v[80:95], v[148:151], a[204:207], v[80:95]
    ds_read_b64_tr_b16 v[148:149], v161 offset:20480
    ds_read_b64_tr_b16 v[150:151], v161 offset:20992
    v_cvt_pk_bf16_f32 v180, -v164, -v164
    v_mov_b32 v181, v180
    v_mfma_f32_32x32x16_bf16 v[96:111], v[152:155], a[204:207], v[96:111]
    ds_read_b64_tr_b16 v[152:153], v162 offset:20480
    ds_read_b64_tr_b16 v[154:155], v162 offset:20992
    s_add_u32 s70, s73, 8192
    buffer_load_dwordx4 a[36:39], v255, s[40:43], s70 offen
    v_mfma_f32_32x32x16_bf16 v[112:127], v[156:159], a[204:207], v[112:127]
    ds_read_b64_tr_b16 v[156:157], v163 offset:20480
    ds_read_b64_tr_b16 v[158:159], v163 offset:20992
    s_waitcnt lgkmcnt(8)
    v_mfma_f32_32x32x16_bf16 v[64:79], v[128:131], a[208:211], v[64:79]
    ds_read_b64_tr_b16 v[128:129], v160 offset:24576
    ds_read_b64_tr_b16 v[130:131], v160 offset:25088
    s_add_u32 s64, s64, 4096
    buffer_load_dwordx4 v[236:239], v1, s[16:19], s64 offen offset:0 sc1
    v_mfma_f32_32x32x16_bf16 v[80:95], v[132:135], a[208:211], v[80:95]
    ds_read_b64_tr_b16 v[132:133], v161 offset:24576
    ds_read_b64_tr_b16 v[134:135], v161 offset:25088
    v_mov_b32 v182, v180
    v_mov_b32 v183, v180
    v_mov_b32 v173, 0
    v_mov_b32 v174, 0
    v_mfma_f32_32x32x16_bf16 v[96:111], v[136:139], a[208:211], v[96:111]
    ds_read_b64_tr_b16 v[136:137], v162 offset:24576
    ds_read_b64_tr_b16 v[138:139], v162 offset:25088
    s_add_u32 s70, s73, 16384
    buffer_load_dwordx4 a[40:43], v255, s[40:43], s70 offen
    v_mfma_f32_32x32x16_bf16 v[112:127], v[140:143], a[208:211], v[112:127]
    ds_read_b64_tr_b16 v[140:141], v163 offset:24576
    ds_read_b64_tr_b16 v[142:143], v163 offset:25088
    s_waitcnt lgkmcnt(8)
    v_mfma_f32_32x32x16_bf16 v[64:79], v[144:147], a[212:215], v[64:79]
    ds_read_b64_tr_b16 v[144:145], v160 offset:28672
    ds_read_b64_tr_b16 v[146:147], v160 offset:29184
    buffer_load_dwordx4 v[240:243], v1, s[16:19], s64 offen offset:1024 sc1
    v_mfma_f32_32x32x16_bf16 v[80:95], v[148:151], a[212:215], v[80:95]
    ds_read_b64_tr_b16 v[148:149], v161 offset:28672
    ds_read_b64_tr_b16 v[150:151], v161 offset:29184
    v_mov_b32 v175, 0
    v_mov_b32 v177, 0
    v_mfma_f32_32x32x16_bf16 v[96:111], v[152:155], a[212:215], v[96:111]
    ds_read_b64_tr_b16 v[152:153], v162 offset:28672
    ds_read_b64_tr_b16 v[154:155], v162 offset:29184
    s_add_u32 s70, s73, 24576
    buffer_load_dwordx4 a[44:47], v255, s[40:43], s70 offen
    v_mfma_f32_32x32x16_bf16 v[112:127], v[156:159], a[212:215], v[112:127]
    ds_read_b64_tr_b16 v[156:157], v163 offset:28672
    ds_read_b64_tr_b16 v[158:159], v163 offset:29184
    s_waitcnt lgkmcnt(8)
    v_mfma_f32_32x32x16_bf16 v[64:79], v[128:131], a[216:219], v[64:79]
    ds_read_b64_tr_b16 v[128:129], v160 offset:32768
    ds_read_b64_tr_b16 v[130:131], v160 offset:33280
    buffer_load_dwordx4 v[244:247], v1, s[16:19], s64 offen offset:2048 sc1
    v_mfma_f32_32x32x16_bf16 v[80:95], v[132:135], a[216:219], v[80:95]
    ds_read_b64_tr_b16 v[132:133], v161 offset:32768
    ds_read_b64_tr_b16 v[134:135], v161 offset:33280
    v_mov_b32 v178, 0
    v_mov_b32 v179, 0
    v_mfma_f32_32x32x16_bf16 v[96:111], v[136:139], a[216:219], v[96:111]
    ds_read_b64_tr_b16 v[136:137], v162 offset:32768
    ds_read_b64_tr_b16 v[138:139], v162 offset:33280
    s_add_u32 s70, s73, 32768
    buffer_load_dwordx4 a[48:51], v255, s[40:43], s70 offen
    v_mfma_f32_32x32x16_bf16 v[112:127], v[140:143], a[216:219], v[112:127]
    ds_read_b64_tr_b16 v[140:141], v163 offset:32768
    ds_read_b64_tr_b16 v[142:143], v163 offset:33280
    s_waitcnt lgkmcnt(8)
    v_mfma_f32_32x32x16_bf16 v[64:79], v[144:147], a[220:223], v[64:79]
    ds_read_b64_tr_b16 v[144:145], v160 offset:36864
    ds_read_b64_tr_b16 v[146:147], v160 offset:37376
    buffer_load_dwordx4 v[248:251], v1, s[16:19], s64 offen offset:3072 sc1
    v_mfma_f32_32x32x16_bf16 v[80:95], v[148:151], a[220:223], v[80:95]
    ds_read_b64_tr_b16 v[148:149], v161 offset:36864
    ds_read_b64_tr_b16 v[150:151], v161 offset:37376
    v_mfma_f32_32x32x16_bf16 v[96:111], v[152:155], a[220:223], v[96:111]
    ds_read_b64_tr_b16 v[152:153], v162 offset:36864
    ds_read_b64_tr_b16 v[154:155], v162 offset:37376
    s_add_u32 s70, s73, 40960
    buffer_load_dwordx4 a[52:55], v255, s[40:43], s70 offen
    v_mfma_f32_32x32x16_bf16 v[112:127], v[156:159], a[220:223], v[112:127]
    ds_read_b64_tr_b16 v[156:157], v163 offset:36864
    ds_read_b64_tr_b16 v[158:159], v163 offset:37376
    v_lshlrev_b32 v253, 2, v0
    v_add_u32 v253, 135168, v253
    s_waitcnt lgkmcnt(0)
    s_barrier
    ds_read_b32 v24, v253 offset:0
    ds_read_b32 v25, v253 offset:8192
    ds_read_b32 v26, v253 offset:16384
    ds_read_b32 v27, v253 offset:24576
    v_mfma_f32_32x32x16_bf16 v[64:79], v[128:131], v[188:191], v[64:79]
    ds_read_b64_tr_b16 v[128:129], v160 offset:40960
    ds_read_b64_tr_b16 v[130:131], v160 offset:41472
    s_add_u32 s64, s64, 4096
    buffer_load_dwordx4 a[192:195], v1, s[16:19], s64 offen offset:0 sc1
    v_mfma_f32_32x32x16_bf16 v[80:95], v[132:135], v[188:191], v[80:95]
    ds_read_b64_tr_b16 v[132:133], v161 offset:40960
    ds_read_b64_tr_b16 v[134:135], v161 offset:41472
    v_mfma_f32_32x32x16_bf16 v[96:111], v[136:139], v[188:191], v[96:111]
    ds_read_b64_tr_b16 v[136:137], v162 offset:40960
    ds_read_b64_tr_b16 v[138:139], v162 offset:41472
    s_add_u32 s73, s73, 49152
    s_sub_u32 s70, s73, s67
    s_cmp_eq_u32 s70, 458752
    s_cmov_b32 s73, s67
    s_add_u32 s70, s73, 0
    buffer_load_dwordx4 a[56:59], v255, s[40:43], s70 offen
    v_mfma_f32_32x32x16_bf16 v[112:127], v[140:143], v[188:191], v[112:127]
    ds_read_b64_tr_b16 v[140:141], v163 offset:40960
    ds_read_b64_tr_b16 v[142:143], v163 offset:41472
    v_mfma_f32_32x32x16_bf16 v[64:79], v[144:147], v[192:195], v[64:79]
    ds_read_b64_tr_b16 v[144:145], v160 offset:45056
    ds_read_b64_tr_b16 v[146:147], v160 offset:45568
    buffer_load_dwordx4 a[196:199], v1, s[16:19], s64 offen offset:1024 sc1
    v_mfma_f32_32x32x16_bf16 v[80:95], v[148:151], v[192:195], v[80:95]
    ds_read_b64_tr_b16 v[148:149], v161 offset:45056
    ds_read_b64_tr_b16 v[150:151], v161 offset:45568
    v_mfma_f32_32x32x16_bf16 v[96:111], v[152:155], v[192:195], v[96:111]
    ds_read_b64_tr_b16 v[152:153], v162 offset:45056
    ds_read_b64_tr_b16 v[154:155], v162 offset:45568
    s_add_u32 s70, s73, 8192
    buffer_load_dwordx4 a[60:63], v255, s[40:43], s70 offen
    v_mfma_f32_32x32x16_bf16 v[112:127], v[156:159], v[192:195], v[112:127]
    ds_read_b64_tr_b16 v[156:157], v163 offset:45056
    ds_read_b64_tr_b16 v[158:159], v163 offset:45568
    s_waitcnt lgkmcnt(8)
    v_mfma_f32_32x32x16_bf16 v[64:79], v[128:131], v[196:199], v[64:79]
    ds_read_b64_tr_b16 v[128:129], v160 offset:49152
    ds_read_b64_tr_b16 v[130:131], v160 offset:49664
    buffer_load_dwordx4 a[200:203], v1, s[16:19], s64 offen offset:2048 sc1
    v_mfma_f32_32x32x16_bf16 v[80:95], v[132:135], v[196:199], v[80:95]
    ds_read_b64_tr_b16 v[132:133], v161 offset:49152
    ds_read_b64_tr_b16 v[134:135], v161 offset:49664
    v_mfma_f32_32x32x16_bf16 v[96:111], v[136:139], v[196:199], v[96:111]
    ds_read_b64_tr_b16 v[136:137], v162 offset:49152
    ds_read_b64_tr_b16 v[138:139], v162 offset:49664
    s_add_u32 s70, s73, 16384
    buffer_load_dwordx4 a[64:67], v255, s[40:43], s70 offen
    v_mfma_f32_32x32x16_bf16 v[112:127], v[140:143], v[196:199], v[112:127]
    ds_read_b64_tr_b16 v[140:141], v163 offset:49152
    ds_read_b64_tr_b16 v[142:143], v163 offset:49664
    s_waitcnt lgkmcnt(8)
    v_mfma_f32_32x32x16_bf16 v[64:79], v[144:147], v[200:203], v[64:79]
    ds_read_b64_tr_b16 v[144:145], v160 offset:53248
    ds_read_b64_tr_b16 v[146:147], v160 offset:53760
    buffer_load_dwordx4 a[204:207], v1, s[16:19], s64 offen offset:3072 sc1
    v_mfma_f32_32x32x16_bf16 v[80:95], v[148:151], v[200:203], v[80:95]
    ds_read_b64_tr_b16 v[148:149], v160 offset:57344
    ds_read_b64_tr_b16 v[150:151], v160 offset:57856
    v_mfma_f32_32x32x16_bf16 v[96:111], v[152:155], v[200:203], v[96:111]
    ds_read_b64_tr_b16 v[152:153], v160 offset:61440
    ds_read_b64_tr_b16 v[154:155], v160 offset:61952
    s_add_u32 s70, s73, 24576
    buffer_load_dwordx4 a[68:71], v255, s[40:43], s70 offen
    v_mfma_f32_32x32x16_bf16 v[112:127], v[156:159], v[200:203], v[112:127]
    ds_read_b64_tr_b16 v[156:157], v161 offset:53248
    ds_read_b64_tr_b16 v[158:159], v161 offset:53760
    s_waitcnt vmcnt(31)
    ds_write_b128 v14, a[0:3]
    s_add_u32 s88, s60, 149504
    buffer_load_dwordx4 v[164:167], v19, s[16:19], s88 offen sc1
    buffer_load_dwordx4 v[168:171], v19, s[16:19], s88 offen offset:16 sc1
    s_add_u32 s87, s57, s59
    s_add_u32 s89, s57, s60
    s_waitcnt lgkmcnt(9)
    v_mfma_f32_32x32x16_bf16 v[64:79], v[128:131], v[204:207], v[64:79]
    ds_read_b64_tr_b16 v[128:129], v161 offset:57344
    ds_read_b64_tr_b16 v[130:131], v161 offset:57856
    s_add_u32 s64, s64, 4096
    buffer_load_dwordx4 a[208:211], v1, s[16:19], s64 offen offset:0 sc1
    s_waitcnt vmcnt(31)
    ds_write_b128 v14, a[4:7] offset:1024
    v_mfma_f32_32x32x16_bf16 v[80:95], v[132:135], v[204:207], v[80:95]
    ds_read_b64_tr_b16 v[132:133], v161 offset:61440
    ds_read_b64_tr_b16 v[134:135], v161 offset:61952
    ds_read_b64_tr_b16 a[0:1], v186
    ds_read_b64_tr_b16 a[2:3], v186 offset:1024
    v_mfma_f32_32x32x16_bf16 v[96:111], v[136:139], v[204:207], v[96:111]
    ds_read_b64_tr_b16 v[136:137], v162 offset:53248
    ds_read_b64_tr_b16 v[138:139], v162 offset:53760
    s_add_u32 s70, s73, 32768
    buffer_load_dwordx4 a[72:75], v255, s[40:43], s70 offen
    s_add_u32 s70, s73, 40960
    buffer_load_dwordx4 a[76:79], v255, s[40:43], s70 offen
    v_mfma_f32_32x32x16_bf16 v[112:127], v[140:143], v[204:207], v[112:127]
    ds_read_b64_tr_b16 v[140:141], v162 offset:57344
    ds_read_b64_tr_b16 v[142:143], v162 offset:57856
    ds_read_b64_tr_b16 a[4:5], v187
    ds_read_b64_tr_b16 a[6:7], v187 offset:1024
    s_waitcnt lgkmcnt(15)
    v_mfma_f32_32x32x16_bf16 v[64:79], v[144:147], v[208:211], v[64:79]
    ds_read_b64_tr_b16 v[144:145], v162 offset:61440
    ds_read_b64_tr_b16 v[146:147], v162 offset:61952
    buffer_load_dwordx4 a[212:215], v1, s[16:19], s64 offen offset:1024 sc1
    v_mfma_f32_32x32x16_bf16 v[64:79], v[148:151], v[212:215], v[64:79]
    ds_read_b64_tr_b16 v[148:149], v163 offset:53248
    ds_read_b64_tr_b16 v[150:151], v163 offset:53760
    v_mov_b32 v172, v24
    v_mfma_f32_32x32x16_bf16 v[64:79], v[152:155], v[216:219], v[64:79]
    ds_read_b64_tr_b16 v[152:153], v163 offset:57344
    ds_read_b64_tr_b16 v[154:155], v163 offset:57856
    s_add_u32 s70, s73, 49152
    buffer_load_dwordx4 a[80:83], v255, s[40:43], s70 offen
    s_add_u32 s70, s73, 57344
    buffer_load_dwordx4 a[84:87], v255, s[40:43], s70 offen
    v_mfma_f32_32x32x16_bf16 v[64:79], v[172:175], v[180:183], v[64:79]
    s_waitcnt vmcnt(35)
    ds_write_b128 v14, a[8:11]
    s_waitcnt lgkmcnt(15)
    v_mfma_f32_32x32x16_bf16 v[80:95], v[156:159], v[208:211], v[80:95]
    ds_read_b64_tr_b16 v[156:157], v163 offset:61440
    ds_read_b64_tr_b16 v[158:159], v163 offset:61952
    buffer_load_dwordx4 a[216:219], v1, s[16:19], s64 offen offset:2048 sc1
    s_waitcnt vmcnt(35)
    ds_write_b128 v14, a[12:15] offset:1024
    v_mfma_f32_32x32x16_bf16 v[80:95], v[128:131], v[212:215], v[80:95]
    v_subrev_u32 v160, 0x10000, v160
    ds_read_b64_tr_b16 v[128:129], v160 offset:0
    ds_read_b64_tr_b16 v[130:131], v160 offset:512
    v_mov_b32 v176, v25
    ds_read_b64_tr_b16 a[8:9], v186
    ds_read_b64_tr_b16 a[10:11], v186 offset:1024
    v_max_f32 v64, 0, v64
    v_max_f32 v65, 0, v65
    v_mfma_f32_32x32x16_bf16 v[80:95], v[132:135], v[216:219], v[80:95]
    ds_read_b64_tr_b16 v[132:133], v160 offset:4096
    ds_read_b64_tr_b16 v[134:135], v160 offset:4608
    s_add_u32 s73, s73, 65536
    s_sub_u32 s70, s73, s67
    s_cmp_eq_u32 s70, 458752
    s_cmov_b32 s73, s67
    s_add_u32 s70, s73, 0
    buffer_load_dwordx4 a[88:91], v255, s[40:43], s70 offen
    s_add_u32 s70, s73, 8192
    buffer_load_dwordx4 a[92:95], v255, s[40:43], s70 offen
    v_max_f32 v66, 0, v66
    v_mfma_f32_32x32x16_bf16 v[80:95], v[176:179], v[180:183], v[80:95]
    ds_read_b64_tr_b16 a[12:13], v187
    ds_read_b64_tr_b16 a[14:15], v187 offset:1024
    v_max_f32 v67, 0, v67
    v_max_f32 v68, 0, v68
    v_max_f32 v69, 0, v69
    v_max_f32 v70, 0, v70
    v_max_f32 v71, 0, v71
    s_waitcnt lgkmcnt(15)
    v_mfma_f32_32x32x16_bf16 v[96:111], v[136:139], v[208:211], v[96:111]
    ds_read_b64_tr_b16 v[136:137], v160 offset:8192
    ds_read_b64_tr_b16 v[138:139], v160 offset:8704
    buffer_load_dwordx4 a[220:223], v1, s[16:19], s64 offen offset:3072 sc1
    v_mul_f32 v64, v64, v72
    v_mul_f32 v65, v65, v73
    v_mul_f32 v66, v66, v74
    v_mul_f32 v67, v67, v75
    v_mfma_f32_32x32x16_bf16 v[96:111], v[140:143], v[212:215], v[96:111]
    ds_read_b64_tr_b16 v[140:141], v160 offset:12288
    ds_read_b64_tr_b16 v[142:143], v160 offset:12800
    v_mov_b32 v172, v26
    v_mul_f32 v68, v68, v76
    v_mul_f32 v69, v69, v77
    v_mul_f32 v70, v70, v78
    v_mul_f32 v71, v71, v79
    v_mfma_f32_32x32x16_bf16 v[96:111], v[144:147], v[216:219], v[96:111]
    v_subrev_u32 v161, 0x10000, v161
    ds_read_b64_tr_b16 v[144:145], v161 offset:0
    ds_read_b64_tr_b16 v[146:147], v161 offset:512
    s_add_u32 s70, s73, 16384
    buffer_load_dwordx4 a[96:99], v255, s[40:43], s70 offen
    s_add_u32 s70, s73, 24576
    buffer_load_dwordx4 a[100:103], v255, s[40:43], s70 offen
    v_cvt_pk_bf16_f32 v64, v64, v65
    v_mfma_f32_32x32x16_bf16 v[96:111], v[172:175], v[180:183], v[96:111]
    v_cvt_pk_bf16_f32 v65, v66, v67
    v_cvt_pk_bf16_f32 v66, v68, v69
    v_cvt_pk_bf16_f32 v67, v70, v71
    s_cmp_ge_u32 s45, 10
    s_cbranch_scc1 L_hs_58
    buffer_store_dwordx4 v[64:67], v1, s[16:19], s87 offen offset:0
L_hr_59:
    v_max_f32 v80, 0, v80
    v_max_f32 v81, 0, v81
    v_max_f32 v82, 0, v82
    s_waitcnt lgkmcnt(15)
    v_mfma_f32_32x32x16_bf16 v[112:127], v[148:151], v[208:211], v[112:127]
    ds_read_b64_tr_b16 v[148:149], v161 offset:4096
    ds_read_b64_tr_b16 v[150:151], v161 offset:4608
    v_max_f32 v83, 0, v83
    v_max_f32 v84, 0, v84
    v_max_f32 v85, 0, v85
    v_max_f32 v86, 0, v86
    v_max_f32 v87, 0, v87
    v_mfma_f32_32x32x16_bf16 v[112:127], v[152:155], v[212:215], v[112:127]
    ds_read_b64_tr_b16 v[152:153], v161 offset:8192
    ds_read_b64_tr_b16 v[154:155], v161 offset:8704
    v_mov_b32 v176, v27
    v_mul_f32 v80, v80, v88
    v_mul_f32 v81, v81, v89
    v_mul_f32 v82, v82, v90
    v_mul_f32 v83, v83, v91
    v_mfma_f32_32x32x16_bf16 v[112:127], v[156:159], v[216:219], v[112:127]
    ds_read_b64_tr_b16 v[156:157], v161 offset:12288
    ds_read_b64_tr_b16 v[158:159], v161 offset:12800
    v_mul_f32 v84, v84, v92
    v_mul_f32 v85, v85, v93
    v_mul_f32 v86, v86, v94
    v_mul_f32 v87, v87, v95
    v_cvt_pk_bf16_f32 v80, v80, v81
    v_mfma_f32_32x32x16_bf16 v[112:127], v[176:179], v[180:183], v[112:127]
    v_cvt_pk_bf16_f32 v81, v82, v83
    v_cvt_pk_bf16_f32 v82, v84, v85
    v_cvt_pk_bf16_f32 v83, v86, v87
    s_cmp_ge_u32 s45, 10
    s_cbranch_scc1 L_hs_60
    buffer_store_dwordx4 v[80:83], v1, s[16:19], s87 offen offset:1024
L_hr_61:
    v_max_f32 v96, 0, v96
    v_max_f32 v97, 0, v97
    v_max_f32 v98, 0, v98
    s_waitcnt vmcnt(35) lgkmcnt(10)
    v_mfma_f32_32x32x16_bf16 v[64:79], v[128:131], v[220:223], 0
    v_subrev_u32 v162, 0x10000, v162
    ds_read_b64_tr_b16 v[128:129], v162 offset:0
    ds_read_b64_tr_b16 v[130:131], v162 offset:512
    s_add_u32 s64, s64, 4096
    buffer_load_dwordx4 v[188:191], v1, s[16:19], s64 offen offset:0 sc1
    v_max_f32 v99, 0, v99
    v_max_f32 v100, 0, v100
    v_max_f32 v101, 0, v101
    v_max_f32 v102, 0, v102
    v_mfma_f32_32x32x16_bf16 v[64:79], v[132:135], v[224:227], v[64:79]
    ds_read_b64_tr_b16 v[132:133], v162 offset:4096
    ds_read_b64_tr_b16 v[134:135], v162 offset:4608
    v_max_f32 v103, 0, v103
    v_mul_f32 v96, v96, v104
    v_mul_f32 v97, v97, v105
    v_mul_f32 v98, v98, v106
    v_mul_f32 v99, v99, v107
    v_mfma_f32_32x32x16_bf16 v[64:79], v[136:139], v[228:231], v[64:79]
    ds_read_b64_tr_b16 v[136:137], v162 offset:8192
    ds_read_b64_tr_b16 v[138:139], v162 offset:8704
    s_add_u32 s70, s73, 32768
    buffer_load_dwordx4 a[104:107], v255, s[40:43], s70 offen
    v_mul_f32 v100, v100, v108
    v_mul_f32 v101, v101, v109
    v_mul_f32 v102, v102, v110
    s_waitcnt vmcnt(35) lgkmcnt(10)
    v_mfma_f32_32x32x16_bf16 v[64:79], v[140:143], v[232:235], v[64:79]
    ds_read_b64_tr_b16 v[140:141], v162 offset:12288
    ds_read_b64_tr_b16 v[142:143], v162 offset:12800
    buffer_load_dwordx4 v[192:195], v1, s[16:19], s64 offen offset:1024 sc1
    v_mul_f32 v103, v103, v111
    v_cvt_pk_bf16_f32 v96, v96, v97
    v_cvt_pk_bf16_f32 v97, v98, v99
    v_cvt_pk_bf16_f32 v98, v100, v101
    v_mfma_f32_32x32x16_bf16 v[80:95], v[144:147], v[220:223], 0
    ds_read_b64_tr_b16 v[144:145], v160 offset:16384
    ds_read_b64_tr_b16 v[146:147], v160 offset:16896
    v_cvt_pk_bf16_f32 v99, v102, v103
    s_cmp_ge_u32 s45, 10
    s_cbranch_scc1 L_hs_62
    buffer_store_dwordx4 v[96:99], v1, s[16:19], s87 offen offset:2048
L_hr_63:
    v_max_f32 v112, 0, v112
    v_max_f32 v113, 0, v113
    v_max_f32 v114, 0, v114
    v_mfma_f32_32x32x16_bf16 v[80:95], v[148:151], v[224:227], v[80:95]
    ds_read_b64_tr_b16 v[148:149], v161 offset:16384
    ds_read_b64_tr_b16 v[150:151], v161 offset:16896
    s_add_u32 s70, s73, 40960
    buffer_load_dwordx4 a[108:111], v255, s[40:43], s70 offen
    v_max_f32 v115, 0, v115
    v_max_f32 v116, 0, v116
    v_max_f32 v117, 0, v117
    s_waitcnt lgkmcnt(10)
    v_mfma_f32_32x32x16_bf16 v[80:95], v[152:155], v[228:231], v[80:95]
    ds_read_b64_tr_b16 v[152:153], v162 offset:16384
    ds_read_b64_tr_b16 v[154:155], v162 offset:16896
    buffer_load_dwordx4 v[196:199], v1, s[16:19], s64 offen offset:2048 sc1
    v_max_f32 v118, 0, v118
    v_max_f32 v119, 0, v119
    v_mul_f32 v112, v112, v120
    v_mul_f32 v113, v113, v121
    v_mfma_f32_32x32x16_bf16 v[80:95], v[156:159], v[232:235], v[80:95]
    ds_read_b64_tr_b16 v[156:157], v160 offset:20480
    ds_read_b64_tr_b16 v[158:159], v160 offset:20992
    v_mul_f32 v114, v114, v122
    v_mul_f32 v115, v115, v123
    v_mul_f32 v116, v116, v124
    v_mul_f32 v117, v117, v125
    v_mul_f32 v118, v118, v126
    v_mfma_f32_32x32x16_bf16 v[96:111], v[128:131], v[220:223], 0
    ds_read_b64_tr_b16 v[128:129], v161 offset:20480
    ds_read_b64_tr_b16 v[130:131], v161 offset:20992
    s_lshl1_add_u32 m0, s69, 135168
    s_add_u32 s73, s73, 49152
    s_sub_u32 s70, s73, s67
    s_cmp_eq_u32 s70, 458752
    s_cmov_b32 s73, s67
    s_add_u32 s70, s73, 0
    buffer_load_dwordx4 v255, s[40:43], s70 offen lds
    v_mul_f32 v119, v119, v127
    v_cvt_pk_bf16_f32 v112, v112, v113
    v_cvt_pk_bf16_f32 v113, v114, v115
    s_waitcnt lgkmcnt(10)
    v_mfma_f32_32x32x16_bf16 v[96:111], v[132:135], v[224:227], v[96:111]
    ds_read_b64_tr_b16 v[132:133], v162 offset:20480
    ds_read_b64_tr_b16 v[134:135], v162 offset:20992
    buffer_load_dwordx4 v[200:203], v1, s[16:19], s64 offen offset:3072 sc1
    v_cvt_pk_bf16_f32 v114, v116, v117
    v_cvt_pk_bf16_f32 v115, v118, v119
    s_cmp_ge_u32 s45, 10
    s_cbranch_scc1 L_hs_64
    buffer_store_dwordx4 v[112:115], v1, s[16:19], s87 offen offset:3072
L_hr_65:
    v_mfma_f32_32x32x16_bf16 v[96:111], v[136:139], v[228:231], v[96:111]
    ds_read_b64_tr_b16 v[136:137], v160 offset:24576
    ds_read_b64_tr_b16 v[138:139], v160 offset:25088
    v_mfma_f32_32x32x16_bf16 v[96:111], v[140:143], v[232:235], v[96:111]
    ds_read_b64_tr_b16 v[140:141], v161 offset:24576
    ds_read_b64_tr_b16 v[142:143], v161 offset:25088
    s_lshl1_add_u32 m0, s69, 136192
    s_add_u32 s70, s73, 8192
    buffer_load_dwordx4 v255, s[40:43], s70 offen lds
    s_waitcnt vmcnt(41) lgkmcnt(10)
    v_mfma_f32_32x32x16_bf16 v[64:79], v[144:147], v[236:239], v[64:79]
    ds_read_b64_tr_b16 v[144:145], v162 offset:24576
    ds_read_b64_tr_b16 v[146:147], v162 offset:25088
    s_add_u32 s64, s64, 4096
    buffer_load_dwordx4 v[204:207], v1, s[16:19], s64 offen offset:0 sc1
    v_mfma_f32_32x32x16_bf16 v[80:95], v[148:151], v[236:239], v[80:95]
    ds_read_b64_tr_b16 v[148:149], v160 offset:28672
    ds_read_b64_tr_b16 v[150:151], v160 offset:29184
    v_mfma_f32_32x32x16_bf16 v[96:111], v[152:155], v[236:239], v[96:111]
    ds_read_b64_tr_b16 v[152:153], v161 offset:28672
    ds_read_b64_tr_b16 v[154:155], v161 offset:29184
    s_lshl1_add_u32 m0, s69, 137216
    s_add_u32 s70, s73, 16384
    buffer_load_dwordx4 v255, s[40:43], s70 offen lds
    s_waitcnt vmcnt(41) lgkmcnt(10)
    v_mfma_f32_32x32x16_bf16 v[64:79], v[156:159], v[240:243], v[64:79]
    ds_read_b64_tr_b16 v[156:157], v162 offset:28672
    ds_read_b64_tr_b16 v[158:159], v162 offset:29184
    buffer_load_dwordx4 v[208:211], v1, s[16:19], s64 offen offset:1024 sc1
    v_mfma_f32_32x32x16_bf16 v[80:95], v[128:131], v[240:243], v[80:95]
    ds_read_b64_tr_b16 v[128:129], v160 offset:32768
    ds_read_b64_tr_b16 v[130:131], v160 offset:33280
    v_mfma_f32_32x32x16_bf16 v[96:111], v[132:135], v[240:243], v[96:111]
    ds_read_b64_tr_b16 v[132:133], v161 offset:32768
    ds_read_b64_tr_b16 v[134:135], v161 offset:33280
    s_lshl1_add_u32 m0, s69, 138240
    s_add_u32 s70, s73, 24576
    buffer_load_dwordx4 v255, s[40:43], s70 offen lds
    s_waitcnt vmcnt(41) lgkmcnt(10)
    v_mfma_f32_32x32x16_bf16 v[64:79], v[136:139], v[244:247], v[64:79]
    ds_read_b64_tr_b16 v[136:137], v162 offset:32768
    ds_read_b64_tr_b16 v[138:139], v162 offset:33280
    buffer_load_dwordx4 v[212:215], v1, s[16:19], s64 offen offset:2048 sc1
    v_mfma_f32_32x32x16_bf16 v[80:95], v[140:143], v[244:247], v[80:95]
    ds_read_b64_tr_b16 v[140:141], v160 offset:36864
    ds_read_b64_tr_b16 v[142:143], v160 offset:37376
    v_mfma_f32_32x32x16_bf16 v[96:111], v[144:147], v[244:247], v[96:111]
    ds_read_b64_tr_b16 v[144:145], v161 offset:36864
    ds_read_b64_tr_b16 v[146:147], v161 offset:37376
    s_lshl1_add_u32 m0, s69, 131072
    s_add_u32 s70, s73, 32768
    buffer_load_dwordx4 v255, s[40:43], s70 offen lds
    s_waitcnt vmcnt(41) lgkmcnt(10)
    v_mfma_f32_32x32x16_bf16 v[64:79], v[148:151], v[248:251], v[64:79]
    ds_read_b64_tr_b16 v[148:149], v162 offset:36864
    ds_read_b64_tr_b16 v[150:151], v162 offset:37376
    buffer_load_dwordx4 v[216:219], v1, s[16:19], s64 offen offset:3072 sc1
    v_mfma_f32_32x32x16_bf16 v[80:95], v[152:155], v[248:251], v[80:95]
    ds_read_b64_tr_b16 v[152:153], v160 offset:40960
    ds_read_b64_tr_b16 v[154:155], v160 offset:41472
    v_mfma_f32_32x32x16_bf16 v[96:111], v[156:159], v[248:251], v[96:111]
    ds_read_b64_tr_b16 v[156:157], v161 offset:40960
    ds_read_b64_tr_b16 v[158:159], v161 offset:41472
    s_lshl1_add_u32 m0, s69, 132096
    s_add_u32 s70, s73, 40960
    buffer_load_dwordx4 v255, s[40:43], s70 offen lds
    s_waitcnt vmcnt(41) lgkmcnt(10)
    v_mfma_f32_32x32x16_bf16 v[64:79], v[128:131], a[192:195], v[64:79]
    ds_read_b64_tr_b16 v[128:129], v162 offset:40960
    ds_read_b64_tr_b16 v[130:131], v162 offset:41472
    s_add_u32 s64, s64, 4096
    buffer_load_dwordx4 v[220:223], v1, s[16:19], s64 offen offset:0 sc1
    v_mfma_f32_32x32x16_bf16 v[80:95], v[132:135], a[192:195], v[80:95]
    ds_read_b64_tr_b16 v[132:133], v160 offset:45056
    ds_read_b64_tr_b16 v[134:135], v160 offset:45568
    v_mfma_f32_32x32x16_bf16 v[96:111], v[136:139], a[192:195], v[96:111]
    ds_read_b64_tr_b16 v[136:137], v161 offset:45056
    ds_read_b64_tr_b16 v[138:139], v161 offset:45568
    s_lshl1_add_u32 m0, s69, 133120
    s_add_u32 s70, s73, 49152
    buffer_load_dwordx4 v255, s[40:43], s70 offen lds
    v_mov_b32 v252, 8
    s_waitcnt vmcnt(11)
    s_mov_b64 exec, 1
    s_cmp_lg_u32 s50, 0
    s_cbranch_scc1 L_pub_66
    buffer_store_dword v252, off, s[16:19], s52
L_pur_67:
    s_mov_b64 exec, -1
    s_waitcnt lgkmcnt(10)
    v_mfma_f32_32x32x16_bf16 v[64:79], v[140:143], a[196:199], v[64:79]
    ds_read_b64_tr_b16 v[140:141], v162 offset:45056
    ds_read_b64_tr_b16 v[142:143], v162 offset:45568
    buffer_load_dwordx4 v[224:227], v1, s[16:19], s64 offen offset:1024 sc1
    v_mfma_f32_32x32x16_bf16 v[80:95], v[144:147], a[196:199], v[80:95]
    ds_read_b64_tr_b16 v[144:145], v160 offset:49152
    ds_read_b64_tr_b16 v[146:147], v160 offset:49664
    v_mfma_f32_32x32x16_bf16 v[96:111], v[148:151], a[196:199], v[96:111]
    ds_read_b64_tr_b16 v[148:149], v161 offset:49152
    ds_read_b64_tr_b16 v[150:151], v161 offset:49664
    s_waitcnt vmcnt(12)
    ds_read_b64_tr_b16 a[112:113], v186 offset:4096
    ds_read_b64_tr_b16 a[114:115], v186 offset:5120
    ds_read_b64_tr_b16 a[116:117], v187 offset:4096
    ds_read_b64_tr_b16 a[118:119], v187 offset:5120
    s_lshl1_add_u32 m0, s69, 134144
    s_add_u32 s70, s73, 57344
    buffer_load_dwordx4 v255, s[40:43], s70 offen lds
    s_waitcnt lgkmcnt(14)
    v_mfma_f32_32x32x16_bf16 v[64:79], v[152:155], a[200:203], v[64:79]
    ds_read_b64_tr_b16 v[152:153], v162 offset:49152
    ds_read_b64_tr_b16 v[154:155], v162 offset:49664
    buffer_load_dwordx4 v[228:231], v1, s[16:19], s64 offen offset:2048 sc1
    v_mfma_f32_32x32x16_bf16 v[80:95], v[156:159], a[200:203], v[80:95]
    ds_read_b64_tr_b16 v[156:157], v160 offset:53248
    ds_read_b64_tr_b16 v[158:159], v160 offset:53760
    v_mfma_f32_32x32x16_bf16 v[96:111], v[128:131], a[200:203], v[96:111]
    ds_read_b64_tr_b16 v[128:129], v161 offset:53248
    ds_read_b64_tr_b16 v[130:131], v161 offset:53760
    s_waitcnt lgkmcnt(6)
    s_lshl1_add_u32 m0, s69, 135168
    s_add_u32 s73, s73, 65536
    s_sub_u32 s70, s73, s67
    s_cmp_eq_u32 s70, 458752
    s_cmov_b32 s73, s67
    s_add_u32 s70, s73, 0
    buffer_load_dwordx4 v255, s[40:43], s70 offen lds
    v_mfma_f32_32x32x16_bf16 v[64:79], v[132:135], a[204:207], v[64:79]
    ds_read_b64_tr_b16 v[132:133], v162 offset:53248
    ds_read_b64_tr_b16 v[134:135], v162 offset:53760
    buffer_load_dwordx4 v[232:235], v1, s[16:19], s64 offen offset:3072 sc1
    v_mfma_f32_32x32x16_bf16 v[80:95], v[136:139], a[204:207], v[80:95]
    ds_read_b64_tr_b16 v[136:137], v160 offset:57344
    ds_read_b64_tr_b16 v[138:139], v160 offset:57856
    v_mfma_f32_32x32x16_bf16 v[96:111], v[140:143], a[204:207], v[96:111]
    ds_read_b64_tr_b16 v[140:141], v161 offset:57344
    ds_read_b64_tr_b16 v[142:143], v161 offset:57856
    s_lshl1_add_u32 m0, s69, 136192
    s_add_u32 s70, s73, 8192
    buffer_load_dwordx4 v255, s[40:43], s70 offen lds
    s_waitcnt lgkmcnt(10)
    v_mfma_f32_32x32x16_bf16 v[64:79], v[144:147], a[208:211], v[64:79]
    ds_read_b64_tr_b16 v[144:145], v162 offset:57344
    ds_read_b64_tr_b16 v[146:147], v162 offset:57856
    s_add_u32 s64, s64, 4096
    buffer_load_dwordx4 v[236:239], v1, s[16:19], s64 offen offset:0 sc1
    s_waitcnt vmcnt(14)
    ds_read_b64_tr_b16 a[120:121], v186 offset:6144
    ds_read_b64_tr_b16 a[122:123], v186 offset:7168
    v_mfma_f32_32x32x16_bf16 v[80:95], v[148:151], a[208:211], v[80:95]
    ds_read_b64_tr_b16 v[148:149], v160 offset:61440
    ds_read_b64_tr_b16 v[150:151], v160 offset:61952
    ds_read_b64_tr_b16 a[124:125], v187 offset:6144
    ds_read_b64_tr_b16 a[126:127], v187 offset:7168
    v_mfma_f32_32x32x16_bf16 v[96:111], v[152:155], a[208:211], v[96:111]
    ds_read_b64_tr_b16 v[152:153], v161 offset:61440
    ds_read_b64_tr_b16 v[154:155], v161 offset:61952
    s_waitcnt lgkmcnt(2)
    s_lshl1_add_u32 m0, s69, 137216
    s_add_u32 s70, s73, 16384
    buffer_load_dwordx4 v255, s[40:43], s70 offen lds
    v_mfma_f32_32x32x16_bf16 v[64:79], v[156:159], a[212:215], v[64:79]
    ds_read_b64_tr_b16 v[156:157], v162 offset:61440
    ds_read_b64_tr_b16 v[158:159], v162 offset:61952
    buffer_load_dwordx4 v[240:243], v1, s[16:19], s64 offen offset:1024 sc1
    v_mfma_f32_32x32x16_bf16 v[80:95], v[128:131], a[212:215], v[80:95]
    v_add_u32 v160, 0x10000, v160
    ds_read_b64_tr_b16 v[128:129], v160 offset:0
    ds_read_b64_tr_b16 v[130:131], v160 offset:512
    v_mfma_f32_32x32x16_bf16 v[96:111], v[132:135], a[212:215], v[96:111]
    v_add_u32 v161, 0x10000, v161
    ds_read_b64_tr_b16 v[132:133], v161 offset:0
    ds_read_b64_tr_b16 v[134:135], v161 offset:512
    s_lshl1_add_u32 m0, s69, 138240
    s_add_u32 s70, s73, 24576
    buffer_load_dwordx4 v255, s[40:43], s70 offen lds
    v_mfma_f32_32x32x16_bf16 v[64:79], v[136:139], a[216:219], v[64:79]
    v_add_u32 v162, 0x10000, v162
    ds_read_b64_tr_b16 v[136:137], v162 offset:0
    ds_read_b64_tr_b16 v[138:139], v162 offset:512
    buffer_load_dwordx4 v[244:247], v1, s[16:19], s64 offen offset:2048 sc1
    s_waitcnt vmcnt(14)
    ds_read_b64_tr_b16 a[128:129], v186 offset:0
    ds_read_b64_tr_b16 a[130:131], v186 offset:1024
    v_mfma_f32_32x32x16_bf16 v[80:95], v[140:143], a[216:219], v[80:95]
    ds_read_b64_tr_b16 v[140:141], v160 offset:4096
    ds_read_b64_tr_b16 v[142:143], v160 offset:4608
    v_add_f32 v164, v164, v165
    v_add_f32 v166, v166, v167
    ds_read_b64_tr_b16 a[132:133], v187 offset:0
    ds_read_b64_tr_b16 a[134:135], v187 offset:1024
    v_mfma_f32_32x32x16_bf16 v[96:111], v[144:147], a[216:219], v[96:111]
    ds_read_b64_tr_b16 v[144:145], v161 offset:4096
    ds_read_b64_tr_b16 v[146:147], v161 offset:4608
    s_waitcnt lgkmcnt(2)
    s_lshl1_add_u32 m0, s69, 131072
    s_add_u32 s70, s73, 32768
    buffer_load_dwordx4 v255, s[40:43], s70 offen lds
    buffer_load_dword v184, v22, s[16:19], s53 offen sc1
    v_mfma_f32_32x32x16_bf16 v[64:79], v[148:151], a[220:223], v[64:79]
    ds_read_b64_tr_b16 v[148:149], v162 offset:4096
    ds_read_b64_tr_b16 v[150:151], v162 offset:4608
    buffer_load_dwordx4 v[248:251], v1, s[16:19], s64 offen offset:3072 sc1
    v_mfma_f32_32x32x16_bf16 v[80:95], v[152:155], a[220:223], v[80:95]
    ds_read_b64_tr_b16 v[152:153], v160 offset:8192
    ds_read_b64_tr_b16 v[154:155], v160 offset:8704
    v_add_f32 v168, v168, v169
    v_add_f32 v170, v170, v171
    v_mfma_f32_32x32x16_bf16 v[96:111], v[156:159], a[220:223], v[96:111]
    ds_read_b64_tr_b16 v[156:157], v161 offset:8192
    ds_read_b64_tr_b16 v[158:159], v161 offset:8704
    s_lshl1_add_u32 m0, s69, 132096
    s_add_u32 s70, s73, 40960
    buffer_load_dwordx4 v255, s[40:43], s70 offen lds
    v_mfma_f32_32x32x16_bf16 v[64:79], v[128:131], v[188:191], v[64:79]
    ds_read_b64_tr_b16 v[128:129], v162 offset:8192
    ds_read_b64_tr_b16 v[130:131], v162 offset:8704
    s_waitcnt vmcnt(13)
    ds_read_b64_tr_b16 a[136:137], v186 offset:2048
    ds_read_b64_tr_b16 a[138:139], v186 offset:3072
    v_mfma_f32_32x32x16_bf16 v[80:95], v[132:135], v[188:191], v[80:95]
    ds_read_b64_tr_b16 v[132:133], v160 offset:12288
    ds_read_b64_tr_b16 v[134:135], v160 offset:12800
    v_add_f32 v164, v164, v166
    v_add_f32 v168, v168, v170
    ds_read_b64_tr_b16 a[140:141], v187 offset:2048
    ds_read_b64_tr_b16 a[142:143], v187 offset:3072
    v_mfma_f32_32x32x16_bf16 v[96:111], v[136:139], v[188:191], v[96:111]
    ds_read_b64_tr_b16 v[136:137], v161 offset:12288
    ds_read_b64_tr_b16 v[138:139], v161 offset:12800
    s_waitcnt lgkmcnt(2)
    s_lshl1_add_u32 m0, s69, 133120
    s_add_u32 s73, s73, 49152
    s_sub_u32 s70, s73, s67
    s_cmp_eq_u32 s70, 458752
    s_cmov_b32 s73, s67
    s_add_u32 s70, s73, 0
    buffer_load_dwordx4 v255, s[40:43], s70 offen lds
    v_mfma_f32_32x32x16_bf16 v[64:79], v[140:143], v[192:195], v[64:79]
    ds_read_b64_tr_b16 v[140:141], v162 offset:12288
    ds_read_b64_tr_b16 v[142:143], v162 offset:12800
    v_mfma_f32_32x32x16_bf16 v[80:95], v[144:147], v[192:195], v[80:95]
    ds_read_b64_tr_b16 v[144:145], v160 offset:16384
    ds_read_b64_tr_b16 v[146:147], v160 offset:16896
    v_add_f32 v164, v164, v168
    v_mov_b32 v165, v164
    v_mfma_f32_32x32x16_bf16 v[96:111], v[148:151], v[192:195], v[96:111]
    ds_read_b64_tr_b16 v[148:149], v161 offset:16384
    ds_read_b64_tr_b16 v[150:151], v161 offset:16896
    s_lshl1_add_u32 m0, s69, 134144
    s_add_u32 s70, s73, 8192
    buffer_load_dwordx4 v255, s[40:43], s70 offen lds
    v_mfma_f32_32x32x16_bf16 v[64:79], v[152:155], v[196:199], v[64:79]
    ds_read_b64_tr_b16 v[152:153], v162 offset:16384
    ds_read_b64_tr_b16 v[154:155], v162 offset:16896
    s_waitcnt vmcnt(11)
    ds_read_b64_tr_b16 a[144:145], v186 offset:4096
    ds_read_b64_tr_b16 a[146:147], v186 offset:5120
    v_mfma_f32_32x32x16_bf16 v[80:95], v[156:159], v[196:199], v[80:95]
    ds_read_b64_tr_b16 v[156:157], v160 offset:20480
    ds_read_b64_tr_b16 v[158:159], v160 offset:20992
    v_permlane32_swap_b32 v164, v165
    v_mul_f32 v164, 0x3b000000, v164
    ds_read_b64_tr_b16 a[148:149], v187 offset:4096
    ds_read_b64_tr_b16 a[150:151], v187 offset:5120
    v_mfma_f32_32x32x16_bf16 v[96:111], v[128:131], v[196:199], v[96:111]
    ds_read_b64_tr_b16 v[128:129], v161 offset:20480
    ds_read_b64_tr_b16 v[130:131], v161 offset:20992
    s_waitcnt lgkmcnt(2)
    s_lshl1_add_u32 m0, s69, 135168
    s_add_u32 s70, s73, 16384
    buffer_load_dwordx4 v255, s[40:43], s70 offen lds
    v_mfma_f32_32x32x16_bf16 v[64:79], v[132:135], v[200:203], v[64:79]
    ds_read_b64_tr_b16 v[132:133], v162 offset:20480
    ds_read_b64_tr_b16 v[134:135], v162 offset:20992
    v_mfma_f32_32x32x16_bf16 v[80:95], v[136:139], v[200:203], v[80:95]
    ds_read_b64_tr_b16 v[136:137], v160 offset:24576
    ds_read_b64_tr_b16 v[138:139], v160 offset:25088
    v_cvt_pk_bf16_f32 v180, -v164, -v164
    v_mov_b32 v181, v180
    v_mfma_f32_32x32x16_bf16 v[96:111], v[140:143], v[200:203], v[96:111]
    ds_read_b64_tr_b16 v[140:141], v161 offset:24576
    ds_read_b64_tr_b16 v[142:143], v161 offset:25088
    s_lshl1_add_u32 m0, s69, 136192
    s_add_u32 s70, s73, 24576
    buffer_load_dwordx4 v255, s[40:43], s70 offen lds
    v_mfma_f32_32x32x16_bf16 v[64:79], v[144:147], v[204:207], v[64:79]
    ds_read_b64_tr_b16 v[144:145], v162 offset:24576
    ds_read_b64_tr_b16 v[146:147], v162 offset:25088
    s_waitcnt vmcnt(9)
    ds_read_b64_tr_b16 a[152:153], v186 offset:6144
    ds_read_b64_tr_b16 a[154:155], v186 offset:7168
    v_mfma_f32_32x32x16_bf16 v[80:95], v[148:151], v[204:207], v[80:95]
    ds_read_b64_tr_b16 v[148:149], v160 offset:28672
    ds_read_b64_tr_b16 v[150:151], v160 offset:29184
    v_mov_b32 v182, v180
    v_mov_b32 v183, v180
    ds_read_b64_tr_b16 a[156:157], v187 offset:6144
    ds_read_b64_tr_b16 a[158:159], v187 offset:7168
    v_mfma_f32_32x32x16_bf16 v[96:111], v[152:155], v[204:207], v[96:111]
    ds_read_b64_tr_b16 v[152:153], v161 offset:28672
    ds_read_b64_tr_b16 v[154:155], v161 offset:29184
    s_waitcnt lgkmcnt(2)
    s_lshl1_add_u32 m0, s69, 137216
    s_add_u32 s70, s73, 32768
    buffer_load_dwordx4 v255, s[40:43], s70 offen lds
    v_mfma_f32_32x32x16_bf16 v[64:79], v[156:159], v[208:211], v[64:79]
    ds_read_b64_tr_b16 v[156:157], v162 offset:28672
    ds_read_b64_tr_b16 v[158:159], v162 offset:29184
    v_mfma_f32_32x32x16_bf16 v[80:95], v[128:131], v[208:211], v[80:95]
    ds_read_b64_tr_b16 v[128:129], v160 offset:32768
    ds_read_b64_tr_b16 v[130:131], v160 offset:33280
    v_mfma_f32_32x32x16_bf16 v[96:111], v[132:135], v[208:211], v[96:111]
    ds_read_b64_tr_b16 v[132:133], v161 offset:32768
    ds_read_b64_tr_b16 v[134:135], v161 offset:33280
    s_lshl1_add_u32 m0, s69, 138240
    s_add_u32 s70, s73, 40960
    buffer_load_dwordx4 v255, s[40:43], s70 offen lds
    v_mfma_f32_32x32x16_bf16 v[64:79], v[136:139], v[212:215], v[64:79]
    ds_read_b64_tr_b16 v[136:137], v162 offset:32768
    ds_read_b64_tr_b16 v[138:139], v162 offset:33280
    s_waitcnt vmcnt(6)
    ds_read_b64_tr_b16 a[160:161], v186 offset:0
    ds_read_b64_tr_b16 a[162:163], v186 offset:1024
    v_mfma_f32_32x32x16_bf16 v[80:95], v[140:143], v[212:215], v[80:95]
    ds_read_b64_tr_b16 v[140:141], v160 offset:36864
    ds_read_b64_tr_b16 v[142:143], v160 offset:37376
    ds_read_b64_tr_b16 a[164:165], v187 offset:0
    ds_read_b64_tr_b16 a[166:167], v187 offset:1024
    v_mfma_f32_32x32x16_bf16 v[96:111], v[144:147], v[212:215], v[96:111]
    ds_read_b64_tr_b16 v[144:145], v161 offset:36864
    ds_read_b64_tr_b16 v[146:147], v161 offset:37376
    s_waitcnt lgkmcnt(2)
    s_lshl1_add_u32 m0, s69, 131072
    s_add_u32 s70, s73, 49152
    buffer_load_dwordx4 v255, s[40:43], s70 offen lds
    v_mfma_f32_32x32x16_bf16 v[64:79], v[148:151], v[216:219], v[64:79]
    ds_read_b64_tr_b16 v[148:149], v162 offset:36864
    ds_read_b64_tr_b16 v[150:151], v162 offset:37376
    v_mfma_f32_32x32x16_bf16 v[80:95], v[152:155], v[216:219], v[80:95]
    ds_read_b64_tr_b16 v[152:153], v160 offset:40960
    ds_read_b64_tr_b16 v[154:155], v160 offset:41472
    v_mfma_f32_32x32x16_bf16 v[96:111], v[156:159], v[216:219], v[96:111]
    ds_read_b64_tr_b16 v[156:157], v161 offset:40960
    ds_read_b64_tr_b16 v[158:159], v161 offset:41472
    s_lshl1_add_u32 m0, s69, 132096
    s_add_u32 s70, s73, 57344
    buffer_load_dwordx4 v255, s[40:43], s70 offen lds
    v_mfma_f32_32x32x16_bf16 v[64:79], v[128:131], v[220:223], v[64:79]
    ds_read_b64_tr_b16 v[128:129], v162 offset:40960
    ds_read_b64_tr_b16 v[130:131], v162 offset:41472
    v_cmp_gt_u32 vcc, 8, v184
    s_nop 1
    s_cbranch_vccnz L_poll_68
L_ok_69:
    s_cmp_lg_u32 s50, 0
    s_cbranch_scc1 L_acq_70
L_acr_71:
    s_add_u32 s80, s75, s61
    s_add_u32 s81, s80, 28672
    s_add_u32 s64, s82, 2
    s_and_b32 s64, s64, 3
    s_mul_i32 s64, s64, 7168
    s_add_u32 s64, s64, s80
    s_add_u32 s64, s64, s83
    buffer_load_dwordx4 v[188:191], v1, s[16:19], s64 offen offset:0 sc1
    s_waitcnt vmcnt(7)
    ds_read_b64_tr_b16 a[168:169], v186 offset:2048
    ds_read_b64_tr_b16 a[170:171], v186 offset:3072
    v_mfma_f32_32x32x16_bf16 v[80:95], v[132:135], v[220:223], v[80:95]
    ds_read_b64_tr_b16 v[132:133], v160 offset:45056
    ds_read_b64_tr_b16 v[134:135], v160 offset:45568
    ds_read_b64_tr_b16 a[172:173], v187 offset:2048
    ds_read_b64_tr_b16 a[174:175], v187 offset:3072
    v_mfma_f32_32x32x16_bf16 v[96:111], v[136:139], v[220:223], v[96:111]
    ds_read_b64_tr_b16 v[136:137], v161 offset:45056
    ds_read_b64_tr_b16 v[138:139], v161 offset:45568
    s_waitcnt lgkmcnt(2)
    s_lshl1_add_u32 m0, s69, 133120
    s_add_u32 s73, s73, 65536
    s_sub_u32 s70, s73, s67
    s_cmp_eq_u32 s70, 458752
    s_cmov_b32 s73, s67
    s_add_u32 s70, s73, 0
    buffer_load_dwordx4 v255, s[40:43], s70 offen lds
    v_mfma_f32_32x32x16_bf16 v[64:79], v[140:143], v[224:227], v[64:79]
    ds_read_b64_tr_b16 v[140:141], v162 offset:45056
    ds_read_b64_tr_b16 v[142:143], v162 offset:45568
    buffer_load_dwordx4 v[192:195], v1, s[16:19], s64 offen offset:1024 sc1
    v_mfma_f32_32x32x16_bf16 v[80:95], v[144:147], v[224:227], v[80:95]
    ds_read_b64_tr_b16 v[144:145], v160 offset:49152
    ds_read_b64_tr_b16 v[146:147], v160 offset:49664
    v_mfma_f32_32x32x16_bf16 v[96:111], v[148:151], v[224:227], v[96:111]
    ds_read_b64_tr_b16 v[148:149], v161 offset:49152
    ds_read_b64_tr_b16 v[150:151], v161 offset:49664
    s_lshl1_add_u32 m0, s69, 134144
    s_add_u32 s70, s73, 8192
    buffer_load_dwordx4 v255, s[40:43], s70 offen lds
    v_mfma_f32_32x32x16_bf16 v[64:79], v[152:155], v[228:231], v[64:79]
    ds_read_b64_tr_b16 v[152:153], v162 offset:49152
    ds_read_b64_tr_b16 v[154:155], v162 offset:49664
    buffer_load_dwordx4 v[196:199], v1, s[16:19], s64 offen offset:2048 sc1
    s_waitcnt vmcnt(9)
    ds_read_b64_tr_b16 a[176:177], v186 offset:4096
    ds_read_b64_tr_b16 a[178:179], v186 offset:5120
    v_mfma_f32_32x32x16_bf16 v[80:95], v[156:159], v[228:231], v[80:95]
    ds_read_b64_tr_b16 v[156:157], v160 offset:53248
    ds_read_b64_tr_b16 v[158:159], v160 offset:53760
    ds_read_b64_tr_b16 a[180:181], v187 offset:4096
    ds_read_b64_tr_b16 a[182:183], v187 offset:5120
    v_mfma_f32_32x32x16_bf16 v[96:111], v[128:131], v[228:231], v[96:111]
    ds_read_b64_tr_b16 v[128:129], v160 offset:57344
    ds_read_b64_tr_b16 v[130:131], v160 offset:57856
    s_add_u32 s70, s73, 16384
    buffer_load_dwordx4 a[208:211], v255, s[40:43], s70 offen
    s_waitcnt lgkmcnt(14)
    v_mfma_f32_32x32x16_bf16 v[64:79], v[132:135], v[232:235], v[64:79]
    ds_read_b64_tr_b16 v[132:133], v160 offset:61440
    ds_read_b64_tr_b16 v[134:135], v160 offset:61952
    buffer_load_dwordx4 v[200:203], v1, s[16:19], s64 offen offset:3072 sc1
    v_mfma_f32_32x32x16_bf16 v[80:95], v[136:139], v[232:235], v[80:95]
    ds_read_b64_tr_b16 v[136:137], v161 offset:53248
    ds_read_b64_tr_b16 v[138:139], v161 offset:53760
    v_mfma_f32_32x32x16_bf16 v[96:111], v[140:143], v[232:235], v[96:111]
    ds_read_b64_tr_b16 v[140:141], v161 offset:57344
    ds_read_b64_tr_b16 v[142:143], v161 offset:57856
    s_add_u32 s70, s73, 24576
    buffer_load_dwordx4 a[212:215], v255, s[40:43], s70 offen
    s_waitcnt lgkmcnt(14)
    v_mfma_f32_32x32x16_bf16 v[64:79], v[144:147], v[236:239], v[64:79]
    ds_read_b64_tr_b16 v[144:145], v161 offset:61440
    ds_read_b64_tr_b16 v[146:147], v161 offset:61952
    s_add_u32 s64, s64, 4096
    s_cmp_eq_u32 s64, s81
    s_cmov_b32 s64, s80
    buffer_load_dwordx4 v[204:207], v1, s[16:19], s64 offen offset:0 sc1
    s_waitcnt vmcnt(11)
    ds_read_b64_tr_b16 a[184:185], v186 offset:6144
    ds_read_b64_tr_b16 a[186:187], v186 offset:7168
    v_mfma_f32_32x32x16_bf16 v[80:95], v[148:151], v[236:239], v[80:95]
    ds_read_b64_tr_b16 v[148:149], v162 offset:53248
    ds_read_b64_tr_b16 v[150:151], v162 offset:53760
    ds_read_b64_tr_b16 a[188:189], v187 offset:6144
    ds_read_b64_tr_b16 a[190:191], v187 offset:7168
    v_mfma_f32_32x32x16_bf16 v[96:111], v[152:155], v[236:239], v[96:111]
    ds_read_b64_tr_b16 v[152:153], v162 offset:57344
    ds_read_b64_tr_b16 v[154:155], v162 offset:57856
    s_add_u32 s70, s73, 32768
    buffer_load_dwordx4 a[216:219], v255, s[40:43], s70 offen
    s_waitcnt lgkmcnt(14)
    v_mfma_f32_32x32x16_bf16 v[64:79], v[156:159], v[240:243], v[64:79]
    ds_read_b64_tr_b16 v[156:157], v162 offset:61440
    ds_read_b64_tr_b16 v[158:159], v162 offset:61952
    buffer_load_dwordx4 v[208:211], v1, s[16:19], s64 offen offset:1024 sc1
    v_mfma_f32_32x32x16_bf16 v[64:79], v[128:131], v[244:247], v[64:79]
    v_mov_b32 v172, v24
    v_mfma_f32_32x32x16_bf16 v[64:79], v[132:135], v[248:251], v[64:79]
    s_add_u32 s70, s73, 40960
    buffer_load_dwordx4 a[220:223], v255, s[40:43], s70 offen
    s_waitcnt lgkmcnt(12)
    v_mfma_f32_32x32x16_bf16 v[64:79], v[172:175], v[180:183], v[64:79]
    buffer_load_dwordx4 v[212:215], v1, s[16:19], s64 offen offset:2048 sc1
    s_waitcnt vmcnt(13)
    ds_read_b64_tr_b16 a[192:193], v186 offset:0
    ds_read_b64_tr_b16 a[194:195], v186 offset:1024
    v_mfma_f32_32x32x16_bf16 v[80:95], v[136:139], v[240:243], v[80:95]
    ds_read_b64_tr_b16 a[196:197], v187 offset:0
    ds_read_b64_tr_b16 a[198:199], v187 offset:1024
    v_mfma_f32_32x32x16_bf16 v[80:95], v[140:143], v[244:247], v[80:95]
    v_mov_b32 v176, v25
    v_max_f32 v64, 0, v64
    v_max_f32 v65, 0, v65
    v_max_f32 v66, 0, v66
    v_max_f32 v67, 0, v67
    v_max_f32 v68, 0, v68
    v_max_f32 v69, 0, v69
    s_waitcnt lgkmcnt(10)
    v_mfma_f32_32x32x16_bf16 v[80:95], v[144:147], v[248:251], v[80:95]
    s_add_u32 s64, s64, 3072
    s_cmp_eq_u32 s64, s81
    s_cmov_b32 s64, s80
    buffer_load_dwordx4 v[216:219], v1, s[16:19], s64 offen offset:0 sc1
    v_max_f32 v70, 0, v70
    v_max_f32 v71, 0, v71
    v_mul_f32 v64, v64, v72
    v_mul_f32 v65, v65, v73
    v_mul_f32 v66, v66, v74
    v_mul_f32 v67, v67, v75
    v_mfma_f32_32x32x16_bf16 v[80:95], v[176:179], v[180:183], v[80:95]
    v_mul_f32 v68, v68, v76
    v_mul_f32 v69, v69, v77
    v_mul_f32 v70, v70, v78
    v_mul_f32 v71, v71, v79
    v_cvt_pk_bf16_f32 v64, v64, v65
    v_cvt_pk_bf16_f32 v65, v66, v67
    v_cvt_pk_bf16_f32 v66, v68, v69
    v_mfma_f32_32x32x16_bf16 v[96:111], v[148:151], v[240:243], v[96:111]
    s_waitcnt vmcnt(10)
    ds_read_b64_tr_b16 a[200:201], v186 offset:2048
    ds_read_b64_tr_b16 a[202:203], v186 offset:3072
    v_cvt_pk_bf16_f32 v67, v70, v71
    s_cmp_ge_u32 s45, 10
    s_cbranch_scc1 L_hs_72
    buffer_store_dwordx4 v[64:67], v1, s[16:19], s89 offen offset:0
L_hr_73:
    s_waitcnt lgkmcnt(6)
    v_mfma_f32_32x32x16_bf16 v[96:111], v[152:155], v[244:247], v[96:111]
    v_mov_b32 v172, v26
    ds_read_b64_tr_b16 a[204:205], v187 offset:2048
    ds_read_b64_tr_b16 a[206:207], v187 offset:3072
    v_max_f32 v80, 0, v80
    v_max_f32 v81, 0, v81
    v_max_f32 v82, 0, v82
    v_max_f32 v83, 0, v83
    v_mfma_f32_32x32x16_bf16 v[96:111], v[156:159], v[248:251], v[96:111]
    v_max_f32 v84, 0, v84
    v_max_f32 v85, 0, v85
    v_max_f32 v86, 0, v86
    v_max_f32 v87, 0, v87
    v_mul_f32 v80, v80, v88
    v_mul_f32 v81, v81, v89
    v_mul_f32 v82, v82, v90
    v_mfma_f32_32x32x16_bf16 v[96:111], v[172:175], v[180:183], v[96:111]
    v_mul_f32 v83, v83, v91
    v_mul_f32 v84, v84, v92
    v_mul_f32 v85, v85, v93
    v_mul_f32 v86, v86, v94
    v_mul_f32 v87, v87, v95
    v_cvt_pk_bf16_f32 v80, v80, v81
    v_cvt_pk_bf16_f32 v81, v82, v83
    v_cvt_pk_bf16_f32 v82, v84, v85
    v_cvt_pk_bf16_f32 v83, v86, v87
    s_cmp_ge_u32 s45, 10
    s_cbranch_scc1 L_hs_74
    buffer_store_dwordx4 v[80:83], v1, s[16:19], s89 offen offset:1024
L_hr_75:
    v_max_f32 v96, 0, v96
    v_max_f32 v97, 0, v97
    v_max_f32 v98, 0, v98
    v_max_f32 v99, 0, v99
    v_max_f32 v100, 0, v100
    v_max_f32 v101, 0, v101
    v_max_f32 v102, 0, v102
    v_max_f32 v103, 0, v103
    v_mul_f32 v96, v96, v104
    v_mul_f32 v97, v97, v105
    v_mul_f32 v98, v98, v106
    v_mul_f32 v99, v99, v107
    v_mul_f32 v100, v100, v108
    v_mul_f32 v101, v101, v109
    v_mul_f32 v102, v102, v110
    v_mul_f32 v103, v103, v111
    v_cvt_pk_bf16_f32 v96, v96, v97
    v_cvt_pk_bf16_f32 v97, v98, v99
    v_cvt_pk_bf16_f32 v98, v100, v101
    v_cvt_pk_bf16_f32 v99, v102, v103
    s_cmp_ge_u32 s45, 10
    s_cbranch_scc1 L_hs_76
    buffer_store_dwordx4 v[96:99], v1, s[16:19], s89 offen offset:2048
L_hr_77:
    s_waitcnt lgkmcnt(0)
    s_nop 1
    s_branch L_dn0
L_ge0:
    ds_read_b64_tr_b16 v[128:129], v161 offset:0
    ds_read_b64_tr_b16 v[130:131], v161 offset:512
    ds_read_b64_tr_b16 v[132:133], v162 offset:0
    ds_read_b64_tr_b16 v[134:135], v162 offset:512
    ds_read_b64_tr_b16 v[136:137], v163 offset:0
    ds_read_b64_tr_b16 v[138:139], v163 offset:512
    ds_read_b64_tr_b16 v[140:141], v161 offset:4096
    ds_read_b64_tr_b16 v[142:143], v161 offset:4608
    ds_read_b64_tr_b16 v[144:145], v162 offset:4096
    ds_read_b64_tr_b16 v[146:147], v162 offset:4608
    ds_read_b64_tr_b16 v[148:149], v163 offset:4096
    ds_read_b64_tr_b16 v[150:151], v163 offset:4608
    ds_read_b64_tr_b16 v[152:153], v161 offset:8192
    ds_read_b64_tr_b16 v[154:155], v161 offset:8704
    ds_read_b64_tr_b16 v[156:157], v162 offset:8192
    ds_read_b64_tr_b16 v[158:159], v162 offset:8704
    s_waitcnt vmcnt(10) lgkmcnt(10)
    v_mfma_f32_32x32x16_bf16 v[64:79], v[128:131], a[128:131], 0
    ds_read_b64_tr_b16 v[128:129], v163 offset:8192
    ds_read_b64_tr_b16 v[130:131], v163 offset:8704
    s_add_u32 s64, s64, 4096
    buffer_load_dwordx4 a[160:163], v1, s[16:19], s64 offen offset:0 sc1
    v_mfma_f32_32x32x16_bf16 v[80:95], v[132:135], a[128:131], 0
    ds_read_b64_tr_b16 v[132:133], v161 offset:12288
    ds_read_b64_tr_b16 v[134:135], v161 offset:12800
    buffer_load_dwordx4 a[164:167], v1, s[16:19], s64 offen offset:1024 sc1
    v_mfma_f32_32x32x16_bf16 v[96:111], v[136:139], a[128:131], 0
    ds_read_b64_tr_b16 v[136:137], v162 offset:12288
    ds_read_b64_tr_b16 v[138:139], v162 offset:12800
    s_waitcnt vmcnt(11) lgkmcnt(10)
    v_mfma_f32_32x32x16_bf16 v[64:79], v[140:143], a[132:135], v[64:79]
    ds_read_b64_tr_b16 v[140:141], v163 offset:12288
    ds_read_b64_tr_b16 v[142:143], v163 offset:12800
    buffer_load_dwordx4 a[168:171], v1, s[16:19], s64 offen offset:2048 sc1
    v_mfma_f32_32x32x16_bf16 v[80:95], v[144:147], a[132:135], v[80:95]
    ds_read_b64_tr_b16 v[144:145], v161 offset:16384
    ds_read_b64_tr_b16 v[146:147], v161 offset:16896
    buffer_load_dwordx4 a[172:175], v1, s[16:19], s64 offen offset:3072 sc1
    v_mfma_f32_32x32x16_bf16 v[96:111], v[148:151], a[132:135], v[96:111]
    ds_read_b64_tr_b16 v[148:149], v162 offset:16384
    ds_read_b64_tr_b16 v[150:151], v162 offset:16896
    s_waitcnt vmcnt(10) lgkmcnt(10)
    v_mfma_f32_32x32x16_bf16 v[64:79], v[152:155], a[136:139], v[64:79]
    ds_read_b64_tr_b16 v[152:153], v163 offset:16384
    ds_read_b64_tr_b16 v[154:155], v163 offset:16896
    s_add_u32 s64, s64, 4096
    buffer_load_dwordx4 a[176:179], v1, s[16:19], s64 offen offset:0 sc1
    v_mfma_f32_32x32x16_bf16 v[80:95], v[156:159], a[136:139], v[80:95]
    ds_read_b64_tr_b16 v[156:157], v161 offset:20480
    ds_read_b64_tr_b16 v[158:159], v161 offset:20992
    buffer_load_dwordx4 a[180:183], v1, s[16:19], s64 offen offset:1024 sc1
    v_mfma_f32_32x32x16_bf16 v[96:111], v[128:131], a[136:139], v[96:111]
    ds_read_b64_tr_b16 v[128:129], v162 offset:20480
    ds_read_b64_tr_b16 v[130:131], v162 offset:20992
    s_waitcnt vmcnt(11) lgkmcnt(10)
    v_mfma_f32_32x32x16_bf16 v[64:79], v[132:135], a[140:143], v[64:79]
    ds_read_b64_tr_b16 v[132:133], v163 offset:20480
    ds_read_b64_tr_b16 v[134:135], v163 offset:20992
    buffer_load_dwordx4 a[184:187], v1, s[16:19], s64 offen offset:2048 sc1
    v_mfma_f32_32x32x16_bf16 v[80:95], v[136:139], a[140:143], v[80:95]
    ds_read_b64_tr_b16 v[136:137], v161 offset:24576
    ds_read_b64_tr_b16 v[138:139], v161 offset:25088
    buffer_load_dwordx4 a[188:191], v1, s[16:19], s64 offen offset:3072 sc1
    v_mfma_f32_32x32x16_bf16 v[96:111], v[140:143], a[140:143], v[96:111]
    ds_read_b64_tr_b16 v[140:141], v162 offset:24576
    ds_read_b64_tr_b16 v[142:143], v162 offset:25088
    s_waitcnt vmcnt(12) lgkmcnt(10)
    v_mfma_f32_32x32x16_bf16 v[64:79], v[144:147], a[144:147], v[64:79]
    ds_read_b64_tr_b16 v[144:145], v163 offset:24576
    ds_read_b64_tr_b16 v[146:147], v163 offset:25088
    s_add_u32 s64, s64, 4096
    buffer_load_dwordx4 a[192:195], v1, s[16:19], s64 offen offset:0 sc1
    v_mfma_f32_32x32x16_bf16 v[80:95], v[148:151], a[144:147], v[80:95]
    ds_read_b64_tr_b16 v[148:149], v161 offset:28672
    ds_read_b64_tr_b16 v[150:151], v161 offset:29184
    buffer_load_dwordx4 a[196:199], v1, s[16:19], s64 offen offset:1024 sc1
    v_mfma_f32_32x32x16_bf16 v[96:111], v[152:155], a[144:147], v[96:111]
    ds_read_b64_tr_b16 v[152:153], v162 offset:28672
    ds_read_b64_tr_b16 v[154:155], v162 offset:29184
    s_waitcnt vmcnt(13) lgkmcnt(10)
    v_mfma_f32_32x32x16_bf16 v[64:79], v[156:159], a[148:151], v[64:79]
    ds_read_b64_tr_b16 v[156:157], v163 offset:28672
    ds_read_b64_tr_b16 v[158:159], v163 offset:29184
    buffer_load_dwordx4 a[200:203], v1, s[16:19], s64 offen offset:2048 sc1
    v_mfma_f32_32x32x16_bf16 v[80:95], v[128:131], a[148:151], v[80:95]
    ds_read_b64_tr_b16 v[128:129], v161 offset:32768
    ds_read_b64_tr_b16 v[130:131], v161 offset:33280
    buffer_load_dwordx4 a[204:207], v1, s[16:19], s64 offen offset:3072 sc1
    v_mfma_f32_32x32x16_bf16 v[96:111], v[132:135], a[148:151], v[96:111]
    ds_read_b64_tr_b16 v[132:133], v162 offset:32768
    ds_read_b64_tr_b16 v[134:135], v162 offset:33280
    s_waitcnt vmcnt(14) lgkmcnt(10)
    v_mfma_f32_32x32x16_bf16 v[64:79], v[136:139], a[152:155], v[64:79]
    ds_read_b64_tr_b16 v[136:137], v163 offset:32768
    ds_read_b64_tr_b16 v[138:139], v163 offset:33280
    s_add_u32 s64, s64, 4096
    buffer_load_dwordx4 a[208:211], v1, s[16:19], s64 offen offset:0 sc1
    v_mfma_f32_32x32x16_bf16 v[80:95], v[140:143], a[152:155], v[80:95]
    ds_read_b64_tr_b16 v[140:141], v161 offset:36864
    ds_read_b64_tr_b16 v[142:143], v161 offset:37376
    buffer_load_dwordx4 a[212:215], v1, s[16:19], s64 offen offset:1024 sc1
    v_mfma_f32_32x32x16_bf16 v[96:111], v[144:147], a[152:155], v[96:111]
    ds_read_b64_tr_b16 v[144:145], v162 offset:36864
    ds_read_b64_tr_b16 v[146:147], v162 offset:37376
    s_waitcnt vmcnt(15) lgkmcnt(10)
    v_mfma_f32_32x32x16_bf16 v[64:79], v[148:151], a[156:159], v[64:79]
    ds_read_b64_tr_b16 v[148:149], v163 offset:36864
    ds_read_b64_tr_b16 v[150:151], v163 offset:37376
    buffer_load_dwordx4 a[216:219], v1, s[16:19], s64 offen offset:2048 sc1
    v_mfma_f32_32x32x16_bf16 v[80:95], v[152:155], a[156:159], v[80:95]
    ds_read_b64_tr_b16 v[152:153], v161 offset:40960
    ds_read_b64_tr_b16 v[154:155], v161 offset:41472
    buffer_load_dwordx4 a[220:223], v1, s[16:19], s64 offen offset:3072 sc1
    v_mfma_f32_32x32x16_bf16 v[96:111], v[156:159], a[156:159], v[96:111]
    ds_read_b64_tr_b16 v[156:157], v162 offset:40960
    ds_read_b64_tr_b16 v[158:159], v162 offset:41472
    s_waitcnt vmcnt(15) lgkmcnt(10)
    v_mfma_f32_32x32x16_bf16 v[64:79], v[128:131], a[160:163], v[64:79]
    ds_read_b64_tr_b16 v[128:129], v163 offset:40960
    ds_read_b64_tr_b16 v[130:131], v163 offset:41472
    s_add_u32 s64, s64, 4096
    buffer_load_dwordx4 v[188:191], v1, s[16:19], s64 offen offset:0 sc1
    v_mfma_f32_32x32x16_bf16 v[80:95], v[132:135], a[160:163], v[80:95]
    ds_read_b64_tr_b16 v[132:133], v161 offset:45056
    ds_read_b64_tr_b16 v[134:135], v161 offset:45568
    buffer_load_dwordx4 v[192:195], v1, s[16:19], s64 offen offset:1024 sc1
    v_mfma_f32_32x32x16_bf16 v[96:111], v[136:139], a[160:163], v[96:111]
    ds_read_b64_tr_b16 v[136:137], v162 offset:45056
    ds_read_b64_tr_b16 v[138:139], v162 offset:45568
    s_waitcnt vmcnt(16) lgkmcnt(10)
    v_mfma_f32_32x32x16_bf16 v[64:79], v[140:143], a[164:167], v[64:79]
    ds_read_b64_tr_b16 v[140:141], v163 offset:45056
    ds_read_b64_tr_b16 v[142:143], v163 offset:45568
    buffer_load_dwordx4 v[196:199], v1, s[16:19], s64 offen offset:2048 sc1
    v_mfma_f32_32x32x16_bf16 v[80:95], v[144:147], a[164:167], v[80:95]
    ds_read_b64_tr_b16 v[144:145], v161 offset:49152
    ds_read_b64_tr_b16 v[146:147], v161 offset:49664
    buffer_load_dwordx4 v[200:203], v1, s[16:19], s64 offen offset:3072 sc1
    v_mfma_f32_32x32x16_bf16 v[96:111], v[148:151], a[164:167], v[96:111]
    ds_read_b64_tr_b16 v[148:149], v162 offset:49152
    ds_read_b64_tr_b16 v[150:151], v162 offset:49664
    buffer_load_dword v184, v21, s[16:19], s53 offen sc1
    s_waitcnt vmcnt(18) lgkmcnt(10)
    v_mfma_f32_32x32x16_bf16 v[64:79], v[152:155], a[168:171], v[64:79]
    ds_read_b64_tr_b16 v[152:153], v163 offset:49152
    ds_read_b64_tr_b16 v[154:155], v163 offset:49664
    s_add_u32 s64, s64, 4096
    buffer_load_dwordx4 v[204:207], v1, s[16:19], s64 offen offset:0 sc1
    v_mfma_f32_32x32x16_bf16 v[80:95], v[156:159], a[168:171], v[80:95]
    ds_read_b64_tr_b16 v[156:157], v161 offset:53248
    ds_read_b64_tr_b16 v[158:159], v161 offset:53760
    buffer_load_dwordx4 v[208:211], v1, s[16:19], s64 offen offset:1024 sc1
    v_mfma_f32_32x32x16_bf16 v[96:111], v[128:131], a[168:171], v[96:111]
    ds_read_b64_tr_b16 v[128:129], v162 offset:53248
    ds_read_b64_tr_b16 v[130:131], v162 offset:53760
    s_add_u32 s73, s82, 0
    s_and_b32 s73, s73, 3
    s_mul_i32 s73, s73, 114688
    s_add_u32 s73, s73, s67
    s_lshl_b32 s70, s83, 4
    s_add_u32 s73, s73, s70
    s_add_u32 s70, s73, 0
    buffer_load_dwordx4 a[0:3], v255, s[40:43], s70 offen
    s_waitcnt vmcnt(20) lgkmcnt(10)
    v_mfma_f32_32x32x16_bf16 v[64:79], v[132:135], a[172:175], v[64:79]
    ds_read_b64_tr_b16 v[132:133], v163 offset:53248
    ds_read_b64_tr_b16 v[134:135], v163 offset:53760
    buffer_load_dwordx4 v[212:215], v1, s[16:19], s64 offen offset:2048 sc1
    v_mfma_f32_32x32x16_bf16 v[80:95], v[136:139], a[172:175], v[80:95]
    ds_read_b64_tr_b16 v[136:137], v161 offset:57344
    ds_read_b64_tr_b16 v[138:139], v161 offset:57856
    buffer_load_dwordx4 v[216:219], v1, s[16:19], s64 offen offset:3072 sc1
    v_mfma_f32_32x32x16_bf16 v[96:111], v[140:143], a[172:175], v[96:111]
    ds_read_b64_tr_b16 v[140:141], v162 offset:57344
    ds_read_b64_tr_b16 v[142:143], v162 offset:57856
    s_add_u32 s70, s73, 8192
    buffer_load_dwordx4 a[4:7], v255, s[40:43], s70 offen
    s_waitcnt vmcnt(22) lgkmcnt(10)
    v_mfma_f32_32x32x16_bf16 v[64:79], v[144:147], a[176:179], v[64:79]
    ds_read_b64_tr_b16 v[144:145], v163 offset:57344
    ds_read_b64_tr_b16 v[146:147], v163 offset:57856
    v_mfma_f32_32x32x16_bf16 v[80:95], v[148:151], a[176:179], v[80:95]
    ds_read_b64_tr_b16 v[148:149], v161 offset:61440
    ds_read_b64_tr_b16 v[150:151], v161 offset:61952
    v_mfma_f32_32x32x16_bf16 v[96:111], v[152:155], a[176:179], v[96:111]
    ds_read_b64_tr_b16 v[152:153], v162 offset:61440
    ds_read_b64_tr_b16 v[154:155], v162 offset:61952
    s_add_u32 s70, s73, 16384
    buffer_load_dwordx4 a[8:11], v255, s[40:43], s70 offen
    s_waitcnt vmcnt(22) lgkmcnt(10)
    v_mfma_f32_32x32x16_bf16 v[64:79], v[156:159], a[180:183], v[64:79]
    ds_read_b64_tr_b16 v[156:157], v163 offset:61440
    ds_read_b64_tr_b16 v[158:159], v163 offset:61952
    v_mfma_f32_32x32x16_bf16 v[80:95], v[128:131], a[180:183], v[80:95]
    v_add_u32 v161, 0x10000, v161
    ds_read_b64_tr_b16 v[128:129], v161 offset:0
    ds_read_b64_tr_b16 v[130:131], v161 offset:512
    v_mfma_f32_32x32x16_bf16 v[96:111], v[132:135], a[180:183], v[96:111]
    v_add_u32 v162, 0x10000, v162
    ds_read_b64_tr_b16 v[132:133], v162 offset:0
    ds_read_b64_tr_b16 v[134:135], v162 offset:512
    s_add_u32 s70, s73, 24576
    buffer_load_dwordx4 a[12:15], v255, s[40:43], s70 offen
    s_waitcnt vmcnt(22) lgkmcnt(10)
    v_mfma_f32_32x32x16_bf16 v[64:79], v[136:139], a[184:187], v[64:79]
    v_add_u32 v163, 0x10000, v163
    ds_read_b64_tr_b16 v[136:137], v163 offset:0
    ds_read_b64_tr_b16 v[138:139], v163 offset:512
    v_mfma_f32_32x32x16_bf16 v[80:95], v[140:143], a[184:187], v[80:95]
    ds_read_b64_tr_b16 v[140:141], v161 offset:4096
    ds_read_b64_tr_b16 v[142:143], v161 offset:4608
    v_add_f32 v164, v164, v165
    v_add_f32 v166, v166, v167
    v_mfma_f32_32x32x16_bf16 v[96:111], v[144:147], a[184:187], v[96:111]
    ds_read_b64_tr_b16 v[144:145], v162 offset:4096
    ds_read_b64_tr_b16 v[146:147], v162 offset:4608
    s_add_u32 s70, s73, 32768
    buffer_load_dwordx4 a[16:19], v255, s[40:43], s70 offen
    s_waitcnt vmcnt(22) lgkmcnt(10)
    v_mfma_f32_32x32x16_bf16 v[64:79], v[148:151], a[188:191], v[64:79]
    ds_read_b64_tr_b16 v[148:149], v163 offset:4096
    ds_read_b64_tr_b16 v[150:151], v163 offset:4608
    v_mfma_f32_32x32x16_bf16 v[80:95], v[152:155], a[188:191], v[80:95]
    ds_read_b64_tr_b16 v[152:153], v161 offset:8192
    ds_read_b64_tr_b16 v[154:155], v161 offset:8704
    v_add_f32 v168, v168, v169
    v_add_f32 v170, v170, v171
    v_mfma_f32_32x32x16_bf16 v[96:111], v[156:159], a[188:191], v[96:111]
    ds_read_b64_tr_b16 v[156:157], v162 offset:8192
    ds_read_b64_tr_b16 v[158:159], v162 offset:8704
    s_add_u32 s70, s73, 40960
    buffer_load_dwordx4 a[20:23], v255, s[40:43], s70 offen
    s_waitcnt vmcnt(22) lgkmcnt(10)
    v_mfma_f32_32x32x16_bf16 v[64:79], v[128:131], a[192:195], v[64:79]
    ds_read_b64_tr_b16 v[128:129], v163 offset:8192
    ds_read_b64_tr_b16 v[130:131], v163 offset:8704
    s_waitcnt vmcnt(10)
    v_cmp_gt_u32 vcc, 7, v184
    s_nop 1
    s_cbranch_vccnz L_poll_78
L_ok_79:
    s_cmp_lg_u32 s50, 0
    s_cbranch_scc1 L_acq_80
L_acr_81:
    s_mov_b32 s64, s60
    buffer_load_dwordx4 v[220:223], v1, s[16:19], s64 offen offset:0 sc1
    v_mfma_f32_32x32x16_bf16 v[80:95], v[132:135], a[192:195], v[80:95]
    ds_read_b64_tr_b16 v[132:133], v161 offset:12288
    ds_read_b64_tr_b16 v[134:135], v161 offset:12800
    v_add_f32 v164, v164, v166
    v_add_f32 v168, v168, v170
    v_mfma_f32_32x32x16_bf16 v[96:111], v[136:139], a[192:195], v[96:111]
    ds_read_b64_tr_b16 v[136:137], v162 offset:12288
    ds_read_b64_tr_b16 v[138:139], v162 offset:12800
    s_add_u32 s70, s73, 49152
    buffer_load_dwordx4 a[24:27], v255, s[40:43], s70 offen
    s_waitcnt lgkmcnt(10)
    v_mfma_f32_32x32x16_bf16 v[64:79], v[140:143], a[196:199], v[64:79]
    ds_read_b64_tr_b16 v[140:141], v163 offset:12288
    ds_read_b64_tr_b16 v[142:143], v163 offset:12800
    buffer_load_dwordx4 v[224:227], v1, s[16:19], s64 offen offset:1024 sc1
    v_mfma_f32_32x32x16_bf16 v[80:95], v[144:147], a[196:199], v[80:95]
    ds_read_b64_tr_b16 v[144:145], v161 offset:16384
    ds_read_b64_tr_b16 v[146:147], v161 offset:16896
    v_add_f32 v164, v164, v168
    v_mov_b32 v165, v164
    v_mfma_f32_32x32x16_bf16 v[96:111], v[148:151], a[196:199], v[96:111]
    ds_read_b64_tr_b16 v[148:149], v162 offset:16384
    ds_read_b64_tr_b16 v[150:151], v162 offset:16896
    s_add_u32 s70, s73, 57344
    buffer_load_dwordx4 a[28:31], v255, s[40:43], s70 offen
    s_waitcnt lgkmcnt(10)
    v_mfma_f32_32x32x16_bf16 v[64:79], v[152:155], a[200:203], v[64:79]
    ds_read_b64_tr_b16 v[152:153], v163 offset:16384
    ds_read_b64_tr_b16 v[154:155], v163 offset:16896
    buffer_load_dwordx4 v[228:231], v1, s[16:19], s64 offen offset:2048 sc1
    v_mfma_f32_32x32x16_bf16 v[80:95], v[156:159], a[200:203], v[80:95]
    ds_read_b64_tr_b16 v[156:157], v161 offset:20480
    ds_read_b64_tr_b16 v[158:159], v161 offset:20992
    v_permlane32_swap_b32 v164, v165
    v_mul_f32 v164, 0x3b000000, v164
    v_mfma_f32_32x32x16_bf16 v[96:111], v[128:131], a[200:203], v[96:111]
    ds_read_b64_tr_b16 v[128:129], v162 offset:20480
    ds_read_b64_tr_b16 v[130:131], v162 offset:20992
    s_add_u32 s73, s73, 65536
    s_sub_u32 s70, s73, s67
    s_cmp_eq_u32 s70, 458752
    s_cmov_b32 s73, s67
    s_add_u32 s70, s73, 0
    buffer_load_dwordx4 a[32:35], v255, s[40:43], s70 offen
    s_waitcnt lgkmcnt(10)
    v_mfma_f32_32x32x16_bf16 v[64:79], v[132:135], a[204:207], v[64:79]
    ds_read_b64_tr_b16 v[132:133], v163 offset:20480
    ds_read_b64_tr_b16 v[134:135], v163 offset:20992
    buffer_load_dwordx4 v[232:235], v1, s[16:19], s64 offen offset:3072 sc1
    v_mfma_f32_32x32x16_bf16 v[80:95], v[136:139], a[204:207], v[80:95]
    ds_read_b64_tr_b16 v[136:137], v161 offset:24576
    ds_read_b64_tr_b16 v[138:139], v161 offset:25088
    v_cvt_pk_bf16_f32 v180, -v164, -v164
    v_mov_b32 v181, v180
    v_mfma_f32_32x32x16_bf16 v[96:111], v[140:143], a[204:207], v[96:111]
    ds_read_b64_tr_b16 v[140:141], v162 offset:24576
    ds_read_b64_tr_b16 v[142:143], v162 offset:25088
    s_add_u32 s70, s73, 8192
    buffer_load_dwordx4 a[36:39], v255, s[40:43], s70 offen
    s_waitcnt lgkmcnt(10)
    v_mfma_f32_32x32x16_bf16 v[64:79], v[144:147], a[208:211], v[64:79]
    ds_read_b64_tr_b16 v[144:145], v163 offset:24576
    ds_read_b64_tr_b16 v[146:147], v163 offset:25088
    s_add_u32 s64, s64, 4096
    buffer_load_dwordx4 v[236:239], v1, s[16:19], s64 offen offset:0 sc1
    v_mfma_f32_32x32x16_bf16 v[80:95], v[148:151], a[208:211], v[80:95]
    ds_read_b64_tr_b16 v[148:149], v161 offset:28672
    ds_read_b64_tr_b16 v[150:151], v161 offset:29184
    v_mov_b32 v182, v180
    v_mov_b32 v183, v180
    v_mov_b32 v173, 0
    v_mov_b32 v174, 0
    v_mfma_f32_32x32x16_bf16 v[96:111], v[152:155], a[208:211], v[96:111]
    ds_read_b64_tr_b16 v[152:153], v162 offset:28672
    ds_read_b64_tr_b16 v[154:155], v162 offset:29184
    s_add_u32 s70, s73, 16384
    buffer_load_dwordx4 a[40:43], v255, s[40:43], s70 offen
    s_waitcnt lgkmcnt(10)
    v_mfma_f32_32x32x16_bf16 v[64:79], v[156:159], a[212:215], v[64:79]
    ds_read_b64_tr_b16 v[156:157], v163 offset:28672
    ds_read_b64_tr_b16 v[158:159], v163 offset:29184
    buffer_load_dwordx4 v[240:243], v1, s[16:19], s64 offen offset:1024 sc1
    v_mfma_f32_32x32x16_bf16 v[80:95], v[128:131], a[212:215], v[80:95]
    ds_read_b64_tr_b16 v[128:129], v161 offset:32768
    ds_read_b64_tr_b16 v[130:131], v161 offset:33280
    v_mov_b32 v175, 0
    v_mov_b32 v177, 0
    v_mfma_f32_32x32x16_bf16 v[96:111], v[132:135], a[212:215], v[96:111]
    ds_read_b64_tr_b16 v[132:133], v162 offset:32768
    ds_read_b64_tr_b16 v[134:135], v162 offset:33280
    s_add_u32 s70, s73, 24576
    buffer_load_dwordx4 a[44:47], v255, s[40:43], s70 offen
    s_waitcnt lgkmcnt(10)
    v_mfma_f32_32x32x16_bf16 v[64:79], v[136:139], a[216:219], v[64:79]
    ds_read_b64_tr_b16 v[136:137], v163 offset:32768
    ds_read_b64_tr_b16 v[138:139], v163 offset:33280
    buffer_load_dwordx4 v[244:247], v1, s[16:19], s64 offen offset:2048 sc1
    v_mfma_f32_32x32x16_bf16 v[80:95], v[140:143], a[216:219], v[80:95]
    ds_read_b64_tr_b16 v[140:141], v161 offset:36864
    ds_read_b64_tr_b16 v[142:143], v161 offset:37376
    v_mov_b32 v178, 0
    v_mov_b32 v179, 0
    v_mfma_f32_32x32x16_bf16 v[96:111], v[144:147], a[216:219], v[96:111]
    ds_read_b64_tr_b16 v[144:145], v162 offset:36864
    ds_read_b64_tr_b16 v[146:147], v162 offset:37376
    s_add_u32 s70, s73, 32768
    buffer_load_dwordx4 a[48:51], v255, s[40:43], s70 offen
    s_waitcnt lgkmcnt(10)
    v_mfma_f32_32x32x16_bf16 v[64:79], v[148:151], a[220:223], v[64:79]
    ds_read_b64_tr_b16 v[148:149], v163 offset:36864
    ds_read_b64_tr_b16 v[150:151], v163 offset:37376
    buffer_load_dwordx4 v[248:251], v1, s[16:19], s64 offen offset:3072 sc1
    v_mfma_f32_32x32x16_bf16 v[80:95], v[152:155], a[220:223], v[80:95]
    ds_read_b64_tr_b16 v[152:153], v161 offset:40960
    ds_read_b64_tr_b16 v[154:155], v161 offset:41472
    v_mfma_f32_32x32x16_bf16 v[96:111], v[156:159], a[220:223], v[96:111]
    ds_read_b64_tr_b16 v[156:157], v162 offset:40960
    ds_read_b64_tr_b16 v[158:159], v162 offset:41472
    s_add_u32 s70, s73, 40960
    buffer_load_dwordx4 a[52:55], v255, s[40:43], s70 offen
    v_lshlrev_b32 v253, 2, v0
    v_add_u32 v253, 135168, v253
    s_waitcnt lgkmcnt(0)
    s_barrier
    ds_read_b32 v24, v253 offset:0
    ds_read_b32 v25, v253 offset:8192
    ds_read_b32 v26, v253 offset:16384
    ds_read_b32 v27, v253 offset:24576
    v_mfma_f32_32x32x16_bf16 v[64:79], v[128:131], v[188:191], v[64:79]
    ds_read_b64_tr_b16 v[128:129], v163 offset:40960
    ds_read_b64_tr_b16 v[130:131], v163 offset:41472
    s_add_u32 s64, s64, 4096
    buffer_load_dwordx4 a[192:195], v1, s[16:19], s64 offen offset:0 sc1
    v_mfma_f32_32x32x16_bf16 v[80:95], v[132:135], v[188:191], v[80:95]
    ds_read_b64_tr_b16 v[132:133], v161 offset:45056
    ds_read_b64_tr_b16 v[134:135], v161 offset:45568
    v_mfma_f32_32x32x16_bf16 v[96:111], v[136:139], v[188:191], v[96:111]
    ds_read_b64_tr_b16 v[136:137], v162 offset:45056
    ds_read_b64_tr_b16 v[138:139], v162 offset:45568
    s_add_u32 s73, s73, 49152
    s_sub_u32 s70, s73, s67
    s_cmp_eq_u32 s70, 458752
    s_cmov_b32 s73, s67
    s_add_u32 s70, s73, 0
    buffer_load_dwordx4 a[56:59], v255, s[40:43], s70 offen
    v_mfma_f32_32x32x16_bf16 v[64:79], v[140:143], v[192:195], v[64:79]
    ds_read_b64_tr_b16 v[140:141], v163 offset:45056
    ds_read_b64_tr_b16 v[142:143], v163 offset:45568
    buffer_load_dwordx4 a[196:199], v1, s[16:19], s64 offen offset:1024 sc1
    v_mfma_f32_32x32x16_bf16 v[80:95], v[144:147], v[192:195], v[80:95]
    ds_read_b64_tr_b16 v[144:145], v161 offset:49152
    ds_read_b64_tr_b16 v[146:147], v161 offset:49664
    v_mfma_f32_32x32x16_bf16 v[96:111], v[148:151], v[192:195], v[96:111]
    ds_read_b64_tr_b16 v[148:149], v162 offset:49152
    ds_read_b64_tr_b16 v[150:151], v162 offset:49664
    s_add_u32 s70, s73, 8192
    buffer_load_dwordx4 a[60:63], v255, s[40:43], s70 offen
    s_waitcnt lgkmcnt(10)
    v_mfma_f32_32x32x16_bf16 v[64:79], v[152:155], v[196:199], v[64:79]
    ds_read_b64_tr_b16 v[152:153], v163 offset:49152
    ds_read_b64_tr_b16 v[154:155], v163 offset:49664
    buffer_load_dwordx4 a[200:203], v1, s[16:19], s64 offen offset:2048 sc1
    v_mfma_f32_32x32x16_bf16 v[80:95], v[156:159], v[196:199], v[80:95]
    ds_read_b64_tr_b16 v[156:157], v161 offset:53248
    ds_read_b64_tr_b16 v[158:159], v161 offset:53760
    v_mfma_f32_32x32x16_bf16 v[96:111], v[128:131], v[196:199], v[96:111]
    ds_read_b64_tr_b16 v[128:129], v161 offset:57344
    ds_read_b64_tr_b16 v[130:131], v161 offset:57856
    s_add_u32 s70, s73, 16384
    buffer_load_dwordx4 a[64:67], v255, s[40:43], s70 offen
    s_waitcnt lgkmcnt(10)
    v_mfma_f32_32x32x16_bf16 v[64:79], v[132:135], v[200:203], v[64:79]
    ds_read_b64_tr_b16 v[132:133], v161 offset:61440
    ds_read_b64_tr_b16 v[134:135], v161 offset:61952
    buffer_load_dwordx4 a[204:207], v1, s[16:19], s64 offen offset:3072 sc1
    v_mfma_f32_32x32x16_bf16 v[80:95], v[136:139], v[200:203], v[80:95]
    ds_read_b64_tr_b16 v[136:137], v162 offset:53248
    ds_read_b64_tr_b16 v[138:139], v162 offset:53760
    v_mfma_f32_32x32x16_bf16 v[96:111], v[140:143], v[200:203], v[96:111]
    ds_read_b64_tr_b16 v[140:141], v162 offset:57344
    ds_read_b64_tr_b16 v[142:143], v162 offset:57856
    s_add_u32 s70, s73, 24576
    buffer_load_dwordx4 a[68:71], v255, s[40:43], s70 offen
    s_add_u32 s88, s60, 149504
    buffer_load_dwordx4 v[164:167], v19, s[16:19], s88 offen sc1
    buffer_load_dwordx4 v[168:171], v19, s[16:19], s88 offen offset:16 sc1
    s_add_u32 s87, s57, s59
    s_add_u32 s89, s57, s60
    s_waitcnt vmcnt(35) lgkmcnt(10)
    v_mfma_f32_32x32x16_bf16 v[64:79], v[144:147], v[204:207], v[64:79]
    ds_read_b64_tr_b16 v[144:145], v162 offset:61440
    ds_read_b64_tr_b16 v[146:147], v162 offset:61952
    s_add_u32 s64, s64, 4096
    buffer_load_dwordx4 a[208:211], v1, s[16:19], s64 offen offset:0 sc1
    s_waitcnt vmcnt(34)
    ds_write_b128 v14, a[0:3]
    v_mfma_f32_32x32x16_bf16 v[80:95], v[148:151], v[204:207], v[80:95]
    ds_read_b64_tr_b16 v[148:149], v163 offset:53248
    ds_read_b64_tr_b16 v[150:151], v163 offset:53760
    s_waitcnt vmcnt(31)
    ds_write_b128 v14, a[4:7] offset:1024
    v_mfma_f32_32x32x16_bf16 v[96:111], v[152:155], v[204:207], v[96:111]
    ds_read_b64_tr_b16 v[152:153], v163 offset:57344
    ds_read_b64_tr_b16 v[154:155], v163 offset:57856
    s_add_u32 s70, s73, 32768
    buffer_load_dwordx4 a[72:75], v255, s[40:43], s70 offen
    s_add_u32 s70, s73, 40960
    buffer_load_dwordx4 a[76:79], v255, s[40:43], s70 offen
    s_waitcnt lgkmcnt(12)
    v_mfma_f32_32x32x16_bf16 v[64:79], v[156:159], v[208:211], v[64:79]
    ds_read_b64_tr_b16 v[156:157], v163 offset:61440
    ds_read_b64_tr_b16 v[158:159], v163 offset:61952
    buffer_load_dwordx4 a[212:215], v1, s[16:19], s64 offen offset:1024 sc1
    ds_read_b64_tr_b16 a[0:1], v186
    ds_read_b64_tr_b16 a[2:3], v186 offset:1024
    v_mfma_f32_32x32x16_bf16 v[64:79], v[128:131], v[212:215], v[64:79]
    ds_read_b64_tr_b16 v[128:129], v160 offset:0
    ds_read_b64_tr_b16 v[130:131], v160 offset:512
    v_mov_b32 v172, v25
    ds_read_b64_tr_b16 a[4:5], v187
    ds_read_b64_tr_b16 a[6:7], v187 offset:1024
    v_mfma_f32_32x32x16_bf16 v[64:79], v[132:135], v[216:219], v[64:79]
    ds_read_b64_tr_b16 v[132:133], v160 offset:4096
    ds_read_b64_tr_b16 v[134:135], v160 offset:4608
    s_add_u32 s70, s73, 49152
    buffer_load_dwordx4 a[80:83], v255, s[40:43], s70 offen
    s_add_u32 s70, s73, 57344
    buffer_load_dwordx4 a[84:87], v255, s[40:43], s70 offen
    s_waitcnt lgkmcnt(15)
    v_mfma_f32_32x32x16_bf16 v[64:79], v[172:175], v[180:183], v[64:79]
    buffer_load_dwordx4 a[216:219], v1, s[16:19], s64 offen offset:2048 sc1
    s_waitcnt vmcnt(36)
    ds_write_b128 v14, a[8:11]
    v_mfma_f32_32x32x16_bf16 v[80:95], v[136:139], v[208:211], v[80:95]
    ds_read_b64_tr_b16 v[136:137], v160 offset:8192
    ds_read_b64_tr_b16 v[138:139], v160 offset:8704
    s_waitcnt vmcnt(35)
    ds_write_b128 v14, a[12:15] offset:1024
    v_mfma_f32_32x32x16_bf16 v[80:95], v[140:143], v[212:215], v[80:95]
    ds_read_b64_tr_b16 v[140:141], v160 offset:12288
    ds_read_b64_tr_b16 v[142:143], v160 offset:12800
    v_mov_b32 v176, v26
    s_add_u32 s73, s73, 65536
    s_sub_u32 s70, s73, s67
    s_cmp_eq_u32 s70, 458752
    s_cmov_b32 s73, s67
    s_add_u32 s70, s73, 0
    buffer_load_dwordx4 a[88:91], v255, s[40:43], s70 offen
    s_add_u32 s70, s73, 8192
    buffer_load_dwordx4 a[92:95], v255, s[40:43], s70 offen
    v_max_f32 v64, 0, v64
    s_waitcnt lgkmcnt(15)
    v_mfma_f32_32x32x16_bf16 v[80:95], v[144:147], v[216:219], v[80:95]
    v_subrev_u32 v161, 0x10000, v161
    ds_read_b64_tr_b16 v[144:145], v161 offset:0
    ds_read_b64_tr_b16 v[146:147], v161 offset:512
    buffer_load_dwordx4 a[220:223], v1, s[16:19], s64 offen offset:3072 sc1
    ds_read_b64_tr_b16 a[8:9], v186
    ds_read_b64_tr_b16 a[10:11], v186 offset:1024
    v_max_f32 v65, 0, v65
    v_max_f32 v66, 0, v66
    v_mfma_f32_32x32x16_bf16 v[80:95], v[176:179], v[180:183], v[80:95]
    ds_read_b64_tr_b16 a[12:13], v187
    ds_read_b64_tr_b16 a[14:15], v187 offset:1024
    v_max_f32 v67, 0, v67
    v_max_f32 v68, 0, v68
    v_max_f32 v69, 0, v69
    v_max_f32 v70, 0, v70
    v_max_f32 v71, 0, v71
    v_mfma_f32_32x32x16_bf16 v[96:111], v[148:151], v[208:211], v[96:111]
    ds_read_b64_tr_b16 v[148:149], v161 offset:4096
    ds_read_b64_tr_b16 v[150:151], v161 offset:4608
    s_add_u32 s70, s73, 16384
    buffer_load_dwordx4 a[96:99], v255, s[40:43], s70 offen
    s_add_u32 s70, s73, 24576
    buffer_load_dwordx4 a[100:103], v255, s[40:43], s70 offen
    v_mul_f32 v64, v64, v72
    s_waitcnt lgkmcnt(15)
    v_mfma_f32_32x32x16_bf16 v[96:111], v[152:155], v[212:215], v[96:111]
    ds_read_b64_tr_b16 v[152:153], v161 offset:8192
    ds_read_b64_tr_b16 v[154:155], v161 offset:8704
    v_mov_b32 v172, v27
    v_mul_f32 v65, v65, v73
    v_mul_f32 v66, v66, v74
    v_mul_f32 v67, v67, v75
    v_mul_f32 v68, v68, v76
    v_mfma_f32_32x32x16_bf16 v[96:111], v[156:159], v[216:219], v[96:111]
    ds_read_b64_tr_b16 v[156:157], v161 offset:12288
    ds_read_b64_tr_b16 v[158:159], v161 offset:12800
    v_mul_f32 v69, v69, v77
    v_mul_f32 v70, v70, v78
    v_mul_f32 v71, v71, v79
    v_cvt_pk_bf16_f32 v64, v64, v65
    v_cvt_pk_bf16_f32 v65, v66, v67
    v_mfma_f32_32x32x16_bf16 v[96:111], v[172:175], v[180:183], v[96:111]
    v_cvt_pk_bf16_f32 v66, v68, v69
    v_cvt_pk_bf16_f32 v67, v70, v71
    s_cmp_ge_u32 s45, 10
    s_cbranch_scc1 L_hs_82
    buffer_store_dwordx4 v[64:67], v1, s[16:19], s87 offen offset:1024
L_hr_83:
    v_max_f32 v80, 0, v80
    v_max_f32 v81, 0, v81
    v_max_f32 v82, 0, v82
    v_max_f32 v83, 0, v83
    s_waitcnt vmcnt(32) lgkmcnt(12)
    v_mfma_f32_32x32x16_bf16 v[112:127], v[128:131], v[220:223], 0
    v_subrev_u32 v162, 0x10000, v162
    ds_read_b64_tr_b16 v[128:129], v162 offset:0
    ds_read_b64_tr_b16 v[130:131], v162 offset:512
    s_add_u32 s64, s64, 4096
    buffer_load_dwordx4 v[188:191], v1, s[16:19], s64 offen offset:0 sc1
    v_max_f32 v84, 0, v84
    v_max_f32 v85, 0, v85
    v_max_f32 v86, 0, v86
    v_max_f32 v87, 0, v87
    v_mfma_f32_32x32x16_bf16 v[112:127], v[132:135], v[224:227], v[112:127]
    ds_read_b64_tr_b16 v[132:133], v162 offset:4096
    ds_read_b64_tr_b16 v[134:135], v162 offset:4608
    v_mul_f32 v80, v80, v88
    v_mul_f32 v81, v81, v89
    v_mul_f32 v82, v82, v90
    v_mul_f32 v83, v83, v91
    v_mul_f32 v84, v84, v92
    v_mfma_f32_32x32x16_bf16 v[112:127], v[136:139], v[228:231], v[112:127]
    ds_read_b64_tr_b16 v[136:137], v162 offset:8192
    ds_read_b64_tr_b16 v[138:139], v162 offset:8704
    s_add_u32 s70, s73, 32768
    buffer_load_dwordx4 a[104:107], v255, s[40:43], s70 offen
    v_mul_f32 v85, v85, v93
    v_mul_f32 v86, v86, v94
    v_mul_f32 v87, v87, v95
    v_mfma_f32_32x32x16_bf16 v[112:127], v[140:143], v[232:235], v[112:127]
    ds_read_b64_tr_b16 v[140:141], v162 offset:12288
    ds_read_b64_tr_b16 v[142:143], v162 offset:12800
    v_cvt_pk_bf16_f32 v80, v80, v81
    v_cvt_pk_bf16_f32 v81, v82, v83
    v_cvt_pk_bf16_f32 v82, v84, v85
    v_cvt_pk_bf16_f32 v83, v86, v87
    s_cmp_ge_u32 s45, 10
    s_cbranch_scc1 L_hs_84
    buffer_store_dwordx4 v[80:83], v1, s[16:19], s87 offen offset:2048
L_hr_85:
    s_waitcnt lgkmcnt(8)
    v_mfma_f32_32x32x16_bf16 v[64:79], v[144:147], v[220:223], 0
    v_subrev_u32 v163, 0x10000, v163
    ds_read_b64_tr_b16 v[144:145], v163 offset:0
    ds_read_b64_tr_b16 v[146:147], v163 offset:512
    buffer_load_dwordx4 v[192:195], v1, s[16:19], s64 offen offset:1024 sc1
    v_max_f32 v96, 0, v96
    v_max_f32 v97, 0, v97
    v_max_f32 v98, 0, v98
    v_max_f32 v99, 0, v99
    v_mfma_f32_32x32x16_bf16 v[64:79], v[148:151], v[224:227], v[64:79]
    ds_read_b64_tr_b16 v[148:149], v163 offset:4096
    ds_read_b64_tr_b16 v[150:151], v163 offset:4608
    v_max_f32 v100, 0, v100
    v_max_f32 v101, 0, v101
    v_max_f32 v102, 0, v102
    v_max_f32 v103, 0, v103
    v_mul_f32 v96, v96, v104
    v_mfma_f32_32x32x16_bf16 v[64:79], v[152:155], v[228:231], v[64:79]
    ds_read_b64_tr_b16 v[152:153], v163 offset:8192
    ds_read_b64_tr_b16 v[154:155], v163 offset:8704
    s_add_u32 s70, s73, 40960
    buffer_load_dwordx4 a[108:111], v255, s[40:43], s70 offen
    v_mul_f32 v97, v97, v105
    v_mul_f32 v98, v98, v106
    v_mul_f32 v99, v99, v107
    v_mfma_f32_32x32x16_bf16 v[64:79], v[156:159], v[232:235], v[64:79]
    ds_read_b64_tr_b16 v[156:157], v163 offset:12288
    ds_read_b64_tr_b16 v[158:159], v163 offset:12800
    v_mul_f32 v100, v100, v108
    v_mul_f32 v101, v101, v109
    v_mul_f32 v102, v102, v110
    v_mul_f32 v103, v103, v111
    v_cvt_pk_bf16_f32 v96, v96, v97
    s_waitcnt lgkmcnt(8)
    v_mfma_f32_32x32x16_bf16 v[80:95], v[128:131], v[220:223], 0
    ds_read_b64_tr_b16 v[128:129], v160 offset:16384
    ds_read_b64_tr_b16 v[130:131], v160 offset:16896
    buffer_load_dwordx4 v[196:199], v1, s[16:19], s64 offen offset:2048 sc1
    v_cvt_pk_bf16_f32 v97, v98, v99
    v_cvt_pk_bf16_f32 v98, v100, v101
    v_cvt_pk_bf16_f32 v99, v102, v103
    s_cmp_ge_u32 s45, 10
    s_cbranch_scc1 L_hs_86
    buffer_store_dwordx4 v[96:99], v1, s[16:19], s87 offen offset:3072
L_hr_87:
    v_mfma_f32_32x32x16_bf16 v[80:95], v[132:135], v[224:227], v[80:95]
    ds_read_b64_tr_b16 v[132:133], v161 offset:16384
    ds_read_b64_tr_b16 v[134:135], v161 offset:16896
    v_mfma_f32_32x32x16_bf16 v[80:95], v[136:139], v[228:231], v[80:95]
    ds_read_b64_tr_b16 v[136:137], v162 offset:16384
    ds_read_b64_tr_b16 v[138:139], v162 offset:16896
    s_lshl1_add_u32 m0, s69, 135168
    s_add_u32 s73, s73, 49152
    s_sub_u32 s70, s73, s67
    s_cmp_eq_u32 s70, 458752
    s_cmov_b32 s73, s67
    s_add_u32 s70, s73, 0
    buffer_load_dwordx4 v255, s[40:43], s70 offen lds
    v_mfma_f32_32x32x16_bf16 v[80:95], v[140:143], v[232:235], v[80:95]
    ds_read_b64_tr_b16 v[140:141], v163 offset:16384
    ds_read_b64_tr_b16 v[142:143], v163 offset:16896
    s_waitcnt lgkmcnt(8)
    v_mfma_f32_32x32x16_bf16 v[96:111], v[144:147], v[220:223], 0
    ds_read_b64_tr_b16 v[144:145], v160 offset:20480
    ds_read_b64_tr_b16 v[146:147], v160 offset:20992
    buffer_load_dwordx4 v[200:203], v1, s[16:19], s64 offen offset:3072 sc1
    v_mfma_f32_32x32x16_bf16 v[96:111], v[148:151], v[224:227], v[96:111]
    ds_read_b64_tr_b16 v[148:149], v161 offset:20480
    ds_read_b64_tr_b16 v[150:151], v161 offset:20992
    v_mfma_f32_32x32x16_bf16 v[96:111], v[152:155], v[228:231], v[96:111]
    ds_read_b64_tr_b16 v[152:153], v162 offset:20480
    ds_read_b64_tr_b16 v[154:155], v162 offset:20992
    s_lshl1_add_u32 m0, s69, 136192
    s_add_u32 s70, s73, 8192
    buffer_load_dwordx4 v255, s[40:43], s70 offen lds
    v_mfma_f32_32x32x16_bf16 v[96:111], v[156:159], v[232:235], v[96:111]
    ds_read_b64_tr_b16 v[156:157], v163 offset:20480
    ds_read_b64_tr_b16 v[158:159], v163 offset:20992
    s_waitcnt vmcnt(40) lgkmcnt(8)
    v_mfma_f32_32x32x16_bf16 v[112:127], v[128:131], v[236:239], v[112:127]
    ds_read_b64_tr_b16 v[128:129], v160 offset:24576
    ds_read_b64_tr_b16 v[130:131], v160 offset:25088
    s_add_u32 s64, s64, 4096
    buffer_load_dwordx4 v[204:207], v1, s[16:19], s64 offen offset:0 sc1
    v_mfma_f32_32x32x16_bf16 v[64:79], v[132:135], v[236:239], v[64:79]
    ds_read_b64_tr_b16 v[132:133], v161 offset:24576
    ds_read_b64_tr_b16 v[134:135], v161 offset:25088
    v_mfma_f32_32x32x16_bf16 v[80:95], v[136:139], v[236:239], v[80:95]
    ds_read_b64_tr_b16 v[136:137], v162 offset:24576
    ds_read_b64_tr_b16 v[138:139], v162 offset:25088
    s_lshl1_add_u32 m0, s69, 137216
    s_add_u32 s70, s73, 16384
    buffer_load_dwordx4 v255, s[40:43], s70 offen lds
    v_mfma_f32_32x32x16_bf16 v[96:111], v[140:143], v[236:239], v[96:111]
    ds_read_b64_tr_b16 v[140:141], v163 offset:24576
    ds_read_b64_tr_b16 v[142:143], v163 offset:25088
    s_waitcnt vmcnt(40) lgkmcnt(8)
    v_mfma_f32_32x32x16_bf16 v[112:127], v[144:147], v[240:243], v[112:127]
    ds_read_b64_tr_b16 v[144:145], v160 offset:28672
    ds_read_b64_tr_b16 v[146:147], v160 offset:29184
    buffer_load_dwordx4 v[208:211], v1, s[16:19], s64 offen offset:1024 sc1
    v_mfma_f32_32x32x16_bf16 v[64:79], v[148:151], v[240:243], v[64:79]
    ds_read_b64_tr_b16 v[148:149], v161 offset:28672
    ds_read_b64_tr_b16 v[150:151], v161 offset:29184
    v_mfma_f32_32x32x16_bf16 v[80:95], v[152:155], v[240:243], v[80:95]
    ds_read_b64_tr_b16 v[152:153], v162 offset:28672
    ds_read_b64_tr_b16 v[154:155], v162 offset:29184
    s_lshl1_add_u32 m0, s69, 138240
    s_add_u32 s70, s73, 24576
    buffer_load_dwordx4 v255, s[40:43], s70 offen lds
    v_mfma_f32_32x32x16_bf16 v[96:111], v[156:159], v[240:243], v[96:111]
    ds_read_b64_tr_b16 v[156:157], v163 offset:28672
    ds_read_b64_tr_b16 v[158:159], v163 offset:29184
    s_waitcnt vmcnt(40) lgkmcnt(8)
    v_mfma_f32_32x32x16_bf16 v[112:127], v[128:131], v[244:247], v[112:127]
    ds_read_b64_tr_b16 v[128:129], v160 offset:32768
    ds_read_b64_tr_b16 v[130:131], v160 offset:33280
    buffer_load_dwordx4 v[212:215], v1, s[16:19], s64 offen offset:2048 sc1
    v_mfma_f32_32x32x16_bf16 v[64:79], v[132:135], v[244:247], v[64:79]
    ds_read_b64_tr_b16 v[132:133], v161 offset:32768
    ds_read_b64_tr_b16 v[134:135], v161 offset:33280
    v_mfma_f32_32x32x16_bf16 v[80:95], v[136:139], v[244:247], v[80:95]
    ds_read_b64_tr_b16 v[136:137], v162 offset:32768
    ds_read_b64_tr_b16 v[138:139], v162 offset:33280
    s_lshl1_add_u32 m0, s69, 131072
    s_add_u32 s70, s73, 32768
    buffer_load_dwordx4 v255, s[40:43], s70 offen lds
    v_mfma_f32_32x32x16_bf16 v[96:111], v[140:143], v[244:247], v[96:111]
    ds_read_b64_tr_b16 v[140:141], v163 offset:32768
    ds_read_b64_tr_b16 v[142:143], v163 offset:33280
    s_waitcnt vmcnt(40) lgkmcnt(8)
    v_mfma_f32_32x32x16_bf16 v[112:127], v[144:147], v[248:251], v[112:127]
    ds_read_b64_tr_b16 v[144:145], v160 offset:36864
    ds_read_b64_tr_b16 v[146:147], v160 offset:37376
    buffer_load_dwordx4 v[216:219], v1, s[16:19], s64 offen offset:3072 sc1
    v_mfma_f32_32x32x16_bf16 v[64:79], v[148:151], v[248:251], v[64:79]
    ds_read_b64_tr_b16 v[148:149], v161 offset:36864
    ds_read_b64_tr_b16 v[150:151], v161 offset:37376
    v_mfma_f32_32x32x16_bf16 v[80:95], v[152:155], v[248:251], v[80:95]
    ds_read_b64_tr_b16 v[152:153], v162 offset:36864
    ds_read_b64_tr_b16 v[154:155], v162 offset:37376
    s_lshl1_add_u32 m0, s69, 132096
    s_add_u32 s70, s73, 40960
    buffer_load_dwordx4 v255, s[40:43], s70 offen lds
    v_mfma_f32_32x32x16_bf16 v[96:111], v[156:159], v[248:251], v[96:111]
    ds_read_b64_tr_b16 v[156:157], v163 offset:36864
    ds_read_b64_tr_b16 v[158:159], v163 offset:37376
    s_waitcnt vmcnt(40) lgkmcnt(8)
    v_mfma_f32_32x32x16_bf16 v[112:127], v[128:131], a[192:195], v[112:127]
    ds_read_b64_tr_b16 v[128:129], v160 offset:40960
    ds_read_b64_tr_b16 v[130:131], v160 offset:41472
    s_add_u32 s64, s64, 4096
    buffer_load_dwordx4 v[220:223], v1, s[16:19], s64 offen offset:0 sc1
    v_mfma_f32_32x32x16_bf16 v[64:79], v[132:135], a[192:195], v[64:79]
    ds_read_b64_tr_b16 v[132:133], v161 offset:40960
    ds_read_b64_tr_b16 v[134:135], v161 offset:41472
    v_mfma_f32_32x32x16_bf16 v[80:95], v[136:139], a[192:195], v[80:95]
    ds_read_b64_tr_b16 v[136:137], v162 offset:40960
    ds_read_b64_tr_b16 v[138:139], v162 offset:41472
    s_lshl1_add_u32 m0, s69, 133120
    s_add_u32 s70, s73, 49152
    buffer_load_dwordx4 v255, s[40:43], s70 offen lds
    v_mfma_f32_32x32x16_bf16 v[96:111], v[140:143], a[192:195], v[96:111]
    ds_read_b64_tr_b16 v[140:141], v163 offset:40960
    ds_read_b64_tr_b16 v[142:143], v163 offset:41472
    v_mov_b32 v252, 8
    s_waitcnt vmcnt(13)
    s_mov_b64 exec, 1
    s_cmp_lg_u32 s50, 0
    s_cbranch_scc1 L_pub_88
    buffer_store_dword v252, off, s[16:19], s52
L_pur_89:
    s_mov_b64 exec, -1
    s_waitcnt lgkmcnt(8)
    v_mfma_f32_32x32x16_bf16 v[112:127], v[144:147], a[196:199], v[112:127]
    ds_read_b64_tr_b16 v[144:145], v160 offset:45056
    ds_read_b64_tr_b16 v[146:147], v160 offset:45568
    buffer_load_dwordx4 v[224:227], v1, s[16:19], s64 offen offset:1024 sc1
    v_mfma_f32_32x32x16_bf16 v[64:79], v[148:151], a[196:199], v[64:79]
    ds_read_b64_tr_b16 v[148:149], v161 offset:45056
    ds_read_b64_tr_b16 v[150:151], v161 offset:45568
    v_mfma_f32_32x32x16_bf16 v[80:95], v[152:155], a[196:199], v[80:95]
    ds_read_b64_tr_b16 v[152:153], v162 offset:45056
    ds_read_b64_tr_b16 v[154:155], v162 offset:45568
    s_waitcnt vmcnt(12)
    ds_read_b64_tr_b16 a[112:113], v186 offset:4096
    ds_read_b64_tr_b16 a[114:115], v186 offset:5120
    ds_read_b64_tr_b16 a[116:117], v187 offset:4096
    ds_read_b64_tr_b16 a[118:119], v187 offset:5120
    s_lshl1_add_u32 m0, s69, 134144
    s_add_u32 s70, s73, 57344
    buffer_load_dwordx4 v255, s[40:43], s70 offen lds
    v_mfma_f32_32x32x16_bf16 v[96:111], v[156:159], a[196:199], v[96:111]
    ds_read_b64_tr_b16 v[156:157], v163 offset:45056
    ds_read_b64_tr_b16 v[158:159], v163 offset:45568
    s_waitcnt lgkmcnt(12)
    v_mfma_f32_32x32x16_bf16 v[112:127], v[128:131], a[200:203], v[112:127]
    ds_read_b64_tr_b16 v[128:129], v160 offset:49152
    ds_read_b64_tr_b16 v[130:131], v160 offset:49664
    buffer_load_dwordx4 v[228:231], v1, s[16:19], s64 offen offset:2048 sc1
    v_mfma_f32_32x32x16_bf16 v[64:79], v[132:135], a[200:203], v[64:79]
    ds_read_b64_tr_b16 v[132:133], v161 offset:49152
    ds_read_b64_tr_b16 v[134:135], v161 offset:49664
    v_mfma_f32_32x32x16_bf16 v[80:95], v[136:139], a[200:203], v[80:95]
    ds_read_b64_tr_b16 v[136:137], v162 offset:49152
    ds_read_b64_tr_b16 v[138:139], v162 offset:49664
    s_waitcnt lgkmcnt(8)
    s_lshl1_add_u32 m0, s69, 135168
    s_add_u32 s73, s73, 65536
    s_sub_u32 s70, s73, s67
    s_cmp_eq_u32 s70, 458752
    s_cmov_b32 s73, s67
    s_add_u32 s70, s73, 0
    buffer_load_dwordx4 v255, s[40:43], s70 offen lds
    v_mfma_f32_32x32x16_bf16 v[96:111], v[140:143], a[200:203], v[96:111]
    ds_read_b64_tr_b16 v[140:141], v163 offset:49152
    ds_read_b64_tr_b16 v[142:143], v163 offset:49664
    s_waitcnt lgkmcnt(8)
    v_mfma_f32_32x32x16_bf16 v[112:127], v[144:147], a[204:207], v[112:127]
    ds_read_b64_tr_b16 v[144:145], v160 offset:53248
    ds_read_b64_tr_b16 v[146:147], v160 offset:53760
    buffer_load_dwordx4 v[232:235], v1, s[16:19], s64 offen offset:3072 sc1
    v_mfma_f32_32x32x16_bf16 v[64:79], v[148:151], a[204:207], v[64:79]
    ds_read_b64_tr_b16 v[148:149], v161 offset:53248
    ds_read_b64_tr_b16 v[150:151], v161 offset:53760
    v_mfma_f32_32x32x16_bf16 v[80:95], v[152:155], a[204:207], v[80:95]
    ds_read_b64_tr_b16 v[152:153], v162 offset:53248
    ds_read_b64_tr_b16 v[154:155], v162 offset:53760
    s_lshl1_add_u32 m0, s69, 136192
    s_add_u32 s70, s73, 8192
    buffer_load_dwordx4 v255, s[40:43], s70 offen lds
    v_mfma_f32_32x32x16_bf16 v[96:111], v[156:159], a[204:207], v[96:111]
    ds_read_b64_tr_b16 v[156:157], v163 offset:53248
    ds_read_b64_tr_b16 v[158:159], v163 offset:53760
    s_waitcnt vmcnt(13)
    ds_read_b64_tr_b16 a[120:121], v186 offset:6144
    ds_read_b64_tr_b16 a[122:123], v186 offset:7168
    s_waitcnt lgkmcnt(10)
    v_mfma_f32_32x32x16_bf16 v[112:127], v[128:131], a[208:211], v[112:127]
    ds_read_b64_tr_b16 v[128:129], v160 offset:57344
    ds_read_b64_tr_b16 v[130:131], v160 offset:57856
    s_add_u32 s64, s64, 4096
    buffer_load_dwordx4 v[236:239], v1, s[16:19], s64 offen offset:0 sc1
    ds_read_b64_tr_b16 a[124:125], v187 offset:6144
    ds_read_b64_tr_b16 a[126:127], v187 offset:7168
    v_mfma_f32_32x32x16_bf16 v[64:79], v[132:135], a[208:211], v[64:79]
    ds_read_b64_tr_b16 v[132:133], v161 offset:57344
    ds_read_b64_tr_b16 v[134:135], v161 offset:57856
    v_mfma_f32_32x32x16_bf16 v[80:95], v[136:139], a[208:211], v[80:95]
    ds_read_b64_tr_b16 v[136:137], v162 offset:57344
    ds_read_b64_tr_b16 v[138:139], v162 offset:57856
    s_waitcnt lgkmcnt(4)
    s_lshl1_add_u32 m0, s69, 137216
    s_add_u32 s70, s73, 16384
    buffer_load_dwordx4 v255, s[40:43], s70 offen lds
    v_mfma_f32_32x32x16_bf16 v[96:111], v[140:143], a[208:211], v[96:111]
    ds_read_b64_tr_b16 v[140:141], v163 offset:57344
    ds_read_b64_tr_b16 v[142:143], v163 offset:57856
    v_mfma_f32_32x32x16_bf16 v[112:127], v[144:147], a[212:215], v[112:127]
    ds_read_b64_tr_b16 v[144:145], v160 offset:61440
    ds_read_b64_tr_b16 v[146:147], v160 offset:61952
    buffer_load_dwordx4 v[240:243], v1, s[16:19], s64 offen offset:1024 sc1
    v_mfma_f32_32x32x16_bf16 v[64:79], v[148:151], a[212:215], v[64:79]
    ds_read_b64_tr_b16 v[148:149], v161 offset:61440
    ds_read_b64_tr_b16 v[150:151], v161 offset:61952
    v_mfma_f32_32x32x16_bf16 v[80:95], v[152:155], a[212:215], v[80:95]
    ds_read_b64_tr_b16 v[152:153], v162 offset:61440
    ds_read_b64_tr_b16 v[154:155], v162 offset:61952
    s_lshl1_add_u32 m0, s69, 138240
    s_add_u32 s70, s73, 24576
    buffer_load_dwordx4 v255, s[40:43], s70 offen lds
    v_mfma_f32_32x32x16_bf16 v[96:111], v[156:159], a[212:215], v[96:111]
    ds_read_b64_tr_b16 v[156:157], v163 offset:61440
    ds_read_b64_tr_b16 v[158:159], v163 offset:61952
    s_waitcnt vmcnt(13)
    ds_read_b64_tr_b16 a[128:129], v186 offset:0
    ds_read_b64_tr_b16 a[130:131], v186 offset:1024
    s_waitcnt lgkmcnt(10)
    v_mfma_f32_32x32x16_bf16 v[112:127], v[128:131], a[216:219], v[112:127]
    v_add_u32 v160, 0x10000, v160
    ds_read_b64_tr_b16 v[128:129], v160 offset:0
    ds_read_b64_tr_b16 v[130:131], v160 offset:512
    buffer_load_dwordx4 v[244:247], v1, s[16:19], s64 offen offset:2048 sc1
    ds_read_b64_tr_b16 a[132:133], v187 offset:0
    ds_read_b64_tr_b16 a[134:135], v187 offset:1024
    v_mfma_f32_32x32x16_bf16 v[64:79], v[132:135], a[216:219], v[64:79]
    v_add_u32 v161, 0x10000, v161
    ds_read_b64_tr_b16 v[132:133], v161 offset:0
    ds_read_b64_tr_b16 v[134:135], v161 offset:512
    v_add_f32 v164, v164, v165
    v_add_f32 v166, v166, v167
    v_mfma_f32_32x32x16_bf16 v[80:95], v[136:139], a[216:219], v[80:95]
    v_add_u32 v162, 0x10000, v162
    ds_read_b64_tr_b16 v[136:137], v162 offset:0
    ds_read_b64_tr_b16 v[138:139], v162 offset:512
    s_waitcnt lgkmcnt(4)
    s_lshl1_add_u32 m0, s69, 131072
    s_add_u32 s70, s73, 32768
    buffer_load_dwordx4 v255, s[40:43], s70 offen lds
    v_mfma_f32_32x32x16_bf16 v[96:111], v[140:143], a[216:219], v[96:111]
    v_add_u32 v163, 0x10000, v163
    ds_read_b64_tr_b16 v[140:141], v163 offset:0
    ds_read_b64_tr_b16 v[142:143], v163 offset:512
    buffer_load_dword v184, v22, s[16:19], s53 offen sc1
    v_mfma_f32_32x32x16_bf16 v[112:127], v[144:147], a[220:223], v[112:127]
    ds_read_b64_tr_b16 v[144:145], v160 offset:4096
    ds_read_b64_tr_b16 v[146:147], v160 offset:4608
    buffer_load_dwordx4 v[248:251], v1, s[16:19], s64 offen offset:3072 sc1
    v_mfma_f32_32x32x16_bf16 v[64:79], v[148:151], a[220:223], v[64:79]
    ds_read_b64_tr_b16 v[148:149], v161 offset:4096
    ds_read_b64_tr_b16 v[150:151], v161 offset:4608
    v_add_f32 v168, v168, v169
    v_add_f32 v170, v170, v171
    v_mfma_f32_32x32x16_bf16 v[80:95], v[152:155], a[220:223], v[80:95]
    ds_read_b64_tr_b16 v[152:153], v162 offset:4096
    ds_read_b64_tr_b16 v[154:155], v162 offset:4608
    s_lshl1_add_u32 m0, s69, 132096
    s_add_u32 s70, s73, 40960
    buffer_load_dwordx4 v255, s[40:43], s70 offen lds
    v_mfma_f32_32x32x16_bf16 v[96:111], v[156:159], a[220:223], v[96:111]
    ds_read_b64_tr_b16 v[156:157], v163 offset:4096
    ds_read_b64_tr_b16 v[158:159], v163 offset:4608
    s_waitcnt vmcnt(13)
    ds_read_b64_tr_b16 a[136:137], v186 offset:2048
    ds_read_b64_tr_b16 a[138:139], v186 offset:3072
    s_waitcnt lgkmcnt(10)
    v_mfma_f32_32x32x16_bf16 v[112:127], v[128:131], v[188:191], v[112:127]
    ds_read_b64_tr_b16 v[128:129], v160 offset:8192
    ds_read_b64_tr_b16 v[130:131], v160 offset:8704
    ds_read_b64_tr_b16 a[140:141], v187 offset:2048
    ds_read_b64_tr_b16 a[142:143], v187 offset:3072
    v_mfma_f32_32x32x16_bf16 v[64:79], v[132:135], v[188:191], v[64:79]
    ds_read_b64_tr_b16 v[132:133], v161 offset:8192
    ds_read_b64_tr_b16 v[134:135], v161 offset:8704
    v_add_f32 v164, v164, v166
    v_add_f32 v168, v168, v170
    v_mfma_f32_32x32x16_bf16 v[80:95], v[136:139], v[188:191], v[80:95]
    ds_read_b64_tr_b16 v[136:137], v162 offset:8192
    ds_read_b64_tr_b16 v[138:139], v162 offset:8704
    s_waitcnt lgkmcnt(4)
    s_lshl1_add_u32 m0, s69, 133120
    s_add_u32 s73, s73, 49152
    s_sub_u32 s70, s73, s67
    s_cmp_eq_u32 s70, 458752
    s_cmov_b32 s73, s67
    s_add_u32 s70, s73, 0
    buffer_load_dwordx4 v255, s[40:43], s70 offen lds
    v_mfma_f32_32x32x16_bf16 v[96:111], v[140:143], v[188:191], v[96:111]
    ds_read_b64_tr_b16 v[140:141], v163 offset:8192
    ds_read_b64_tr_b16 v[142:143], v163 offset:8704
    v_mfma_f32_32x32x16_bf16 v[112:127], v[144:147], v[192:195], v[112:127]
    ds_read_b64_tr_b16 v[144:145], v160 offset:12288
    ds_read_b64_tr_b16 v[146:147], v160 offset:12800
    v_mfma_f32_32x32x16_bf16 v[64:79], v[148:151], v[192:195], v[64:79]
    ds_read_b64_tr_b16 v[148:149], v161 offset:12288
    ds_read_b64_tr_b16 v[150:151], v161 offset:12800
    v_add_f32 v164, v164, v168
    v_mov_b32 v165, v164
    v_mfma_f32_32x32x16_bf16 v[80:95], v[152:155], v[192:195], v[80:95]
    ds_read_b64_tr_b16 v[152:153], v162 offset:12288
    ds_read_b64_tr_b16 v[154:155], v162 offset:12800
    s_lshl1_add_u32 m0, s69, 134144
    s_add_u32 s70, s73, 8192
    buffer_load_dwordx4 v255, s[40:43], s70 offen lds
    v_mfma_f32_32x32x16_bf16 v[96:111], v[156:159], v[192:195], v[96:111]
    ds_read_b64_tr_b16 v[156:157], v163 offset:12288
    ds_read_b64_tr_b16 v[158:159], v163 offset:12800
    s_waitcnt vmcnt(11)
    ds_read_b64_tr_b16 a[144:145], v186 offset:4096
    ds_read_b64_tr_b16 a[146:147], v186 offset:5120
    s_waitcnt lgkmcnt(10)
    v_mfma_f32_32x32x16_bf16 v[112:127], v[128:131], v[196:199], v[112:127]
    ds_read_b64_tr_b16 v[128:129], v160 offset:16384
    ds_read_b64_tr_b16 v[130:131], v160 offset:16896
    ds_read_b64_tr_b16 a[148:149], v187 offset:4096
    ds_read_b64_tr_b16 a[150:151], v187 offset:5120
    v_mfma_f32_32x32x16_bf16 v[64:79], v[132:135], v[196:199], v[64:79]
    ds_read_b64_tr_b16 v[132:133], v161 offset:16384
    ds_read_b64_tr_b16 v[134:135], v161 offset:16896
    v_permlane32_swap_b32 v164, v165
    v_mul_f32 v164, 0x3b000000, v164
    v_mfma_f32_32x32x16_bf16 v[80:95], v[136:139], v[196:199], v[80:95]
    ds_read_b64_tr_b16 v[136:137], v162 offset:16384
    ds_read_b64_tr_b16 v[138:139], v162 offset:16896
    s_waitcnt lgkmcnt(4)
    s_lshl1_add_u32 m0, s69, 135168
    s_add_u32 s70, s73, 16384
    buffer_load_dwordx4 v255, s[40:43], s70 offen lds
    v_mfma_f32_32x32x16_bf16 v[96:111], v[140:143], v[196:199], v[96:111]
    ds_read_b64_tr_b16 v[140:141], v163 offset:16384
    ds_read_b64_tr_b16 v[142:143], v163 offset:16896
    v_mfma_f32_32x32x16_bf16 v[112:127], v[144:147], v[200:203], v[112:127]
    ds_read_b64_tr_b16 v[144:145], v160 offset:20480
    ds_read_b64_tr_b16 v[146:147], v160 offset:20992
    v_mfma_f32_32x32x16_bf16 v[64:79], v[148:151], v[200:203], v[64:79]
    ds_read_b64_tr_b16 v[148:149], v161 offset:20480
    ds_read_b64_tr_b16 v[150:151], v161 offset:20992
    v_cvt_pk_bf16_f32 v180, -v164, -v164
    v_mov_b32 v181, v180
    v_mfma_f32_32x32x16_bf16 v[80:95], v[152:155], v[200:203], v[80:95]
    ds_read_b64_tr_b16 v[152:153], v162 offset:20480
    ds_read_b64_tr_b16 v[154:155], v162 offset:20992
    s_lshl1_add_u32 m0, s69, 136192
    s_add_u32 s70, s73, 24576
    buffer_load_dwordx4 v255, s[40:43], s70 offen lds
    v_mfma_f32_32x32x16_bf16 v[96:111], v[156:159], v[200:203], v[96:111]
    ds_read_b64_tr_b16 v[156:157], v163 offset:20480
    ds_read_b64_tr_b16 v[158:159], v163 offset:20992
    s_waitcnt vmcnt(9)
    ds_read_b64_tr_b16 a[152:153], v186 offset:6144
    ds_read_b64_tr_b16 a[154:155], v186 offset:7168
    s_waitcnt lgkmcnt(10)
    v_mfma_f32_32x32x16_bf16 v[112:127], v[128:131], v[204:207], v[112:127]
    ds_read_b64_tr_b16 v[128:129], v160 offset:24576
    ds_read_b64_tr_b16 v[130:131], v160 offset:25088
    ds_read_b64_tr_b16 a[156:157], v187 offset:6144
    ds_read_b64_tr_b16 a[158:159], v187 offset:7168
    v_mfma_f32_32x32x16_bf16 v[64:79], v[132:135], v[204:207], v[64:79]
    ds_read_b64_tr_b16 v[132:133], v161 offset:24576
    ds_read_b64_tr_b16 v[134:135], v161 offset:25088
    v_mov_b32 v182, v180
    v_mov_b32 v183, v180
    v_mfma_f32_32x32x16_bf16 v[80:95], v[136:139], v[204:207], v[80:95]
    ds_read_b64_tr_b16 v[136:137], v162 offset:24576
    ds_read_b64_tr_b16 v[138:139], v162 offset:25088
    s_waitcnt lgkmcnt(4)
    s_lshl1_add_u32 m0, s69, 137216
    s_add_u32 s70, s73, 32768
    buffer_load_dwordx4 v255, s[40:43], s70 offen lds
    v_mfma_f32_32x32x16_bf16 v[96:111], v[140:143], v[204:207], v[96:111]
    ds_read_b64_tr_b16 v[140:141], v163 offset:24576
    ds_read_b64_tr_b16 v[142:143], v163 offset:25088
    v_mfma_f32_32x32x16_bf16 v[112:127], v[144:147], v[208:211], v[112:127]
    ds_read_b64_tr_b16 v[144:145], v160 offset:28672
    ds_read_b64_tr_b16 v[146:147], v160 offset:29184
    v_mfma_f32_32x32x16_bf16 v[64:79], v[148:151], v[208:211], v[64:79]
    ds_read_b64_tr_b16 v[148:149], v161 offset:28672
    ds_read_b64_tr_b16 v[150:151], v161 offset:29184
    v_mfma_f32_32x32x16_bf16 v[80:95], v[152:155], v[208:211], v[80:95]
    ds_read_b64_tr_b16 v[152:153], v162 offset:28672
    ds_read_b64_tr_b16 v[154:155], v162 offset:29184
    s_lshl1_add_u32 m0, s69, 138240
    s_add_u32 s70, s73, 40960
    buffer_load_dwordx4 v255, s[40:43], s70 offen lds
    v_mfma_f32_32x32x16_bf16 v[96:111], v[156:159], v[208:211], v[96:111]
    ds_read_b64_tr_b16 v[156:157], v163 offset:28672
    ds_read_b64_tr_b16 v[158:159], v163 offset:29184
    s_waitcnt vmcnt(6)
    ds_read_b64_tr_b16 a[160:161], v186 offset:0
    ds_read_b64_tr_b16 a[162:163], v186 offset:1024
    s_waitcnt lgkmcnt(10)
    v_mfma_f32_32x32x16_bf16 v[112:127], v[128:131], v[212:215], v[112:127]
    ds_read_b64_tr_b16 v[128:129], v160 offset:32768
    ds_read_b64_tr_b16 v[130:131], v160 offset:33280
    ds_read_b64_tr_b16 a[164:165], v187 offset:0
    ds_read_b64_tr_b16 a[166:167], v187 offset:1024
    v_mfma_f32_32x32x16_bf16 v[64:79], v[132:135], v[212:215], v[64:79]
    ds_read_b64_tr_b16 v[132:133], v161 offset:32768
    ds_read_b64_tr_b16 v[134:135], v161 offset:33280
    v_mfma_f32_32x32x16_bf16 v[80:95], v[136:139], v[212:215], v[80:95]
    ds_read_b64_tr_b16 v[136:137], v162 offset:32768
    ds_read_b64_tr_b16 v[138:139], v162 offset:33280
    s_waitcnt lgkmcnt(4)
    s_lshl1_add_u32 m0, s69, 131072
    s_add_u32 s70, s73, 49152
    buffer_load_dwordx4 v255, s[40:43], s70 offen lds
    v_mfma_f32_32x32x16_bf16 v[96:111], v[140:143], v[212:215], v[96:111]
    ds_read_b64_tr_b16 v[140:141], v163 offset:32768
    ds_read_b64_tr_b16 v[142:143], v163 offset:33280
    v_mfma_f32_32x32x16_bf16 v[112:127], v[144:147], v[216:219], v[112:127]
    ds_read_b64_tr_b16 v[144:145], v160 offset:36864
    ds_read_b64_tr_b16 v[146:147], v160 offset:37376
    v_mfma_f32_32x32x16_bf16 v[64:79], v[148:151], v[216:219], v[64:79]
    ds_read_b64_tr_b16 v[148:149], v161 offset:36864
    ds_read_b64_tr_b16 v[150:151], v161 offset:37376
    v_mfma_f32_32x32x16_bf16 v[80:95], v[152:155], v[216:219], v[80:95]
    ds_read_b64_tr_b16 v[152:153], v162 offset:36864
    ds_read_b64_tr_b16 v[154:155], v162 offset:37376
    s_lshl1_add_u32 m0, s69, 132096
    s_add_u32 s70, s73, 57344
    buffer_load_dwordx4 v255, s[40:43], s70 offen lds
    v_mfma_f32_32x32x16_bf16 v[96:111], v[156:159], v[216:219], v[96:111]
    ds_read_b64_tr_b16 v[156:157], v163 offset:36864
    ds_read_b64_tr_b16 v[158:159], v163 offset:37376
    s_waitcnt vmcnt(6)
    ds_read_b64_tr_b16 a[168:169], v186 offset:2048
    ds_read_b64_tr_b16 a[170:171], v186 offset:3072
    s_waitcnt lgkmcnt(10)
    v_mfma_f32_32x32x16_bf16 v[112:127], v[128:131], v[220:223], v[112:127]
    ds_read_b64_tr_b16 v[128:129], v160 offset:40960
    ds_read_b64_tr_b16 v[130:131], v160 offset:41472
    v_cmp_gt_u32 vcc, 8, v184
    s_nop 1
    s_cbranch_vccnz L_poll_90
L_ok_91:
    s_cmp_lg_u32 s50, 0
    s_cbranch_scc1 L_acq_92
L_acr_93:
    s_add_u32 s80, s75, s61
    s_add_u32 s81, s80, 28672
    s_add_u32 s64, s82, 2
    s_and_b32 s64, s64, 3
    s_mul_i32 s64, s64, 7168
    s_add_u32 s64, s64, s80
    s_add_u32 s64, s64, s83
    buffer_load_dwordx4 v[188:191], v1, s[16:19], s64 offen offset:0 sc1
    ds_read_b64_tr_b16 a[172:173], v187 offset:2048
    ds_read_b64_tr_b16 a[174:175], v187 offset:3072
    v_mfma_f32_32x32x16_bf16 v[64:79], v[132:135], v[220:223], v[64:79]
    ds_read_b64_tr_b16 v[132:133], v161 offset:40960
    ds_read_b64_tr_b16 v[134:135], v161 offset:41472
    v_mfma_f32_32x32x16_bf16 v[80:95], v[136:139], v[220:223], v[80:95]
    ds_read_b64_tr_b16 v[136:137], v162 offset:40960
    ds_read_b64_tr_b16 v[138:139], v162 offset:41472
    s_waitcnt lgkmcnt(4)
    s_lshl1_add_u32 m0, s69, 133120
    s_add_u32 s73, s73, 65536
    s_sub_u32 s70, s73, s67
    s_cmp_eq_u32 s70, 458752
    s_cmov_b32 s73, s67
    s_add_u32 s70, s73, 0
    buffer_load_dwordx4 v255, s[40:43], s70 offen lds
    v_mfma_f32_32x32x16_bf16 v[96:111], v[140:143], v[220:223], v[96:111]
    ds_read_b64_tr_b16 v[140:141], v163 offset:40960
    ds_read_b64_tr_b16 v[142:143], v163 offset:41472
    v_mfma_f32_32x32x16_bf16 v[112:127], v[144:147], v[224:227], v[112:127]
    ds_read_b64_tr_b16 v[144:145], v160 offset:45056
    ds_read_b64_tr_b16 v[146:147], v160 offset:45568
    buffer_load_dwordx4 v[192:195], v1, s[16:19], s64 offen offset:1024 sc1
    v_mfma_f32_32x32x16_bf16 v[64:79], v[148:151], v[224:227], v[64:79]
    ds_read_b64_tr_b16 v[148:149], v161 offset:45056
    ds_read_b64_tr_b16 v[150:151], v161 offset:45568
    v_mfma_f32_32x32x16_bf16 v[80:95], v[152:155], v[224:227], v[80:95]
    ds_read_b64_tr_b16 v[152:153], v162 offset:45056
    ds_read_b64_tr_b16 v[154:155], v162 offset:45568
    s_lshl1_add_u32 m0, s69, 134144
    s_add_u32 s70, s73, 8192
    buffer_load_dwordx4 v255, s[40:43], s70 offen lds
    v_mfma_f32_32x32x16_bf16 v[96:111], v[156:159], v[224:227], v[96:111]
    ds_read_b64_tr_b16 v[156:157], v163 offset:45056
    ds_read_b64_tr_b16 v[158:159], v163 offset:45568
    s_waitcnt vmcnt(8)
    ds_read_b64_tr_b16 a[176:177], v186 offset:4096
    ds_read_b64_tr_b16 a[178:179], v186 offset:5120
    s_waitcnt lgkmcnt(10)
    v_mfma_f32_32x32x16_bf16 v[112:127], v[128:131], v[228:231], v[112:127]
    ds_read_b64_tr_b16 v[128:129], v160 offset:49152
    ds_read_b64_tr_b16 v[130:131], v160 offset:49664
    buffer_load_dwordx4 v[196:199], v1, s[16:19], s64 offen offset:2048 sc1
    ds_read_b64_tr_b16 a[180:181], v187 offset:4096
    ds_read_b64_tr_b16 a[182:183], v187 offset:5120
    v_mfma_f32_32x32x16_bf16 v[64:79], v[132:135], v[228:231], v[64:79]
    ds_read_b64_tr_b16 v[132:133], v161 offset:49152
    ds_read_b64_tr_b16 v[134:135], v161 offset:49664
    v_mfma_f32_32x32x16_bf16 v[80:95], v[136:139], v[228:231], v[80:95]
    ds_read_b64_tr_b16 v[136:137], v162 offset:49152
    ds_read_b64_tr_b16 v[138:139], v162 offset:49664
    s_add_u32 s70, s73, 16384
    buffer_load_dwordx4 a[208:211], v255, s[40:43], s70 offen
    v_mfma_f32_32x32x16_bf16 v[96:111], v[140:143], v[228:231], v[96:111]
    ds_read_b64_tr_b16 v[140:141], v163 offset:49152
    ds_read_b64_tr_b16 v[142:143], v163 offset:49664
    s_waitcnt lgkmcnt(12)
    v_mfma_f32_32x32x16_bf16 v[112:127], v[144:147], v[232:235], v[112:127]
    ds_read_b64_tr_b16 v[144:145], v160 offset:53248
    ds_read_b64_tr_b16 v[146:147], v160 offset:53760
    buffer_load_dwordx4 v[200:203], v1, s[16:19], s64 offen offset:3072 sc1
    v_mfma_f32_32x32x16_bf16 v[64:79], v[148:151], v[232:235], v[64:79]
    ds_read_b64_tr_b16 v[148:149], v160 offset:57344
    ds_read_b64_tr_b16 v[150:151], v160 offset:57856
    v_mfma_f32_32x32x16_bf16 v[80:95], v[152:155], v[232:235], v[80:95]
    ds_read_b64_tr_b16 v[152:153], v160 offset:61440
    ds_read_b64_tr_b16 v[154:155], v160 offset:61952
    s_add_u32 s70, s73, 24576
    buffer_load_dwordx4 a[212:215], v255, s[40:43], s70 offen
    v_mfma_f32_32x32x16_bf16 v[96:111], v[156:159], v[232:235], v[96:111]
    ds_read_b64_tr_b16 v[156:157], v161 offset:53248
    ds_read_b64_tr_b16 v[158:159], v161 offset:53760
    s_waitcnt vmcnt(10)
    ds_read_b64_tr_b16 a[184:185], v186 offset:6144
    ds_read_b64_tr_b16 a[186:187], v186 offset:7168
    s_waitcnt lgkmcnt(10)
    v_mfma_f32_32x32x16_bf16 v[112:127], v[128:131], v[236:239], v[112:127]
    ds_read_b64_tr_b16 v[128:129], v161 offset:57344
    ds_read_b64_tr_b16 v[130:131], v161 offset:57856
    s_add_u32 s64, s64, 4096
    s_cmp_eq_u32 s64, s81
    s_cmov_b32 s64, s80
    buffer_load_dwordx4 v[204:207], v1, s[16:19], s64 offen offset:0 sc1
    ds_read_b64_tr_b16 a[188:189], v187 offset:6144
    ds_read_b64_tr_b16 a[190:191], v187 offset:7168
    v_mfma_f32_32x32x16_bf16 v[64:79], v[132:135], v[236:239], v[64:79]
    ds_read_b64_tr_b16 v[132:133], v161 offset:61440
    ds_read_b64_tr_b16 v[134:135], v161 offset:61952
    v_mfma_f32_32x32x16_bf16 v[80:95], v[136:139], v[236:239], v[80:95]
    ds_read_b64_tr_b16 v[136:137], v162 offset:53248
    ds_read_b64_tr_b16 v[138:139], v162 offset:53760
    s_add_u32 s70, s73, 32768
    buffer_load_dwordx4 a[216:219], v255, s[40:43], s70 offen
    v_mfma_f32_32x32x16_bf16 v[96:111], v[140:143], v[236:239], v[96:111]
    ds_read_b64_tr_b16 v[140:141], v162 offset:57344
    ds_read_b64_tr_b16 v[142:143], v162 offset:57856
    s_waitcnt lgkmcnt(14)
    v_mfma_f32_32x32x16_bf16 v[112:127], v[144:147], v[240:243], v[112:127]
    ds_read_b64_tr_b16 v[144:145], v162 offset:61440
    ds_read_b64_tr_b16 v[146:147], v162 offset:61952
    buffer_load_dwordx4 v[208:211], v1, s[16:19], s64 offen offset:1024 sc1
    v_mfma_f32_32x32x16_bf16 v[112:127], v[148:151], v[244:247], v[112:127]
    ds_read_b64_tr_b16 v[148:149], v163 offset:53248
    ds_read_b64_tr_b16 v[150:151], v163 offset:53760
    v_mov_b32 v176, v24
    v_mfma_f32_32x32x16_bf16 v[112:127], v[152:155], v[248:251], v[112:127]
    ds_read_b64_tr_b16 v[152:153], v163 offset:57344
    ds_read_b64_tr_b16 v[154:155], v163 offset:57856
    s_add_u32 s70, s73, 40960
    buffer_load_dwordx4 a[220:223], v255, s[40:43], s70 offen
    v_mfma_f32_32x32x16_bf16 v[112:127], v[176:179], v[180:183], v[112:127]
    s_waitcnt vmcnt(12)
    ds_read_b64_tr_b16 a[192:193], v186 offset:0
    ds_read_b64_tr_b16 a[194:195], v186 offset:1024
    s_waitcnt lgkmcnt(12)
    v_mfma_f32_32x32x16_bf16 v[64:79], v[156:159], v[240:243], v[64:79]
    ds_read_b64_tr_b16 v[156:157], v163 offset:61440
    ds_read_b64_tr_b16 v[158:159], v163 offset:61952
    buffer_load_dwordx4 v[212:215], v1, s[16:19], s64 offen offset:2048 sc1
    ds_read_b64_tr_b16 a[196:197], v187 offset:0
    ds_read_b64_tr_b16 a[198:199], v187 offset:1024
    v_mfma_f32_32x32x16_bf16 v[64:79], v[128:131], v[244:247], v[64:79]
    v_mov_b32 v172, v25
    v_max_f32 v112, 0, v112
    v_max_f32 v113, 0, v113
    v_max_f32 v114, 0, v114
    v_max_f32 v115, 0, v115
    v_max_f32 v116, 0, v116
    v_max_f32 v117, 0, v117
    v_mfma_f32_32x32x16_bf16 v[64:79], v[132:135], v[248:251], v[64:79]
    v_max_f32 v118, 0, v118
    v_max_f32 v119, 0, v119
    v_mul_f32 v112, v112, v120
    v_mul_f32 v113, v113, v121
    v_mul_f32 v114, v114, v122
    v_mul_f32 v115, v115, v123
    v_mul_f32 v116, v116, v124
    v_mfma_f32_32x32x16_bf16 v[64:79], v[172:175], v[180:183], v[64:79]
    v_mul_f32 v117, v117, v125
    v_mul_f32 v118, v118, v126
    v_mul_f32 v119, v119, v127
    v_cvt_pk_bf16_f32 v112, v112, v113
    v_cvt_pk_bf16_f32 v113, v114, v115
    v_cvt_pk_bf16_f32 v114, v116, v117
    v_cvt_pk_bf16_f32 v115, v118, v119
    s_waitcnt lgkmcnt(10)
    v_mfma_f32_32x32x16_bf16 v[80:95], v[136:139], v[240:243], v[80:95]
    s_add_u32 s64, s64, 3072
    s_cmp_eq_u32 s64, s81
    s_cmov_b32 s64, s80
    buffer_load_dwordx4 v[216:219], v1, s[16:19], s64 offen offset:0 sc1
    s_cmp_ge_u32 s45, 10
    s_cbranch_scc1 L_hs_94
    buffer_store_dwordx4 v[112:115], v1, s[16:19], s89 offen offset:0
L_hr_95:
    v_mfma_f32_32x32x16_bf16 v[80:95], v[140:143], v[244:247], v[80:95]
    v_mov_b32 v176, v26
    v_max_f32 v64, 0, v64
    v_max_f32 v65, 0, v65
    v_max_f32 v66, 0, v66
    v_max_f32 v67, 0, v67
    v_max_f32 v68, 0, v68
    v_max_f32 v69, 0, v69
    v_mfma_f32_32x32x16_bf16 v[80:95], v[144:147], v[248:251], v[80:95]
    s_waitcnt vmcnt(11)
    ds_read_b64_tr_b16 a[200:201], v186 offset:2048
    ds_read_b64_tr_b16 a[202:203], v186 offset:3072
    v_max_f32 v70, 0, v70
    v_max_f32 v71, 0, v71
    v_mul_f32 v64, v64, v72
    v_mul_f32 v65, v65, v73
    v_mul_f32 v66, v66, v74
    v_mfma_f32_32x32x16_bf16 v[80:95], v[176:179], v[180:183], v[80:95]
    ds_read_b64_tr_b16 a[204:205], v187 offset:2048
    ds_read_b64_tr_b16 a[206:207], v187 offset:3072
    v_mul_f32 v67, v67, v75
    v_mul_f32 v68, v68, v76
    v_mul_f32 v69, v69, v77
    v_mul_f32 v70, v70, v78
    v_mul_f32 v71, v71, v79
    s_waitcnt lgkmcnt(6)
    v_mfma_f32_32x32x16_bf16 v[96:111], v[148:151], v[240:243], v[96:111]
    v_cvt_pk_bf16_f32 v64, v64, v65
    v_cvt_pk_bf16_f32 v65, v66, v67
    v_cvt_pk_bf16_f32 v66, v68, v69
    v_cvt_pk_bf16_f32 v67, v70, v71
    s_cmp_ge_u32 s45, 10
    s_cbranch_scc1 L_hs_96
    buffer_store_dwordx4 v[64:67], v1, s[16:19], s89 offen offset:1024
L_hr_97:
    v_mfma_f32_32x32x16_bf16 v[96:111], v[152:155], v[244:247], v[96:111]
    v_mov_b32 v172, v27
    v_max_f32 v80, 0, v80
    v_max_f32 v81, 0, v81
    v_max_f32 v82, 0, v82
    v_max_f32 v83, 0, v83
    v_max_f32 v84, 0, v84
    v_max_f32 v85, 0, v85
    v_mfma_f32_32x32x16_bf16 v[96:111], v[156:159], v[248:251], v[96:111]
    v_max_f32 v86, 0, v86
    v_max_f32 v87, 0, v87
    v_mul_f32 v80, v80, v88
    v_mul_f32 v81, v81, v89
    v_mul_f32 v82, v82, v90
    v_mul_f32 v83, v83, v91
    v_mul_f32 v84, v84, v92
    v_mfma_f32_32x32x16_bf16 v[96:111], v[172:175], v[180:183], v[96:111]
    v_mul_f32 v85, v85, v93
    v_mul_f32 v86, v86, v94
    v_mul_f32 v87, v87, v95
    v_cvt_pk_bf16_f32 v80, v80, v81
    v_cvt_pk_bf16_f32 v81, v82, v83
    v_cvt_pk_bf16_f32 v82, v84, v85
    v_cvt_pk_bf16_f32 v83, v86, v87
    s_cmp_ge_u32 s45, 10
    s_cbranch_scc1 L_hs_98
    buffer_store_dwordx4 v[80:83], v1, s[16:19], s89 offen offset:2048
L_hr_99:
    s_nop 1
    v_max_f32 v96, 0, v96
    v_max_f32 v97, 0, v97
    v_max_f32 v98, 0, v98
    v_max_f32 v99, 0, v99
    v_max_f32 v100, 0, v100
    v_max_f32 v101, 0, v101
    v_max_f32 v102, 0, v102
    v_max_f32 v103, 0, v103
    v_mul_f32 v96, v96, v104
    v_mul_f32 v97, v97, v105
    v_mul_f32 v98, v98, v106
    v_mul_f32 v99, v99, v107
    v_mul_f32 v100, v100, v108
    v_mul_f32 v101, v101, v109
    v_mul_f32 v102, v102, v110
    v_mul_f32 v103, v103, v111
    v_cvt_pk_bf16_f32 v96, v96, v97
    v_cvt_pk_bf16_f32 v97, v98, v99
    v_cvt_pk_bf16_f32 v98, v100, v101
    v_cvt_pk_bf16_f32 v99, v102, v103
    s_cmp_ge_u32 s45, 10
    s_cbranch_scc1 L_hs_100
    buffer_store_dwordx4 v[96:99], v1, s[16:19], s89 offen offset:3072
L_hr_101:
    s_waitcnt lgkmcnt(0)
    s_nop 1
L_dn0:
    buffer_load_dwordx4 v[220:223], v1, s[16:19], s64 offen offset:1024 sc1
    buffer_load_dwordx4 v[224:227], v1, s[16:19], s64 offen offset:2048 sc1
    buffer_load_dwordx4 v[228:231], v1, s[16:19], s64 offen offset:3072 sc1
    s_add_u32 s64, s64, 4096
    s_cmp_eq_u32 s64, s81
    s_cmov_b32 s64, s80
    buffer_load_dwordx4 v[232:235], v1, s[16:19], s64 offen offset:0 sc1
    s_add_u32 s86, s61, 149504
    buffer_load_dwordx4 v[96:99], v20, s[16:19], s86 offen sc1
    buffer_load_dwordx4 v[100:103], v20, s[16:19], s86 offen offset:16 sc1
    v_mfma_f32_32x32x16_bf16 v[64:79], a[112:115], v[188:191], 0
    buffer_load_dwordx4 v[236:239], v1, s[16:19], s64 offen offset:1024 sc1
    v_mfma_f32_32x32x16_bf16 v[80:95], a[116:119], v[188:191], 0
    v_mfma_f32_32x32x16_bf16 v[64:79], a[120:123], v[192:195], v[64:79]
    s_waitcnt vmcnt(18)
    ds_write_b128 v14, a[208:211]
    buffer_load_dwordx4 v[240:243], v1, s[16:19], s64 offen offset:2048 sc1
    v_mfma_f32_32x32x16_bf16 v[80:95], a[124:127], v[192:195], v[80:95]
    s_waitcnt vmcnt(17)
    ds_write_b128 v14, a[212:215] offset:1024
    ds_read_b64_tr_b16 a[208:209], v186
    ds_read_b64_tr_b16 a[210:211], v186 offset:1024
    ds_read_b64_tr_b16 a[212:213], v187
    ds_read_b64_tr_b16 a[214:215], v187 offset:1024
    v_mfma_f32_32x32x16_bf16 v[64:79], a[128:131], v[196:199], v[64:79]
    s_waitcnt vmcnt(15)
    ds_write_b128 v14, a[216:219]
    s_add_u32 s64, s64, 3072
    s_cmp_eq_u32 s64, s81
    s_cmov_b32 s64, s80
    buffer_load_dwordx4 v[244:247], v1, s[16:19], s64 offen offset:0 sc1
    v_mfma_f32_32x32x16_bf16 v[80:95], a[132:135], v[196:199], v[80:95]
    s_waitcnt vmcnt(14)
    ds_write_b128 v14, a[220:223] offset:1024
    ds_read_b64_tr_b16 a[216:217], v186
    ds_read_b64_tr_b16 a[218:219], v186 offset:1024
    ds_read_b64_tr_b16 a[220:221], v187
    ds_read_b64_tr_b16 a[222:223], v187 offset:1024
    v_mfma_f32_32x32x16_bf16 v[64:79], a[136:139], v[200:203], v[64:79]
    ds_write_b128 v14, a[16:19]
    buffer_load_dwordx4 v[248:251], v1, s[16:19], s64 offen offset:1024 sc1
    v_mfma_f32_32x32x16_bf16 v[80:95], a[140:143], v[200:203], v[80:95]
    ds_write_b128 v14, a[20:23] offset:1024
    ds_read_b64_tr_b16 a[16:17], v186
    ds_read_b64_tr_b16 a[18:19], v186 offset:1024
    ds_read_b64_tr_b16 a[20:21], v187
    ds_read_b64_tr_b16 a[22:23], v187 offset:1024
    v_mov_b32 v252, 9
    s_waitcnt vmcnt(10)
    s_mov_b64 exec, 1
    s_cmp_lg_u32 s50, 0
    s_cbranch_scc1 L_pub_102
    buffer_store_dword v252, off, s[16:19], s52
L_pur_103:
    s_mov_b64 exec, -1
    v_mfma_f32_32x32x16_bf16 v[64:79], a[144:147], v[204:207], v[64:79]
    ds_write_b128 v14, a[24:27]
    buffer_load_dwordx4 v[112:115], v1, s[16:19], s64 offen offset:2048 sc1
    v_mfma_f32_32x32x16_bf16 v[80:95], a[148:151], v[204:207], v[80:95]
    ds_write_b128 v14, a[28:31] offset:1024
    ds_read_b64_tr_b16 a[24:25], v186
    ds_read_b64_tr_b16 a[26:27], v186 offset:1024
    ds_read_b64_tr_b16 a[28:29], v187
    ds_read_b64_tr_b16 a[30:31], v187 offset:1024
    v_mfma_f32_32x32x16_bf16 v[64:79], a[152:155], v[208:211], v[64:79]
    ds_write_b128 v14, a[32:35]
    buffer_load_dwordx4 v[116:119], v1, s[16:19], s64 offen offset:3072 sc1
    v_mfma_f32_32x32x16_bf16 v[80:95], a[156:159], v[208:211], v[80:95]
    ds_write_b128 v14, a[36:39] offset:1024
    ds_read_b64_tr_b16 a[32:33], v186
    ds_read_b64_tr_b16 a[34:35], v186 offset:1024
    ds_read_b64_tr_b16 a[36:37], v187
    ds_read_b64_tr_b16 a[38:39], v187 offset:1024
    s_mul_i32 s90, s45, 49152
    s_lshl_b32 s91, s46, 13
    s_add_u32 s90, s90, s91
    s_add_u32 s90, s90, 19939328
    v_lshlrev_b32 v253, 7, v0
    buffer_load_dword v107, v253, s[16:19], s90 offen sc1
    v_mfma_f32_32x32x16_bf16 v[64:79], a[160:163], v[212:215], v[64:79]
    ds_write_b128 v14, a[40:43]
    s_add_u32 s64, s64, 4096
    s_cmp_eq_u32 s64, s81
    s_cmov_b32 s64, s80
    buffer_load_dwordx4 v[120:123], v1, s[16:19], s64 offen offset:0 sc1
    v_mfma_f32_32x32x16_bf16 v[80:95], a[164:167], v[212:215], v[80:95]
    ds_write_b128 v14, a[44:47] offset:1024
    ds_read_b64_tr_b16 a[40:41], v186
    ds_read_b64_tr_b16 a[42:43], v186 offset:1024
    ds_read_b64_tr_b16 a[44:45], v187
    ds_read_b64_tr_b16 a[46:47], v187 offset:1024
    v_mfma_f32_32x32x16_bf16 v[64:79], a[168:171], v[216:219], v[64:79]
    ds_write_b128 v14, a[48:51]
    buffer_load_dwordx4 v[124:127], v1, s[16:19], s64 offen offset:1024 sc1
    v_mfma_f32_32x32x16_bf16 v[80:95], a[172:175], v[216:219], v[80:95]
    ds_write_b128 v14, a[52:55] offset:1024
    ds_read_b64_tr_b16 a[48:49], v186
    ds_read_b64_tr_b16 a[50:51], v186 offset:1024
    ds_read_b64_tr_b16 a[52:53], v187
    ds_read_b64_tr_b16 a[54:55], v187 offset:1024
    s_waitcnt vmcnt(15)
    v_mfma_f32_32x32x16_bf16 v[64:79], a[176:179], v[220:223], v[64:79]
    ds_write_b128 v14, a[56:59]
    s_waitcnt vmcnt(11)
    v_add_f32 v96, v96, v97
    v_add_f32 v98, v98, v99
    buffer_load_dwordx4 v[128:131], v1, s[16:19], s64 offen offset:2048 sc1
    v_mfma_f32_32x32x16_bf16 v[80:95], a[180:183], v[220:223], v[80:95]
    ds_write_b128 v14, a[60:63] offset:1024
    ds_read_b64_tr_b16 a[56:57], v186
    ds_read_b64_tr_b16 a[58:59], v186 offset:1024
    ds_read_b64_tr_b16 a[60:61], v187
    ds_read_b64_tr_b16 a[62:63], v187 offset:1024
    s_waitcnt vmcnt(11)
    v_add_f32 v100, v100, v101
    v_add_f32 v102, v102, v103
    v_mfma_f32_32x32x16_bf16 v[64:79], a[184:187], v[224:227], v[64:79]
    ds_write_b128 v14, a[64:67]
    v_add_f32 v96, v96, v98
    v_add_f32 v100, v100, v102
    s_add_u32 s64, s64, 3072
    s_cmp_eq_u32 s64, s81
    s_cmov_b32 s64, s80
    buffer_load_dwordx4 v[132:135], v1, s[16:19], s64 offen offset:0 sc1
    v_mfma_f32_32x32x16_bf16 v[80:95], a[188:191], v[224:227], v[80:95]
    ds_write_b128 v14, a[68:71] offset:1024
    ds_read_b64_tr_b16 a[64:65], v186
    ds_read_b64_tr_b16 a[66:67], v186 offset:1024
    ds_read_b64_tr_b16 a[68:69], v187
    ds_read_b64_tr_b16 a[70:71], v187 offset:1024
    v_add_f32 v96, v96, v100
    v_and_b32 v100, 8, v0
    v_mfma_f32_32x32x16_bf16 v[64:79], a[192:195], v[228:231], v[64:79]
    ds_write_b128 v14, a[72:75]
    v_mov_b32_dpp v97, v96 row_ror:8 row_mask:0xf bank_mask:0xf
    v_cmp_ne_u32 vcc, 0, v100
    s_nop 1
    v_cndmask_b32 v98, v96, v97, vcc
    v_cndmask_b32 v99, v97, v96, vcc
    buffer_load_dwordx4 v[136:139], v1, s[16:19], s64 offen offset:1024 sc1
    v_mfma_f32_32x32x16_bf16 v[80:95], a[196:199], v[228:231], v[80:95]
    ds_write_b128 v14, a[76:79] offset:1024
    ds_read_b64_tr_b16 a[72:73], v186
    ds_read_b64_tr_b16 a[74:75], v186 offset:1024
    ds_read_b64_tr_b16 a[76:77], v187
    ds_read_b64_tr_b16 a[78:79], v187 offset:1024
    v_mul_f32 v98, 0x3b000000, v98
    v_mul_f32 v99, 0x3b000000, v99
    buffer_load_dword v106, v22, s[16:19], s53 offen sc1
    v_mfma_f32_32x32x16_bf16 v[64:79], a[200:203], v[232:235], v[64:79]
    ds_write_b128 v14, a[80:83]
    v_fma_f32 v99, -v98, v98, v99
    v_max_f32 v99, 0, v99
    buffer_load_dwordx4 v[140:143], v1, s[16:19], s64 offen offset:2048 sc1
    v_mfma_f32_32x32x16_bf16 v[80:95], a[204:207], v[232:235], v[80:95]
    ds_write_b128 v14, a[84:87] offset:1024
    ds_read_b64_tr_b16 a[80:81], v186
    ds_read_b64_tr_b16 a[82:83], v186 offset:1024
    ds_read_b64_tr_b16 a[84:85], v187
    ds_read_b64_tr_b16 a[86:87], v187 offset:1024
    v_cvt_pk_bf16_f32 v100, v99, v99
    v_and_b32 v100, 0xffff0000, v100
    s_waitcnt vmcnt(14) lgkmcnt(15)
    v_mfma_f32_32x32x16_bf16 v[64:79], a[208:211], v[236:239], v[64:79]
    ds_write_b128 v14, a[88:91]
    v_add_f32 v100, 0x3727c5ac, v100
    v_cvt_pk_bf16_f32 v100, v100, v100
    buffer_load_dwordx4 v[144:147], v1, s[16:19], s64 offen offset:3072 sc1
    s_waitcnt lgkmcnt(15)
    v_mfma_f32_32x32x16_bf16 v[80:95], a[212:215], v[236:239], v[80:95]
    ds_write_b128 v14, a[92:95] offset:1024
    ds_read_b64_tr_b16 a[88:89], v186
    ds_read_b64_tr_b16 a[90:91], v186 offset:1024
    ds_read_b64_tr_b16 a[92:93], v187
    ds_read_b64_tr_b16 a[94:95], v187 offset:1024
    v_and_b32 v100, 0xffff0000, v100
    v_sqrt_f32 v100, v100
    s_waitcnt vmcnt(14) lgkmcnt(15)
    v_mfma_f32_32x32x16_bf16 v[64:79], a[216:219], v[240:243], v[64:79]
    ds_write_b128 v14, a[96:99]
    v_cvt_pk_bf16_f32 v100, v100, v100
    v_and_b32 v100, 0xffff0000, v100
    s_add_u32 s64, s64, 4096
    s_cmp_eq_u32 s64, s81
    s_cmov_b32 s64, s80
    buffer_load_dwordx4 v[148:151], v1, s[16:19], s64 offen offset:0 sc1
    s_waitcnt lgkmcnt(15)
    v_mfma_f32_32x32x16_bf16 v[80:95], a[220:223], v[240:243], v[80:95]
    ds_write_b128 v14, a[100:103] offset:1024
    ds_read_b64_tr_b16 a[96:97], v186
    ds_read_b64_tr_b16 a[98:99], v186 offset:1024
    ds_read_b64_tr_b16 a[100:101], v187
    ds_read_b64_tr_b16 a[102:103], v187 offset:1024
    v_rcp_f32 v104, v100
    s_nop 0
    v_mul_f32 v104, v104, v104
    s_waitcnt vmcnt(14)
    v_mfma_f32_32x32x16_bf16 v[64:79], a[0:3], v[244:247], v[64:79]
    ds_write_b128 v14, a[104:107]
    buffer_load_dwordx4 v[188:191], v1, s[16:19], s64 offen offset:1024 sc1
    v_mfma_f32_32x32x16_bf16 v[80:95], a[4:7], v[244:247], v[80:95]
    ds_write_b128 v14, a[108:111] offset:1024
    ds_read_b64_tr_b16 a[104:105], v186
    ds_read_b64_tr_b16 a[106:107], v186 offset:1024
    ds_read_b64_tr_b16 a[108:109], v187
    ds_read_b64_tr_b16 a[110:111], v187 offset:1024
    s_waitcnt vmcnt(14)
    v_mfma_f32_32x32x16_bf16 v[64:79], a[8:11], v[248:251], v[64:79]
    buffer_load_dwordx4 v[192:195], v1, s[16:19], s64 offen offset:2048 sc1
    v_mfma_f32_32x32x16_bf16 v[80:95], a[12:15], v[248:251], v[80:95]
    s_waitcnt vmcnt(13) lgkmcnt(15)
    v_mfma_f32_32x32x16_bf16 v[64:79], a[16:19], v[112:115], v[64:79]
    s_waitcnt lgkmcnt(15)
    v_mfma_f32_32x32x16_bf16 v[80:95], a[20:23], v[112:115], v[80:95]
    s_waitcnt vmcnt(5)
    v_cmp_gt_u32 vcc, 9, v106
    s_nop 1
    s_cbranch_vccnz L_poll_104
L_ok_105:
    s_cmp_lg_u32 s50, 0
    s_cbranch_scc1 L_acq_106
L_acr_107:
    s_add_u32 s86, s62, 149504
    buffer_load_dwordx4 v[96:99], v20, s[16:19], s86 offen sc1
    buffer_load_dwordx4 v[100:103], v20, s[16:19], s86 offen offset:16 sc1
    s_waitcnt lgkmcnt(15)
    v_mfma_f32_32x32x16_bf16 v[64:79], a[24:27], v[116:119], v[64:79]
    s_add_u32 s80, s75, s62
    s_add_u32 s81, s80, 28672
    s_add_u32 s64, s82, 2
    s_and_b32 s64, s64, 3
    s_mul_i32 s64, s64, 7168
    s_add_u32 s64, s64, s80
    s_add_u32 s64, s64, s83
    buffer_load_dwordx4 v[196:199], v1, s[16:19], s64 offen offset:0 sc1
    buffer_load_dwordx4 v[200:203], v1, s[16:19], s64 offen offset:1024 sc1
    s_waitcnt lgkmcnt(15)
    v_mfma_f32_32x32x16_bf16 v[80:95], a[28:31], v[116:119], v[80:95]
    s_waitcnt lgkmcnt(15)
    v_mfma_f32_32x32x16_bf16 v[64:79], a[32:35], v[120:123], v[64:79]
    buffer_load_dwordx4 v[204:207], v1, s[16:19], s64 offen offset:2048 sc1
    s_waitcnt lgkmcnt(15)
    v_mfma_f32_32x32x16_bf16 v[80:95], a[36:39], v[120:123], v[80:95]
    s_waitcnt lgkmcnt(15)
    v_mfma_f32_32x32x16_bf16 v[64:79], a[40:43], v[124:127], v[64:79]
    buffer_load_dwordx4 v[208:211], v1, s[16:19], s64 offen offset:3072 sc1
    s_waitcnt lgkmcnt(15)
    v_mfma_f32_32x32x16_bf16 v[80:95], a[44:47], v[124:127], v[80:95]
    s_waitcnt lgkmcnt(15)
    v_mfma_f32_32x32x16_bf16 v[64:79], a[48:51], v[128:131], v[64:79]
    s_add_u32 s64, s64, 4096
    s_cmp_eq_u32 s64, s81
    s_cmov_b32 s64, s80
    buffer_load_dwordx4 v[212:215], v1, s[16:19], s64 offen offset:0 sc1
    s_waitcnt lgkmcnt(15)
    v_mfma_f32_32x32x16_bf16 v[80:95], a[52:55], v[128:131], v[80:95]
    s_waitcnt lgkmcnt(15)
    v_mfma_f32_32x32x16_bf16 v[64:79], a[56:59], v[132:135], v[64:79]
    buffer_load_dwordx4 v[216:219], v1, s[16:19], s64 offen offset:1024 sc1
    s_waitcnt lgkmcnt(15)
    v_mfma_f32_32x32x16_bf16 v[80:95], a[60:63], v[132:135], v[80:95]
    s_waitcnt lgkmcnt(15)
    v_mfma_f32_32x32x16_bf16 v[64:79], a[64:67], v[136:139], v[64:79]
    buffer_load_dwordx4 v[220:223], v1, s[16:19], s64 offen offset:2048 sc1
    s_waitcnt lgkmcnt(15)
    v_mfma_f32_32x32x16_bf16 v[80:95], a[68:71], v[136:139], v[80:95]
    s_waitcnt vmcnt(13) lgkmcnt(15)
    v_mfma_f32_32x32x16_bf16 v[64:79], a[72:75], v[140:143], v[64:79]
    s_add_u32 s64, s64, 3072
    s_cmp_eq_u32 s64, s81
    s_cmov_b32 s64, s80
    buffer_load_dwordx4 v[224:227], v1, s[16:19], s64 offen offset:0 sc1
    s_waitcnt lgkmcnt(15)
    v_mfma_f32_32x32x16_bf16 v[80:95], a[76:79], v[140:143], v[80:95]
    s_waitcnt vmcnt(13) lgkmcnt(15)
    v_mfma_f32_32x32x16_bf16 v[64:79], a[80:83], v[144:147], v[64:79]
    buffer_load_dwordx4 v[228:231], v1, s[16:19], s64 offen offset:1024 sc1
    s_waitcnt lgkmcnt(15)
    v_mfma_f32_32x32x16_bf16 v[80:95], a[84:87], v[144:147], v[80:95]
    s_waitcnt vmcnt(13) lgkmcnt(14)
    v_mfma_f32_32x32x16_bf16 v[64:79], a[88:91], v[148:151], v[64:79]
    buffer_load_dwordx4 v[232:235], v1, s[16:19], s64 offen offset:2048 sc1
    s_waitcnt lgkmcnt(12)
    v_mfma_f32_32x32x16_bf16 v[80:95], a[92:95], v[148:151], v[80:95]
    s_waitcnt vmcnt(13) lgkmcnt(8)
    v_mfma_f32_32x32x16_bf16 v[64:79], a[96:99], v[188:191], v[64:79]
    buffer_load_dwordx4 v[236:239], v1, s[16:19], s64 offen offset:3072 sc1
    s_waitcnt lgkmcnt(6)
    v_mfma_f32_32x32x16_bf16 v[80:95], a[100:103], v[188:191], v[80:95]
    s_waitcnt vmcnt(13) lgkmcnt(2)
    v_mfma_f32_32x32x16_bf16 v[64:79], a[104:107], v[192:195], v[64:79]
    s_add_u32 s64, s64, 4096
    s_cmp_eq_u32 s64, s81
    s_cmov_b32 s64, s80
    buffer_load_dwordx4 v[240:243], v1, s[16:19], s64 offen offset:0 sc1
    s_waitcnt lgkmcnt(0)
    v_mfma_f32_32x32x16_bf16 v[80:95], a[108:111], v[192:195], v[80:95]
    s_waitcnt vmcnt(11)
    v_mfma_f32_32x32x16_bf16 v[152:167], a[112:115], v[196:199], 0
    buffer_load_dwordx4 v[244:247], v1, s[16:19], s64 offen offset:1024 sc1
    v_mfma_f32_32x32x16_bf16 v[168:183], a[116:119], v[196:199], 0
    s_waitcnt vmcnt(11)
    v_mfma_f32_32x32x16_bf16 v[152:167], a[120:123], v[200:203], v[152:167]
    ds_write_b128 v14, v[64:67] offset:0
    v_add_f32 v96, v96, v97
    v_add_f32 v98, v98, v99
    buffer_load_dwordx4 v[248:251], v1, s[16:19], s64 offen offset:2048 sc1
    v_mfma_f32_32x32x16_bf16 v[168:183], a[124:127], v[200:203], v[168:183]
    ds_write_b128 v15, v[68:71] offset:1024
    v_add_f32 v100, v100, v101
    v_add_f32 v102, v102, v103
    s_waitcnt vmcnt(11)
    v_mfma_f32_32x32x16_bf16 v[152:167], a[128:131], v[204:207], v[152:167]
    ds_write_b128 v14, v[72:75] offset:2048
    v_add_f32 v96, v96, v98
    v_add_f32 v100, v100, v102
    s_add_u32 s64, s64, 3072
    s_cmp_eq_u32 s64, s81
    s_cmov_b32 s64, s80
    buffer_load_dwordx4 v[112:115], v1, s[16:19], s64 offen offset:0 sc1
    v_mfma_f32_32x32x16_bf16 v[168:183], a[132:135], v[204:207], v[168:183]
    ds_write_b128 v15, v[76:79] offset:3072
    v_add_f32 v96, v96, v100
    v_and_b32 v100, 8, v0
    s_waitcnt vmcnt(11)
    v_mfma_f32_32x32x16_bf16 v[152:167], a[136:139], v[208:211], v[152:167]
    ds_write_b128 v14, v[80:83] offset:4096
    v_mov_b32_dpp v97, v96 row_ror:8 row_mask:0xf bank_mask:0xf
    v_cmp_ne_u32 vcc, 0, v100
    s_nop 1
    v_cndmask_b32 v98, v96, v97, vcc
    v_cndmask_b32 v99, v97, v96, vcc
    buffer_load_dwordx4 v[116:119], v1, s[16:19], s64 offen offset:1024 sc1
    v_mfma_f32_32x32x16_bf16 v[168:183], a[140:143], v[208:211], v[168:183]
    ds_write_b128 v15, v[84:87] offset:5120
    v_mul_f32 v98, 0x3b000000, v98
    v_mul_f32 v99, 0x3b000000, v99
    s_waitcnt vmcnt(11)
    v_mfma_f32_32x32x16_bf16 v[152:167], a[144:147], v[212:215], v[152:167]
    ds_write_b128 v14, v[88:91] offset:6144
    v_fma_f32 v99, -v98, v98, v99
    v_max_f32 v99, 0, v99
    buffer_load_dwordx4 v[120:123], v1, s[16:19], s64 offen offset:2048 sc1
    v_mfma_f32_32x32x16_bf16 v[168:183], a[148:151], v[212:215], v[168:183]
    ds_write_b128 v15, v[92:95] offset:7168
    v_cvt_pk_bf16_f32 v100, v99, v99
    v_and_b32 v100, 0xffff0000, v100
    s_waitcnt vmcnt(11)
    v_mfma_f32_32x32x16_bf16 v[152:167], a[152:155], v[216:219], v[152:167]
    v_add_f32 v100, 0x3727c5ac, v100
    v_cvt_pk_bf16_f32 v100, v100, v100
    buffer_load_dwordx4 v[124:127], v1, s[16:19], s64 offen offset:3072 sc1
    v_mfma_f32_32x32x16_bf16 v[168:183], a[156:159], v[216:219], v[168:183]
    v_and_b32 v100, 0xffff0000, v100
    v_sqrt_f32 v100, v100
    s_waitcnt vmcnt(11)
    v_mfma_f32_32x32x16_bf16 v[152:167], a[160:163], v[220:223], v[152:167]
    v_cvt_pk_bf16_f32 v100, v100, v100
    v_and_b32 v100, 0xffff0000, v100
    s_add_u32 s64, s64, 4096
    s_cmp_eq_u32 s64, s81
    s_cmov_b32 s64, s80
    buffer_load_dwordx4 v[128:131], v1, s[16:19], s64 offen offset:0 sc1
    v_mfma_f32_32x32x16_bf16 v[168:183], a[164:167], v[220:223], v[168:183]
    v_rcp_f32 v105, v100
    s_nop 0
    v_mul_f32 v105, v105, v105
    s_waitcnt lgkmcnt(0)
    s_barrier
    s_waitcnt vmcnt(11)
    v_mfma_f32_32x32x16_bf16 v[152:167], a[168:171], v[224:227], v[152:167]
    ds_read_b128 v[64:67], v13 offset:0
    buffer_load_dwordx4 v[132:135], v1, s[16:19], s64 offen offset:1024 sc1
    v_mfma_f32_32x32x16_bf16 v[168:183], a[172:175], v[224:227], v[168:183]
    ds_read_b128 v[68:71], v13 offset:512
    s_waitcnt vmcnt(11)
    v_mfma_f32_32x32x16_bf16 v[152:167], a[176:179], v[228:231], v[152:167]
    ds_read_b128 v[72:75], v13 offset:8192
    buffer_load_dwordx4 v[136:139], v1, s[16:19], s64 offen offset:2048 sc1
    v_mfma_f32_32x32x16_bf16 v[168:183], a[180:183], v[228:231], v[168:183]
    ds_read_b128 v[76:79], v13 offset:8704
    s_waitcnt vmcnt(11)
    v_mfma_f32_32x32x16_bf16 v[152:167], a[184:187], v[232:235], v[152:167]
    ds_read_b128 v[80:83], v13 offset:16384
    s_add_u32 s64, s64, 3072
    s_cmp_eq_u32 s64, s81
    s_cmov_b32 s64, s80
    buffer_load_dwordx4 v[140:143], v1, s[16:19], s64 offen offset:0 sc1
    v_mfma_f32_32x32x16_bf16 v[168:183], a[188:191], v[232:235], v[168:183]
    ds_read_b128 v[84:87], v13 offset:16896
    s_waitcnt vmcnt(11)
    v_mfma_f32_32x32x16_bf16 v[152:167], a[192:195], v[236:239], v[152:167]
    ds_read_b128 v[88:91], v13 offset:24576
    s_waitcnt lgkmcnt(4)
    v_add_f32 v64, v64, v72
    v_add_f32 v65, v65, v73
    v_add_f32 v66, v66, v74
    buffer_load_dwordx4 v[144:147], v1, s[16:19], s64 offen offset:1024 sc1
    v_mfma_f32_32x32x16_bf16 v[168:183], a[196:199], v[236:239], v[168:183]
    ds_read_b128 v[92:95], v13 offset:25088
    v_add_f32 v67, v67, v75
    s_waitcnt lgkmcnt(4)
    v_add_f32 v68, v68, v76
    v_add_f32 v69, v69, v77
    s_waitcnt vmcnt(11)
    v_mfma_f32_32x32x16_bf16 v[152:167], a[200:203], v[240:243], v[152:167]
    v_add_f32 v70, v70, v78
    v_add_f32 v71, v71, v79
    s_waitcnt lgkmcnt(1)
    v_add_f32 v80, v80, v88
    buffer_load_dwordx4 v[148:151], v1, s[16:19], s64 offen offset:2048 sc1
    v_mfma_f32_32x32x16_bf16 v[168:183], a[204:207], v[240:243], v[168:183]
    v_add_f32 v81, v81, v89
    v_add_f32 v82, v82, v90
    v_add_f32 v83, v83, v91
    s_waitcnt vmcnt(11)
    v_mfma_f32_32x32x16_bf16 v[152:167], a[208:211], v[244:247], v[152:167]
    s_waitcnt lgkmcnt(0)
    v_add_f32 v84, v84, v92
    v_add_f32 v85, v85, v93
    v_add_f32 v86, v86, v94
    buffer_load_dwordx4 v[188:191], v1, s[16:19], s64 offen offset:3072 sc1
    v_mfma_f32_32x32x16_bf16 v[168:183], a[212:215], v[244:247], v[168:183]
    v_add_f32 v87, v87, v95
    v_lshlrev_b32 v72, 16, v2
    v_and_b32 v73, 0xffff0000, v2
    s_waitcnt vmcnt(11)
    v_mfma_f32_32x32x16_bf16 v[152:167], a[216:219], v[248:251], v[152:167]
    v_lshlrev_b32 v74, 16, v3
    v_and_b32 v75, 0xffff0000, v3
    v_lshlrev_b32 v76, 16, v4
    s_add_u32 s64, s64, 4096
    s_cmp_eq_u32 s64, s81
    s_cmov_b32 s64, s80
    buffer_load_dwordx4 v[192:195], v1, s[16:19], s64 offen offset:0 sc1
    v_mfma_f32_32x32x16_bf16 v[168:183], a[220:223], v[248:251], v[168:183]
    v_and_b32 v77, 0xffff0000, v4
    v_lshlrev_b32 v78, 16, v5
    v_and_b32 v79, 0xffff0000, v5
    s_waitcnt vmcnt(11)
    v_mfma_f32_32x32x16_bf16 v[152:167], a[0:3], v[112:115], v[152:167]
    v_add_f32 v64, v64, v80
    v_add_f32 v65, v65, v81
    v_add_f32 v66, v66, v82
    buffer_load_dwordx4 v[196:199], v1, s[16:19], s64 offen offset:1024 sc1
    v_mfma_f32_32x32x16_bf16 v[168:183], a[4:7], v[112:115], v[168:183]
    v_add_f32 v67, v67, v83
    v_add_f32 v68, v68, v84
    v_add_f32 v69, v69, v85
    s_waitcnt vmcnt(11)
    v_mfma_f32_32x32x16_bf16 v[152:167], a[8:11], v[116:119], v[152:167]
    v_add_f32 v70, v70, v86
    v_add_f32 v71, v71, v87
    v_fma_f32 v64, v64, v104, v72
    buffer_load_dwordx4 v[200:203], v1, s[16:19], s64 offen offset:2048 sc1
    v_mfma_f32_32x32x16_bf16 v[168:183], a[12:15], v[116:119], v[168:183]
    v_fma_f32 v65, v65, v104, v73
    v_fma_f32 v66, v66, v104, v74
    v_fma_f32 v67, v67, v104, v75
    s_waitcnt vmcnt(11)
    v_mfma_f32_32x32x16_bf16 v[152:167], a[16:19], v[120:123], v[152:167]
    v_fma_f32 v68, v68, v104, v76
    v_fma_f32 v69, v69, v104, v77
    v_fma_f32 v70, v70, v104, v78
    v_mfma_f32_32x32x16_bf16 v[168:183], a[20:23], v[120:123], v[168:183]
    v_fma_f32 v71, v71, v104, v79
    v_cvt_pk_bf16_f32 v2, v64, v65
    v_cvt_pk_bf16_f32 v3, v66, v67
    s_mul_i32 s51, s45, 49152
    s_add_u32 s51, s51, s69
    s_add_u32 s51, s51, 19922944
    s_add_u32 m0, s69, 114688
    s_nop 0
    buffer_load_dwordx4 v1, s[16:19], s51 offen offset:0 sc1 lds
    buffer_load_dwordx4 v1, s[16:19], s51 offen offset:1024 sc1 lds
    buffer_load_dwordx4 v1, s[16:19], s51 offen offset:2048 sc1 lds
    buffer_load_dwordx4 v1, s[16:19], s51 offen offset:3072 sc1 lds
    s_waitcnt vmcnt(14)
    v_mfma_f32_32x32x16_bf16 v[152:167], a[24:27], v[124:127], v[152:167]
    v_cvt_pk_bf16_f32 v4, v68, v69
    v_cvt_pk_bf16_f32 v5, v70, v71
    s_lshl_b32 s87, s48, 12
    v_mfma_f32_32x32x16_bf16 v[168:183], a[28:31], v[124:127], v[168:183]
    s_add_u32 s86, s61, s87
    buffer_store_dwordx4 v[2:5], v16, s[16:19], s86 offen
    v_mov_b32 v64, 0
    s_waitcnt vmcnt(14)
    v_mfma_f32_32x32x16_bf16 v[152:167], a[32:35], v[128:131], v[152:167]
    v_mov_b32 v65, 0
    v_dot2c_f32_bf16 v64, s55, v2
    v_dot2c_f32_bf16 v65, v2, v2
    v_mfma_f32_32x32x16_bf16 v[168:183], a[36:39], v[128:131], v[168:183]
    v_dot2c_f32_bf16 v64, s55, v3
    v_dot2c_f32_bf16 v65, v3, v3
    v_dot2c_f32_bf16 v64, s55, v4
    s_waitcnt vmcnt(13)
    v_mfma_f32_32x32x16_bf16 v[152:167], a[40:43], v[132:135], v[152:167]
    v_dot2c_f32_bf16 v65, v4, v4
    v_dot2c_f32_bf16 v64, s55, v5
    v_dot2c_f32_bf16 v65, v5, v5
    v_mfma_f32_32x32x16_bf16 v[168:183], a[44:47], v[132:135], v[168:183]
    s_lshl_b32 s87, s48, 2
    s_add_u32 s86, s61, s87
    s_add_u32 s86, s86, 147456
    s_barrier
    s_waitcnt vmcnt(12)
    v_mfma_f32_32x32x16_bf16 v[152:167], a[48:51], v[136:139], v[152:167]
    v_add_f32_dpp v64, v64, v64 row_ror:8 row_mask:0xf bank_mask:0xf
    v_add_f32_dpp v65, v65, v65 row_ror:8 row_mask:0xf bank_mask:0xf
    s_nop 1
    v_permlane16_swap_b32 v64, v65
    s_waitcnt vmcnt(11)
    v_mfma_f32_32x32x16_bf16 v[152:167], a[56:59], v[140:143], v[152:167]
    v_add_f32 v64, v64, v65
    v_mov_b32 v65, v64
    s_nop 1
    v_permlane32_swap_b32 v64, v65
    s_waitcnt vmcnt(10)
    v_mfma_f32_32x32x16_bf16 v[152:167], a[64:67], v[144:147], v[152:167]
    v_add_f32 v64, v64, v65
    buffer_store_dword v64, v18, s[16:19], s86 offen offset:0
    s_waitcnt vmcnt(10)
    v_mfma_f32_32x32x16_bf16 v[152:167], a[72:75], v[148:151], v[152:167]
    s_waitcnt vmcnt(9)
    v_mfma_f32_32x32x16_bf16 v[152:167], a[80:83], v[188:191], v[152:167]
    s_waitcnt vmcnt(8)
    v_mfma_f32_32x32x16_bf16 v[152:167], a[88:91], v[192:195], v[152:167]
    s_waitcnt vmcnt(7)
    v_mfma_f32_32x32x16_bf16 v[152:167], a[96:99], v[196:199], v[152:167]
    s_waitcnt vmcnt(6)
    v_mfma_f32_32x32x16_bf16 v[152:167], a[104:107], v[200:203], v[152:167]
    v_mfma_f32_32x32x16_bf16 v[168:183], a[52:55], v[136:139], v[168:183]
    s_nop 3
    ds_write_b128 v14, v[152:155] offset:0
    v_mfma_f32_32x32x16_bf16 v[168:183], a[60:63], v[140:143], v[168:183]
    ds_write_b128 v15, v[156:159] offset:1024
    v_mfma_f32_32x32x16_bf16 v[168:183], a[68:71], v[144:147], v[168:183]
    ds_write_b128 v14, v[160:163] offset:2048
    v_mfma_f32_32x32x16_bf16 v[168:183], a[76:79], v[148:151], v[168:183]
    ds_write_b128 v15, v[164:167] offset:3072
    v_mfma_f32_32x32x16_bf16 v[168:183], a[84:87], v[188:191], v[168:183]
    v_mfma_f32_32x32x16_bf16 v[168:183], a[92:95], v[192:195], v[168:183]
    v_mov_b32 v252, 10
    s_waitcnt vmcnt(0)
    s_mov_b64 exec, 1
    s_cmp_lg_u32 s50, 0
    s_cbranch_scc1 L_pub_108
    buffer_store_dword v252, off, s[16:19], s52
L_pur_109:
    s_mov_b64 exec, -1
    v_mfma_f32_32x32x16_bf16 v[168:183], a[100:103], v[196:199], v[168:183]
    v_mfma_f32_32x32x16_bf16 v[168:183], a[108:111], v[200:203], v[168:183]
    s_nop 11
    ds_write_b128 v14, v[168:171] offset:4096
    ds_write_b128 v15, v[172:175] offset:5120
    ds_write_b128 v14, v[176:179] offset:6144
    ds_write_b128 v15, v[180:183] offset:7168
    buffer_load_dword v106, v21, s[16:19], s53 offen sc1
    s_waitcnt lgkmcnt(0)
    s_barrier
    ds_read_b128 v[152:155], v13 offset:0
    ds_read_b128 v[156:159], v13 offset:512
    ds_read_b128 v[160:163], v13 offset:8192
    ds_read_b128 v[164:167], v13 offset:8704
    ds_read_b128 v[168:171], v13 offset:16384
    ds_read_b128 v[172:175], v13 offset:16896
    ds_read_b128 v[176:179], v13 offset:24576
    ds_read_b128 v[180:183], v13 offset:25088
    s_add_u32 s65, s65, 4194304
    s_waitcnt vmcnt(0)
    v_cmp_gt_u32 vcc, 10, v106
    s_nop 1
    s_cbranch_vccnz L_poll_110
L_ok_111:
    s_cmp_lg_u32 s50, 0
    s_cbranch_scc1 L_acq_112
L_acr_113:
    s_mov_b32 s64, s59
    buffer_load_dwordx4 v[64:67], v1, s[16:19], s64 offen offset:0 sc1
    s_add_u32 s92, s59, 147456
    buffer_load_dwordx4 v[192:195], v19, s[16:19], s92 offen sc1
    buffer_load_dwordx4 v[196:199], v19, s[16:19], s92 offen offset:16 sc1
    s_waitcnt lgkmcnt(5)
    v_pk_add_f32 v[152:153], v[152:153], v[160:161]
    v_pk_add_f32 v[154:155], v[154:155], v[162:163]
    s_waitcnt lgkmcnt(4)
    v_pk_add_f32 v[156:157], v[156:157], v[164:165]
    buffer_load_dwordx4 v[68:71], v1, s[16:19], s64 offen offset:1024 sc1
    v_pk_add_f32 v[158:159], v[158:159], v[166:167]
    s_waitcnt lgkmcnt(1)
    v_pk_add_f32 v[168:169], v[168:169], v[176:177]
    v_pk_add_f32 v[170:171], v[170:171], v[178:179]
    buffer_load_dwordx4 v[72:75], v1, s[16:19], s64 offen offset:2048 sc1
    s_waitcnt lgkmcnt(0)
    v_pk_add_f32 v[172:173], v[172:173], v[180:181]
    v_pk_add_f32 v[174:175], v[174:175], v[182:183]
    v_lshlrev_b32 v160, 16, v6
    buffer_load_dwordx4 v[76:79], v1, s[16:19], s64 offen offset:3072 sc1
    v_and_b32 v161, 0xffff0000, v6
    v_lshlrev_b32 v162, 16, v7
    v_and_b32 v163, 0xffff0000, v7
    s_add_u32 s64, s64, 4096
    buffer_load_dwordx4 v[80:83], v1, s[16:19], s64 offen offset:0 sc1
    v_lshlrev_b32 v164, 16, v8
    v_and_b32 v165, 0xffff0000, v8
    v_lshlrev_b32 v166, 16, v9
    buffer_load_dwordx4 v[84:87], v1, s[16:19], s64 offen offset:1024 sc1
    v_and_b32 v167, 0xffff0000, v9
    v_pk_add_f32 v[152:153], v[152:153], v[168:169]
    v_pk_add_f32 v[154:155], v[154:155], v[170:171]
    buffer_load_dwordx4 v[88:91], v1, s[16:19], s64 offen offset:2048 sc1
    v_pk_add_f32 v[156:157], v[156:157], v[172:173]
    v_pk_add_f32 v[158:159], v[158:159], v[174:175]
    v_pk_fma_f32 v[152:153], v[152:153], v[104:105], v[160:161] op_sel:[0,1,0] op_sel_hi:[1,1,1]
    buffer_load_dwordx4 v[92:95], v1, s[16:19], s64 offen offset:3072 sc1
    v_pk_fma_f32 v[154:155], v[154:155], v[104:105], v[162:163] op_sel:[0,1,0] op_sel_hi:[1,1,1]
    v_pk_fma_f32 v[156:157], v[156:157], v[104:105], v[164:165] op_sel:[0,1,0] op_sel_hi:[1,1,1]
    v_pk_fma_f32 v[158:159], v[158:159], v[104:105], v[166:167] op_sel:[0,1,0] op_sel_hi:[1,1,1]
    s_add_u32 s64, s64, 4096
    buffer_load_dwordx4 v[96:99], v1, s[16:19], s64 offen offset:0 sc1
    v_cvt_pk_bf16_f32 v6, v152, v153
    v_cvt_pk_bf16_f32 v7, v154, v155
    v_cvt_pk_bf16_f32 v8, v156, v157
    buffer_load_dwordx4 v[100:103], v1, s[16:19], s64 offen offset:1024 sc1
    v_cvt_pk_bf16_f32 v9, v158, v159
    buffer_load_dwordx4 v[236:239], v1, s[16:19], s64 offen offset:2048 sc1
    buffer_load_dwordx4 v[240:243], v1, s[16:19], s64 offen offset:3072 sc1
    s_barrier
    s_lshl_b32 s87, s48, 12
    s_add_u32 s86, s62, s87
    buffer_store_dwordx4 v[6:9], v16, s[16:19], s86 offen
    v_mov_b32 v152, 0
    v_mov_b32 v153, 0
    v_dot2c_f32_bf16 v152, s55, v6
    v_dot2c_f32_bf16 v153, v6, v6
    v_dot2c_f32_bf16 v152, s55, v7
    v_dot2c_f32_bf16 v153, v7, v7
    v_dot2c_f32_bf16 v152, s55, v8
    v_dot2c_f32_bf16 v153, v8, v8
    v_dot2c_f32_bf16 v152, s55, v9
    v_dot2c_f32_bf16 v153, v9, v9
    s_lshl_b32 s87, s48, 2
    s_add_u32 s86, s62, s87
    s_add_u32 s86, s86, 147456
    v_add_f32_dpp v152, v152, v152 row_ror:8 row_mask:0xf bank_mask:0xf
    v_add_f32_dpp v153, v153, v153 row_ror:8 row_mask:0xf bank_mask:0xf
    s_nop 1
    v_permlane16_swap_b32 v152, v153
    v_add_f32 v152, v152, v153
    v_mov_b32 v153, v152
    s_nop 1
    v_permlane32_swap_b32 v152, v153
    v_add_f32 v152, v152, v153
    buffer_store_dword v152, v18, s[16:19], s86 offen offset:0
    ds_read_b128 v[112:115], v10 offset:4096
    ds_read_b128 v[116:119], v12 offset:12288
    ds_read_b128 v[120:123], v10 offset:5120
    ds_read_b128 v[124:127], v12 offset:12800
    s_waitcnt vmcnt(15) lgkmcnt(2)
    v_mfma_f32_32x32x16_bf16 v[128:143], v[112:115], v[64:67], 0
    ds_read_b128 v[112:115], v10 offset:6144
    s_add_u32 s51, s51, 16384
    s_add_u32 m0, s69, 131072
    s_nop 0
    buffer_load_dwordx4 v1, s[16:19], s51 offen offset:0 sc1 lds
    v_mfma_f32_32x32x16_bf16 v[144:159], v[64:67], v[116:119], 0
    ds_read_b128 v[116:119], v12 offset:13312
    s_add_u32 m0, s69, 131072
    s_nop 0
    buffer_load_dwordx4 v1, s[16:19], s51 offen offset:1024 sc1 lds
    s_waitcnt vmcnt(14) lgkmcnt(2)
    v_mfma_f32_32x32x16_bf16 v[128:143], v[120:123], v[68:71], v[128:143]
    ds_read_b128 v[120:123], v10 offset:7168
    s_add_u32 m0, s69, 131072
    s_nop 0
    buffer_load_dwordx4 v1, s[16:19], s51 offen offset:2048 sc1 lds
    v_mfma_f32_32x32x16_bf16 v[144:159], v[68:71], v[124:127], v[144:159]
    ds_read_b128 v[124:127], v12 offset:13824
    s_add_u32 m0, s69, 131072
    s_nop 0
    buffer_load_dwordx4 v1, s[16:19], s51 offen offset:3072 sc1 lds
    s_waitcnt vmcnt(15) lgkmcnt(2)
    v_mfma_f32_32x32x16_bf16 v[128:143], v[112:115], v[72:75], v[128:143]
    ds_read_b128 v[112:115], v10 offset:8192
    s_add_u32 s51, s51, 16384
    s_add_u32 m0, s69, 147456
    s_nop 0
    buffer_load_dwordx4 v1, s[16:19], s51 offen offset:0 sc1 lds
    v_add_f32 v192, v192, v193
    v_add_f32 v194, v194, v195
    v_mfma_f32_32x32x16_bf16 v[144:159], v[72:75], v[116:119], v[144:159]
    ds_read_b128 v[116:119], v12 offset:14336
    s_add_u32 s64, s64, 4096
    buffer_load_dwordx4 v[244:247], v1, s[16:19], s64 offen offset:0 sc1
    v_add_f32 v196, v196, v197
    v_add_f32 v198, v198, v199
    v_mov_b32 v252, 11
    s_waitcnt vmcnt(6)
    s_mov_b64 exec, 1
    s_cmp_lg_u32 s50, 0
    s_cbranch_scc1 L_pub_114
    buffer_store_dword v252, off, s[16:19], s52
L_pur_115:
    s_mov_b64 exec, -1
    s_waitcnt lgkmcnt(2)
    v_mfma_f32_32x32x16_bf16 v[128:143], v[120:123], v[76:79], v[128:143]
    ds_read_b128 v[120:123], v10 offset:9216
    s_add_u32 m0, s69, 147456
    s_nop 0
    buffer_load_dwordx4 v1, s[16:19], s51 offen offset:1024 sc1 lds
    v_add_f32 v192, v192, v194
    v_add_f32 v196, v196, v198
    v_mfma_f32_32x32x16_bf16 v[144:159], v[76:79], v[124:127], v[144:159]
    ds_read_b128 v[124:127], v12 offset:14848
    buffer_load_dwordx4 v[248:251], v1, s[16:19], s64 offen offset:1024 sc1
    v_add_f32 v192, v192, v196
    v_mov_b32 v214, v192
    s_waitcnt lgkmcnt(2)
    v_mfma_f32_32x32x16_bf16 v[128:143], v[112:115], v[80:83], v[128:143]
    ds_read_b128 v[112:115], v10 offset:10240
    s_add_u32 m0, s69, 147456
    s_nop 0
    buffer_load_dwordx4 v1, s[16:19], s51 offen offset:2048 sc1 lds
    v_mov_b32 v215, v192
    s_nop 1
    v_permlane32_swap_b32 v214, v215
    v_mfma_f32_32x32x16_bf16 v[144:159], v[80:83], v[116:119], v[144:159]
    ds_read_b128 v[116:119], v12 offset:15360
    buffer_load_dwordx4 v[64:67], v1, s[16:19], s64 offen offset:2048 sc1
    v_mul_f32 v214, 0x3b000000, v214
    v_mul_f32 v215, 0x3b000000, v215
    s_waitcnt lgkmcnt(2)
    v_mfma_f32_32x32x16_bf16 v[128:143], v[120:123], v[84:87], v[128:143]
    ds_read_b128 v[120:123], v10 offset:11264
    s_add_u32 m0, s69, 147456
    s_nop 0
    buffer_load_dwordx4 v1, s[16:19], s51 offen offset:3072 sc1 lds
    v_fma_f32 v215, -v214, v214, v215
    v_max_f32 v215, 0, v215
    v_mfma_f32_32x32x16_bf16 v[144:159], v[84:87], v[124:127], v[144:159]
    ds_read_b128 v[124:127], v12 offset:15872
    buffer_load_dwordx4 v[68:71], v1, s[16:19], s64 offen offset:3072 sc1
    v_cvt_pk_bf16_f32 v208, -v214, -v214
    v_cvt_pk_bf16_f32 v216, v215, v215
    s_waitcnt vmcnt(9)
    s_barrier
    s_waitcnt lgkmcnt(2)
    v_mfma_f32_32x32x16_bf16 v[128:143], v[112:115], v[88:91], v[128:143]
    ds_read_b128 v[112:115], v10 offset:20480
    s_add_u32 s64, s64, 4096
    buffer_load_dwordx4 v[72:75], v1, s[16:19], s64 offen offset:0 sc1
    v_and_b32 v216, 0xffff0000, v216
    v_add_f32 v216, 0x3727c5ac, v216
    v_mfma_f32_32x32x16_bf16 v[144:159], v[88:91], v[116:119], v[144:159]
    ds_read_b128 v[116:119], v12 offset:28672
    buffer_load_dwordx4 v[76:79], v1, s[16:19], s64 offen offset:1024 sc1
    v_cvt_pk_bf16_f32 v216, v216, v216
    v_and_b32 v216, 0xffff0000, v216
    s_waitcnt lgkmcnt(2)
    v_mfma_f32_32x32x16_bf16 v[128:143], v[120:123], v[92:95], v[128:143]
    ds_read_b128 v[120:123], v10 offset:21504
    buffer_load_dwordx4 v[80:83], v1, s[16:19], s64 offen offset:2048 sc1
    v_sqrt_f32 v216, v216
    s_nop 0
    v_cvt_pk_bf16_f32 v216, v216, v216
    v_mfma_f32_32x32x16_bf16 v[144:159], v[92:95], v[124:127], v[144:159]
    ds_read_b128 v[124:127], v12 offset:29184
    v_and_b32 v216, 0xffff0000, v216
    v_rcp_f32 v212, v216
    s_waitcnt lgkmcnt(2)
    v_mfma_f32_32x32x16_bf16 v[128:143], v[112:115], v[96:99], v[128:143]
    ds_read_b128 v[112:115], v10 offset:22528
    buffer_load_dwordx4 v[84:87], v1, s[16:19], s64 offen offset:3072 sc1
    v_mov_b32 v209, v208
    v_mov_b32 v210, v208
    v_mfma_f32_32x32x16_bf16 v[144:159], v[96:99], v[116:119], v[144:159]
    ds_read_b128 v[116:119], v12 offset:29696
    v_mov_b32 v211, v208
    v_mul_f32 v213, 0x3eb8aa3b, v212
    s_waitcnt lgkmcnt(2)
    v_mfma_f32_32x32x16_bf16 v[128:143], v[120:123], v[100:103], v[128:143]
    ds_read_b128 v[120:123], v10 offset:23552
    s_add_u32 s64, s64, 4096
    buffer_load_dwordx4 v[88:91], v1, s[16:19], s64 offen offset:0 sc1
    v_lshrrev_b32 v217, 5, v0
    v_lshlrev_b32 v217, 4, v217
    v_mfma_f32_32x32x16_bf16 v[144:159], v[100:103], v[124:127], v[144:159]
    ds_read_b128 v[124:127], v12 offset:30208
    ds_bpermute_b32 v192, v217, v212 offset:0
    s_waitcnt lgkmcnt(3)
    v_mfma_f32_32x32x16_bf16 v[128:143], v[112:115], v[236:239], v[128:143]
    ds_read_b128 v[112:115], v10 offset:24576
    buffer_load_dwordx4 v[92:95], v1, s[16:19], s64 offen offset:1024 sc1
    ds_bpermute_b32 v193, v217, v212 offset:4
    v_mfma_f32_32x32x16_bf16 v[144:159], v[236:239], v[116:119], v[144:159]
    ds_read_b128 v[116:119], v12 offset:30720
    ds_bpermute_b32 v194, v217, v212 offset:8
    s_waitcnt lgkmcnt(5)
    v_mfma_f32_32x32x16_bf16 v[128:143], v[120:123], v[240:243], v[128:143]
    ds_read_b128 v[120:123], v10 offset:25600
    buffer_load_dwordx4 v[96:99], v1, s[16:19], s64 offen offset:2048 sc1
    ds_bpermute_b32 v195, v217, v212 offset:12
    v_mfma_f32_32x32x16_bf16 v[144:159], v[240:243], v[124:127], v[144:159]
    ds_read_b128 v[124:127], v12 offset:31232
    ds_bpermute_b32 v196, v217, v212 offset:32
    s_waitcnt vmcnt(14) lgkmcnt(5)
    v_mfma_f32_32x32x16_bf16 v[128:143], v[112:115], v[244:247], v[128:143]
    ds_read_b128 v[112:115], v10 offset:26624
    buffer_load_dwordx4 v[100:103], v1, s[16:19], s64 offen offset:3072 sc1
    ds_bpermute_b32 v197, v217, v212 offset:36
    v_mfma_f32_32x32x16_bf16 v[144:159], v[244:247], v[116:119], v[144:159]
    ds_read_b128 v[116:119], v12 offset:31744
    ds_bpermute_b32 v198, v217, v212 offset:40
    s_waitcnt vmcnt(12) lgkmcnt(5)
    v_mfma_f32_32x32x16_bf16 v[128:143], v[120:123], v[248:251], v[128:143]
    ds_read_b128 v[120:123], v10 offset:27648
    s_add_u32 s64, s64, 4096
    buffer_load_dwordx4 v[236:239], v1, s[16:19], s64 offen offset:0 sc1
    ds_bpermute_b32 v199, v217, v212 offset:44
    v_mfma_f32_32x32x16_bf16 v[144:159], v[248:251], v[124:127], v[144:159]
    ds_read_b128 v[124:127], v12 offset:32256
    ds_bpermute_b32 v200, v217, v212 offset:64
    s_waitcnt vmcnt(10)
    s_barrier
    s_waitcnt lgkmcnt(5)
    v_mfma_f32_32x32x16_bf16 v[128:143], v[112:115], v[64:67], v[128:143]
    ds_read_b128 v[112:115], v10 offset:36864
    buffer_load_dwordx4 v[240:243], v1, s[16:19], s64 offen offset:1024 sc1
    ds_bpermute_b32 v201, v217, v212 offset:68
    v_mfma_f32_32x32x16_bf16 v[144:159], v[64:67], v[116:119], v[144:159]
    ds_read_b128 v[116:119], v12 offset:45056
    ds_bpermute_b32 v202, v217, v212 offset:72
    buffer_load_dword v111, v21, s[16:19], s53 offen sc1
    s_waitcnt vmcnt(11) lgkmcnt(5)
    v_mfma_f32_32x32x16_bf16 v[128:143], v[120:123], v[68:71], v[128:143]
    ds_read_b128 v[120:123], v10 offset:37888
    buffer_load_dwordx4 v[244:247], v1, s[16:19], s64 offen offset:2048 sc1
    ds_bpermute_b32 v203, v217, v212 offset:76
    v_mfma_f32_32x32x16_bf16 v[144:159], v[68:71], v[124:127], v[144:159]
    ds_read_b128 v[124:127], v12 offset:45568
    ds_bpermute_b32 v204, v217, v212 offset:96
    s_waitcnt vmcnt(11) lgkmcnt(5)
    v_mfma_f32_32x32x16_bf16 v[128:143], v[112:115], v[72:75], v[128:143]
    ds_read_b128 v[112:115], v10 offset:38912
    buffer_load_dwordx4 v[248:251], v1, s[16:19], s64 offen offset:3072 sc1
    ds_bpermute_b32 v205, v217, v212 offset:100
    v_mfma_f32_32x32x16_bf16 v[144:159], v[72:75], v[116:119], v[144:159]
    ds_read_b128 v[116:119], v12 offset:46080
    ds_bpermute_b32 v206, v217, v212 offset:104
    s_waitcnt vmcnt(11) lgkmcnt(5)
    v_mfma_f32_32x32x16_bf16 v[128:143], v[120:123], v[76:79], v[128:143]
    ds_read_b128 v[120:123], v10 offset:39936
    s_add_u32 s64, s64, 4096
    buffer_load_dwordx4 v[64:67], v1, s[16:19], s64 offen offset:0 sc1
    ds_bpermute_b32 v207, v217, v212 offset:108
    v_and_b32 v253, 31, v0
    v_lshrrev_b32 v254, 5, v0
    v_lshlrev_b32 v235, 2, v254
    v_sub_u32 v235, v253, v235
    v_mov_b32 v11, 0xf149f2ca
    v_cmp_le_i32_e64 s[94:95], 0, v235
    v_mfma_f32_32x32x16_bf16 v[144:159], v[76:79], v[124:127], v[144:159]
    ds_read_b128 v[124:127], v12 offset:46592
    v_cmp_le_i32_e64 s[96:97], 1, v235
    v_cndmask_b32_e64 v220, v11, 0, s[94:95]
    s_waitcnt vmcnt(11) lgkmcnt(4)
    v_mfma_f32_32x32x16_bf16 v[128:143], v[112:115], v[80:83], v[128:143]
    ds_read_b128 v[112:115], v10 offset:40960
    buffer_load_dwordx4 v[68:71], v1, s[16:19], s64 offen offset:1024 sc1
    v_cmp_le_i32_e64 s[94:95], 2, v235
    v_cndmask_b32_e64 v221, v11, 0, s[96:97]
    v_mfma_f32_32x32x16_bf16 v[144:159], v[80:83], v[116:119], v[144:159]
    ds_read_b128 v[116:119], v12 offset:47104
    v_cmp_le_i32_e64 s[96:97], 3, v235
    v_cndmask_b32_e64 v222, v11, 0, s[94:95]
    s_waitcnt vmcnt(11) lgkmcnt(2)
    v_mfma_f32_32x32x16_bf16 v[128:143], v[120:123], v[84:87], v[128:143]
    ds_read_b128 v[120:123], v10 offset:41984
    buffer_load_dwordx4 v[72:75], v1, s[16:19], s64 offen offset:2048 sc1
    v_cmp_le_i32_e64 s[94:95], 8, v235
    v_cndmask_b32_e64 v223, v11, 0, s[96:97]
    v_mfma_f32_32x32x16_bf16 v[144:159], v[84:87], v[124:127], v[144:159]
    ds_read_b128 v[124:127], v12 offset:47616
    v_cmp_le_i32_e64 s[96:97], 9, v235
    v_cndmask_b32_e64 v224, v11, 0, s[94:95]
    s_waitcnt vmcnt(11) lgkmcnt(2)
    v_mfma_f32_32x32x16_bf16 v[128:143], v[112:115], v[88:91], v[128:143]
    ds_read_b128 v[112:115], v10 offset:43008
    s_waitcnt vmcnt(5)
    v_cmp_gt_u32 vcc, 11, v111
    s_nop 1
    s_cbranch_vccnz L_poll_116
L_ok_117:
    s_cmp_lg_u32 s50, 0
    s_cbranch_scc1 L_acq_118
L_acr_119:
    buffer_load_dwordx4 v[76:79], v1, s[16:19], s64 offen offset:3072 sc1
    v_cmp_le_i32_e64 s[94:95], 10, v235
    v_cndmask_b32_e64 v225, v11, 0, s[96:97]
    v_mfma_f32_32x32x16_bf16 v[144:159], v[88:91], v[116:119], v[144:159]
    ds_read_b128 v[116:119], v12 offset:48128
    v_cmp_le_i32_e64 s[96:97], 11, v235
    v_cndmask_b32_e64 v226, v11, 0, s[94:95]
    s_waitcnt lgkmcnt(2)
    v_mfma_f32_32x32x16_bf16 v[128:143], v[120:123], v[92:95], v[128:143]
    ds_read_b128 v[120:123], v10 offset:44032
    s_mov_b32 s64, s60
    buffer_load_dwordx4 v[80:83], v1, s[16:19], s64 offen offset:0 sc1
    s_add_u32 s92, s60, 147456
    buffer_load_dwordx4 v[104:107], v19, s[16:19], s92 offen sc1
    buffer_load_dwordx4 v[108:111], v19, s[16:19], s92 offen offset:16 sc1
    v_cmp_le_i32_e64 s[94:95], 16, v235
    v_cndmask_b32_e64 v227, v11, 0, s[96:97]
    v_mfma_f32_32x32x16_bf16 v[144:159], v[92:95], v[124:127], v[144:159]
    ds_read_b128 v[124:127], v12 offset:48640
    v_cmp_le_i32_e64 s[96:97], 17, v235
    v_cndmask_b32_e64 v228, v11, 0, s[94:95]
    s_waitcnt lgkmcnt(2)
    v_mfma_f32_32x32x16_bf16 v[128:143], v[112:115], v[96:99], v[128:143]
    ds_read_b128 v[112:115], v10 offset:0
    buffer_load_dwordx4 v[84:87], v1, s[16:19], s64 offen offset:1024 sc1
    v_cmp_le_i32_e64 s[94:95], 18, v235
    v_cndmask_b32_e64 v229, v11, 0, s[96:97]
    v_mfma_f32_32x32x16_bf16 v[144:159], v[96:99], v[116:119], v[144:159]
    ds_read_b128 v[116:119], v12 offset:32768
    v_cmp_le_i32_e64 s[96:97], 19, v235
    v_cndmask_b32_e64 v230, v11, 0, s[94:95]
    s_waitcnt lgkmcnt(2)
    v_mfma_f32_32x32x16_bf16 v[128:143], v[120:123], v[100:103], v[128:143]
    ds_read_b128 v[120:123], v10 offset:1024
    buffer_load_dwordx4 v[88:91], v1, s[16:19], s64 offen offset:2048 sc1
    v_cmp_le_i32_e64 s[94:95], 24, v235
    v_cndmask_b32_e64 v231, v11, 0, s[96:97]
    v_mfma_f32_32x32x16_bf16 v[144:159], v[100:103], v[124:127], v[144:159]
    ds_read_b128 v[124:127], v12 offset:33280
    v_cmp_le_i32_e64 s[96:97], 25, v235
    v_cndmask_b32_e64 v232, v11, 0, s[94:95]
    s_waitcnt lgkmcnt(2)
    v_mfma_f32_32x32x16_bf16 v[128:143], v[112:115], v[236:239], v[128:143]
    ds_read_b128 v[112:115], v10 offset:2048
    buffer_load_dwordx4 v[92:95], v1, s[16:19], s64 offen offset:3072 sc1
    v_cmp_le_i32_e64 s[94:95], 26, v235
    v_cndmask_b32_e64 v233, v11, 0, s[96:97]
    v_mfma_f32_32x32x16_bf16 v[144:159], v[236:239], v[116:119], v[144:159]
    ds_read_b128 v[116:119], v12 offset:33792
    v_cmp_le_i32_e64 s[96:97], 27, v235
    v_cndmask_b32_e64 v234, v11, 0, s[94:95]
    s_waitcnt lgkmcnt(2)
    v_mfma_f32_32x32x16_bf16 v[128:143], v[120:123], v[240:243], v[128:143]
    ds_read_b128 v[120:123], v10 offset:3072
    s_add_u32 s64, s64, 4096
    buffer_load_dwordx4 v[96:99], v1, s[16:19], s64 offen offset:0 sc1
    v_cndmask_b32_e64 v235, v11, 0, s[96:97]
    v_mfma_f32_32x32x16_bf16 v[144:159], v[240:243], v[124:127], v[144:159]
    ds_read_b128 v[124:127], v12 offset:34304
    s_waitcnt vmcnt(12) lgkmcnt(2)
    v_mfma_f32_32x32x16_bf16 v[128:143], v[112:115], v[244:247], v[128:143]
    ds_read_b128 v[112:115], v10 offset:16384
    buffer_load_dwordx4 v[100:103], v1, s[16:19], s64 offen offset:1024 sc1
    v_mfma_f32_32x32x16_bf16 v[144:159], v[244:247], v[116:119], v[144:159]
    ds_read_b128 v[116:119], v12 offset:34816
    s_waitcnt vmcnt(12) lgkmcnt(2)
    v_mfma_f32_32x32x16_bf16 v[128:143], v[120:123], v[248:251], v[128:143]
    ds_read_b128 v[120:123], v10 offset:17408
    buffer_load_dwordx4 v[236:239], v1, s[16:19], s64 offen offset:2048 sc1
    v_mfma_f32_32x32x16_bf16 v[144:159], v[248:251], v[124:127], v[144:159]
    ds_read_b128 v[124:127], v12 offset:35328
    s_waitcnt vmcnt(12) lgkmcnt(2)
    v_mfma_f32_32x32x16_bf16 v[128:143], v[112:115], v[64:67], v[128:143]
    ds_read_b128 v[112:115], v10 offset:18432
    buffer_load_dwordx4 v[240:243], v1, s[16:19], s64 offen offset:3072 sc1
    v_mfma_f32_32x32x16_bf16 v[144:159], v[64:67], v[116:119], v[144:159]
    ds_read_b128 v[116:119], v12 offset:35840
    s_waitcnt vmcnt(12) lgkmcnt(2)
    v_mfma_f32_32x32x16_bf16 v[128:143], v[120:123], v[68:71], v[128:143]
    ds_read_b128 v[120:123], v10 offset:19456
    s_add_u32 s64, s64, 4096
    buffer_load_dwordx4 v[244:247], v1, s[16:19], s64 offen offset:0 sc1
    v_mfma_f32_32x32x16_bf16 v[144:159], v[68:71], v[124:127], v[144:159]
    ds_read_b128 v[124:127], v12 offset:36352
    s_waitcnt vmcnt(12) lgkmcnt(2)
    v_mfma_f32_32x32x16_bf16 v[128:143], v[112:115], v[72:75], v[128:143]
    v_mov_b32 v112, v28
    v_mov_b32 v113, 0
    v_mov_b32 v114, 0
    v_mov_b32 v115, 0
    buffer_load_dwordx4 v[248:251], v1, s[16:19], s64 offen offset:1024 sc1
    v_mfma_f32_32x32x16_bf16 v[144:159], v[72:75], v[116:119], v[144:159]
    v_mov_b32 v116, v29
    v_mov_b32 v117, 0
    v_mov_b32 v118, 0
    v_mov_b32 v119, 0
    s_waitcnt vmcnt(12) lgkmcnt(0)
    v_mfma_f32_32x32x16_bf16 v[128:143], v[120:123], v[76:79], v[128:143]
    ds_read_b128 v[120:123], v10 offset:4096
    buffer_load_dwordx4 v[64:67], v1, s[16:19], s64 offen offset:2048 sc1
    v_mfma_f32_32x32x16_bf16 v[144:159], v[76:79], v[124:127], v[144:159]
    ds_read_b128 v[124:127], v12 offset:12288
    v_mfma_f32_32x32x16_bf16 v[128:143], v[112:115], v[208:211], v[128:143]
    ds_read_b128 v[112:115], v10 offset:5120
    buffer_load_dwordx4 v[68:71], v1, s[16:19], s64 offen offset:3072 sc1
    v_mfma_f32_32x32x16_bf16 v[144:159], v[208:211], v[116:119], v[144:159]
    ds_read_b128 v[116:119], v12 offset:12800
    s_waitcnt vmcnt(13) lgkmcnt(2)
    v_mfma_f32_32x32x16_bf16 v[160:175], v[120:123], v[80:83], 0
    ds_read_b128 v[120:123], v10 offset:6144
    s_add_u32 s64, s64, 4096
    buffer_load_dwordx4 v[72:75], v1, s[16:19], s64 offen offset:0 sc1
    v_mfma_f32_32x32x16_bf16 v[176:191], v[80:83], v[124:127], 0
    ds_read_b128 v[124:127], v12 offset:13312
    v_mul_f32 v136, v136, v212
    v_mul_f32 v137, v137, v212
    v_mul_f32 v138, v138, v212
    v_mul_f32 v139, v139, v212
    s_waitcnt vmcnt(11) lgkmcnt(2)
    v_mfma_f32_32x32x16_bf16 v[160:175], v[112:115], v[84:87], v[160:175]
    ds_read_b128 v[112:115], v10 offset:7168
    buffer_load_dwordx4 v[76:79], v1, s[16:19], s64 offen offset:1024 sc1
    v_mul_f32 v140, v140, v212
    v_mul_f32 v141, v141, v212
    v_mul_f32 v142, v142, v212
    v_mul_f32 v143, v143, v212
    v_mfma_f32_32x32x16_bf16 v[176:191], v[84:87], v[116:119], v[176:191]
    ds_read_b128 v[116:119], v12 offset:13824
    v_cvt_pk_bf16_f32 v136, v136, v137
    v_cvt_pk_bf16_f32 v137, v138, v139
    v_cvt_pk_bf16_f32 v138, v140, v141
    v_cvt_pk_bf16_f32 v139, v142, v143
    s_waitcnt vmcnt(11) lgkmcnt(2)
    v_mfma_f32_32x32x16_bf16 v[160:175], v[120:123], v[88:91], v[160:175]
    ds_read_b128 v[120:123], v10 offset:8192
    buffer_load_dwordx4 v[80:83], v1, s[16:19], s64 offen offset:2048 sc1
    v_mul_f32 v144, v144, v192
    v_mul_f32 v145, v145, v193
    v_mul_f32 v146, v146, v194
    v_mul_f32 v147, v147, v195
    v_mfma_f32_32x32x16_bf16 v[176:191], v[88:91], v[124:127], v[176:191]
    ds_read_b128 v[124:127], v12 offset:14336
    v_mul_f32 v148, v148, v196
    v_mul_f32 v149, v149, v197
    v_mul_f32 v150, v150, v198
    v_mul_f32 v151, v151, v199
    s_waitcnt vmcnt(11) lgkmcnt(2)
    v_mfma_f32_32x32x16_bf16 v[160:175], v[112:115], v[92:95], v[160:175]
    ds_read_b128 v[112:115], v10 offset:9216
    buffer_load_dwordx4 v[84:87], v1, s[16:19], s64 offen offset:3072 sc1
    v_mul_f32 v152, v152, v200
    v_mul_f32 v153, v153, v201
    v_mul_f32 v154, v154, v202
    v_mul_f32 v155, v155, v203
    v_mfma_f32_32x32x16_bf16 v[176:191], v[92:95], v[116:119], v[176:191]
    ds_read_b128 v[116:119], v12 offset:14848
    v_mul_f32 v156, v156, v204
    v_mul_f32 v157, v157, v205
    v_mul_f32 v158, v158, v206
    v_mul_f32 v159, v159, v207
    s_waitcnt vmcnt(11) lgkmcnt(2)
    v_mfma_f32_32x32x16_bf16 v[160:175], v[120:123], v[96:99], v[160:175]
    ds_read_b128 v[120:123], v10 offset:10240
    s_add_u32 s64, s64, 4096
    buffer_load_dwordx4 v[88:91], v1, s[16:19], s64 offen offset:0 sc1
    v_cvt_pk_bf16_f32 v144, v144, v145
    v_cvt_pk_bf16_f32 v145, v146, v147
    v_cvt_pk_bf16_f32 v146, v148, v149
    v_cvt_pk_bf16_f32 v147, v150, v151
    v_mfma_f32_32x32x16_bf16 v[176:191], v[96:99], v[124:127], v[176:191]
    ds_read_b128 v[124:127], v12 offset:15360
    v_cvt_pk_bf16_f32 v148, v152, v153
    v_cvt_pk_bf16_f32 v149, v154, v155
    v_cvt_pk_bf16_f32 v150, v156, v157
    v_cvt_pk_bf16_f32 v151, v158, v159
    s_waitcnt vmcnt(11) lgkmcnt(2)
    v_mfma_f32_32x32x16_bf16 v[160:175], v[112:115], v[100:103], v[160:175]
    ds_read_b128 v[112:115], v10 offset:11264
    buffer_load_dwordx4 v[92:95], v1, s[16:19], s64 offen offset:1024 sc1
    v_permlane16_swap_b32 v144, v148
    v_permlane16_swap_b32 v145, v149
    v_permlane16_swap_b32 v146, v150
    v_permlane16_swap_b32 v147, v151
    v_mfma_f32_32x32x16_bf16 v[176:191], v[100:103], v[116:119], v[176:191]
    ds_read_b128 v[116:119], v12 offset:15872
    s_sub_u32 s86, s65, s72
    s_add_u32 s86, s86, 7168
    s_add_u32 s87, s86, 8192
    buffer_store_dwordx4 v[136:139], v1, s[16:19], s86 offen sc1
    buffer_store_dwordx4 v[144:147], v1, s[16:19], s87 offen sc1
    v_mul_f32 v128, v128, v213
    v_mul_f32 v129, v129, v213
    v_mul_f32 v130, v130, v213
    s_waitcnt vmcnt(13) lgkmcnt(2)
    v_mfma_f32_32x32x16_bf16 v[160:175], v[120:123], v[236:239], v[160:175]
    ds_read_b128 v[120:123], v10 offset:20480
    buffer_load_dwordx4 v[96:99], v1, s[16:19], s64 offen offset:2048 sc1
    v_mul_f32 v131, v131, v213
    v_mul_f32 v132, v132, v213
    v_mul_f32 v133, v133, v213
    v_mul_f32 v134, v134, v213
    v_mfma_f32_32x32x16_bf16 v[176:191], v[236:239], v[124:127], v[176:191]
    ds_read_b128 v[124:127], v12 offset:28672
    v_mul_f32 v135, v135, v213
    v_cvt_pk_bf16_f32 v128, v128, v129
    v_cvt_pk_bf16_f32 v129, v130, v131
    v_cvt_pk_bf16_f32 v130, v132, v133
    s_waitcnt vmcnt(13) lgkmcnt(2)
    v_mfma_f32_32x32x16_bf16 v[160:175], v[112:115], v[240:243], v[160:175]
    ds_read_b128 v[112:115], v10 offset:21504
    buffer_load_dwordx4 v[100:103], v1, s[16:19], s64 offen offset:3072 sc1
    v_cvt_pk_bf16_f32 v131, v134, v135
    v_add_f32 v104, v104, v105
    v_add_f32 v106, v106, v107
    v_mfma_f32_32x32x16_bf16 v[176:191], v[240:243], v[116:119], v[176:191]
    ds_read_b128 v[116:119], v12 offset:29184
    v_add_f32 v108, v108, v109
    v_add_f32 v110, v110, v111
    v_add_f32 v104, v104, v106
    s_waitcnt vmcnt(13) lgkmcnt(2)
    v_mfma_f32_32x32x16_bf16 v[160:175], v[120:123], v[244:247], v[160:175]
    ds_read_b128 v[120:123], v10 offset:22528
    s_add_u32 s64, s64, 4096
    buffer_load_dwordx4 v[236:239], v1, s[16:19], s64 offen offset:0 sc1
    v_add_f32 v108, v108, v110
    v_add_f32 v104, v104, v108
    v_mov_b32 v214, v104
    v_mfma_f32_32x32x16_bf16 v[176:191], v[244:247], v[124:127], v[176:191]
    ds_read_b128 v[124:127], v12 offset:29696
    v_mov_b32 v215, v104
    s_nop 1
    v_permlane32_swap_b32 v214, v215
    v_mul_f32 v214, 0x3b000000, v214
    s_waitcnt vmcnt(13) lgkmcnt(2)
    v_mfma_f32_32x32x16_bf16 v[160:175], v[112:115], v[248:251], v[160:175]
    ds_read_b128 v[112:115], v10 offset:23552
    buffer_load_dwordx4 v[240:243], v1, s[16:19], s64 offen offset:1024 sc1
    v_mul_f32 v215, 0x3b000000, v215
    v_fma_f32 v215, -v214, v214, v215
    v_max_f32 v215, 0, v215
    v_mfma_f32_32x32x16_bf16 v[176:191], v[248:251], v[116:119], v[176:191]
    ds_read_b128 v[116:119], v12 offset:30208
    v_cvt_pk_bf16_f32 v208, -v214, -v214
    v_cvt_pk_bf16_f32 v216, v215, v215
    v_and_b32 v216, 0xffff0000, v216
    s_waitcnt vmcnt(13) lgkmcnt(2)
    v_mfma_f32_32x32x16_bf16 v[160:175], v[120:123], v[64:67], v[160:175]
    ds_read_b128 v[120:123], v10 offset:24576
    buffer_load_dwordx4 v[244:247], v1, s[16:19], s64 offen offset:2048 sc1
    v_add_f32 v216, 0x3727c5ac, v216
    v_cvt_pk_bf16_f32 v216, v216, v216
    v_and_b32 v216, 0xffff0000, v216
    v_mfma_f32_32x32x16_bf16 v[176:191], v[64:67], v[124:127], v[176:191]
    ds_read_b128 v[124:127], v12 offset:30720
    v_sqrt_f32 v216, v216
    s_nop 0
    v_cvt_pk_bf16_f32 v216, v216, v216
    v_and_b32 v216, 0xffff0000, v216
    s_waitcnt vmcnt(13) lgkmcnt(2)
    v_mfma_f32_32x32x16_bf16 v[160:175], v[112:115], v[68:71], v[160:175]
    ds_read_b128 v[112:115], v10 offset:25600
    buffer_load_dwordx4 v[248:251], v1, s[16:19], s64 offen offset:3072 sc1
    v_rcp_f32 v212, v216
    v_mov_b32 v209, v208
    v_mov_b32 v210, v208
    v_mfma_f32_32x32x16_bf16 v[176:191], v[68:71], v[116:119], v[176:191]
    ds_read_b128 v[116:119], v12 offset:31232
    v_mov_b32 v211, v208
    v_mul_f32 v213, 0x3eb8aa3b, v212
    v_lshrrev_b32 v217, 5, v0
    v_mov_b32 v252, 3
    s_add_u32 s99, s52, 4096
    s_waitcnt vmcnt(6)
    s_mov_b64 exec, 1
    buffer_store_dword v252, off, s[16:19], s99 sc1
    s_mov_b64 exec, -1
    s_waitcnt lgkmcnt(2)
    v_mfma_f32_32x32x16_bf16 v[160:175], v[120:123], v[72:75], v[160:175]
    ds_read_b128 v[120:123], v10 offset:26624
    s_add_u32 s64, s64, 4096
    buffer_load_dwordx4 v[64:67], v1, s[16:19], s64 offen offset:0 sc1
    v_lshlrev_b32 v217, 4, v217
    ds_bpermute_b32 v192, v217, v212 offset:0
    ds_bpermute_b32 v193, v217, v212 offset:4
    v_mfma_f32_32x32x16_bf16 v[176:191], v[72:75], v[124:127], v[176:191]
    ds_read_b128 v[124:127], v12 offset:31744
    ds_bpermute_b32 v194, v217, v212 offset:8
    ds_bpermute_b32 v195, v217, v212 offset:12
    s_waitcnt lgkmcnt(6)
    v_mfma_f32_32x32x16_bf16 v[160:175], v[112:115], v[76:79], v[160:175]
    ds_read_b128 v[112:115], v10 offset:27648
    buffer_load_dwordx4 v[68:71], v1, s[16:19], s64 offen offset:1024 sc1
    ds_bpermute_b32 v196, v217, v212 offset:32
    ds_bpermute_b32 v197, v217, v212 offset:36
    v_mfma_f32_32x32x16_bf16 v[176:191], v[76:79], v[116:119], v[176:191]
    ds_read_b128 v[116:119], v12 offset:32256
    ds_bpermute_b32 v198, v217, v212 offset:40
    ds_bpermute_b32 v199, v217, v212 offset:44
    s_waitcnt lgkmcnt(8)
    v_mfma_f32_32x32x16_bf16 v[160:175], v[120:123], v[80:83], v[160:175]
    ds_read_b128 v[120:123], v10 offset:36864
    buffer_load_dwordx4 v[72:75], v1, s[16:19], s64 offen offset:2048 sc1
    ds_bpermute_b32 v200, v217, v212 offset:64
    ds_bpermute_b32 v201, v217, v212 offset:68
    v_mfma_f32_32x32x16_bf16 v[176:191], v[80:83], v[124:127], v[176:191]
    ds_read_b128 v[124:127], v12 offset:45056
    ds_bpermute_b32 v202, v217, v212 offset:72
    ds_bpermute_b32 v203, v217, v212 offset:76
    s_waitcnt lgkmcnt(8)
    v_mfma_f32_32x32x16_bf16 v[160:175], v[112:115], v[84:87], v[160:175]
    ds_read_b128 v[112:115], v10 offset:37888
    buffer_load_dwordx4 v[76:79], v1, s[16:19], s64 offen offset:3072 sc1
    ds_bpermute_b32 v204, v217, v212 offset:96
    ds_bpermute_b32 v205, v217, v212 offset:100
    v_mfma_f32_32x32x16_bf16 v[176:191], v[84:87], v[116:119], v[176:191]
    ds_read_b128 v[116:119], v12 offset:45568
    ds_bpermute_b32 v206, v217, v212 offset:104
    ds_bpermute_b32 v207, v217, v212 offset:108
    s_waitcnt lgkmcnt(8)
    v_mfma_f32_32x32x16_bf16 v[160:175], v[120:123], v[88:91], v[160:175]
    ds_read_b128 v[120:123], v10 offset:38912
    s_add_u32 s64, s64, 4096
    buffer_load_dwordx4 v[80:83], v1, s[16:19], s64 offen offset:0 sc1
    s_sub_u32 s87, 7168, s72
    v_add_u32 v216, 114688, v1
    v_add_u32 v217, s87, v216
    v_mfma_f32_32x32x16_bf16 v[176:191], v[88:91], v[124:127], v[176:191]
    ds_read_b128 v[124:127], v12 offset:46080
    v_add_u32 v216, s72, v216
    v_and_b32 v218, 15, v0
    v_lshlrev_b32 v218, 4, v218
    s_waitcnt lgkmcnt(4)
    v_mfma_f32_32x32x16_bf16 v[160:175], v[112:115], v[92:95], v[160:175]
    ds_read_b128 v[112:115], v10 offset:39936
    buffer_load_dwordx4 v[84:87], v1, s[16:19], s64 offen offset:1024 sc1
    v_lshrrev_b32 v253, 5, v0
    v_lshl_add_u32 v218, v253, 9, v218
    v_bfe_u32 v253, v0, 4, 1
    v_mfma_f32_32x32x16_bf16 v[176:191], v[92:95], v[116:119], v[176:191]
    ds_read_b128 v[116:119], v12 offset:46592
    v_lshl_add_u32 v218, v253, 14, v218
    v_add_u32 v218, 131072, v218
    v_add_u32 v219, s87, v218
    s_waitcnt vmcnt(12) lgkmcnt(2)
    v_mfma_f32_32x32x16_bf16 v[160:175], v[120:123], v[96:99], v[160:175]
    ds_read_b128 v[120:123], v10 offset:40960
    buffer_load_dwordx4 v[88:91], v1, s[16:19], s64 offen offset:2048 sc1
    v_add_u32 v218, s72, v218
    v_and_b32 v214, 3, v0
    v_lshlrev_b32 v214, 2, v214
    v_mfma_f32_32x32x16_bf16 v[176:191], v[96:99], v[124:127], v[176:191]
    ds_read_b128 v[124:127], v12 offset:47104
    s_cmp_eq_u32 s44, 0
    s_cselect_b32 s87, 0, s55
    v_mov_b32 v132, s55
    v_mov_b32 v133, s55
    s_waitcnt vmcnt(12) lgkmcnt(2)
    v_mfma_f32_32x32x16_bf16 v[160:175], v[112:115], v[100:103], v[160:175]
    ds_read_b128 v[112:115], v10 offset:41984
    buffer_load_dwordx4 v[92:95], v1, s[16:19], s64 offen offset:3072 sc1
    v_mov_b32 v134, s55
    v_mov_b32 v135, s55
    v_mov_b32 v140, s87
    v_mfma_f32_32x32x16_bf16 v[176:191], v[100:103], v[116:119], v[176:191]
    ds_read_b128 v[116:119], v12 offset:47616
    v_mov_b32 v141, s87
    v_mov_b32 v142, s87
    v_mov_b32 v143, s87
    s_waitcnt vmcnt(12) lgkmcnt(2)
    v_mfma_f32_32x32x16_bf16 v[160:175], v[120:123], v[236:239], v[160:175]
    ds_read_b128 v[120:123], v10 offset:43008
    v_mfma_f32_32x32x16_bf16 v[176:191], v[236:239], v[124:127], v[176:191]
    ds_read_b128 v[124:127], v12 offset:48128
    s_waitcnt vmcnt(11) lgkmcnt(2)
    v_mfma_f32_32x32x16_bf16 v[160:175], v[112:115], v[240:243], v[160:175]
    ds_read_b128 v[112:115], v10 offset:44032
    v_mfma_f32_32x32x16_bf16 v[176:191], v[240:243], v[116:119], v[176:191]
    ds_read_b128 v[116:119], v12 offset:48640
    s_waitcnt vmcnt(10) lgkmcnt(2)
    v_mfma_f32_32x32x16_bf16 v[160:175], v[120:123], v[244:247], v[160:175]
    ds_read_b128 v[120:123], v10 offset:0
    v_mfma_f32_32x32x16_bf16 v[176:191], v[244:247], v[124:127], v[176:191]
    ds_read_b128 v[124:127], v12 offset:32768
    s_waitcnt vmcnt(9) lgkmcnt(2)
    s_barrier
    v_mfma_f32_32x32x16_bf16 v[160:175], v[112:115], v[248:251], v[160:175]
    ds_read_b128 v[112:115], v10 offset:1024
    ds_write_b128 v217, v[136:139] offset:8192
    v_mfma_f32_32x32x16_bf16 v[176:191], v[248:251], v[116:119], v[176:191]
    ds_read_b128 v[116:119], v12 offset:33280
    s_waitcnt vmcnt(7) lgkmcnt(3)
    v_mfma_f32_32x32x16_bf16 v[160:175], v[120:123], v[64:67], v[160:175]
    ds_read_b128 v[120:123], v10 offset:2048
    ds_write_b128 v217, v[144:147] offset:24576
    v_sub_f32 v236, v11, v220
    v_mfma_f32_32x32x16_bf16 v[176:191], v[64:67], v[124:127], v[176:191]
    ds_read_b128 v[124:127], v12 offset:33792
    v_sub_f32 v237, v11, v221
    s_waitcnt vmcnt(6) lgkmcnt(3)
    v_mfma_f32_32x32x16_bf16 v[160:175], v[112:115], v[68:71], v[160:175]
    ds_read_b128 v[112:115], v10 offset:3072
    ds_write_b128 v217, v[132:135] offset:40960
    v_sub_f32 v238, v11, v222
    v_mfma_f32_32x32x16_bf16 v[176:191], v[68:71], v[116:119], v[176:191]
    ds_read_b128 v[116:119], v12 offset:34304
    v_sub_f32 v239, v11, v223
    s_waitcnt vmcnt(5) lgkmcnt(3)
    v_mfma_f32_32x32x16_bf16 v[160:175], v[120:123], v[72:75], v[160:175]
    ds_read_b128 v[120:123], v10 offset:16384
    ds_write_b128 v216, v[132:135] offset:40960
    v_sub_f32 v240, v11, v224
    v_mfma_f32_32x32x16_bf16 v[176:191], v[72:75], v[124:127], v[176:191]
    ds_read_b128 v[124:127], v12 offset:34816
    v_sub_f32 v241, v11, v225
    s_waitcnt vmcnt(4) lgkmcnt(3)
    v_mfma_f32_32x32x16_bf16 v[160:175], v[112:115], v[76:79], v[160:175]
    ds_read_b128 v[112:115], v10 offset:17408
    ds_write_b128 v216, v[140:143] offset:36864
    v_sub_f32 v242, v11, v226
    v_mfma_f32_32x32x16_bf16 v[176:191], v[76:79], v[116:119], v[176:191]
    ds_read_b128 v[116:119], v12 offset:35328
    v_sub_f32 v243, v11, v227
    s_waitcnt vmcnt(3) lgkmcnt(3)
    v_mfma_f32_32x32x16_bf16 v[160:175], v[120:123], v[80:83], v[160:175]
    ds_read_b128 v[120:123], v10 offset:18432
    s_cmp_lg_u32 s44, 0
    s_cbranch_scc1 L_c_120
    ds_write_b128 v216, v[140:143] offset:4096
    ds_write_b128 v216, v[140:143] offset:20480
L_c_120:
    v_sub_f32 v244, v11, v228
    v_mfma_f32_32x32x16_bf16 v[176:191], v[80:83], v[124:127], v[176:191]
    ds_read_b128 v[124:127], v12 offset:35840
    v_sub_f32 v245, v11, v229
    s_waitcnt vmcnt(2) lgkmcnt(2)
    v_mfma_f32_32x32x16_bf16 v[160:175], v[112:115], v[84:87], v[160:175]
    ds_read_b128 v[112:115], v10 offset:19456
    v_sub_f32 v246, v11, v230
    v_mfma_f32_32x32x16_bf16 v[176:191], v[84:87], v[116:119], v[176:191]
    ds_read_b128 v[116:119], v12 offset:36352
    v_sub_f32 v247, v11, v231
    buffer_load_dword v215, v214, s[16:19], s71 offen sc1
    s_waitcnt vmcnt(2) lgkmcnt(2)
    v_mfma_f32_32x32x16_bf16 v[160:175], v[120:123], v[88:91], v[160:175]
    v_mov_b32 v120, v28
    v_mov_b32 v121, 0
    v_mov_b32 v122, 0
    v_mov_b32 v123, 0
    v_sub_f32 v248, v11, v232
    v_mfma_f32_32x32x16_bf16 v[176:191], v[88:91], v[124:127], v[176:191]
    v_mov_b32 v124, v29
    v_mov_b32 v125, 0
    v_mov_b32 v126, 0
    v_mov_b32 v127, 0
    v_sub_f32 v249, v11, v233
    s_waitcnt vmcnt(1) lgkmcnt(0)
    v_mfma_f32_32x32x16_bf16 v[160:175], v[112:115], v[92:95], v[160:175]
    v_sub_f32 v250, v11, v234
    v_mfma_f32_32x32x16_bf16 v[176:191], v[92:95], v[116:119], v[176:191]
    v_sub_f32 v251, v11, v235
    v_mfma_f32_32x32x16_bf16 v[160:175], v[120:123], v[208:211], v[160:175]
    v_mfma_f32_32x32x16_bf16 v[176:191], v[208:211], v[124:127], v[176:191]
    s_nop 3
    v_mul_f32 v168, v168, v212
    v_mul_f32 v169, v169, v212
    v_mul_f32 v170, v170, v212
    v_mul_f32 v171, v171, v212
    v_mul_f32 v172, v172, v212
    v_mul_f32 v173, v173, v212
    v_mul_f32 v174, v174, v212
    v_mul_f32 v175, v175, v212
    v_cvt_pk_bf16_f32 v168, v168, v169
    v_cvt_pk_bf16_f32 v169, v170, v171
    v_cvt_pk_bf16_f32 v170, v172, v173
    v_cvt_pk_bf16_f32 v171, v174, v175
    v_mul_f32 v176, v176, v192
    v_mul_f32 v177, v177, v193
    v_mul_f32 v178, v178, v194
    v_mul_f32 v179, v179, v195
    v_mul_f32 v180, v180, v196
    v_mul_f32 v181, v181, v197
    v_mul_f32 v182, v182, v198
    v_mul_f32 v183, v183, v199
    v_mul_f32 v184, v184, v200
    v_mul_f32 v185, v185, v201
    v_mul_f32 v186, v186, v202
    v_mul_f32 v187, v187, v203
    v_mul_f32 v188, v188, v204
    v_mul_f32 v189, v189, v205
    v_mul_f32 v190, v190, v206
    v_mul_f32 v191, v191, v207
    v_cvt_pk_bf16_f32 v176, v176, v177
    v_cvt_pk_bf16_f32 v177, v178, v179
    v_cvt_pk_bf16_f32 v178, v180, v181
    v_cvt_pk_bf16_f32 v179, v182, v183
    v_cvt_pk_bf16_f32 v180, v184, v185
    v_cvt_pk_bf16_f32 v181, v186, v187
    v_cvt_pk_bf16_f32 v182, v188, v189
    v_cvt_pk_bf16_f32 v183, v190, v191
    v_permlane16_swap_b32 v176, v180
    v_permlane16_swap_b32 v177, v181
    v_permlane16_swap_b32 v178, v182
    v_permlane16_swap_b32 v179, v183
    s_mov_b32 s63, 0
    ds_write_b128 v216, v[168:171] offset:8192
    ds_write_b128 v216, v[176:179] offset:24576
    s_add_u32 s86, s65, s72
    s_add_u32 s87, s86, 8192
    buffer_store_dwordx4 v[168:171], v1, s[16:19], s86 offen sc1
    buffer_store_dwordx4 v[176:179], v1, s[16:19], s87 offen sc1
    s_lshl_b32 s88, s45, 10
    s_add_u32 s88, s88, 32768
    s_add_u32 s86, s88, s59
    s_add_u32 s87, s88, s60
    ds_read_b128 v[112:115], v217 offset:8192
    ds_read_b128 v[144:147], v219 offset:8192
    ds_read_b128 v[148:151], v219 offset:8448
    v_mul_f32 v160, v160, v213
    v_mul_f32 v161, v161, v213
    v_mul_f32 v162, v162, v213
    v_mul_f32 v163, v163, v213
    v_mul_f32 v164, v164, v213
    v_mul_f32 v165, v165, v213
    v_mul_f32 v166, v166, v213
    v_mul_f32 v167, v167, v213
    v_cvt_pk_bf16_f32 v160, v160, v161
    v_cvt_pk_bf16_f32 v161, v162, v163
    v_cvt_pk_bf16_f32 v162, v164, v165
    v_cvt_pk_bf16_f32 v163, v166, v167
    s_waitcnt lgkmcnt(2)
    v_mfma_f32_32x32x16_bf16 v[64:79], v[112:115], v[128:131], v[220:235]
    s_barrier
    ds_read_b128 v[116:119], v217 offset:7168
    ds_read_b128 v[112:115], v217 offset:6144
    ds_read_b128 v[152:155], v219 offset:7168
    s_nop 7
    v_exp_f32 v64, v64
    v_exp_f32 v65, v65
    v_exp_f32 v66, v66
    v_exp_f32 v67, v67
    ds_read_b128 v[156:159], v219 offset:7424
    v_exp_f32 v68, v68
    v_exp_f32 v69, v69
    v_exp_f32 v70, v70
    v_exp_f32 v71, v71
    s_waitcnt lgkmcnt(3)
    v_mfma_f32_32x32x16_bf16 v[80:95], v[116:119], v[128:131], 0
    v_cvt_pk_bf16_f32 v96, v64, v65
    v_cvt_pk_bf16_f32 v97, v66, v67
    v_cvt_pk_bf16_f32 v98, v68, v69
    v_cvt_pk_bf16_f32 v99, v70, v71
    v_exp_f32 v72, v72
    v_exp_f32 v73, v73
    v_exp_f32 v74, v74
    v_exp_f32 v75, v75
    v_mfma_f32_32x32x16_bf16 v[176:191], v[144:147], v[96:99], 0
    v_exp_f32 v76, v76
    v_exp_f32 v77, v77
    v_exp_f32 v78, v78
    v_exp_f32 v79, v79
    v_cvt_pk_bf16_f32 v100, v72, v73
    v_cvt_pk_bf16_f32 v101, v74, v75
    v_cvt_pk_bf16_f32 v102, v76, v77
    v_cvt_pk_bf16_f32 v103, v78, v79
    ds_write_b128 v216, v[140:143] offset:32768
    s_cmp_lg_u32 s44, 0
    s_cbranch_scc1 L_c_121
    ds_write_b128 v216, v[140:143]
    ds_write_b128 v216, v[140:143] offset:16384
L_c_121:
    s_waitcnt vmcnt(2)
    s_cmp_eq_u32 s44, 0
    s_cbranch_scc1 L_hx_122
    v_cmp_gt_u32 vcc, 3, v215
    s_nop 1
    s_cbranch_vccnz L_poll_124
L_ok_125:
    s_cmp_lg_u32 s50, 0
    s_cbranch_scc1 L_acq_126
L_acr_127:
    s_add_u32 s89, s65, s72
    s_sub_u32 s89, s89, 520192
    s_add_u32 s90, s89, 8192
    s_add_u32 m0, s72, 118784
    s_nop 0
    buffer_load_dwordx4 v1, s[16:19], s89 offen sc1 lds
    s_add_u32 m0, s72, 135168
    s_nop 0
    buffer_load_dwordx4 v1, s[16:19], s90 offen sc1 lds
L_hy_123:
    s_waitcnt lgkmcnt(3)
    v_mfma_f32_32x32x16_bf16 v[64:79], v[112:115], v[128:131], 0
    ds_read_b128 v[116:119], v217 offset:5120
    ds_read_b128 v[144:147], v219 offset:6144
    v_exp_f32 v80, v80
    v_exp_f32 v81, v81
    v_exp_f32 v82, v82
    v_exp_f32 v83, v83
    v_mfma_f32_32x32x16_bf16 v[176:191], v[148:151], v[100:103], v[176:191]
    ds_read_b128 v[148:151], v219 offset:6400
    v_exp_f32 v84, v84
    v_exp_f32 v85, v85
    v_exp_f32 v86, v86
    v_exp_f32 v87, v87
    v_cvt_pk_bf16_f32 v104, v80, v81
    v_cvt_pk_bf16_f32 v105, v82, v83
    v_cvt_pk_bf16_f32 v106, v84, v85
    v_cvt_pk_bf16_f32 v107, v86, v87
    v_exp_f32 v88, v88
    v_exp_f32 v89, v89
    v_exp_f32 v90, v90
    v_exp_f32 v91, v91
    s_waitcnt lgkmcnt(5)
    v_mfma_f32_32x32x16_bf16 v[176:191], v[152:155], v[104:107], v[176:191]
    v_exp_f32 v92, v92
    v_exp_f32 v93, v93
    v_exp_f32 v94, v94
    v_exp_f32 v95, v95
    v_cvt_pk_bf16_f32 v108, v88, v89
    v_cvt_pk_bf16_f32 v109, v90, v91
    v_cvt_pk_bf16_f32 v110, v92, v93
    v_cvt_pk_bf16_f32 v111, v94, v95
    s_waitcnt lgkmcnt(2)
    v_mfma_f32_32x32x16_bf16 v[80:95], v[116:119], v[128:131], 0
    ds_read_b128 v[112:115], v217 offset:4096
    ds_read_b128 v[152:155], v219 offset:5120
    v_exp_f32 v64, v64
    v_exp_f32 v65, v65
    v_exp_f32 v66, v66
    v_exp_f32 v67, v67
    v_mfma_f32_32x32x16_bf16 v[176:191], v[156:159], v[108:111], v[176:191]
    ds_read_b128 v[156:159], v219 offset:5376
    v_exp_f32 v68, v68
    v_exp_f32 v69, v69
    v_exp_f32 v70, v70
    v_exp_f32 v71, v71
    v_cvt_pk_bf16_f32 v96, v64, v65
    v_cvt_pk_bf16_f32 v97, v66, v67
    v_cvt_pk_bf16_f32 v98, v68, v69
    v_cvt_pk_bf16_f32 v99, v70, v71
    v_exp_f32 v72, v72
    v_exp_f32 v73, v73
    v_exp_f32 v74, v74
    v_exp_f32 v75, v75
    s_waitcnt lgkmcnt(4)
    v_mfma_f32_32x32x16_bf16 v[176:191], v[144:147], v[96:99], v[176:191]
    v_exp_f32 v76, v76
    v_exp_f32 v77, v77
    v_exp_f32 v78, v78
    v_exp_f32 v79, v79
    v_cvt_pk_bf16_f32 v100, v72, v73
    v_cvt_pk_bf16_f32 v101, v74, v75
    v_cvt_pk_bf16_f32 v102, v76, v77
    v_cvt_pk_bf16_f32 v103, v78, v79
    v_mov_b32 v252, 4
    s_add_u32 s99, s52, 4096
    s_waitcnt vmcnt(2)
    s_mov_b64 exec, 1
    buffer_store_dword v252, off, s[16:19], s99 sc1
    s_mov_b64 exec, -1
    s_waitcnt lgkmcnt(2)
    v_mfma_f32_32x32x16_bf16 v[64:79], v[112:115], v[128:131], 0
    ds_read_b128 v[144:147], v219 offset:4096
    v_exp_f32 v80, v80
    v_exp_f32 v81, v81
    v_exp_f32 v82, v82
    v_exp_f32 v83, v83
    v_mfma_f32_32x32x16_bf16 v[176:191], v[148:151], v[100:103], v[176:191]
    ds_read_b128 v[148:151], v219 offset:4352
    v_exp_f32 v84, v84
    v_exp_f32 v85, v85
    v_exp_f32 v86, v86
    v_exp_f32 v87, v87
    v_cvt_pk_bf16_f32 v104, v80, v81
    v_cvt_pk_bf16_f32 v105, v82, v83
    v_cvt_pk_bf16_f32 v106, v84, v85
    v_cvt_pk_bf16_f32 v107, v86, v87
    v_exp_f32 v88, v88
    v_exp_f32 v89, v89
    v_exp_f32 v90, v90
    v_exp_f32 v91, v91
    s_waitcnt lgkmcnt(3)
    v_mfma_f32_32x32x16_bf16 v[176:191], v[152:155], v[104:107], v[176:191]
    v_exp_f32 v92, v92
    v_exp_f32 v93, v93
    v_exp_f32 v94, v94
    v_exp_f32 v95, v95
    v_cvt_pk_bf16_f32 v108, v88, v89
    v_cvt_pk_bf16_f32 v109, v90, v91
    v_cvt_pk_bf16_f32 v110, v92, v93
    v_cvt_pk_bf16_f32 v111, v94, v95
    s_waitcnt vmcnt(1)
    s_barrier
    ds_read_b128 v[116:119], v217 offset:3072
    ds_read_b128 v[112:115], v217 offset:2048
    ds_read_b128 v[152:155], v219 offset:3072
    v_exp_f32 v64, v64
    v_exp_f32 v65, v65
    v_exp_f32 v66, v66
    v_exp_f32 v67, v67
    s_waitcnt lgkmcnt(5)
    v_mfma_f32_32x32x16_bf16 v[176:191], v[156:159], v[108:111], v[176:191]
    ds_read_b128 v[156:159], v219 offset:3328
    v_exp_f32 v68, v68
    v_exp_f32 v69, v69
    v_exp_f32 v70, v70
    v_exp_f32 v71, v71
    s_waitcnt lgkmcnt(3)
    v_mfma_f32_32x32x16_bf16 v[80:95], v[116:119], v[128:131], 0
    v_cvt_pk_bf16_f32 v96, v64, v65
    v_cvt_pk_bf16_f32 v97, v66, v67
    v_cvt_pk_bf16_f32 v98, v68, v69
    v_cvt_pk_bf16_f32 v99, v70, v71
    v_exp_f32 v72, v72
    v_exp_f32 v73, v73
    v_exp_f32 v74, v74
    v_exp_f32 v75, v75
    v_mfma_f32_32x32x16_bf16 v[176:191], v[144:147], v[96:99], v[176:191]
    v_exp_f32 v76, v76
    v_exp_f32 v77, v77
    v_exp_f32 v78, v78
    v_exp_f32 v79, v79
    v_cvt_pk_bf16_f32 v100, v72, v73
    v_cvt_pk_bf16_f32 v101, v74, v75
    v_cvt_pk_bf16_f32 v102, v76, v77
    v_cvt_pk_bf16_f32 v103, v78, v79
    s_waitcnt lgkmcnt(2)
    v_mfma_f32_32x32x16_bf16 v[64:79], v[112:115], v[128:131], 0
    ds_read_b128 v[116:119], v217 offset:1024
    ds_read_b128 v[144:147], v219 offset:2048
    v_exp_f32 v80, v80
    v_exp_f32 v81, v81
    v_exp_f32 v82, v82
    v_exp_f32 v83, v83
    v_mfma_f32_32x32x16_bf16 v[176:191], v[148:151], v[100:103], v[176:191]
    ds_read_b128 v[148:151], v219 offset:2304
    v_exp_f32 v84, v84
    v_exp_f32 v85, v85
    v_exp_f32 v86, v86
    v_exp_f32 v87, v87
    v_cvt_pk_bf16_f32 v104, v80, v81
    v_cvt_pk_bf16_f32 v105, v82, v83
    v_cvt_pk_bf16_f32 v106, v84, v85
    v_cvt_pk_bf16_f32 v107, v86, v87
    v_exp_f32 v88, v88
    v_exp_f32 v89, v89
    v_exp_f32 v90, v90
    v_exp_f32 v91, v91
    s_waitcnt lgkmcnt(4)
    v_mfma_f32_32x32x16_bf16 v[176:191], v[152:155], v[104:107], v[176:191]
    v_exp_f32 v92, v92
    v_exp_f32 v93, v93
    v_exp_f32 v94, v94
    v_exp_f32 v95, v95
    v_cvt_pk_bf16_f32 v108, v88, v89
    v_cvt_pk_bf16_f32 v109, v90, v91
    v_cvt_pk_bf16_f32 v110, v92, v93
    v_cvt_pk_bf16_f32 v111, v94, v95
    s_getpc_b64 s[92:93]
L_ct_128:
    s_lshl_b32 s70, s45, 2
    s_add_u32 s70, s70, s46
    s_lshl_b32 s70, s70, 9
    v_and_b32 v253, 3, v0
    v_lshlrev_b32 v253, 7, v253
    v_add_u32 v253, s70, v253
    v_min_u32 v253, L_end-L_ct_128-4, v253
    global_load_dword v124, v253, s[92:93]
    v_mov_b32 v132, -1
    v_mov_b32 v133, -1
    v_mov_b32 v134, -1
    v_mov_b32 v135, -1
    buffer_store_dwordx4 v[132:135], v1, s[16:19], s87 offen
    s_waitcnt lgkmcnt(2)
    v_mfma_f32_32x32x16_bf16 v[80:95], v[116:119], v[128:131], 0
    ds_read_b128 v[112:115], v217 offset:0
    ds_read_b128 v[152:155], v219 offset:1024
    v_exp_f32 v64, v64
    v_exp_f32 v65, v65
    v_exp_f32 v66, v66
    v_exp_f32 v67, v67
    v_mfma_f32_32x32x16_bf16 v[176:191], v[156:159], v[108:111], v[176:191]
    ds_read_b128 v[156:159], v219 offset:1280
    v_exp_f32 v68, v68
    v_exp_f32 v69, v69
    v_exp_f32 v70, v70
    v_exp_f32 v71, v71
    v_cvt_pk_bf16_f32 v96, v64, v65
    v_cvt_pk_bf16_f32 v97, v66, v67
    v_cvt_pk_bf16_f32 v98, v68, v69
    v_cvt_pk_bf16_f32 v99, v70, v71
    v_exp_f32 v72, v72
    v_exp_f32 v73, v73
    v_exp_f32 v74, v74
    v_exp_f32 v75, v75
    s_waitcnt lgkmcnt(4)
    v_mfma_f32_32x32x16_bf16 v[176:191], v[144:147], v[96:99], v[176:191]
    v_exp_f32 v76, v76
    v_exp_f32 v77, v77
    v_exp_f32 v78, v78
    v_exp_f32 v79, v79
    v_cvt_pk_bf16_f32 v100, v72, v73
    v_cvt_pk_bf16_f32 v101, v74, v75
    v_cvt_pk_bf16_f32 v102, v76, v77
    v_cvt_pk_bf16_f32 v103, v78, v79
    s_waitcnt lgkmcnt(2)
    v_mfma_f32_32x32x16_bf16 v[64:79], v[112:115], v[128:131], v[236:251]
    ds_read_b128 v[116:119], v216 offset:8192
    ds_read_b128 v[144:147], v219 offset:0
    v_exp_f32 v80, v80
    v_exp_f32 v81, v81
    v_exp_f32 v82, v82
    v_exp_f32 v83, v83
    v_mfma_f32_32x32x16_bf16 v[176:191], v[148:151], v[100:103], v[176:191]
    ds_read_b128 v[148:151], v219 offset:256
    v_exp_f32 v84, v84
    v_exp_f32 v85, v85
    v_exp_f32 v86, v86
    v_exp_f32 v87, v87
    v_cvt_pk_bf16_f32 v104, v80, v81
    v_cvt_pk_bf16_f32 v105, v82, v83
    v_cvt_pk_bf16_f32 v106, v84, v85
    v_cvt_pk_bf16_f32 v107, v86, v87
    v_exp_f32 v88, v88
    v_exp_f32 v89, v89
    v_exp_f32 v90, v90
    v_exp_f32 v91, v91
    s_waitcnt lgkmcnt(4)
    v_mfma_f32_32x32x16_bf16 v[176:191], v[152:155], v[104:107], v[176:191]
    v_exp_f32 v92, v92
    v_exp_f32 v93, v93
    v_exp_f32 v94, v94
    v_exp_f32 v95, v95
    v_cvt_pk_bf16_f32 v108, v88, v89
    v_cvt_pk_bf16_f32 v109, v90, v91
    v_cvt_pk_bf16_f32 v110, v92, v93
    v_cvt_pk_bf16_f32 v111, v94, v95
    s_waitcnt lgkmcnt(2)
    v_mfma_f32_32x32x16_bf16 v[80:95], v[116:119], v[160:163], v[220:235]
    ds_read_b128 v[112:115], v216 offset:7168
    ds_read_b128 v[152:155], v218 offset:8192
    v_exp_f32 v64, v64
    v_exp_f32 v65, v65
    v_exp_f32 v66, v66
    v_exp_f32 v67, v67
    v_mfma_f32_32x32x16_bf16 v[176:191], v[156:159], v[108:111], v[176:191]
    ds_read_b128 v[156:159], v218 offset:8448
    v_exp_f32 v68, v68
    v_exp_f32 v69, v69
    v_exp_f32 v70, v70
    v_exp_f32 v71, v71
    v_cvt_pk_bf16_f32 v96, v64, v65
    v_cvt_pk_bf16_f32 v97, v66, v67
    v_cvt_pk_bf16_f32 v98, v68, v69
    v_cvt_pk_bf16_f32 v99, v70, v71
    v_exp_f32 v72, v72
    v_exp_f32 v73, v73
    v_exp_f32 v74, v74
    v_exp_f32 v75, v75
    s_waitcnt lgkmcnt(4)
    v_mfma_f32_32x32x16_bf16 v[176:191], v[144:147], v[96:99], v[176:191]
    v_exp_f32 v76, v76
    v_exp_f32 v77, v77
    v_exp_f32 v78, v78
    v_exp_f32 v79, v79
    v_cvt_pk_bf16_f32 v100, v72, v73
    v_cvt_pk_bf16_f32 v101, v74, v75
    v_cvt_pk_bf16_f32 v102, v76, v77
    v_cvt_pk_bf16_f32 v103, v78, v79
    buffer_load_dword v215, v214, s[16:19], s71 offen sc1
    s_waitcnt lgkmcnt(2)
    v_mfma_f32_32x32x16_bf16 v[64:79], v[112:115], v[160:163], 0
    ds_read_b128 v[116:119], v216 offset:6144
    ds_read_b128 v[144:147], v218 offset:7168
    v_exp_f32 v80, v80
    v_exp_f32 v81, v81
    v_exp_f32 v82, v82
    v_exp_f32 v83, v83
    v_mfma_f32_32x32x16_bf16 v[176:191], v[148:151], v[100:103], v[176:191]
    ds_read_b128 v[148:151], v218 offset:7424
    v_exp_f32 v84, v84
    v_exp_f32 v85, v85
    v_exp_f32 v86, v86
    v_exp_f32 v87, v87
    v_cvt_pk_bf16_f32 v104, v80, v81
    v_cvt_pk_bf16_f32 v105, v82, v83
    v_cvt_pk_bf16_f32 v106, v84, v85
    v_cvt_pk_bf16_f32 v107, v86, v87
    v_exp_f32 v88, v88
    v_exp_f32 v89, v89
    v_exp_f32 v90, v90
    v_exp_f32 v91, v91
    s_waitcnt lgkmcnt(4)
    v_mfma_f32_32x32x16_bf16 v[192:207], v[152:155], v[104:107], 0
    v_exp_f32 v92, v92
    v_exp_f32 v93, v93
    v_exp_f32 v94, v94
    v_exp_f32 v95, v95
    v_cvt_pk_bf16_f32 v108, v88, v89
    v_cvt_pk_bf16_f32 v109, v90, v91
    v_cvt_pk_bf16_f32 v110, v92, v93
    v_cvt_pk_bf16_f32 v111, v94, v95
    v_rcp_f32 v185, v184
    s_nop 0
    v_mul_f32 v176, v176, v185
    v_mul_f32 v177, v177, v185
    v_mul_f32 v178, v178, v185
    v_mul_f32 v179, v179, v185
    v_mul_f32 v180, v180, v185
    v_mul_f32 v181, v181, v185
    v_mul_f32 v182, v182, v185
    v_mul_f32 v183, v183, v185
    v_cvt_pk_bf16_f32 v188, v176, v177
    v_cvt_pk_bf16_f32 v189, v178, v179
    v_cvt_pk_bf16_f32 v190, v180, v181
    v_cvt_pk_bf16_f32 v191, v182, v183
    buffer_store_dwordx4 v[188:191], v1, s[16:19], s86 offen
    v_mov_b32 v186, 0
    v_dot2c_f32_bf16 v186, s55, v188
    v_dot2c_f32_bf16 v186, s55, v189
    v_dot2c_f32_bf16 v186, s55, v190
    v_dot2c_f32_bf16 v186, s55, v191
    s_nop 2
    v_fma_f32 v186, v186, 0, v184
    v_subrev_u32 v186, 0x30800000, v186
    v_cmp_le_u32 vcc, 0x28000000, v186
    s_nop 1
    s_cmp_lg_u64 vcc, 0
    s_cselect_b32 s63, 1, s63
    s_waitcnt lgkmcnt(2)
    v_mfma_f32_32x32x16_bf16 v[80:95], v[116:119], v[160:163], 0
    ds_read_b128 v[112:115], v216 offset:5120
    ds_read_b128 v[152:155], v218 offset:6144
    v_exp_f32 v64, v64
    v_exp_f32 v65, v65
    v_exp_f32 v66, v66
    v_exp_f32 v67, v67
    v_mfma_f32_32x32x16_bf16 v[192:207], v[156:159], v[108:111], v[192:207]
    ds_read_b128 v[156:159], v218 offset:6400
    v_exp_f32 v68, v68
    v_exp_f32 v69, v69
    v_exp_f32 v70, v70
    v_exp_f32 v71, v71
    v_cvt_pk_bf16_f32 v96, v64, v65
    v_cvt_pk_bf16_f32 v97, v66, v67
    v_cvt_pk_bf16_f32 v98, v68, v69
    v_cvt_pk_bf16_f32 v99, v70, v71
    v_exp_f32 v72, v72
    v_exp_f32 v73, v73
    v_exp_f32 v74, v74
    v_exp_f32 v75, v75
    s_waitcnt lgkmcnt(4)
    v_mfma_f32_32x32x16_bf16 v[192:207], v[144:147], v[96:99], v[192:207]
    v_exp_f32 v76, v76
    v_exp_f32 v77, v77
    v_exp_f32 v78, v78
    v_exp_f32 v79, v79
    v_cvt_pk_bf16_f32 v100, v72, v73
    v_cvt_pk_bf16_f32 v101, v74, v75
    v_cvt_pk_bf16_f32 v102, v76, v77
    v_cvt_pk_bf16_f32 v103, v78, v79
    s_waitcnt vmcnt(1)
    s_cmp_eq_u32 s44, 0
    s_cbranch_scc1 L_hx_129
    v_cmp_gt_u32 vcc, 4, v215
    s_nop 1
    s_cbranch_vccnz L_poll_131
L_ok_132:
    s_cmp_lg_u32 s50, 0
    s_cbranch_scc1 L_acq_133
L_acr_134:
    s_add_u32 s89, s65, s72
    s_sub_u32 s89, s89, 524288
    s_add_u32 s90, s89, 8192
    s_add_u32 m0, s72, 114688
    s_nop 0
    buffer_load_dwordx4 v1, s[16:19], s89 offen sc1 lds
    s_add_u32 m0, s72, 131072
    s_nop 0
    buffer_load_dwordx4 v1, s[16:19], s90 offen sc1 lds
L_hy_130:
    s_waitcnt lgkmcnt(2)
    v_mfma_f32_32x32x16_bf16 v[64:79], v[112:115], v[160:163], 0
    ds_read_b128 v[116:119], v216 offset:4096
    ds_read_b128 v[144:147], v218 offset:5120
    v_exp_f32 v80, v80
    v_exp_f32 v81, v81
    v_exp_f32 v82, v82
    v_exp_f32 v83, v83
    v_mfma_f32_32x32x16_bf16 v[192:207], v[148:151], v[100:103], v[192:207]
    ds_read_b128 v[148:151], v218 offset:5376
    v_exp_f32 v84, v84
    v_exp_f32 v85, v85
    v_exp_f32 v86, v86
    v_exp_f32 v87, v87
    v_cvt_pk_bf16_f32 v104, v80, v81
    v_cvt_pk_bf16_f32 v105, v82, v83
    v_cvt_pk_bf16_f32 v106, v84, v85
    v_cvt_pk_bf16_f32 v107, v86, v87
    v_exp_f32 v88, v88
    v_exp_f32 v89, v89
    v_exp_f32 v90, v90
    v_exp_f32 v91, v91
    s_waitcnt lgkmcnt(4)
    v_mfma_f32_32x32x16_bf16 v[192:207], v[152:155], v[104:107], v[192:207]
    v_exp_f32 v92, v92
    v_exp_f32 v93, v93
    v_exp_f32 v94, v94
    v_exp_f32 v95, v95
    v_cvt_pk_bf16_f32 v108, v88, v89
    v_cvt_pk_bf16_f32 v109, v90, v91
    v_cvt_pk_bf16_f32 v110, v92, v93
    v_cvt_pk_bf16_f32 v111, v94, v95
    s_cmp_lg_u32 s63, 0
    s_cbranch_scc1 L_c_135
    v_mov_b32 v252, 13
    s_waitcnt vmcnt(2)
    s_mov_b64 exec, 1
    s_cmp_lg_u32 s50, 0
    s_cbranch_scc1 L_pub_136
    buffer_store_dword v252, off, s[16:19], s52
L_pur_137:
    s_mov_b64 exec, -1
L_c_135:
    s_waitcnt lgkmcnt(2)
    v_mfma_f32_32x32x16_bf16 v[80:95], v[116:119], v[160:163], 0
    ds_read_b128 v[152:155], v218 offset:4096
    v_exp_f32 v64, v64
    v_exp_f32 v65, v65
    v_exp_f32 v66, v66
    v_exp_f32 v67, v67
    v_mfma_f32_32x32x16_bf16 v[192:207], v[156:159], v[108:111], v[192:207]
    ds_read_b128 v[156:159], v218 offset:4352
    v_exp_f32 v68, v68
    v_exp_f32 v69, v69
    v_exp_f32 v70, v70
    v_exp_f32 v71, v71
    v_cvt_pk_bf16_f32 v96, v64, v65
    v_cvt_pk_bf16_f32 v97, v66, v67
    v_cvt_pk_bf16_f32 v98, v68, v69
    v_cvt_pk_bf16_f32 v99, v70, v71
    v_exp_f32 v72, v72
    v_exp_f32 v73, v73
    v_exp_f32 v74, v74
    v_exp_f32 v75, v75
    s_waitcnt lgkmcnt(3)
    v_mfma_f32_32x32x16_bf16 v[192:207], v[144:147], v[96:99], v[192:207]
    v_exp_f32 v76, v76
    v_exp_f32 v77, v77
    v_exp_f32 v78, v78
    v_exp_f32 v79, v79
    v_cvt_pk_bf16_f32 v100, v72, v73
    v_cvt_pk_bf16_f32 v101, v74, v75
    v_cvt_pk_bf16_f32 v102, v76, v77
    v_cvt_pk_bf16_f32 v103, v78, v79
    s_waitcnt vmcnt(0)
    s_barrier
    ds_read_b128 v[112:115], v216 offset:3072
    ds_read_b128 v[116:119], v216 offset:2048
    ds_read_b128 v[144:147], v218 offset:3072
    v_exp_f32 v80, v80
    v_exp_f32 v81, v81
    v_exp_f32 v82, v82
    v_exp_f32 v83, v83
    s_waitcnt lgkmcnt(5)
    v_mfma_f32_32x32x16_bf16 v[192:207], v[148:151], v[100:103], v[192:207]
    ds_read_b128 v[148:151], v218 offset:3328
    v_exp_f32 v84, v84
    v_exp_f32 v85, v85
    v_exp_f32 v86, v86
    v_exp_f32 v87, v87
    s_waitcnt lgkmcnt(3)
    v_mfma_f32_32x32x16_bf16 v[64:79], v[112:115], v[160:163], 0
    v_cvt_pk_bf16_f32 v104, v80, v81
    v_cvt_pk_bf16_f32 v105, v82, v83
    v_cvt_pk_bf16_f32 v106, v84, v85
    v_cvt_pk_bf16_f32 v107, v86, v87
    v_exp_f32 v88, v88
    v_exp_f32 v89, v89
    v_exp_f32 v90, v90
    v_exp_f32 v91, v91
    v_mfma_f32_32x32x16_bf16 v[192:207], v[152:155], v[104:107], v[192:207]
    v_exp_f32 v92, v92
    v_exp_f32 v93, v93
    v_exp_f32 v94, v94
    v_exp_f32 v95, v95
    v_cvt_pk_bf16_f32 v108, v88, v89
    v_cvt_pk_bf16_f32 v109, v90, v91
    v_cvt_pk_bf16_f32 v110, v92, v93
    v_cvt_pk_bf16_f32 v111, v94, v95
    buffer_load_dword v120, v22, s[16:19], s53 offen sc1
    s_waitcnt lgkmcnt(2)
    v_mfma_f32_32x32x16_bf16 v[80:95], v[116:119], v[160:163], 0
    ds_read_b128 v[112:115], v216 offset:1024
    ds_read_b128 v[152:155], v218 offset:2048
    v_exp_f32 v64, v64
    v_exp_f32 v65, v65
    v_exp_f32 v66, v66
    v_exp_f32 v67, v67
    v_mfma_f32_32x32x16_bf16 v[192:207], v[156:159], v[108:111], v[192:207]
    ds_read_b128 v[156:159], v218 offset:2304
    v_exp_f32 v68, v68
    v_exp_f32 v69, v69
    v_exp_f32 v70, v70
    v_exp_f32 v71, v71
    v_cvt_pk_bf16_f32 v96, v64, v65
    v_cvt_pk_bf16_f32 v97, v66, v67
    v_cvt_pk_bf16_f32 v98, v68, v69
    v_cvt_pk_bf16_f32 v99, v70, v71
    v_exp_f32 v72, v72
    v_exp_f32 v73, v73
    v_exp_f32 v74, v74
    v_exp_f32 v75, v75
    s_waitcnt lgkmcnt(4)
    v_mfma_f32_32x32x16_bf16 v[192:207], v[144:147], v[96:99], v[192:207]
    v_exp_f32 v76, v76
    v_exp_f32 v77, v77
    v_exp_f32 v78, v78
    v_exp_f32 v79, v79
    v_cvt_pk_bf16_f32 v100, v72, v73
    v_cvt_pk_bf16_f32 v101, v74, v75
    v_cvt_pk_bf16_f32 v102, v76, v77
    v_cvt_pk_bf16_f32 v103, v78, v79
    s_mov_b32 s91, s63
    s_waitcnt vmcnt(0)
    s_cmp_lg_u32 s63, 0
    s_cbranch_scc1 L_c_138
    v_cmp_gt_u32 vcc, 13, v120
    s_nop 1
    s_cbranch_vccnz L_poll_139
L_ok_140:
    s_cmp_lg_u32 s50, 0
    s_cbranch_scc1 L_acq_141
L_acr_142:
L_c_138:
    s_add_u32 s92, s61, s76
    buffer_load_dwordx4 v[132:135], v1, s[16:19], s92 offen offset:0 sc1
    s_add_u32 s92, s61, s76
    buffer_load_dwordx4 v[136:139], v1, s[16:19], s92 offen offset:1024 sc1
    s_waitcnt lgkmcnt(2)
    v_mfma_f32_32x32x16_bf16 v[64:79], v[112:115], v[160:163], 0
    ds_read_b128 v[116:119], v216 offset:0
    ds_read_b128 v[144:147], v218 offset:1024
    v_exp_f32 v80, v80
    v_exp_f32 v81, v81
    v_exp_f32 v82, v82
    v_exp_f32 v83, v83
    v_mfma_f32_32x32x16_bf16 v[192:207], v[148:151], v[100:103], v[192:207]
    ds_read_b128 v[148:151], v218 offset:1280
    v_exp_f32 v84, v84
    v_exp_f32 v85, v85
    v_exp_f32 v86, v86
    v_exp_f32 v87, v87
    s_add_u32 s92, s61, s77
    buffer_load_dwordx4 v[140:143], v1, s[16:19], s92 offen offset:0 sc1
    v_cvt_pk_bf16_f32 v104, v80, v81
    v_cvt_pk_bf16_f32 v105, v82, v83
    v_cvt_pk_bf16_f32 v106, v84, v85
    v_cvt_pk_bf16_f32 v107, v86, v87
    v_exp_f32 v88, v88
    v_exp_f32 v89, v89
    v_exp_f32 v90, v90
    v_exp_f32 v91, v91
    s_waitcnt lgkmcnt(4)
    v_mfma_f32_32x32x16_bf16 v[192:207], v[152:155], v[104:107], v[192:207]
    s_add_u32 s92, s61, s77
    buffer_load_dwordx4 v[164:167], v1, s[16:19], s92 offen offset:1024 sc1
    v_exp_f32 v92, v92
    v_exp_f32 v93, v93
    v_exp_f32 v94, v94
    v_exp_f32 v95, v95
    s_add_u32 s92, s61, s78
    buffer_load_dwordx4 v[168:171], v1, s[16:19], s92 offen offset:0 sc1
    v_cvt_pk_bf16_f32 v108, v88, v89
    v_cvt_pk_bf16_f32 v109, v90, v91
    v_cvt_pk_bf16_f32 v110, v92, v93
    v_cvt_pk_bf16_f32 v111, v94, v95
    s_waitcnt lgkmcnt(2)
    v_mfma_f32_32x32x16_bf16 v[80:95], v[116:119], v[160:163], v[236:251]
    ds_read_b128 v[152:155], v218 offset:0
    v_exp_f32 v64, v64
    v_exp_f32 v65, v65
    v_exp_f32 v66, v66
    v_exp_f32 v67, v67
    v_mfma_f32_32x32x16_bf16 v[192:207], v[156:159], v[108:111], v[192:207]
    ds_read_b128 v[156:159], v218 offset:256
    v_exp_f32 v68, v68
    v_exp_f32 v69, v69
    v_exp_f32 v70, v70
    v_exp_f32 v71, v71
    s_waitcnt vmcnt(4)
    v_mfma_f32_32x32x16_bf16 v[176:191], v[32:35], v[132:135], 0
    s_add_u32 s92, s61, s78
    buffer_load_dwordx4 v[172:175], v1, s[16:19], s92 offen offset:1024 sc1
    v_cvt_pk_bf16_f32 v96, v64, v65
    v_cvt_pk_bf16_f32 v97, v66, v67
    v_cvt_pk_bf16_f32 v98, v68, v69
    v_cvt_pk_bf16_f32 v99, v70, v71
    v_exp_f32 v72, v72
    v_exp_f32 v73, v73
    v_exp_f32 v74, v74
    v_exp_f32 v75, v75
    s_waitcnt lgkmcnt(3)
    v_mfma_f32_32x32x16_bf16 v[192:207], v[144:147], v[96:99], v[192:207]
    s_add_u32 s92, s61, s79
    buffer_load_dwordx4 v[208:211], v1, s[16:19], s92 offen offset:0 sc1
    v_exp_f32 v76, v76
    v_exp_f32 v77, v77
    v_exp_f32 v78, v78
    v_exp_f32 v79, v79
    s_add_u32 s92, s61, s79
    buffer_load_dwordx4 v[212:215], v1, s[16:19], s92 offen offset:1024 sc1
    v_mfma_f32_32x32x16_bf16 v[220:235], v[36:39], v[132:135], 0
    v_cvt_pk_bf16_f32 v100, v72, v73
    v_cvt_pk_bf16_f32 v101, v74, v75
    v_cvt_pk_bf16_f32 v102, v76, v77
    v_cvt_pk_bf16_f32 v103, v78, v79
    s_waitcnt vmcnt(6)
    v_mfma_f32_32x32x16_bf16 v[176:191], v[40:43], v[136:139], v[176:191]
    v_exp_f32 v80, v80
    v_exp_f32 v81, v81
    v_exp_f32 v82, v82
    v_exp_f32 v83, v83
    s_waitcnt lgkmcnt(2)
    v_mfma_f32_32x32x16_bf16 v[192:207], v[148:151], v[100:103], v[192:207]
    v_exp_f32 v84, v84
    v_exp_f32 v85, v85
    v_exp_f32 v86, v86
    v_exp_f32 v87, v87
    v_mfma_f32_32x32x16_bf16 v[220:235], v[44:47], v[136:139], v[220:235]
    v_cvt_pk_bf16_f32 v104, v80, v81
    v_cvt_pk_bf16_f32 v105, v82, v83
    v_cvt_pk_bf16_f32 v106, v84, v85
    v_cvt_pk_bf16_f32 v107, v86, v87
    v_exp_f32 v88, v88
    v_exp_f32 v89, v89
    s_waitcnt vmcnt(5)
    v_mfma_f32_32x32x16_bf16 v[176:191], v[48:51], v[140:143], v[176:191]
    v_exp_f32 v90, v90
    v_exp_f32 v91, v91
    v_exp_f32 v92, v92
    v_exp_f32 v93, v93
    s_waitcnt lgkmcnt(1)
    v_mfma_f32_32x32x16_bf16 v[192:207], v[152:155], v[104:107], v[192:207]
    v_exp_f32 v94, v94
    v_exp_f32 v95, v95
    v_cvt_pk_bf16_f32 v108, v88, v89
    v_cvt_pk_bf16_f32 v109, v90, v91
    v_cvt_pk_bf16_f32 v110, v92, v93
    v_cvt_pk_bf16_f32 v111, v94, v95
    v_mfma_f32_32x32x16_bf16 v[220:235], v[52:55], v[140:143], v[220:235]
    s_waitcnt lgkmcnt(0)
    v_mfma_f32_32x32x16_bf16 v[192:207], v[156:159], v[108:111], v[192:207]
    s_waitcnt vmcnt(4)
    v_mfma_f32_32x32x16_bf16 v[176:191], v[56:59], v[164:167], v[176:191]
    v_mfma_f32_32x32x16_bf16 v[220:235], v[60:63], v[164:167], v[220:235]
    v_rcp_f32 v201, v200
    v_subrev_u32 v202, 0x30800000, v200
    v_cmp_le_u32 vcc, 0x28000000, v202
    s_nop 1
    v_cndmask_b32_e64 v201, v201, -1, vcc
    s_waitcnt vmcnt(3)
    v_mfma_f32_32x32x16_bf16 v[176:191], a[224:227], v[168:171], v[176:191]
    v_mul_f32 v192, v192, v201
    v_mul_f32 v193, v193, v201
    v_mul_f32 v194, v194, v201
    v_mul_f32 v195, v195, v201
    v_mfma_f32_32x32x16_bf16 v[220:235], a[228:231], v[168:171], v[220:235]
    v_mul_f32 v196, v196, v201
    v_mul_f32 v197, v197, v201
    v_mul_f32 v198, v198, v201
    v_mul_f32 v199, v199, v201
    s_waitcnt vmcnt(2)
    v_mfma_f32_32x32x16_bf16 v[176:191], a[232:235], v[172:175], v[176:191]
    v_cvt_pk_bf16_f32 v204, v192, v193
    v_cvt_pk_bf16_f32 v205, v194, v195
    v_cvt_pk_bf16_f32 v206, v196, v197
    v_cvt_pk_bf16_f32 v207, v198, v199
    v_mfma_f32_32x32x16_bf16 v[220:235], a[236:239], v[172:175], v[220:235]
    buffer_store_dwordx4 v[204:207], v1, s[16:19], s87 offen
    v_mov_b32 v202, 0
    v_dot2c_f32_bf16 v202, s55, v204
    v_dot2c_f32_bf16 v202, s55, v205
    s_waitcnt vmcnt(2)
    v_mfma_f32_32x32x16_bf16 v[176:191], a[240:243], v[208:211], v[176:191]
    v_dot2c_f32_bf16 v202, s55, v206
    v_dot2c_f32_bf16 v202, s55, v207
    s_nop 2
    v_fma_f32 v202, v202, 0, v200
    v_subrev_u32 v202, 0x30800000, v202
    v_mfma_f32_32x32x16_bf16 v[220:235], a[244:247], v[208:211], v[220:235]
    v_cmp_le_u32 vcc, 0x28000000, v202
    s_nop 1
    s_cmp_lg_u64 vcc, 0
    s_cselect_b32 s63, 1, s63
    s_cmp_lg_u32 s63, 0
    s_cbranch_scc1 L_fb1
L_fbr1:
    s_waitcnt vmcnt(1)
    v_mfma_f32_32x32x16_bf16 v[176:191], a[248:251], v[212:215], v[176:191]
    v_mfma_f32_32x32x16_bf16 v[220:235], a[252:255], v[212:215], v[220:235]
    s_barrier
    s_nop 2
    ds_write_b128 v14, v[176:179] offset:0
    ds_write_b128 v15, v[180:183] offset:1024
    ds_write_b128 v14, v[184:187] offset:2048
    ds_write_b128 v15, v[188:191] offset:3072
    s_nop 3
    ds_write_b128 v14, v[220:223] offset:4096
    ds_write_b128 v15, v[224:227] offset:5120
    ds_write_b128 v14, v[228:231] offset:6144
    ds_write_b128 v15, v[232:235] offset:7168
    s_add_u32 s92, s62, s76
    buffer_load_dwordx4 v[144:147], v1, s[16:19], s92 offen offset:0 sc1
    buffer_load_dwordx4 v[148:151], v1, s[16:19], s92 offen offset:1024 sc1
    s_waitcnt lgkmcnt(0)
    s_barrier
    s_add_u32 s92, s62, s77
    buffer_load_dwordx4 v[152:155], v1, s[16:19], s92 offen offset:0 sc1
    buffer_load_dwordx4 v[156:159], v1, s[16:19], s92 offen offset:1024 sc1
    ds_read_b128 v[64:67], v13 offset:0
    ds_read_b128 v[68:71], v13 offset:512
    ds_read_b128 v[72:75], v13 offset:8192
    ds_read_b128 v[76:79], v13 offset:8704
    ds_read_b128 v[80:83], v13 offset:16384
    ds_read_b128 v[84:87], v13 offset:16896
    ds_read_b128 v[88:91], v13 offset:24576
    ds_read_b128 v[92:95], v13 offset:25088
    s_add_u32 s92, s62, s78
    buffer_load_dwordx4 v[176:179], v1, s[16:19], s92 offen offset:0 sc1
    buffer_load_dwordx4 v[180:183], v1, s[16:19], s92 offen offset:1024 sc1
    v_lshrrev_b32 v253, 5, v0
    v_lshlrev_b32 v163, 10, v253
    v_bfe_u32 v253, v0, 4, 1
    v_lshl_add_u32 v163, v253, 11, v163
    v_bfe_u32 v254, v0, 2, 2
    v_lshl_add_u32 v163, v254, 7, v163
    v_xor_b32 v253, v253, v254
    v_lshl_add_u32 v163, v253, 5, v163
    v_and_b32 v253, 3, v0
    v_lshl_add_u32 v160, v253, 3, v163
    v_xor_b32 v161, 32, v160
    v_xor_b32 v162, 64, v160
    v_xor_b32 v163, 96, v160
    v_mov_b32 v252, 14
    s_waitcnt vmcnt(6)
    s_mov_b64 exec, 1
    s_cmp_lg_u32 s50, 0
    s_cbranch_scc1 L_pub_143
    buffer_store_dword v252, off, s[16:19], s52
L_pur_144:
    s_mov_b64 exec, -1
    s_lshl_b32 s87, s48, 12
    s_add_u32 s92, s62, s79
    buffer_load_dwordx4 v[184:187], v1, s[16:19], s92 offen offset:0 sc1
    s_add_u32 s86, s61, s87
    s_waitcnt lgkmcnt(5)
    v_pk_add_f32 v[64:65], v[64:65], v[72:73]
    v_pk_add_f32 v[66:67], v[66:67], v[74:75]
    s_waitcnt lgkmcnt(4)
    v_pk_add_f32 v[68:69], v[68:69], v[76:77]
    v_pk_add_f32 v[70:71], v[70:71], v[78:79]
    s_waitcnt lgkmcnt(1)
    v_pk_add_f32 v[80:81], v[80:81], v[88:89]
    buffer_load_dwordx4 v[220:223], v1, s[16:19], s92 offen offset:1024 sc1
    v_pk_add_f32 v[82:83], v[82:83], v[90:91]
    s_waitcnt lgkmcnt(0)
    v_pk_add_f32 v[84:85], v[84:85], v[92:93]
    v_pk_add_f32 v[86:87], v[86:87], v[94:95]
    v_lshlrev_b32 v72, 16, v2
    v_and_b32 v73, 0xffff0000, v2
    v_lshlrev_b32 v74, 16, v3
    v_and_b32 v75, 0xffff0000, v3
    v_lshlrev_b32 v76, 16, v4
    v_and_b32 v77, 0xffff0000, v4
    v_lshlrev_b32 v78, 16, v5
    v_and_b32 v79, 0xffff0000, v5
    v_pk_add_f32 v[64:65], v[64:65], v[80:81]
    v_pk_add_f32 v[66:67], v[66:67], v[82:83]
    v_pk_add_f32 v[68:69], v[68:69], v[84:85]
    v_pk_add_f32 v[70:71], v[70:71], v[86:87]
    v_pk_add_f32 v[64:65], v[64:65], v[72:73]
    v_pk_add_f32 v[66:67], v[66:67], v[74:75]
    v_pk_add_f32 v[68:69], v[68:69], v[76:77]
    v_pk_add_f32 v[70:71], v[70:71], v[78:79]
    v_cvt_pk_bf16_f32 v2, v64, v65
    v_cvt_pk_bf16_f32 v3, v66, v67
    v_cvt_pk_bf16_f32 v4, v68, v69
    v_cvt_pk_bf16_f32 v5, v70, v71
    buffer_store_dwordx4 v[2:5], v16, s[16:19], s86 offen
    v_mov_b32 v64, 0
    v_mov_b32 v65, 0
    v_dot2c_f32_bf16 v64, s55, v2
    v_dot2c_f32_bf16 v65, v2, v2
    v_dot2c_f32_bf16 v64, s55, v3
    v_dot2c_f32_bf16 v65, v3, v3
    v_dot2c_f32_bf16 v64, s55, v4
    v_dot2c_f32_bf16 v65, v4, v4
    v_dot2c_f32_bf16 v64, s55, v5
    v_dot2c_f32_bf16 v65, v5, v5
    s_lshl_b32 s87, s48, 2
    s_add_u32 s86, s61, s87
    s_add_u32 s86, s86, 149504
    v_add_f32_dpp v64, v64, v64 row_ror:8 row_mask:0xf bank_mask:0xf
    v_add_f32_dpp v65, v65, v65 row_ror:8 row_mask:0xf bank_mask:0xf
    s_nop 1
    v_permlane16_swap_b32 v64, v65
    v_add_f32 v64, v64, v65
    v_mov_b32 v65, v64
    s_nop 1
    v_permlane32_swap_b32 v64, v65
    v_add_f32 v64, v64, v65
    buffer_store_dword v64, v18, s[16:19], s86 offen offset:0
    s_waitcnt vmcnt(10)
    v_mfma_f32_32x32x16_bf16 v[96:111], v[32:35], v[144:147], 0
    s_waitcnt vmcnt(9)
    v_mfma_f32_32x32x16_bf16 v[96:111], v[40:43], v[148:151], v[96:111]
    s_waitcnt vmcnt(8)
    v_mfma_f32_32x32x16_bf16 v[96:111], v[48:51], v[152:155], v[96:111]
    s_waitcnt vmcnt(7)
    v_mfma_f32_32x32x16_bf16 v[96:111], v[56:59], v[156:159], v[96:111]
    v_mov_b32 v252, 15
    s_waitcnt vmcnt(0)
    s_mov_b64 exec, 1
    s_cmp_lg_u32 s50, 0
    s_cbranch_scc1 L_pub_145
    buffer_store_dword v252, off, s[16:19], s52
L_pur_146:
    s_mov_b64 exec, -1
    v_mfma_f32_32x32x16_bf16 v[96:111], a[224:227], v[176:179], v[96:111]
    v_mfma_f32_32x32x16_bf16 v[96:111], a[232:235], v[180:183], v[96:111]
    v_mfma_f32_32x32x16_bf16 v[96:111], a[240:243], v[184:187], v[96:111]
    v_mfma_f32_32x32x16_bf16 v[96:111], a[248:251], v[220:223], v[96:111]
    s_barrier
    v_mfma_f32_32x32x16_bf16 v[112:127], v[36:39], v[144:147], 0
    v_mfma_f32_32x32x16_bf16 v[112:127], v[44:47], v[148:151], v[112:127]
    s_movk_i32 s93, 0x207
    v_cmp_class_f32 vcc, v96, s93
    s_cmp_lg_u32 s50, 0
    s_cbranch_scc1 L_wx_147
    s_cbranch_vccnz L_wx_147
L_wy_148:
    ds_write_b128 v14, v[96:99] offset:0
    v_mfma_f32_32x32x16_bf16 v[112:127], v[52:55], v[152:155], v[112:127]
    ds_write_b128 v15, v[100:103] offset:1024
    v_mfma_f32_32x32x16_bf16 v[112:127], v[60:63], v[156:159], v[112:127]
    ds_write_b128 v14, v[104:107] offset:2048
    v_mfma_f32_32x32x16_bf16 v[112:127], a[228:231], v[176:179], v[112:127]
    ds_write_b128 v15, v[108:111] offset:3072
    v_mfma_f32_32x32x16_bf16 v[112:127], a[236:239], v[180:183], v[112:127]
    v_mfma_f32_32x32x16_bf16 v[112:127], a[244:247], v[184:187], v[112:127]
    v_mfma_f32_32x32x16_bf16 v[112:127], a[252:255], v[220:223], v[112:127]
    buffer_load_dword v129, v21, s[16:19], s53 offen sc1
    s_nop 10
    ds_write_b128 v14, v[112:115] offset:4096
    ds_write_b128 v15, v[116:119] offset:5120
    ds_write_b128 v14, v[120:123] offset:6144
    ds_write_b128 v15, v[124:127] offset:7168
    s_waitcnt lgkmcnt(0)
    s_barrier
    ds_read_b128 v[96:99], v13 offset:0
    ds_read_b128 v[100:103], v13 offset:512
    ds_read_b128 v[104:107], v13 offset:8192
    ds_read_b128 v[108:111], v13 offset:8704
    ds_read_b128 v[112:115], v13 offset:16384
    ds_read_b128 v[116:119], v13 offset:16896
    ds_read_b128 v[120:123], v13 offset:24576
    ds_read_b128 v[124:127], v13 offset:25088
    s_waitcnt vmcnt(0)
    v_cmp_gt_u32 vcc, 15, v129
    s_nop 1
    s_cbranch_vccnz L_poll_153
L_ok_154:
    s_cmp_lg_u32 s50, 0
    s_cbranch_scc1 L_acq_155
L_acr_156:
    s_mov_b32 s64, s59
    buffer_load_dwordx4 v[188:191], v1, s[16:19], s64 offen offset:0 sc1
    s_add_u32 s88, s59, 149504
    buffer_load_dwordx4 v[164:167], v19, s[16:19], s88 offen sc1
    buffer_load_dwordx4 v[168:171], v19, s[16:19], s88 offen offset:16 sc1
    s_waitcnt lgkmcnt(5)
    v_pk_add_f32 v[96:97], v[96:97], v[104:105]
    v_pk_add_f32 v[98:99], v[98:99], v[106:107]
    s_waitcnt lgkmcnt(4)
    v_pk_add_f32 v[100:101], v[100:101], v[108:109]
    v_pk_add_f32 v[102:103], v[102:103], v[110:111]
    s_waitcnt lgkmcnt(1)
    v_pk_add_f32 v[112:113], v[112:113], v[120:121]
    buffer_load_dwordx4 v[192:195], v1, s[16:19], s64 offen offset:1024 sc1
    v_pk_add_f32 v[114:115], v[114:115], v[122:123]
    s_waitcnt lgkmcnt(0)
    v_pk_add_f32 v[116:117], v[116:117], v[124:125]
    v_pk_add_f32 v[118:119], v[118:119], v[126:127]
    v_lshlrev_b32 v104, 16, v6
    v_and_b32 v105, 0xffff0000, v6
    buffer_load_dwordx4 v[196:199], v1, s[16:19], s64 offen offset:2048 sc1
    v_lshlrev_b32 v106, 16, v7
    v_and_b32 v107, 0xffff0000, v7
    v_lshlrev_b32 v108, 16, v8
    v_and_b32 v109, 0xffff0000, v8
    v_lshlrev_b32 v110, 16, v9
    buffer_load_dwordx4 v[200:203], v1, s[16:19], s64 offen offset:3072 sc1
    v_and_b32 v111, 0xffff0000, v9
    v_pk_add_f32 v[96:97], v[96:97], v[112:113]
    v_pk_add_f32 v[98:99], v[98:99], v[114:115]
    v_pk_add_f32 v[100:101], v[100:101], v[116:117]
    v_pk_add_f32 v[102:103], v[102:103], v[118:119]
    s_add_u32 s64, s64, 4096
    buffer_load_dwordx4 v[204:207], v1, s[16:19], s64 offen offset:0 sc1
    v_pk_add_f32 v[96:97], v[96:97], v[104:105]
    v_pk_add_f32 v[98:99], v[98:99], v[106:107]
    v_pk_add_f32 v[100:101], v[100:101], v[108:109]
    v_pk_add_f32 v[102:103], v[102:103], v[110:111]
    v_cvt_pk_bf16_f32 v6, v96, v97
    buffer_load_dwordx4 v[208:211], v1, s[16:19], s64 offen offset:1024 sc1
    v_cvt_pk_bf16_f32 v7, v98, v99
    v_cvt_pk_bf16_f32 v8, v100, v101
    v_cvt_pk_bf16_f32 v9, v102, v103
    s_lshl_b32 s87, s48, 12
    s_add_u32 s86, s62, s87
    buffer_store_dwordx4 v[6:9], v16, s[16:19], s86 offen
    v_mov_b32 v96, 0
    v_mov_b32 v97, 0
    v_dot2c_f32_bf16 v96, s55, v6
    v_dot2c_f32_bf16 v97, v6, v6
    v_dot2c_f32_bf16 v96, s55, v7
    v_dot2c_f32_bf16 v97, v7, v7
    v_dot2c_f32_bf16 v96, s55, v8
    v_dot2c_f32_bf16 v97, v8, v8
    v_dot2c_f32_bf16 v96, s55, v9
    v_dot2c_f32_bf16 v97, v9, v9
    s_lshl_b32 s87, s48, 2
    s_add_u32 s86, s62, s87
    s_add_u32 s86, s86, 149504
    v_add_f32_dpp v96, v96, v96 row_ror:8 row_mask:0xf bank_mask:0xf
    v_add_f32_dpp v97, v97, v97 row_ror:8 row_mask:0xf bank_mask:0xf
    s_nop 1
    v_permlane16_swap_b32 v96, v97
    v_add_f32 v96, v96, v97
    v_mov_b32 v97, v96
    s_nop 1
    v_permlane32_swap_b32 v96, v97
    v_add_f32 v96, v96, v97
    buffer_store_dword v96, v18, s[16:19], s86 offen offset:0
    s_lshr_b32 s57, s45, 1
    s_mul_i32 s57, s57, 7168
    s_add_u32 s57, s57, 32768
    s_mul_i32 s88, s49, 3072
    s_add_u32 s57, s57, s88
    s_cmp_lg_u32 s49, 0
    s_cbranch_scc1 L_ge1
    ds_read_b64_tr_b16 v[128:129], v160 offset:0
    ds_read_b64_tr_b16 v[130:131], v160 offset:512
    ds_read_b64_tr_b16 v[132:133], v161 offset:0
    ds_read_b64_tr_b16 v[134:135], v161 offset:512
    ds_read_b64_tr_b16 v[136:137], v162 offset:0
    ds_read_b64_tr_b16 v[138:139], v162 offset:512
    ds_read_b64_tr_b16 v[140:141], v163 offset:0
    ds_read_b64_tr_b16 v[142:143], v163 offset:512
    ds_read_b64_tr_b16 v[144:145], v160 offset:4096
    ds_read_b64_tr_b16 v[146:147], v160 offset:4608
    ds_read_b64_tr_b16 v[148:149], v161 offset:4096
    ds_read_b64_tr_b16 v[150:151], v161 offset:4608
    ds_read_b64_tr_b16 v[152:153], v162 offset:4096
    ds_read_b64_tr_b16 v[154:155], v162 offset:4608
    ds_read_b64_tr_b16 v[156:157], v163 offset:4096
    ds_read_b64_tr_b16 v[158:159], v163 offset:4608
    s_waitcnt vmcnt(9) lgkmcnt(8)
    v_mfma_f32_32x32x16_bf16 v[64:79], v[128:131], v[188:191], 0
    ds_read_b64_tr_b16 v[128:129], v160 offset:8192
    ds_read_b64_tr_b16 v[130:131], v160 offset:8704
    buffer_load_dwordx4 v[212:215], v1, s[16:19], s64 offen offset:2048 sc1
    v_mfma_f32_32x32x16_bf16 v[80:95], v[132:135], v[188:191], 0
    ds_read_b64_tr_b16 v[132:133], v161 offset:8192
    ds_read_b64_tr_b16 v[134:135], v161 offset:8704
    buffer_load_dwordx4 v[216:219], v1, s[16:19], s64 offen offset:3072 sc1
    v_mfma_f32_32x32x16_bf16 v[96:111], v[136:139], v[188:191], 0
    ds_read_b64_tr_b16 v[136:137], v162 offset:8192
    ds_read_b64_tr_b16 v[138:139], v162 offset:8704
    v_mfma_f32_32x32x16_bf16 v[112:127], v[140:143], v[188:191], 0
    ds_read_b64_tr_b16 v[140:141], v163 offset:8192
    ds_read_b64_tr_b16 v[142:143], v163 offset:8704
    s_waitcnt vmcnt(8) lgkmcnt(8)
    v_mfma_f32_32x32x16_bf16 v[64:79], v[144:147], v[192:195], v[64:79]
    ds_read_b64_tr_b16 v[144:145], v160 offset:12288
    ds_read_b64_tr_b16 v[146:147], v160 offset:12800
    s_add_u32 s64, s64, 4096
    buffer_load_dwordx4 v[220:223], v1, s[16:19], s64 offen offset:0 sc1
    v_mfma_f32_32x32x16_bf16 v[80:95], v[148:151], v[192:195], v[80:95]
    ds_read_b64_tr_b16 v[148:149], v161 offset:12288
    ds_read_b64_tr_b16 v[150:151], v161 offset:12800
    buffer_load_dwordx4 v[224:227], v1, s[16:19], s64 offen offset:1024 sc1
    v_mfma_f32_32x32x16_bf16 v[96:111], v[152:155], v[192:195], v[96:111]
    ds_read_b64_tr_b16 v[152:153], v162 offset:12288
    ds_read_b64_tr_b16 v[154:155], v162 offset:12800
    v_mfma_f32_32x32x16_bf16 v[112:127], v[156:159], v[192:195], v[112:127]
    ds_read_b64_tr_b16 v[156:157], v163 offset:12288
    ds_read_b64_tr_b16 v[158:159], v163 offset:12800
    s_waitcnt vmcnt(9) lgkmcnt(8)
    v_mfma_f32_32x32x16_bf16 v[64:79], v[128:131], v[196:199], v[64:79]
    ds_read_b64_tr_b16 v[128:129], v160 offset:16384
    ds_read_b64_tr_b16 v[130:131], v160 offset:16896
    buffer_load_dwordx4 v[228:231], v1, s[16:19], s64 offen offset:2048 sc1
    v_mfma_f32_32x32x16_bf16 v[80:95], v[132:135], v[196:199], v[80:95]
    ds_read_b64_tr_b16 v[132:133], v161 offset:16384
    ds_read_b64_tr_b16 v[134:135], v161 offset:16896
    buffer_load_dwordx4 v[232:235], v1, s[16:19], s64 offen offset:3072 sc1
    v_mfma_f32_32x32x16_bf16 v[96:111], v[136:139], v[196:199], v[96:111]
    ds_read_b64_tr_b16 v[136:137], v162 offset:16384
    ds_read_b64_tr_b16 v[138:139], v162 offset:16896
    v_mfma_f32_32x32x16_bf16 v[112:127], v[140:143], v[196:199], v[112:127]
    ds_read_b64_tr_b16 v[140:141], v163 offset:16384
    ds_read_b64_tr_b16 v[142:143], v163 offset:16896
    s_waitcnt vmcnt(10) lgkmcnt(8)
    v_mfma_f32_32x32x16_bf16 v[64:79], v[144:147], v[200:203], v[64:79]
    ds_read_b64_tr_b16 v[144:145], v160 offset:20480
    ds_read_b64_tr_b16 v[146:147], v160 offset:20992
    s_add_u32 s64, s64, 4096
    buffer_load_dwordx4 v[236:239], v1, s[16:19], s64 offen offset:0 sc1
    v_mfma_f32_32x32x16_bf16 v[80:95], v[148:151], v[200:203], v[80:95]
    ds_read_b64_tr_b16 v[148:149], v161 offset:20480
    ds_read_b64_tr_b16 v[150:151], v161 offset:20992
    buffer_load_dwordx4 v[240:243], v1, s[16:19], s64 offen offset:1024 sc1
    v_add_f32 v164, v164, v165
    v_add_f32 v166, v166, v167
    v_mfma_f32_32x32x16_bf16 v[96:111], v[152:155], v[200:203], v[96:111]
    ds_read_b64_tr_b16 v[152:153], v162 offset:20480
    ds_read_b64_tr_b16 v[154:155], v162 offset:20992
    v_mfma_f32_32x32x16_bf16 v[112:127], v[156:159], v[200:203], v[112:127]
    ds_read_b64_tr_b16 v[156:157], v163 offset:20480
    ds_read_b64_tr_b16 v[158:159], v163 offset:20992
    s_waitcnt vmcnt(11) lgkmcnt(8)
    v_mfma_f32_32x32x16_bf16 v[64:79], v[128:131], v[204:207], v[64:79]
    ds_read_b64_tr_b16 v[128:129], v160 offset:24576
    ds_read_b64_tr_b16 v[130:131], v160 offset:25088
    buffer_load_dwordx4 v[244:247], v1, s[16:19], s64 offen offset:2048 sc1
    v_mfma_f32_32x32x16_bf16 v[80:95], v[132:135], v[204:207], v[80:95]
    ds_read_b64_tr_b16 v[132:133], v161 offset:24576
    ds_read_b64_tr_b16 v[134:135], v161 offset:25088
    buffer_load_dwordx4 v[248:251], v1, s[16:19], s64 offen offset:3072 sc1
    v_add_f32 v168, v168, v169
    v_add_f32 v170, v170, v171
    v_mfma_f32_32x32x16_bf16 v[96:111], v[136:139], v[204:207], v[96:111]
    ds_read_b64_tr_b16 v[136:137], v162 offset:24576
    ds_read_b64_tr_b16 v[138:139], v162 offset:25088
    v_mfma_f32_32x32x16_bf16 v[112:127], v[140:143], v[204:207], v[112:127]
    ds_read_b64_tr_b16 v[140:141], v163 offset:24576
    ds_read_b64_tr_b16 v[142:143], v163 offset:25088
    v_mov_b32 v252, 16
    s_waitcnt vmcnt(10)
    s_mov_b64 exec, 1
    s_cmp_lg_u32 s50, 0
    s_cbranch_scc1 L_pub_157
    buffer_store_dword v252, off, s[16:19], s52
L_pur_158:
    s_mov_b64 exec, -1
    s_waitcnt lgkmcnt(8)
    v_mfma_f32_32x32x16_bf16 v[64:79], v[144:147], v[208:211], v[64:79]
    ds_read_b64_tr_b16 v[144:145], v160 offset:28672
    ds_read_b64_tr_b16 v[146:147], v160 offset:29184
    s_add_u32 s64, s64, 4096
    buffer_load_dwordx4 v[188:191], v1, s[16:19], s64 offen offset:0 sc1
    v_mfma_f32_32x32x16_bf16 v[80:95], v[148:151], v[208:211], v[80:95]
    ds_read_b64_tr_b16 v[148:149], v161 offset:28672
    ds_read_b64_tr_b16 v[150:151], v161 offset:29184
    buffer_load_dwordx4 v[192:195], v1, s[16:19], s64 offen offset:1024 sc1
    v_add_f32 v164, v164, v166
    v_add_f32 v168, v168, v170
    v_mfma_f32_32x32x16_bf16 v[96:111], v[152:155], v[208:211], v[96:111]
    ds_read_b64_tr_b16 v[152:153], v162 offset:28672
    ds_read_b64_tr_b16 v[154:155], v162 offset:29184
    v_mfma_f32_32x32x16_bf16 v[112:127], v[156:159], v[208:211], v[112:127]
    ds_read_b64_tr_b16 v[156:157], v163 offset:28672
    ds_read_b64_tr_b16 v[158:159], v163 offset:29184
    s_waitcnt vmcnt(12) lgkmcnt(8)
    v_mfma_f32_32x32x16_bf16 v[64:79], v[128:131], v[212:215], v[64:79]
    ds_read_b64_tr_b16 v[128:129], v160 offset:32768
    ds_read_b64_tr_b16 v[130:131], v160 offset:33280
    buffer_load_dwordx4 v[196:199], v1, s[16:19], s64 offen offset:2048 sc1
    v_mfma_f32_32x32x16_bf16 v[80:95], v[132:135], v[212:215], v[80:95]
    ds_read_b64_tr_b16 v[132:133], v161 offset:32768
    ds_read_b64_tr_b16 v[134:135], v161 offset:33280
    v_add_f32 v164, v164, v168
    v_mov_b32 v165, v164
    v_mfma_f32_32x32x16_bf16 v[96:111], v[136:139], v[212:215], v[96:111]
    ds_read_b64_tr_b16 v[136:137], v162 offset:32768
    ds_read_b64_tr_b16 v[138:139], v162 offset:33280
    v_mfma_f32_32x32x16_bf16 v[112:127], v[140:143], v[212:215], v[112:127]
    ds_read_b64_tr_b16 v[140:141], v163 offset:32768
    ds_read_b64_tr_b16 v[142:143], v163 offset:33280
    s_waitcnt vmcnt(12) lgkmcnt(8)
    v_mfma_f32_32x32x16_bf16 v[64:79], v[144:147], v[216:219], v[64:79]
    ds_read_b64_tr_b16 v[144:145], v160 offset:36864
    ds_read_b64_tr_b16 v[146:147], v160 offset:37376
    buffer_load_dwordx4 v[200:203], v1, s[16:19], s64 offen offset:3072 sc1
    v_mfma_f32_32x32x16_bf16 v[80:95], v[148:151], v[216:219], v[80:95]
    ds_read_b64_tr_b16 v[148:149], v161 offset:36864
    ds_read_b64_tr_b16 v[150:151], v161 offset:37376
    v_permlane32_swap_b32 v164, v165
    v_mul_f32 v164, 0x3b000000, v164
    v_mfma_f32_32x32x16_bf16 v[96:111], v[152:155], v[216:219], v[96:111]
    ds_read_b64_tr_b16 v[152:153], v162 offset:36864
    ds_read_b64_tr_b16 v[154:155], v162 offset:37376
    v_mfma_f32_32x32x16_bf16 v[112:127], v[156:159], v[216:219], v[112:127]
    ds_read_b64_tr_b16 v[156:157], v163 offset:36864
    ds_read_b64_tr_b16 v[158:159], v163 offset:37376
    s_waitcnt vmcnt(12) lgkmcnt(8)
    v_mfma_f32_32x32x16_bf16 v[64:79], v[128:131], v[220:223], v[64:79]
    ds_read_b64_tr_b16 v[128:129], v160 offset:40960
    ds_read_b64_tr_b16 v[130:131], v160 offset:41472
    s_add_u32 s64, s64, 4096
    buffer_load_dwordx4 v[204:207], v1, s[16:19], s64 offen offset:0 sc1
    v_mfma_f32_32x32x16_bf16 v[80:95], v[132:135], v[220:223], v[80:95]
    ds_read_b64_tr_b16 v[132:133], v161 offset:40960
    ds_read_b64_tr_b16 v[134:135], v161 offset:41472
    v_cvt_pk_bf16_f32 v180, -v164, -v164
    v_mov_b32 v181, v180
    v_mfma_f32_32x32x16_bf16 v[96:111], v[136:139], v[220:223], v[96:111]
    ds_read_b64_tr_b16 v[136:137], v162 offset:40960
    ds_read_b64_tr_b16 v[138:139], v162 offset:41472
    s_add_u32 s70, s66, 1605632
    s_add_u32 m0, s69, 114688
    s_nop 0
    buffer_load_dwordx4 v30, s[32:35], s70 offen lds
    v_mfma_f32_32x32x16_bf16 v[112:127], v[140:143], v[220:223], v[112:127]
    ds_read_b64_tr_b16 v[140:141], v163 offset:40960
    ds_read_b64_tr_b16 v[142:143], v163 offset:41472
    s_waitcnt vmcnt(13) lgkmcnt(8)
    v_mfma_f32_32x32x16_bf16 v[64:79], v[144:147], v[224:227], v[64:79]
    ds_read_b64_tr_b16 v[144:145], v160 offset:45056
    ds_read_b64_tr_b16 v[146:147], v160 offset:45568
    buffer_load_dwordx4 v[208:211], v1, s[16:19], s64 offen offset:1024 sc1
    v_mfma_f32_32x32x16_bf16 v[80:95], v[148:151], v[224:227], v[80:95]
    ds_read_b64_tr_b16 v[148:149], v161 offset:45056
    ds_read_b64_tr_b16 v[150:151], v161 offset:45568
    v_mov_b32 v182, v180
    v_mov_b32 v183, v180
    v_mfma_f32_32x32x16_bf16 v[96:111], v[152:155], v[224:227], v[96:111]
    ds_read_b64_tr_b16 v[152:153], v162 offset:45056
    ds_read_b64_tr_b16 v[154:155], v162 offset:45568
    s_add_u32 s70, s66, 1634304
    s_add_u32 m0, s69, 115712
    s_nop 0
    buffer_load_dwordx4 v30, s[32:35], s70 offen lds
    v_mfma_f32_32x32x16_bf16 v[112:127], v[156:159], v[224:227], v[112:127]
    ds_read_b64_tr_b16 v[156:157], v163 offset:45056
    ds_read_b64_tr_b16 v[158:159], v163 offset:45568
    s_waitcnt vmcnt(14) lgkmcnt(8)
    v_mfma_f32_32x32x16_bf16 v[64:79], v[128:131], v[228:231], v[64:79]
    ds_read_b64_tr_b16 v[128:129], v160 offset:49152
    ds_read_b64_tr_b16 v[130:131], v160 offset:49664
    buffer_load_dwordx4 v[212:215], v1, s[16:19], s64 offen offset:2048 sc1
    v_mfma_f32_32x32x16_bf16 v[80:95], v[132:135], v[228:231], v[80:95]
    ds_read_b64_tr_b16 v[132:133], v161 offset:49152
    ds_read_b64_tr_b16 v[134:135], v161 offset:49664
    v_mfma_f32_32x32x16_bf16 v[96:111], v[136:139], v[228:231], v[96:111]
    ds_read_b64_tr_b16 v[136:137], v162 offset:49152
    ds_read_b64_tr_b16 v[138:139], v162 offset:49664
    s_add_u32 s70, s66, 1605632
    s_add_u32 m0, s69, 116736
    s_nop 0
    buffer_load_dwordx4 v31, s[36:39], s70 offen lds
    v_mfma_f32_32x32x16_bf16 v[112:127], v[140:143], v[228:231], v[112:127]
    ds_read_b64_tr_b16 v[140:141], v163 offset:49152
    ds_read_b64_tr_b16 v[142:143], v163 offset:49664
    s_waitcnt vmcnt(15) lgkmcnt(8)
    v_mfma_f32_32x32x16_bf16 v[64:79], v[144:147], v[232:235], v[64:79]
    ds_read_b64_tr_b16 v[144:145], v160 offset:53248
    ds_read_b64_tr_b16 v[146:147], v160 offset:53760
    buffer_load_dwordx4 v[216:219], v1, s[16:19], s64 offen offset:3072 sc1
    v_mfma_f32_32x32x16_bf16 v[80:95], v[148:151], v[232:235], v[80:95]
    ds_read_b64_tr_b16 v[148:149], v161 offset:53248
    ds_read_b64_tr_b16 v[150:151], v161 offset:53760
    v_mfma_f32_32x32x16_bf16 v[96:111], v[152:155], v[232:235], v[96:111]
    ds_read_b64_tr_b16 v[152:153], v162 offset:53248
    ds_read_b64_tr_b16 v[154:155], v162 offset:53760
    s_add_u32 s70, s66, 1634304
    s_add_u32 m0, s69, 117760
    s_nop 0
    buffer_load_dwordx4 v31, s[36:39], s70 offen lds
    v_mfma_f32_32x32x16_bf16 v[112:127], v[156:159], v[232:235], v[112:127]
    ds_read_b64_tr_b16 v[156:157], v163 offset:53248
    ds_read_b64_tr_b16 v[158:159], v163 offset:53760
    s_waitcnt vmcnt(16) lgkmcnt(8)
    v_mfma_f32_32x32x16_bf16 v[64:79], v[128:131], v[236:239], v[64:79]
    ds_read_b64_tr_b16 v[128:129], v160 offset:57344
    ds_read_b64_tr_b16 v[130:131], v160 offset:57856
    s_add_u32 s64, s64, 4096
    buffer_load_dwordx4 v[220:223], v1, s[16:19], s64 offen offset:0 sc1
    v_mfma_f32_32x32x16_bf16 v[80:95], v[132:135], v[236:239], v[80:95]
    ds_read_b64_tr_b16 v[132:133], v161 offset:57344
    ds_read_b64_tr_b16 v[134:135], v161 offset:57856
    v_mfma_f32_32x32x16_bf16 v[96:111], v[136:139], v[236:239], v[96:111]
    ds_read_b64_tr_b16 v[136:137], v162 offset:57344
    ds_read_b64_tr_b16 v[138:139], v162 offset:57856
    v_mfma_f32_32x32x16_bf16 v[112:127], v[140:143], v[236:239], v[112:127]
    ds_read_b64_tr_b16 v[140:141], v163 offset:57344
    ds_read_b64_tr_b16 v[142:143], v163 offset:57856
    s_waitcnt vmcnt(16) lgkmcnt(8)
    v_mfma_f32_32x32x16_bf16 v[64:79], v[144:147], v[240:243], v[64:79]
    ds_read_b64_tr_b16 v[144:145], v160 offset:61440
    ds_read_b64_tr_b16 v[146:147], v160 offset:61952
    buffer_load_dwordx4 v[224:227], v1, s[16:19], s64 offen offset:1024 sc1
    v_mfma_f32_32x32x16_bf16 v[80:95], v[148:151], v[240:243], v[80:95]
    ds_read_b64_tr_b16 v[148:149], v161 offset:61440
    ds_read_b64_tr_b16 v[150:151], v161 offset:61952
    v_mfma_f32_32x32x16_bf16 v[96:111], v[152:155], v[240:243], v[96:111]
    ds_read_b64_tr_b16 v[152:153], v162 offset:61440
    ds_read_b64_tr_b16 v[154:155], v162 offset:61952
    v_mfma_f32_32x32x16_bf16 v[112:127], v[156:159], v[240:243], v[112:127]
    ds_read_b64_tr_b16 v[156:157], v163 offset:61440
    ds_read_b64_tr_b16 v[158:159], v163 offset:61952
    s_waitcnt vmcnt(16) lgkmcnt(8)
    v_mfma_f32_32x32x16_bf16 v[64:79], v[128:131], v[244:247], v[64:79]
    v_add_u32 v160, 0x10000, v160
    ds_read_b64_tr_b16 v[128:129], v160 offset:0
    ds_read_b64_tr_b16 v[130:131], v160 offset:512
    buffer_load_dwordx4 v[228:231], v1, s[16:19], s64 offen offset:2048 sc1
    v_mfma_f32_32x32x16_bf16 v[80:95], v[132:135], v[244:247], v[80:95]
    v_add_u32 v161, 0x10000, v161
    ds_read_b64_tr_b16 v[132:133], v161 offset:0
    ds_read_b64_tr_b16 v[134:135], v161 offset:512
    v_mfma_f32_32x32x16_bf16 v[96:111], v[136:139], v[244:247], v[96:111]
    v_add_u32 v162, 0x10000, v162
    ds_read_b64_tr_b16 v[136:137], v162 offset:0
    ds_read_b64_tr_b16 v[138:139], v162 offset:512
    v_mfma_f32_32x32x16_bf16 v[112:127], v[140:143], v[244:247], v[112:127]
    v_add_u32 v163, 0x10000, v163
    ds_read_b64_tr_b16 v[140:141], v163 offset:0
    ds_read_b64_tr_b16 v[142:143], v163 offset:512
    s_waitcnt vmcnt(16) lgkmcnt(8)
    v_mfma_f32_32x32x16_bf16 v[64:79], v[144:147], v[248:251], v[64:79]
    ds_read_b64_tr_b16 v[144:145], v160 offset:4096
    ds_read_b64_tr_b16 v[146:147], v160 offset:4608
    buffer_load_dwordx4 v[232:235], v1, s[16:19], s64 offen offset:3072 sc1
    v_mfma_f32_32x32x16_bf16 v[80:95], v[148:151], v[248:251], v[80:95]
    ds_read_b64_tr_b16 v[148:149], v161 offset:4096
    ds_read_b64_tr_b16 v[150:151], v161 offset:4608
    v_mfma_f32_32x32x16_bf16 v[96:111], v[152:155], v[248:251], v[96:111]
    ds_read_b64_tr_b16 v[152:153], v162 offset:4096
    ds_read_b64_tr_b16 v[154:155], v162 offset:4608
    v_mfma_f32_32x32x16_bf16 v[112:127], v[156:159], v[248:251], v[112:127]
    ds_read_b64_tr_b16 v[156:157], v163 offset:4096
    ds_read_b64_tr_b16 v[158:159], v163 offset:4608
    s_waitcnt vmcnt(15) lgkmcnt(8)
    v_mfma_f32_32x32x16_bf16 v[64:79], v[128:131], v[188:191], v[64:79]
    ds_read_b64_tr_b16 v[128:129], v160 offset:8192
    ds_read_b64_tr_b16 v[130:131], v160 offset:8704
    s_add_u32 s64, s64, 4096
    buffer_load_dwordx4 v[236:239], v1, s[16:19], s64 offen offset:0 sc1
    v_mfma_f32_32x32x16_bf16 v[80:95], v[132:135], v[188:191], v[80:95]
    ds_read_b64_tr_b16 v[132:133], v161 offset:8192
    ds_read_b64_tr_b16 v[134:135], v161 offset:8704
    v_mfma_f32_32x32x16_bf16 v[96:111], v[136:139], v[188:191], v[96:111]
    ds_read_b64_tr_b16 v[136:137], v162 offset:8192
    ds_read_b64_tr_b16 v[138:139], v162 offset:8704
    v_mfma_f32_32x32x16_bf16 v[112:127], v[140:143], v[188:191], v[112:127]
    ds_read_b64_tr_b16 v[140:141], v163 offset:8192
    ds_read_b64_tr_b16 v[142:143], v163 offset:8704
    buffer_load_dword v184, v21, s[16:19], s53 offen sc1
    s_waitcnt vmcnt(16) lgkmcnt(8)
    v_mfma_f32_32x32x16_bf16 v[64:79], v[144:147], v[192:195], v[64:79]
    ds_read_b64_tr_b16 v[144:145], v160 offset:12288
    ds_read_b64_tr_b16 v[146:147], v160 offset:12800
    buffer_load_dwordx4 v[240:243], v1, s[16:19], s64 offen offset:1024 sc1
    v_mfma_f32_32x32x16_bf16 v[80:95], v[148:151], v[192:195], v[80:95]
    ds_read_b64_tr_b16 v[148:149], v161 offset:12288
    ds_read_b64_tr_b16 v[150:151], v161 offset:12800
    v_mfma_f32_32x32x16_bf16 v[96:111], v[152:155], v[192:195], v[96:111]
    ds_read_b64_tr_b16 v[152:153], v162 offset:12288
    ds_read_b64_tr_b16 v[154:155], v162 offset:12800
    v_mfma_f32_32x32x16_bf16 v[112:127], v[156:159], v[192:195], v[112:127]
    ds_read_b64_tr_b16 v[156:157], v163 offset:12288
    ds_read_b64_tr_b16 v[158:159], v163 offset:12800
    s_waitcnt vmcnt(16) lgkmcnt(8)
    v_mfma_f32_32x32x16_bf16 v[64:79], v[128:131], v[196:199], v[64:79]
    ds_read_b64_tr_b16 v[128:129], v160 offset:16384
    ds_read_b64_tr_b16 v[130:131], v160 offset:16896
    buffer_load_dwordx4 v[244:247], v1, s[16:19], s64 offen offset:2048 sc1
    v_mfma_f32_32x32x16_bf16 v[80:95], v[132:135], v[196:199], v[80:95]
    ds_read_b64_tr_b16 v[132:133], v161 offset:16384
    ds_read_b64_tr_b16 v[134:135], v161 offset:16896
    v_mfma_f32_32x32x16_bf16 v[96:111], v[136:139], v[196:199], v[96:111]
    ds_read_b64_tr_b16 v[136:137], v162 offset:16384
    ds_read_b64_tr_b16 v[138:139], v162 offset:16896
    v_mfma_f32_32x32x16_bf16 v[112:127], v[140:143], v[196:199], v[112:127]
    ds_read_b64_tr_b16 v[140:141], v163 offset:16384
    ds_read_b64_tr_b16 v[142:143], v163 offset:16896
    s_waitcnt vmcnt(16) lgkmcnt(8)
    v_mfma_f32_32x32x16_bf16 v[64:79], v[144:147], v[200:203], v[64:79]
    ds_read_b64_tr_b16 v[144:145], v160 offset:20480
    ds_read_b64_tr_b16 v[146:147], v160 offset:20992
    buffer_load_dwordx4 v[248:251], v1, s[16:19], s64 offen offset:3072 sc1
    v_mfma_f32_32x32x16_bf16 v[80:95], v[148:151], v[200:203], v[80:95]
    ds_read_b64_tr_b16 v[148:149], v161 offset:20480
    ds_read_b64_tr_b16 v[150:151], v161 offset:20992
    v_mfma_f32_32x32x16_bf16 v[96:111], v[152:155], v[200:203], v[96:111]
    ds_read_b64_tr_b16 v[152:153], v162 offset:20480
    ds_read_b64_tr_b16 v[154:155], v162 offset:20992
    v_mfma_f32_32x32x16_bf16 v[112:127], v[156:159], v[200:203], v[112:127]
    ds_read_b64_tr_b16 v[156:157], v163 offset:20480
    ds_read_b64_tr_b16 v[158:159], v163 offset:20992
    s_waitcnt vmcnt(16) lgkmcnt(8)
    v_mfma_f32_32x32x16_bf16 v[64:79], v[128:131], v[204:207], v[64:79]
    ds_read_b64_tr_b16 v[128:129], v160 offset:24576
    ds_read_b64_tr_b16 v[130:131], v160 offset:25088
    s_waitcnt vmcnt(3)
    v_cmp_gt_u32 vcc, 16, v184
    s_nop 1
    s_cbranch_vccnz L_poll_159
L_ok_160:
    s_cmp_lg_u32 s50, 0
    s_cbranch_scc1 L_acq_161
L_acr_162:
    s_mov_b32 s64, s60
    buffer_load_dwordx4 v[188:191], v1, s[16:19], s64 offen offset:0 sc1
    v_mfma_f32_32x32x16_bf16 v[80:95], v[132:135], v[204:207], v[80:95]
    ds_read_b64_tr_b16 v[132:133], v161 offset:24576
    ds_read_b64_tr_b16 v[134:135], v161 offset:25088
    buffer_load_dwordx4 v[192:195], v1, s[16:19], s64 offen offset:1024 sc1
    v_mov_b32 v173, 0
    v_mov_b32 v174, 0
    v_mfma_f32_32x32x16_bf16 v[96:111], v[136:139], v[204:207], v[96:111]
    ds_read_b64_tr_b16 v[136:137], v162 offset:24576
    ds_read_b64_tr_b16 v[138:139], v162 offset:25088
    v_mfma_f32_32x32x16_bf16 v[112:127], v[140:143], v[204:207], v[112:127]
    ds_read_b64_tr_b16 v[140:141], v163 offset:24576
    ds_read_b64_tr_b16 v[142:143], v163 offset:25088
    s_waitcnt lgkmcnt(8)
    v_mfma_f32_32x32x16_bf16 v[64:79], v[144:147], v[208:211], v[64:79]
    ds_read_b64_tr_b16 v[144:145], v160 offset:28672
    ds_read_b64_tr_b16 v[146:147], v160 offset:29184
    buffer_load_dwordx4 v[196:199], v1, s[16:19], s64 offen offset:2048 sc1
    v_mfma_f32_32x32x16_bf16 v[80:95], v[148:151], v[208:211], v[80:95]
    ds_read_b64_tr_b16 v[148:149], v161 offset:28672
    ds_read_b64_tr_b16 v[150:151], v161 offset:29184
    buffer_load_dwordx4 v[200:203], v1, s[16:19], s64 offen offset:3072 sc1
    v_mov_b32 v175, 0
    v_mov_b32 v177, 0
    v_mfma_f32_32x32x16_bf16 v[96:111], v[152:155], v[208:211], v[96:111]
    ds_read_b64_tr_b16 v[152:153], v162 offset:28672
    ds_read_b64_tr_b16 v[154:155], v162 offset:29184
    v_mfma_f32_32x32x16_bf16 v[112:127], v[156:159], v[208:211], v[112:127]
    ds_read_b64_tr_b16 v[156:157], v163 offset:28672
    ds_read_b64_tr_b16 v[158:159], v163 offset:29184
    s_waitcnt lgkmcnt(8)
    v_mfma_f32_32x32x16_bf16 v[64:79], v[128:131], v[212:215], v[64:79]
    ds_read_b64_tr_b16 v[128:129], v160 offset:32768
    ds_read_b64_tr_b16 v[130:131], v160 offset:33280
    s_add_u32 s64, s64, 4096
    buffer_load_dwordx4 v[204:207], v1, s[16:19], s64 offen offset:0 sc1
    v_mfma_f32_32x32x16_bf16 v[80:95], v[132:135], v[212:215], v[80:95]
    ds_read_b64_tr_b16 v[132:133], v161 offset:32768
    ds_read_b64_tr_b16 v[134:135], v161 offset:33280
    buffer_load_dwordx4 v[208:211], v1, s[16:19], s64 offen offset:1024 sc1
    v_mov_b32 v178, 0
    v_mov_b32 v179, 0
    v_mfma_f32_32x32x16_bf16 v[96:111], v[136:139], v[212:215], v[96:111]
    ds_read_b64_tr_b16 v[136:137], v162 offset:32768
    ds_read_b64_tr_b16 v[138:139], v162 offset:33280
    v_mfma_f32_32x32x16_bf16 v[112:127], v[140:143], v[212:215], v[112:127]
    ds_read_b64_tr_b16 v[140:141], v163 offset:32768
    ds_read_b64_tr_b16 v[142:143], v163 offset:33280
    s_waitcnt lgkmcnt(8)
    v_mfma_f32_32x32x16_bf16 v[64:79], v[144:147], v[216:219], v[64:79]
    ds_read_b64_tr_b16 v[144:145], v160 offset:36864
    ds_read_b64_tr_b16 v[146:147], v160 offset:37376
    buffer_load_dwordx4 v[212:215], v1, s[16:19], s64 offen offset:2048 sc1
    v_mfma_f32_32x32x16_bf16 v[80:95], v[148:151], v[216:219], v[80:95]
    ds_read_b64_tr_b16 v[148:149], v161 offset:36864
    ds_read_b64_tr_b16 v[150:151], v161 offset:37376
    v_mfma_f32_32x32x16_bf16 v[96:111], v[152:155], v[216:219], v[96:111]
    ds_read_b64_tr_b16 v[152:153], v162 offset:36864
    ds_read_b64_tr_b16 v[154:155], v162 offset:37376
    v_mfma_f32_32x32x16_bf16 v[112:127], v[156:159], v[216:219], v[112:127]
    ds_read_b64_tr_b16 v[156:157], v163 offset:36864
    ds_read_b64_tr_b16 v[158:159], v163 offset:37376
    s_waitcnt lgkmcnt(8)
    v_mfma_f32_32x32x16_bf16 v[64:79], v[128:131], v[220:223], v[64:79]
    ds_read_b64_tr_b16 v[128:129], v160 offset:40960
    ds_read_b64_tr_b16 v[130:131], v160 offset:41472
    buffer_load_dwordx4 v[216:219], v1, s[16:19], s64 offen offset:3072 sc1
    v_mfma_f32_32x32x16_bf16 v[80:95], v[132:135], v[220:223], v[80:95]
    ds_read_b64_tr_b16 v[132:133], v161 offset:40960
    ds_read_b64_tr_b16 v[134:135], v161 offset:41472
    v_mfma_f32_32x32x16_bf16 v[96:111], v[136:139], v[220:223], v[96:111]
    ds_read_b64_tr_b16 v[136:137], v162 offset:40960
    ds_read_b64_tr_b16 v[138:139], v162 offset:41472
    v_mfma_f32_32x32x16_bf16 v[112:127], v[140:143], v[220:223], v[112:127]
    ds_read_b64_tr_b16 v[140:141], v163 offset:40960
    ds_read_b64_tr_b16 v[142:143], v163 offset:41472
    s_waitcnt lgkmcnt(8)
    v_mfma_f32_32x32x16_bf16 v[64:79], v[144:147], v[224:227], v[64:79]
    ds_read_b64_tr_b16 v[144:145], v160 offset:45056
    ds_read_b64_tr_b16 v[146:147], v160 offset:45568
    s_add_u32 s64, s64, 4096
    buffer_load_dwordx4 v[220:223], v1, s[16:19], s64 offen offset:0 sc1
    v_mfma_f32_32x32x16_bf16 v[80:95], v[148:151], v[224:227], v[80:95]
    ds_read_b64_tr_b16 v[148:149], v161 offset:45056
    ds_read_b64_tr_b16 v[150:151], v161 offset:45568
    v_mfma_f32_32x32x16_bf16 v[96:111], v[152:155], v[224:227], v[96:111]
    ds_read_b64_tr_b16 v[152:153], v162 offset:45056
    ds_read_b64_tr_b16 v[154:155], v162 offset:45568
    v_mfma_f32_32x32x16_bf16 v[112:127], v[156:159], v[224:227], v[112:127]
    ds_read_b64_tr_b16 v[156:157], v163 offset:45056
    ds_read_b64_tr_b16 v[158:159], v163 offset:45568
    s_waitcnt lgkmcnt(8)
    v_mfma_f32_32x32x16_bf16 v[64:79], v[128:131], v[228:231], v[64:79]
    s_barrier
    ds_read_b64_tr_b16 v[128:129], v160 offset:49152
    ds_read_b64_tr_b16 v[130:131], v160 offset:49664
    buffer_load_dwordx4 v[224:227], v1, s[16:19], s64 offen offset:1024 sc1
    v_mfma_f32_32x32x16_bf16 v[80:95], v[132:135], v[228:231], v[80:95]
    ds_read_b64_tr_b16 v[132:133], v161 offset:49152
    ds_read_b64_tr_b16 v[134:135], v161 offset:49664
    v_mfma_f32_32x32x16_bf16 v[96:111], v[136:139], v[228:231], v[96:111]
    ds_read_b64_tr_b16 v[136:137], v162 offset:49152
    ds_read_b64_tr_b16 v[138:139], v162 offset:49664
    v_mfma_f32_32x32x16_bf16 v[112:127], v[140:143], v[228:231], v[112:127]
    ds_read_b64_tr_b16 v[140:141], v163 offset:49152
    ds_read_b64_tr_b16 v[142:143], v163 offset:49664
    s_waitcnt lgkmcnt(8)
    v_mfma_f32_32x32x16_bf16 v[64:79], v[144:147], v[232:235], v[64:79]
    ds_read_b64_tr_b16 v[144:145], v160 offset:53248
    ds_read_b64_tr_b16 v[146:147], v160 offset:53760
    buffer_load_dwordx4 v[228:231], v1, s[16:19], s64 offen offset:2048 sc1
    v_mfma_f32_32x32x16_bf16 v[80:95], v[148:151], v[232:235], v[80:95]
    ds_read_b64_tr_b16 v[148:149], v160 offset:57344
    ds_read_b64_tr_b16 v[150:151], v160 offset:57856
    v_mfma_f32_32x32x16_bf16 v[96:111], v[152:155], v[232:235], v[96:111]
    ds_read_b64_tr_b16 v[152:153], v160 offset:61440
    ds_read_b64_tr_b16 v[154:155], v160 offset:61952
    v_mfma_f32_32x32x16_bf16 v[112:127], v[156:159], v[232:235], v[112:127]
    ds_read_b64_tr_b16 v[156:157], v161 offset:53248
    ds_read_b64_tr_b16 v[158:159], v161 offset:53760
    s_add_u32 s88, s60, 149504
    buffer_load_dwordx4 v[164:167], v19, s[16:19], s88 offen sc1
    buffer_load_dwordx4 v[168:171], v19, s[16:19], s88 offen offset:16 sc1
    s_add_u32 s87, s57, s59
    s_add_u32 s89, s57, s60
    s_waitcnt lgkmcnt(8)
    v_mfma_f32_32x32x16_bf16 v[64:79], v[128:131], v[236:239], v[64:79]
    ds_read_b64_tr_b16 v[128:129], v161 offset:57344
    ds_read_b64_tr_b16 v[130:131], v161 offset:57856
    buffer_load_dwordx4 v[232:235], v1, s[16:19], s64 offen offset:3072 sc1
    v_mfma_f32_32x32x16_bf16 v[80:95], v[132:135], v[236:239], v[80:95]
    ds_read_b64_tr_b16 v[132:133], v161 offset:61440
    ds_read_b64_tr_b16 v[134:135], v161 offset:61952
    v_mfma_f32_32x32x16_bf16 v[96:111], v[136:139], v[236:239], v[96:111]
    ds_read_b64_tr_b16 v[136:137], v162 offset:53248
    ds_read_b64_tr_b16 v[138:139], v162 offset:53760
    v_mfma_f32_32x32x16_bf16 v[112:127], v[140:143], v[236:239], v[112:127]
    ds_read_b64_tr_b16 v[140:141], v162 offset:57344
    ds_read_b64_tr_b16 v[142:143], v162 offset:57856
    s_waitcnt vmcnt(14) lgkmcnt(10)
    v_mfma_f32_32x32x16_bf16 v[64:79], v[144:147], v[240:243], v[64:79]
    ds_read_b64_tr_b16 v[144:145], v162 offset:61440
    ds_read_b64_tr_b16 v[146:147], v162 offset:61952
    s_add_u32 s64, s64, 4096
    buffer_load_dwordx4 v[236:239], v1, s[16:19], s64 offen offset:0 sc1
    v_mfma_f32_32x32x16_bf16 v[64:79], v[148:151], v[244:247], v[64:79]
    ds_read_b64_tr_b16 v[148:149], v163 offset:53248
    ds_read_b64_tr_b16 v[150:151], v163 offset:53760
    v_mov_b32 v172, v24
    v_mfma_f32_32x32x16_bf16 v[64:79], v[152:155], v[248:251], v[64:79]
    ds_read_b64_tr_b16 v[152:153], v163 offset:57344
    ds_read_b64_tr_b16 v[154:155], v163 offset:57856
    v_mfma_f32_32x32x16_bf16 v[64:79], v[172:175], v[180:183], v[64:79]
    s_waitcnt lgkmcnt(10)
    v_mfma_f32_32x32x16_bf16 v[80:95], v[156:159], v[240:243], v[80:95]
    ds_read_b64_tr_b16 v[156:157], v163 offset:61440
    ds_read_b64_tr_b16 v[158:159], v163 offset:61952
    v_mfma_f32_32x32x16_bf16 v[80:95], v[128:131], v[244:247], v[80:95]
    v_subrev_u32 v160, 0x10000, v160
    ds_read_b64_tr_b16 v[128:129], v160 offset:0
    ds_read_b64_tr_b16 v[130:131], v160 offset:512
    v_mov_b32 v176, v25
    v_max_f32 v64, 0, v64
    v_max_f32 v65, 0, v65
    v_max_f32 v66, 0, v66
    v_max_f32 v67, 0, v67
    v_mfma_f32_32x32x16_bf16 v[80:95], v[132:135], v[248:251], v[80:95]
    ds_read_b64_tr_b16 v[132:133], v160 offset:4096
    ds_read_b64_tr_b16 v[134:135], v160 offset:4608
    v_max_f32 v68, 0, v68
    v_max_f32 v69, 0, v69
    v_max_f32 v70, 0, v70
    v_max_f32 v71, 0, v71
    v_mul_f32 v64, v64, v72
    v_mfma_f32_32x32x16_bf16 v[80:95], v[176:179], v[180:183], v[80:95]
    v_mul_f32 v65, v65, v73
    v_mul_f32 v66, v66, v74
    v_mul_f32 v67, v67, v75
    v_mul_f32 v68, v68, v76
    v_mul_f32 v69, v69, v77
    v_mul_f32 v70, v70, v78
    v_mul_f32 v71, v71, v79
    s_waitcnt lgkmcnt(10)
    v_mfma_f32_32x32x16_bf16 v[96:111], v[136:139], v[240:243], v[96:111]
    ds_read_b64_tr_b16 v[136:137], v160 offset:8192
    ds_read_b64_tr_b16 v[138:139], v160 offset:8704
    v_cvt_pk_bf16_f32 v64, v64, v65
    v_cvt_pk_bf16_f32 v65, v66, v67
    v_cvt_pk_bf16_f32 v66, v68, v69
    v_cvt_pk_bf16_f32 v67, v70, v71
    buffer_store_dwordx4 v[64:67], v1, s[16:19], s87 offen offset:0
    v_mfma_f32_32x32x16_bf16 v[96:111], v[140:143], v[244:247], v[96:111]
    ds_read_b64_tr_b16 v[140:141], v160 offset:12288
    ds_read_b64_tr_b16 v[142:143], v160 offset:12800
    v_mov_b32 v172, v26
    v_max_f32 v80, 0, v80
    v_max_f32 v81, 0, v81
    v_max_f32 v82, 0, v82
    v_max_f32 v83, 0, v83
    v_mfma_f32_32x32x16_bf16 v[96:111], v[144:147], v[248:251], v[96:111]
    v_subrev_u32 v161, 0x10000, v161
    ds_read_b64_tr_b16 v[144:145], v161 offset:0
    ds_read_b64_tr_b16 v[146:147], v161 offset:512
    v_max_f32 v84, 0, v84
    v_max_f32 v85, 0, v85
    v_max_f32 v86, 0, v86
    v_max_f32 v87, 0, v87
    v_mul_f32 v80, v80, v88
    v_mfma_f32_32x32x16_bf16 v[96:111], v[172:175], v[180:183], v[96:111]
    v_mul_f32 v81, v81, v89
    v_mul_f32 v82, v82, v90
    v_mul_f32 v83, v83, v91
    v_mul_f32 v84, v84, v92
    v_mul_f32 v85, v85, v93
    v_mul_f32 v86, v86, v94
    v_mul_f32 v87, v87, v95
    s_waitcnt lgkmcnt(10)
    v_mfma_f32_32x32x16_bf16 v[112:127], v[148:151], v[240:243], v[112:127]
    ds_read_b64_tr_b16 v[148:149], v161 offset:4096
    ds_read_b64_tr_b16 v[150:151], v161 offset:4608
    buffer_load_dwordx4 v[240:243], v1, s[16:19], s64 offen offset:1024 sc1
    v_cvt_pk_bf16_f32 v80, v80, v81
    v_cvt_pk_bf16_f32 v81, v82, v83
    v_cvt_pk_bf16_f32 v82, v84, v85
    v_cvt_pk_bf16_f32 v83, v86, v87
    v_mfma_f32_32x32x16_bf16 v[112:127], v[152:155], v[244:247], v[112:127]
    ds_read_b64_tr_b16 v[152:153], v161 offset:8192
    ds_read_b64_tr_b16 v[154:155], v161 offset:8704
    v_mov_b32 v176, v27
    buffer_load_dwordx4 v[244:247], v1, s[16:19], s64 offen offset:2048 sc1
    buffer_store_dwordx4 v[80:83], v1, s[16:19], s87 offen offset:1024
    v_max_f32 v96, 0, v96
    v_max_f32 v97, 0, v97
    v_mfma_f32_32x32x16_bf16 v[112:127], v[156:159], v[248:251], v[112:127]
    ds_read_b64_tr_b16 v[156:157], v161 offset:12288
    ds_read_b64_tr_b16 v[158:159], v161 offset:12800
    v_max_f32 v98, 0, v98
    v_max_f32 v99, 0, v99
    v_max_f32 v100, 0, v100
    v_max_f32 v101, 0, v101
    v_max_f32 v102, 0, v102
    v_mfma_f32_32x32x16_bf16 v[112:127], v[176:179], v[180:183], v[112:127]
    v_max_f32 v103, 0, v103
    v_mul_f32 v96, v96, v104
    v_mul_f32 v97, v97, v105
    v_mul_f32 v98, v98, v106
    v_mul_f32 v99, v99, v107
    v_mul_f32 v100, v100, v108
    v_mul_f32 v101, v101, v109
    s_waitcnt vmcnt(16) lgkmcnt(10)
    v_mfma_f32_32x32x16_bf16 v[64:79], v[128:131], v[188:191], 0
    v_subrev_u32 v162, 0x10000, v162
    ds_read_b64_tr_b16 v[128:129], v162 offset:0
    ds_read_b64_tr_b16 v[130:131], v162 offset:512
    buffer_load_dwordx4 v[248:251], v1, s[16:19], s64 offen offset:3072 sc1
    v_mul_f32 v102, v102, v110
    v_mul_f32 v103, v103, v111
    v_cvt_pk_bf16_f32 v96, v96, v97
    v_cvt_pk_bf16_f32 v97, v98, v99
    v_mfma_f32_32x32x16_bf16 v[64:79], v[132:135], v[192:195], v[64:79]
    ds_read_b64_tr_b16 v[132:133], v162 offset:4096
    ds_read_b64_tr_b16 v[134:135], v162 offset:4608
    v_cvt_pk_bf16_f32 v98, v100, v101
    v_cvt_pk_bf16_f32 v99, v102, v103
    buffer_store_dwordx4 v[96:99], v1, s[16:19], s87 offen offset:2048
    v_max_f32 v112, 0, v112
    v_max_f32 v113, 0, v113
    v_mfma_f32_32x32x16_bf16 v[64:79], v[136:139], v[196:199], v[64:79]
    ds_read_b64_tr_b16 v[136:137], v162 offset:8192
    ds_read_b64_tr_b16 v[138:139], v162 offset:8704
    v_max_f32 v114, 0, v114
    v_max_f32 v115, 0, v115
    v_max_f32 v116, 0, v116
    v_max_f32 v117, 0, v117
    v_max_f32 v118, 0, v118
    s_waitcnt vmcnt(17) lgkmcnt(10)
    v_mfma_f32_32x32x16_bf16 v[64:79], v[140:143], v[200:203], v[64:79]
    ds_read_b64_tr_b16 v[140:141], v162 offset:12288
    ds_read_b64_tr_b16 v[142:143], v162 offset:12800
    v_max_f32 v119, 0, v119
    v_mul_f32 v112, v112, v120
    v_mul_f32 v113, v113, v121
    v_mul_f32 v114, v114, v122
    v_mul_f32 v115, v115, v123
    v_mfma_f32_32x32x16_bf16 v[80:95], v[144:147], v[188:191], 0
    ds_read_b64_tr_b16 v[144:145], v160 offset:16384
    ds_read_b64_tr_b16 v[146:147], v160 offset:16896
    v_mul_f32 v116, v116, v124
    v_mul_f32 v117, v117, v125
    v_mul_f32 v118, v118, v126
    v_mul_f32 v119, v119, v127
    v_cvt_pk_bf16_f32 v112, v112, v113
    v_mfma_f32_32x32x16_bf16 v[80:95], v[148:151], v[192:195], v[80:95]
    ds_read_b64_tr_b16 v[148:149], v161 offset:16384
    ds_read_b64_tr_b16 v[150:151], v161 offset:16896
    v_cvt_pk_bf16_f32 v113, v114, v115
    v_cvt_pk_bf16_f32 v114, v116, v117
    v_cvt_pk_bf16_f32 v115, v118, v119
    buffer_store_dwordx4 v[112:115], v1, s[16:19], s87 offen offset:3072
    s_waitcnt lgkmcnt(10)
    v_mfma_f32_32x32x16_bf16 v[80:95], v[152:155], v[196:199], v[80:95]
    ds_read_b64_tr_b16 v[152:153], v162 offset:16384
    ds_read_b64_tr_b16 v[154:155], v162 offset:16896
    v_mfma_f32_32x32x16_bf16 v[80:95], v[156:159], v[200:203], v[80:95]
    ds_read_b64_tr_b16 v[156:157], v160 offset:20480
    ds_read_b64_tr_b16 v[158:159], v160 offset:20992
    v_mfma_f32_32x32x16_bf16 v[96:111], v[128:131], v[188:191], 0
    ds_read_b64_tr_b16 v[128:129], v161 offset:20480
    ds_read_b64_tr_b16 v[130:131], v161 offset:20992
    s_waitcnt lgkmcnt(10)
    v_mfma_f32_32x32x16_bf16 v[96:111], v[132:135], v[192:195], v[96:111]
    ds_read_b64_tr_b16 v[132:133], v162 offset:20480
    ds_read_b64_tr_b16 v[134:135], v162 offset:20992
    s_add_u32 s64, s64, 4096
    buffer_load_dwordx4 v[188:191], v1, s[16:19], s64 offen offset:0 sc1
    v_mfma_f32_32x32x16_bf16 v[96:111], v[136:139], v[196:199], v[96:111]
    ds_read_b64_tr_b16 v[136:137], v160 offset:24576
    ds_read_b64_tr_b16 v[138:139], v160 offset:25088
    buffer_load_dwordx4 v[192:195], v1, s[16:19], s64 offen offset:1024 sc1
    s_waitcnt vmcnt(12)
    v_add_f32 v164, v164, v165
    v_add_f32 v166, v166, v167
    v_mfma_f32_32x32x16_bf16 v[96:111], v[140:143], v[200:203], v[96:111]
    ds_read_b64_tr_b16 v[140:141], v161 offset:24576
    ds_read_b64_tr_b16 v[142:143], v161 offset:25088
    s_waitcnt lgkmcnt(10)
    v_mfma_f32_32x32x16_bf16 v[64:79], v[144:147], v[204:207], v[64:79]
    ds_read_b64_tr_b16 v[144:145], v162 offset:24576
    ds_read_b64_tr_b16 v[146:147], v162 offset:25088
    buffer_load_dwordx4 v[196:199], v1, s[16:19], s64 offen offset:2048 sc1
    v_mfma_f32_32x32x16_bf16 v[80:95], v[148:151], v[204:207], v[80:95]
    ds_read_b64_tr_b16 v[148:149], v160 offset:28672
    ds_read_b64_tr_b16 v[150:151], v160 offset:29184
    buffer_load_dwordx4 v[200:203], v1, s[16:19], s64 offen offset:3072 sc1
    s_waitcnt vmcnt(13)
    v_add_f32 v168, v168, v169
    v_add_f32 v170, v170, v171
    v_mfma_f32_32x32x16_bf16 v[96:111], v[152:155], v[204:207], v[96:111]
    ds_read_b64_tr_b16 v[152:153], v161 offset:28672
    ds_read_b64_tr_b16 v[154:155], v161 offset:29184
    v_mov_b32 v252, 17
    s_waitcnt vmcnt(4)
    s_mov_b64 exec, 1
    s_cmp_lg_u32 s50, 0
    s_cbranch_scc1 L_pub_163
    buffer_store_dword v252, off, s[16:19], s52
L_pur_164:
    s_mov_b64 exec, -1
    s_waitcnt lgkmcnt(10)
    v_mfma_f32_32x32x16_bf16 v[64:79], v[156:159], v[208:211], v[64:79]
    ds_read_b64_tr_b16 v[156:157], v162 offset:28672
    ds_read_b64_tr_b16 v[158:159], v162 offset:29184
    s_add_u32 s64, s64, 4096
    buffer_load_dwordx4 v[204:207], v1, s[16:19], s64 offen offset:0 sc1
    v_mfma_f32_32x32x16_bf16 v[80:95], v[128:131], v[208:211], v[80:95]
    ds_read_b64_tr_b16 v[128:129], v160 offset:32768
    ds_read_b64_tr_b16 v[130:131], v160 offset:33280
    v_add_f32 v164, v164, v166
    v_add_f32 v168, v168, v170
    v_mfma_f32_32x32x16_bf16 v[96:111], v[132:135], v[208:211], v[96:111]
    ds_read_b64_tr_b16 v[132:133], v161 offset:32768
    ds_read_b64_tr_b16 v[134:135], v161 offset:33280
    s_waitcnt lgkmcnt(10)
    v_mfma_f32_32x32x16_bf16 v[64:79], v[136:139], v[212:215], v[64:79]
    ds_read_b64_tr_b16 v[136:137], v162 offset:32768
    ds_read_b64_tr_b16 v[138:139], v162 offset:33280
    buffer_load_dwordx4 v[208:211], v1, s[16:19], s64 offen offset:1024 sc1
    v_mfma_f32_32x32x16_bf16 v[80:95], v[140:143], v[212:215], v[80:95]
    ds_read_b64_tr_b16 v[140:141], v160 offset:36864
    ds_read_b64_tr_b16 v[142:143], v160 offset:37376
    v_add_f32 v164, v164, v168
    v_mov_b32 v165, v164
    v_mfma_f32_32x32x16_bf16 v[96:111], v[144:147], v[212:215], v[96:111]
    ds_read_b64_tr_b16 v[144:145], v161 offset:36864
    ds_read_b64_tr_b16 v[146:147], v161 offset:37376
    s_waitcnt lgkmcnt(10)
    v_mfma_f32_32x32x16_bf16 v[64:79], v[148:151], v[216:219], v[64:79]
    ds_read_b64_tr_b16 v[148:149], v162 offset:36864
    ds_read_b64_tr_b16 v[150:151], v162 offset:37376
    buffer_load_dwordx4 v[212:215], v1, s[16:19], s64 offen offset:2048 sc1
    v_mfma_f32_32x32x16_bf16 v[80:95], v[152:155], v[216:219], v[80:95]
    ds_read_b64_tr_b16 v[152:153], v160 offset:40960
    ds_read_b64_tr_b16 v[154:155], v160 offset:41472
    v_permlane32_swap_b32 v164, v165
    v_mul_f32 v164, 0x3b000000, v164
    v_mfma_f32_32x32x16_bf16 v[96:111], v[156:159], v[216:219], v[96:111]
    ds_read_b64_tr_b16 v[156:157], v161 offset:40960
    ds_read_b64_tr_b16 v[158:159], v161 offset:41472
    s_waitcnt lgkmcnt(10)
    v_mfma_f32_32x32x16_bf16 v[64:79], v[128:131], v[220:223], v[64:79]
    ds_read_b64_tr_b16 v[128:129], v162 offset:40960
    ds_read_b64_tr_b16 v[130:131], v162 offset:41472
    buffer_load_dwordx4 v[216:219], v1, s[16:19], s64 offen offset:3072 sc1
    v_mfma_f32_32x32x16_bf16 v[80:95], v[132:135], v[220:223], v[80:95]
    ds_read_b64_tr_b16 v[132:133], v160 offset:45056
    ds_read_b64_tr_b16 v[134:135], v160 offset:45568
    v_cvt_pk_bf16_f32 v180, -v164, -v164
    v_mov_b32 v181, v180
    v_mfma_f32_32x32x16_bf16 v[96:111], v[136:139], v[220:223], v[96:111]
    ds_read_b64_tr_b16 v[136:137], v161 offset:45056
    ds_read_b64_tr_b16 v[138:139], v161 offset:45568
    s_waitcnt lgkmcnt(10)
    v_mfma_f32_32x32x16_bf16 v[64:79], v[140:143], v[224:227], v[64:79]
    ds_read_b64_tr_b16 v[140:141], v162 offset:45056
    ds_read_b64_tr_b16 v[142:143], v162 offset:45568
    s_add_u32 s64, s64, 4096
    buffer_load_dwordx4 v[220:223], v1, s[16:19], s64 offen offset:0 sc1
    v_mfma_f32_32x32x16_bf16 v[80:95], v[144:147], v[224:227], v[80:95]
    ds_read_b64_tr_b16 v[144:145], v160 offset:49152
    ds_read_b64_tr_b16 v[146:147], v160 offset:49664
    v_mov_b32 v182, v180
    v_mov_b32 v183, v180
    v_mfma_f32_32x32x16_bf16 v[96:111], v[148:151], v[224:227], v[96:111]
    ds_read_b64_tr_b16 v[148:149], v161 offset:49152
    ds_read_b64_tr_b16 v[150:151], v161 offset:49664
    s_waitcnt lgkmcnt(10)
    v_mfma_f32_32x32x16_bf16 v[64:79], v[152:155], v[228:231], v[64:79]
    ds_read_b64_tr_b16 v[152:153], v162 offset:49152
    ds_read_b64_tr_b16 v[154:155], v162 offset:49664
    buffer_load_dwordx4 v[224:227], v1, s[16:19], s64 offen offset:1024 sc1
    v_mfma_f32_32x32x16_bf16 v[80:95], v[156:159], v[228:231], v[80:95]
    ds_read_b64_tr_b16 v[156:157], v160 offset:53248
    ds_read_b64_tr_b16 v[158:159], v160 offset:53760
    v_mfma_f32_32x32x16_bf16 v[96:111], v[128:131], v[228:231], v[96:111]
    ds_read_b64_tr_b16 v[128:129], v161 offset:53248
    ds_read_b64_tr_b16 v[130:131], v161 offset:53760
    s_waitcnt lgkmcnt(10)
    v_mfma_f32_32x32x16_bf16 v[64:79], v[132:135], v[232:235], v[64:79]
    ds_read_b64_tr_b16 v[132:133], v162 offset:53248
    ds_read_b64_tr_b16 v[134:135], v162 offset:53760
    buffer_load_dwordx4 v[228:231], v1, s[16:19], s64 offen offset:2048 sc1
    v_mfma_f32_32x32x16_bf16 v[80:95], v[136:139], v[232:235], v[80:95]
    ds_read_b64_tr_b16 v[136:137], v160 offset:57344
    ds_read_b64_tr_b16 v[138:139], v160 offset:57856
    v_mfma_f32_32x32x16_bf16 v[96:111], v[140:143], v[232:235], v[96:111]
    ds_read_b64_tr_b16 v[140:141], v161 offset:57344
    ds_read_b64_tr_b16 v[142:143], v161 offset:57856
    s_waitcnt lgkmcnt(10)
    v_mfma_f32_32x32x16_bf16 v[64:79], v[144:147], v[236:239], v[64:79]
    ds_read_b64_tr_b16 v[144:145], v162 offset:57344
    ds_read_b64_tr_b16 v[146:147], v162 offset:57856
    buffer_load_dwordx4 v[232:235], v1, s[16:19], s64 offen offset:3072 sc1
    v_mfma_f32_32x32x16_bf16 v[80:95], v[148:151], v[236:239], v[80:95]
    ds_read_b64_tr_b16 v[148:149], v160 offset:61440
    ds_read_b64_tr_b16 v[150:151], v160 offset:61952
    v_mfma_f32_32x32x16_bf16 v[96:111], v[152:155], v[236:239], v[96:111]
    ds_read_b64_tr_b16 v[152:153], v161 offset:61440
    ds_read_b64_tr_b16 v[154:155], v161 offset:61952
    s_waitcnt lgkmcnt(10)
    v_mfma_f32_32x32x16_bf16 v[64:79], v[156:159], v[240:243], v[64:79]
    ds_read_b64_tr_b16 v[156:157], v162 offset:61440
    ds_read_b64_tr_b16 v[158:159], v162 offset:61952
    s_add_u32 s64, s64, 4096
    buffer_load_dwordx4 v[236:239], v1, s[16:19], s64 offen offset:0 sc1
    v_mfma_f32_32x32x16_bf16 v[80:95], v[128:131], v[240:243], v[80:95]
    v_add_u32 v160, 0x10000, v160
    ds_read_b64_tr_b16 v[128:129], v160 offset:0
    ds_read_b64_tr_b16 v[130:131], v160 offset:512
    v_mfma_f32_32x32x16_bf16 v[96:111], v[132:135], v[240:243], v[96:111]
    v_add_u32 v161, 0x10000, v161
    ds_read_b64_tr_b16 v[132:133], v161 offset:0
    ds_read_b64_tr_b16 v[134:135], v161 offset:512
    s_waitcnt lgkmcnt(10)
    v_mfma_f32_32x32x16_bf16 v[64:79], v[136:139], v[244:247], v[64:79]
    v_add_u32 v162, 0x10000, v162
    ds_read_b64_tr_b16 v[136:137], v162 offset:0
    ds_read_b64_tr_b16 v[138:139], v162 offset:512
    buffer_load_dwordx4 v[240:243], v1, s[16:19], s64 offen offset:1024 sc1
    v_mfma_f32_32x32x16_bf16 v[80:95], v[140:143], v[244:247], v[80:95]
    ds_read_b64_tr_b16 v[140:141], v160 offset:4096
    ds_read_b64_tr_b16 v[142:143], v160 offset:4608
    v_mfma_f32_32x32x16_bf16 v[96:111], v[144:147], v[244:247], v[96:111]
    ds_read_b64_tr_b16 v[144:145], v161 offset:4096
    ds_read_b64_tr_b16 v[146:147], v161 offset:4608
    s_waitcnt lgkmcnt(10)
    v_mfma_f32_32x32x16_bf16 v[64:79], v[148:151], v[248:251], v[64:79]
    ds_read_b64_tr_b16 v[148:149], v162 offset:4096
    ds_read_b64_tr_b16 v[150:151], v162 offset:4608
    buffer_load_dwordx4 v[244:247], v1, s[16:19], s64 offen offset:2048 sc1
    v_mfma_f32_32x32x16_bf16 v[80:95], v[152:155], v[248:251], v[80:95]
    ds_read_b64_tr_b16 v[152:153], v160 offset:8192
    ds_read_b64_tr_b16 v[154:155], v160 offset:8704
    v_mfma_f32_32x32x16_bf16 v[96:111], v[156:159], v[248:251], v[96:111]
    ds_read_b64_tr_b16 v[156:157], v161 offset:8192
    ds_read_b64_tr_b16 v[158:159], v161 offset:8704
    s_waitcnt vmcnt(15) lgkmcnt(10)
    v_mfma_f32_32x32x16_bf16 v[64:79], v[128:131], v[188:191], v[64:79]
    ds_read_b64_tr_b16 v[128:129], v162 offset:8192
    ds_read_b64_tr_b16 v[130:131], v162 offset:8704
    buffer_load_dwordx4 v[248:251], v1, s[16:19], s64 offen offset:3072 sc1
    v_mfma_f32_32x32x16_bf16 v[80:95], v[132:135], v[188:191], v[80:95]
    ds_read_b64_tr_b16 v[132:133], v160 offset:12288
    ds_read_b64_tr_b16 v[134:135], v160 offset:12800
    v_mfma_f32_32x32x16_bf16 v[96:111], v[136:139], v[188:191], v[96:111]
    ds_read_b64_tr_b16 v[136:137], v161 offset:12288
    ds_read_b64_tr_b16 v[138:139], v161 offset:12800
    s_lshl_b32 s90, s45, 2
    s_add_u32 s90, s90, s46
    s_and_b32 s90, s90, 127
    s_cbranch_scc0 L_wb_165
    buffer_load_dword v185, off, s[16:19], s52
L_wr_166:
    s_waitcnt vmcnt(16) lgkmcnt(10)
    v_mfma_f32_32x32x16_bf16 v[64:79], v[140:143], v[192:195], v[64:79]
    ds_read_b64_tr_b16 v[140:141], v162 offset:12288
    ds_read_b64_tr_b16 v[142:143], v162 offset:12800
    v_mfma_f32_32x32x16_bf16 v[80:95], v[144:147], v[192:195], v[80:95]
    ds_read_b64_tr_b16 v[144:145], v160 offset:16384
    ds_read_b64_tr_b16 v[146:147], v160 offset:16896
    v_mfma_f32_32x32x16_bf16 v[96:111], v[148:151], v[192:195], v[96:111]
    ds_read_b64_tr_b16 v[148:149], v161 offset:16384
    ds_read_b64_tr_b16 v[150:151], v161 offset:16896
    s_waitcnt vmcnt(15) lgkmcnt(10)
    v_mfma_f32_32x32x16_bf16 v[64:79], v[152:155], v[196:199], v[64:79]
    ds_read_b64_tr_b16 v[152:153], v162 offset:16384
    ds_read_b64_tr_b16 v[154:155], v162 offset:16896
    v_mfma_f32_32x32x16_bf16 v[80:95], v[156:159], v[196:199], v[80:95]
    ds_read_b64_tr_b16 v[156:157], v160 offset:20480
    ds_read_b64_tr_b16 v[158:159], v160 offset:20992
    v_mfma_f32_32x32x16_bf16 v[96:111], v[128:131], v[196:199], v[96:111]
    ds_read_b64_tr_b16 v[128:129], v161 offset:20480
    ds_read_b64_tr_b16 v[130:131], v161 offset:20992
    s_waitcnt vmcnt(14) lgkmcnt(10)
    v_mfma_f32_32x32x16_bf16 v[64:79], v[132:135], v[200:203], v[64:79]
    ds_read_b64_tr_b16 v[132:133], v162 offset:20480
    ds_read_b64_tr_b16 v[134:135], v162 offset:20992
    v_mfma_f32_32x32x16_bf16 v[80:95], v[136:139], v[200:203], v[80:95]
    ds_read_b64_tr_b16 v[136:137], v160 offset:24576
    ds_read_b64_tr_b16 v[138:139], v160 offset:25088
    v_mfma_f32_32x32x16_bf16 v[96:111], v[140:143], v[200:203], v[96:111]
    ds_read_b64_tr_b16 v[140:141], v161 offset:24576
    ds_read_b64_tr_b16 v[142:143], v161 offset:25088
    s_waitcnt vmcnt(12) lgkmcnt(10)
    v_mfma_f32_32x32x16_bf16 v[64:79], v[144:147], v[204:207], v[64:79]
    ds_read_b64_tr_b16 v[144:145], v162 offset:24576
    ds_read_b64_tr_b16 v[146:147], v162 offset:25088
    v_mfma_f32_32x32x16_bf16 v[80:95], v[148:151], v[204:207], v[80:95]
    ds_read_b64_tr_b16 v[148:149], v160 offset:28672
    ds_read_b64_tr_b16 v[150:151], v160 offset:29184
    v_mfma_f32_32x32x16_bf16 v[96:111], v[152:155], v[204:207], v[96:111]
    ds_read_b64_tr_b16 v[152:153], v161 offset:28672
    ds_read_b64_tr_b16 v[154:155], v161 offset:29184
    s_waitcnt vmcnt(11) lgkmcnt(10)
    v_mfma_f32_32x32x16_bf16 v[64:79], v[156:159], v[208:211], v[64:79]
    ds_read_b64_tr_b16 v[156:157], v162 offset:28672
    ds_read_b64_tr_b16 v[158:159], v162 offset:29184
    v_mfma_f32_32x32x16_bf16 v[80:95], v[128:131], v[208:211], v[80:95]
    ds_read_b64_tr_b16 v[128:129], v160 offset:32768
    ds_read_b64_tr_b16 v[130:131], v160 offset:33280
    v_mfma_f32_32x32x16_bf16 v[96:111], v[132:135], v[208:211], v[96:111]
    ds_read_b64_tr_b16 v[132:133], v161 offset:32768
    ds_read_b64_tr_b16 v[134:135], v161 offset:33280
    s_waitcnt vmcnt(10) lgkmcnt(10)
    v_mfma_f32_32x32x16_bf16 v[64:79], v[136:139], v[212:215], v[64:79]
    ds_read_b64_tr_b16 v[136:137], v162 offset:32768
    ds_read_b64_tr_b16 v[138:139], v162 offset:33280
    v_mfma_f32_32x32x16_bf16 v[80:95], v[140:143], v[212:215], v[80:95]
    ds_read_b64_tr_b16 v[140:141], v160 offset:36864
    ds_read_b64_tr_b16 v[142:143], v160 offset:37376
    v_mfma_f32_32x32x16_bf16 v[96:111], v[144:147], v[212:215], v[96:111]
    ds_read_b64_tr_b16 v[144:145], v161 offset:36864
    ds_read_b64_tr_b16 v[146:147], v161 offset:37376
    s_waitcnt vmcnt(9) lgkmcnt(10)
    v_mfma_f32_32x32x16_bf16 v[64:79], v[148:151], v[216:219], v[64:79]
    ds_read_b64_tr_b16 v[148:149], v162 offset:36864
    ds_read_b64_tr_b16 v[150:151], v162 offset:37376
    v_mfma_f32_32x32x16_bf16 v[80:95], v[152:155], v[216:219], v[80:95]
    ds_read_b64_tr_b16 v[152:153], v160 offset:40960
    ds_read_b64_tr_b16 v[154:155], v160 offset:41472
    v_mfma_f32_32x32x16_bf16 v[96:111], v[156:159], v[216:219], v[96:111]
    ds_read_b64_tr_b16 v[156:157], v161 offset:40960
    ds_read_b64_tr_b16 v[158:159], v161 offset:41472
    s_waitcnt vmcnt(8) lgkmcnt(10)
    v_mfma_f32_32x32x16_bf16 v[64:79], v[128:131], v[220:223], v[64:79]
    ds_read_b64_tr_b16 v[128:129], v162 offset:40960
    ds_read_b64_tr_b16 v[130:131], v162 offset:41472
    v_mfma_f32_32x32x16_bf16 v[80:95], v[132:135], v[220:223], v[80:95]
    ds_read_b64_tr_b16 v[132:133], v160 offset:45056
    ds_read_b64_tr_b16 v[134:135], v160 offset:45568
    v_mfma_f32_32x32x16_bf16 v[96:111], v[136:139], v[220:223], v[96:111]
    ds_read_b64_tr_b16 v[136:137], v161 offset:45056
    ds_read_b64_tr_b16 v[138:139], v161 offset:45568
    s_waitcnt vmcnt(7) lgkmcnt(10)
    v_mfma_f32_32x32x16_bf16 v[64:79], v[140:143], v[224:227], v[64:79]
    ds_read_b64_tr_b16 v[140:141], v162 offset:45056
    ds_read_b64_tr_b16 v[142:143], v162 offset:45568
    v_mfma_f32_32x32x16_bf16 v[80:95], v[144:147], v[224:227], v[80:95]
    ds_read_b64_tr_b16 v[144:145], v160 offset:49152
    ds_read_b64_tr_b16 v[146:147], v160 offset:49664
    v_mfma_f32_32x32x16_bf16 v[96:111], v[148:151], v[224:227], v[96:111]
    ds_read_b64_tr_b16 v[148:149], v161 offset:49152
    ds_read_b64_tr_b16 v[150:151], v161 offset:49664
    buffer_load_dword v184, v22, s[16:19], s53 offen sc1
    s_waitcnt vmcnt(7) lgkmcnt(10)
    v_mfma_f32_32x32x16_bf16 v[64:79], v[152:155], v[228:231], v[64:79]
    ds_read_b64_tr_b16 v[152:153], v162 offset:49152
    ds_read_b64_tr_b16 v[154:155], v162 offset:49664
    v_mfma_f32_32x32x16_bf16 v[80:95], v[156:159], v[228:231], v[80:95]
    ds_read_b64_tr_b16 v[156:157], v160 offset:53248
    ds_read_b64_tr_b16 v[158:159], v160 offset:53760
    v_mfma_f32_32x32x16_bf16 v[96:111], v[128:131], v[228:231], v[96:111]
    ds_read_b64_tr_b16 v[128:129], v160 offset:57344
    ds_read_b64_tr_b16 v[130:131], v160 offset:57856
    s_waitcnt vmcnt(6) lgkmcnt(10)
    v_mfma_f32_32x32x16_bf16 v[64:79], v[132:135], v[232:235], v[64:79]
    ds_read_b64_tr_b16 v[132:133], v160 offset:61440
    ds_read_b64_tr_b16 v[134:135], v160 offset:61952
    s_waitcnt vmcnt(0)
    v_cmp_gt_u32 vcc, 17, v184
    s_nop 1
    s_cbranch_vccnz L_poll_167
L_ok_168:
    s_cmp_lg_u32 s50, 0
    s_cbranch_scc1 L_acq_169
L_acr_170:
    s_add_u32 s80, s75, s61
    s_add_u32 s81, s80, 28672
    s_add_u32 s64, s82, 0
    s_and_b32 s64, s64, 3
    s_mul_i32 s64, s64, 7168
    s_add_u32 s64, s64, s80
    s_add_u32 s64, s64, s83
    buffer_load_dwordx4 v[188:191], v1, s[16:19], s64 offen offset:0 sc1
    v_mfma_f32_32x32x16_bf16 v[80:95], v[136:139], v[232:235], v[80:95]
    ds_read_b64_tr_b16 v[136:137], v161 offset:53248
    ds_read_b64_tr_b16 v[138:139], v161 offset:53760
    buffer_load_dwordx4 v[192:195], v1, s[16:19], s64 offen offset:1024 sc1
    v_mfma_f32_32x32x16_bf16 v[96:111], v[140:143], v[232:235], v[96:111]
    ds_read_b64_tr_b16 v[140:141], v161 offset:57344
    ds_read_b64_tr_b16 v[142:143], v161 offset:57856
    s_waitcnt lgkmcnt(10)
    v_mfma_f32_32x32x16_bf16 v[64:79], v[144:147], v[236:239], v[64:79]
    ds_read_b64_tr_b16 v[144:145], v161 offset:61440
    ds_read_b64_tr_b16 v[146:147], v161 offset:61952
    buffer_load_dwordx4 v[196:199], v1, s[16:19], s64 offen offset:2048 sc1
    v_mfma_f32_32x32x16_bf16 v[80:95], v[148:151], v[236:239], v[80:95]
    ds_read_b64_tr_b16 v[148:149], v162 offset:53248
    ds_read_b64_tr_b16 v[150:151], v162 offset:53760
    buffer_load_dwordx4 v[200:203], v1, s[16:19], s64 offen offset:3072 sc1
    v_mfma_f32_32x32x16_bf16 v[96:111], v[152:155], v[236:239], v[96:111]
    ds_read_b64_tr_b16 v[152:153], v162 offset:57344
    ds_read_b64_tr_b16 v[154:155], v162 offset:57856
    s_waitcnt lgkmcnt(10)
    v_mfma_f32_32x32x16_bf16 v[64:79], v[156:159], v[240:243], v[64:79]
    ds_read_b64_tr_b16 v[156:157], v162 offset:61440
    ds_read_b64_tr_b16 v[158:159], v162 offset:61952
    s_add_u32 s64, s64, 4096
    s_cmp_eq_u32 s64, s81
    s_cmov_b32 s64, s80
    buffer_load_dwordx4 v[204:207], v1, s[16:19], s64 offen offset:0 sc1
    v_mfma_f32_32x32x16_bf16 v[64:79], v[128:131], v[244:247], v[64:79]
    v_mov_b32 v172, v24
    buffer_load_dwordx4 v[208:211], v1, s[16:19], s64 offen offset:1024 sc1
    v_mfma_f32_32x32x16_bf16 v[64:79], v[132:135], v[248:251], v[64:79]
    s_waitcnt lgkmcnt(8)
    v_mfma_f32_32x32x16_bf16 v[64:79], v[172:175], v[180:183], v[64:79]
    buffer_load_dwordx4 v[212:215], v1, s[16:19], s64 offen offset:2048 sc1
    v_mfma_f32_32x32x16_bf16 v[80:95], v[136:139], v[240:243], v[80:95]
    s_add_u32 s64, s64, 3072
    s_cmp_eq_u32 s64, s81
    s_cmov_b32 s64, s80
    buffer_load_dwordx4 v[216:219], v1, s[16:19], s64 offen offset:0 sc1
    v_mfma_f32_32x32x16_bf16 v[80:95], v[140:143], v[244:247], v[80:95]
    v_mov_b32 v176, v25
    v_max_f32 v64, 0, v64
    v_max_f32 v65, 0, v65
    v_max_f32 v66, 0, v66
    v_max_f32 v67, 0, v67
    v_max_f32 v68, 0, v68
    v_max_f32 v69, 0, v69
    s_waitcnt lgkmcnt(4)
    v_mfma_f32_32x32x16_bf16 v[80:95], v[144:147], v[248:251], v[80:95]
    buffer_load_dwordx4 v[220:223], v1, s[16:19], s64 offen offset:1024 sc1
    v_max_f32 v70, 0, v70
    v_max_f32 v71, 0, v71
    v_mul_f32 v64, v64, v72
    v_mul_f32 v65, v65, v73
    v_mul_f32 v66, v66, v74
    v_mul_f32 v67, v67, v75
    v_mfma_f32_32x32x16_bf16 v[80:95], v[176:179], v[180:183], v[80:95]
    buffer_load_dwordx4 v[224:227], v1, s[16:19], s64 offen offset:2048 sc1
    v_mul_f32 v68, v68, v76
    v_mul_f32 v69, v69, v77
    v_mul_f32 v70, v70, v78
    v_mul_f32 v71, v71, v79
    v_cvt_pk_bf16_f32 v64, v64, v65
    v_cvt_pk_bf16_f32 v65, v66, v67
    v_mfma_f32_32x32x16_bf16 v[96:111], v[148:151], v[240:243], v[96:111]
    v_cvt_pk_bf16_f32 v66, v68, v69
    v_cvt_pk_bf16_f32 v67, v70, v71
    buffer_store_dwordx4 v[64:67], v1, s[16:19], s89 offen offset:0
    s_waitcnt lgkmcnt(0)
    v_mfma_f32_32x32x16_bf16 v[96:111], v[152:155], v[244:247], v[96:111]
    v_mov_b32 v172, v26
    v_max_f32 v80, 0, v80
    v_max_f32 v81, 0, v81
    v_max_f32 v82, 0, v82
    v_max_f32 v83, 0, v83
    v_max_f32 v84, 0, v84
    v_max_f32 v85, 0, v85
    v_mfma_f32_32x32x16_bf16 v[96:111], v[156:159], v[248:251], v[96:111]
    v_max_f32 v86, 0, v86
    v_max_f32 v87, 0, v87
    v_mul_f32 v80, v80, v88
    v_mul_f32 v81, v81, v89
    v_mul_f32 v82, v82, v90
    v_mul_f32 v83, v83, v91
    v_mul_f32 v84, v84, v92
    v_mfma_f32_32x32x16_bf16 v[96:111], v[172:175], v[180:183], v[96:111]
    v_mul_f32 v85, v85, v93
    v_mul_f32 v86, v86, v94
    v_mul_f32 v87, v87, v95
    v_cvt_pk_bf16_f32 v80, v80, v81
    v_cvt_pk_bf16_f32 v81, v82, v83
    v_cvt_pk_bf16_f32 v82, v84, v85
    v_cvt_pk_bf16_f32 v83, v86, v87
    buffer_store_dwordx4 v[80:83], v1, s[16:19], s89 offen offset:1024
    s_nop 3
    v_max_f32 v96, 0, v96
    v_max_f32 v97, 0, v97
    v_max_f32 v98, 0, v98
    v_max_f32 v99, 0, v99
    v_max_f32 v100, 0, v100
    v_max_f32 v101, 0, v101
    v_max_f32 v102, 0, v102
    v_max_f32 v103, 0, v103
    v_mul_f32 v96, v96, v104
    v_mul_f32 v97, v97, v105
    v_mul_f32 v98, v98, v106
    v_mul_f32 v99, v99, v107
    v_mul_f32 v100, v100, v108
    v_mul_f32 v101, v101, v109
    v_mul_f32 v102, v102, v110
    v_mul_f32 v103, v103, v111
    v_cvt_pk_bf16_f32 v96, v96, v97
    v_cvt_pk_bf16_f32 v97, v98, v99
    v_cvt_pk_bf16_f32 v98, v100, v101
    v_cvt_pk_bf16_f32 v99, v102, v103
    buffer_store_dwordx4 v[96:99], v1, s[16:19], s89 offen offset:2048
    s_waitcnt lgkmcnt(0)
    s_nop 2
    s_branch L_dn1
L_ge1:
    ds_read_b64_tr_b16 v[128:129], v161 offset:0
    ds_read_b64_tr_b16 v[130:131], v161 offset:512
    ds_read_b64_tr_b16 v[132:133], v162 offset:0
    ds_read_b64_tr_b16 v[134:135], v162 offset:512
    ds_read_b64_tr_b16 v[136:137], v163 offset:0
    ds_read_b64_tr_b16 v[138:139], v163 offset:512
    ds_read_b64_tr_b16 v[140:141], v161 offset:4096
    ds_read_b64_tr_b16 v[142:143], v161 offset:4608
    ds_read_b64_tr_b16 v[144:145], v162 offset:4096
    ds_read_b64_tr_b16 v[146:147], v162 offset:4608
    ds_read_b64_tr_b16 v[148:149], v163 offset:4096
    ds_read_b64_tr_b16 v[150:151], v163 offset:4608
    ds_read_b64_tr_b16 v[152:153], v161 offset:8192
    ds_read_b64_tr_b16 v[154:155], v161 offset:8704
    ds_read_b64_tr_b16 v[156:157], v162 offset:8192
    ds_read_b64_tr_b16 v[158:159], v162 offset:8704
    s_waitcnt vmcnt(9) lgkmcnt(10)
    v_mfma_f32_32x32x16_bf16 v[64:79], v[128:131], v[188:191], 0
    ds_read_b64_tr_b16 v[128:129], v163 offset:8192
    ds_read_b64_tr_b16 v[130:131], v163 offset:8704
    buffer_load_dwordx4 v[212:215], v1, s[16:19], s64 offen offset:2048 sc1
    v_mfma_f32_32x32x16_bf16 v[80:95], v[132:135], v[188:191], 0
    ds_read_b64_tr_b16 v[132:133], v161 offset:12288
    ds_read_b64_tr_b16 v[134:135], v161 offset:12800
    buffer_load_dwordx4 v[216:219], v1, s[16:19], s64 offen offset:3072 sc1
    v_mfma_f32_32x32x16_bf16 v[96:111], v[136:139], v[188:191], 0
    ds_read_b64_tr_b16 v[136:137], v162 offset:12288
    ds_read_b64_tr_b16 v[138:139], v162 offset:12800
    s_waitcnt vmcnt(8) lgkmcnt(10)
    v_mfma_f32_32x32x16_bf16 v[64:79], v[140:143], v[192:195], v[64:79]
    ds_read_b64_tr_b16 v[140:141], v163 offset:12288
    ds_read_b64_tr_b16 v[142:143], v163 offset:12800
    s_add_u32 s64, s64, 4096
    buffer_load_dwordx4 v[220:223], v1, s[16:19], s64 offen offset:0 sc1
    v_mfma_f32_32x32x16_bf16 v[80:95], v[144:147], v[192:195], v[80:95]
    ds_read_b64_tr_b16 v[144:145], v161 offset:16384
    ds_read_b64_tr_b16 v[146:147], v161 offset:16896
    buffer_load_dwordx4 v[224:227], v1, s[16:19], s64 offen offset:1024 sc1
    v_mfma_f32_32x32x16_bf16 v[96:111], v[148:151], v[192:195], v[96:111]
    ds_read_b64_tr_b16 v[148:149], v162 offset:16384
    ds_read_b64_tr_b16 v[150:151], v162 offset:16896
    s_waitcnt vmcnt(9) lgkmcnt(10)
    v_mfma_f32_32x32x16_bf16 v[64:79], v[152:155], v[196:199], v[64:79]
    ds_read_b64_tr_b16 v[152:153], v163 offset:16384
    ds_read_b64_tr_b16 v[154:155], v163 offset:16896
    buffer_load_dwordx4 v[228:231], v1, s[16:19], s64 offen offset:2048 sc1
    v_mfma_f32_32x32x16_bf16 v[80:95], v[156:159], v[196:199], v[80:95]
    ds_read_b64_tr_b16 v[156:157], v161 offset:20480
    ds_read_b64_tr_b16 v[158:159], v161 offset:20992
    buffer_load_dwordx4 v[232:235], v1, s[16:19], s64 offen offset:3072 sc1
    v_mfma_f32_32x32x16_bf16 v[96:111], v[128:131], v[196:199], v[96:111]
    ds_read_b64_tr_b16 v[128:129], v162 offset:20480
    ds_read_b64_tr_b16 v[130:131], v162 offset:20992
    s_waitcnt vmcnt(10) lgkmcnt(10)
    v_mfma_f32_32x32x16_bf16 v[64:79], v[132:135], v[200:203], v[64:79]
    ds_read_b64_tr_b16 v[132:133], v163 offset:20480
    ds_read_b64_tr_b16 v[134:135], v163 offset:20992
    s_add_u32 s64, s64, 4096
    buffer_load_dwordx4 v[236:239], v1, s[16:19], s64 offen offset:0 sc1
    v_mfma_f32_32x32x16_bf16 v[80:95], v[136:139], v[200:203], v[80:95]
    ds_read_b64_tr_b16 v[136:137], v161 offset:24576
    ds_read_b64_tr_b16 v[138:139], v161 offset:25088
    buffer_load_dwordx4 v[240:243], v1, s[16:19], s64 offen offset:1024 sc1
    v_add_f32 v164, v164, v165
    v_add_f32 v166, v166, v167
    v_mfma_f32_32x32x16_bf16 v[96:111], v[140:143], v[200:203], v[96:111]
    ds_read_b64_tr_b16 v[140:141], v162 offset:24576
    ds_read_b64_tr_b16 v[142:143], v162 offset:25088
    s_waitcnt vmcnt(11) lgkmcnt(10)
    v_mfma_f32_32x32x16_bf16 v[64:79], v[144:147], v[204:207], v[64:79]
    ds_read_b64_tr_b16 v[144:145], v163 offset:24576
    ds_read_b64_tr_b16 v[146:147], v163 offset:25088
    buffer_load_dwordx4 v[244:247], v1, s[16:19], s64 offen offset:2048 sc1
    v_mfma_f32_32x32x16_bf16 v[80:95], v[148:151], v[204:207], v[80:95]
    ds_read_b64_tr_b16 v[148:149], v161 offset:28672
    ds_read_b64_tr_b16 v[150:151], v161 offset:29184
    buffer_load_dwordx4 v[248:251], v1, s[16:19], s64 offen offset:3072 sc1
    v_add_f32 v168, v168, v169
    v_add_f32 v170, v170, v171
    v_mfma_f32_32x32x16_bf16 v[96:111], v[152:155], v[204:207], v[96:111]
    ds_read_b64_tr_b16 v[152:153], v162 offset:28672
    ds_read_b64_tr_b16 v[154:155], v162 offset:29184
    v_mov_b32 v252, 16
    s_waitcnt vmcnt(10)
    s_mov_b64 exec, 1
    s_cmp_lg_u32 s50, 0
    s_cbranch_scc1 L_pub_171
    buffer_store_dword v252, off, s[16:19], s52
L_pur_172:
    s_mov_b64 exec, -1
    s_waitcnt lgkmcnt(10)
    v_mfma_f32_32x32x16_bf16 v[64:79], v[156:159], v[208:211], v[64:79]
    ds_read_b64_tr_b16 v[156:157], v163 offset:28672
    ds_read_b64_tr_b16 v[158:159], v163 offset:29184
    s_add_u32 s64, s64, 4096
    buffer_load_dwordx4 v[188:191], v1, s[16:19], s64 offen offset:0 sc1
    v_mfma_f32_32x32x16_bf16 v[80:95], v[128:131], v[208:211], v[80:95]
    ds_read_b64_tr_b16 v[128:129], v161 offset:32768
    ds_read_b64_tr_b16 v[130:131], v161 offset:33280
    buffer_load_dwordx4 v[192:195], v1, s[16:19], s64 offen offset:1024 sc1
    v_add_f32 v164, v164, v166
    v_add_f32 v168, v168, v170
    v_mfma_f32_32x32x16_bf16 v[96:111], v[132:135], v[208:211], v[96:111]
    ds_read_b64_tr_b16 v[132:133], v162 offset:32768
    ds_read_b64_tr_b16 v[134:135], v162 offset:33280
    s_waitcnt vmcnt(12) lgkmcnt(10)
    v_mfma_f32_32x32x16_bf16 v[64:79], v[136:139], v[212:215], v[64:79]
    ds_read_b64_tr_b16 v[136:137], v163 offset:32768
    ds_read_b64_tr_b16 v[138:139], v163 offset:33280
    buffer_load_dwordx4 v[196:199], v1, s[16:19], s64 offen offset:2048 sc1
    v_mfma_f32_32x32x16_bf16 v[80:95], v[140:143], v[212:215], v[80:95]
    ds_read_b64_tr_b16 v[140:141], v161 offset:36864
    ds_read_b64_tr_b16 v[142:143], v161 offset:37376
    v_add_f32 v164, v164, v168
    v_mov_b32 v165, v164
    v_mfma_f32_32x32x16_bf16 v[96:111], v[144:147], v[212:215], v[96:111]
    ds_read_b64_tr_b16 v[144:145], v162 offset:36864
    ds_read_b64_tr_b16 v[146:147], v162 offset:37376
    s_waitcnt vmcnt(12) lgkmcnt(10)
    v_mfma_f32_32x32x16_bf16 v[64:79], v[148:151], v[216:219], v[64:79]
    ds_read_b64_tr_b16 v[148:149], v163 offset:36864
    ds_read_b64_tr_b16 v[150:151], v163 offset:37376
    buffer_load_dwordx4 v[200:203], v1, s[16:19], s64 offen offset:3072 sc1
    v_mfma_f32_32x32x16_bf16 v[80:95], v[152:155], v[216:219], v[80:95]
    ds_read_b64_tr_b16 v[152:153], v161 offset:40960
    ds_read_b64_tr_b16 v[154:155], v161 offset:41472
    v_permlane32_swap_b32 v164, v165
    v_mul_f32 v164, 0x3b000000, v164
    v_mfma_f32_32x32x16_bf16 v[96:111], v[156:159], v[216:219], v[96:111]
    ds_read_b64_tr_b16 v[156:157], v162 offset:40960
    ds_read_b64_tr_b16 v[158:159], v162 offset:41472
    s_waitcnt vmcnt(12) lgkmcnt(10)
    v_mfma_f32_32x32x16_bf16 v[64:79], v[128:131], v[220:223], v[64:79]
    ds_read_b64_tr_b16 v[128:129], v163 offset:40960
    ds_read_b64_tr_b16 v[130:131], v163 offset:41472
    s_add_u32 s64, s64, 4096
    buffer_load_dwordx4 v[204:207], v1, s[16:19], s64 offen offset:0 sc1
    v_mfma_f32_32x32x16_bf16 v[80:95], v[132:135], v[220:223], v[80:95]
    ds_read_b64_tr_b16 v[132:133], v161 offset:45056
    ds_read_b64_tr_b16 v[134:135], v161 offset:45568
    v_cvt_pk_bf16_f32 v180, -v164, -v164
    v_mov_b32 v181, v180
    v_mfma_f32_32x32x16_bf16 v[96:111], v[136:139], v[220:223], v[96:111]
    ds_read_b64_tr_b16 v[136:137], v162 offset:45056
    ds_read_b64_tr_b16 v[138:139], v162 offset:45568
    s_add_u32 s70, s66, 1605632
    s_add_u32 m0, s69, 114688
    s_nop 0
    buffer_load_dwordx4 v30, s[32:35], s70 offen lds
    s_waitcnt vmcnt(13) lgkmcnt(10)
    v_mfma_f32_32x32x16_bf16 v[64:79], v[140:143], v[224:227], v[64:79]
    ds_read_b64_tr_b16 v[140:141], v163 offset:45056
    ds_read_b64_tr_b16 v[142:143], v163 offset:45568
    buffer_load_dwordx4 v[208:211], v1, s[16:19], s64 offen offset:1024 sc1
    v_mfma_f32_32x32x16_bf16 v[80:95], v[144:147], v[224:227], v[80:95]
    ds_read_b64_tr_b16 v[144:145], v161 offset:49152
    ds_read_b64_tr_b16 v[146:147], v161 offset:49664
    v_mov_b32 v182, v180
    v_mov_b32 v183, v180
    v_mfma_f32_32x32x16_bf16 v[96:111], v[148:151], v[224:227], v[96:111]
    ds_read_b64_tr_b16 v[148:149], v162 offset:49152
    ds_read_b64_tr_b16 v[150:151], v162 offset:49664
    s_add_u32 s70, s66, 1634304
    s_add_u32 m0, s69, 115712
    s_nop 0
    buffer_load_dwordx4 v30, s[32:35], s70 offen lds
    s_waitcnt vmcnt(14) lgkmcnt(10)
    v_mfma_f32_32x32x16_bf16 v[64:79], v[152:155], v[228:231], v[64:79]
    ds_read_b64_tr_b16 v[152:153], v163 offset:49152
    ds_read_b64_tr_b16 v[154:155], v163 offset:49664
    buffer_load_dwordx4 v[212:215], v1, s[16:19], s64 offen offset:2048 sc1
    v_mfma_f32_32x32x16_bf16 v[80:95], v[156:159], v[228:231], v[80:95]
    ds_read_b64_tr_b16 v[156:157], v161 offset:53248
    ds_read_b64_tr_b16 v[158:159], v161 offset:53760
    v_mfma_f32_32x32x16_bf16 v[96:111], v[128:131], v[228:231], v[96:111]
    ds_read_b64_tr_b16 v[128:129], v162 offset:53248
    ds_read_b64_tr_b16 v[130:131], v162 offset:53760
    s_add_u32 s70, s66, 1605632
    s_add_u32 m0, s69, 116736
    s_nop 0
    buffer_load_dwordx4 v31, s[36:39], s70 offen lds
    s_waitcnt vmcnt(15) lgkmcnt(10)
    v_mfma_f32_32x32x16_bf16 v[64:79], v[132:135], v[232:235], v[64:79]
    ds_read_b64_tr_b16 v[132:133], v163 offset:53248
    ds_read_b64_tr_b16 v[134:135], v163 offset:53760
    buffer_load_dwordx4 v[216:219], v1, s[16:19], s64 offen offset:3072 sc1
    v_mfma_f32_32x32x16_bf16 v[80:95], v[136:139], v[232:235], v[80:95]
    ds_read_b64_tr_b16 v[136:137], v161 offset:57344
    ds_read_b64_tr_b16 v[138:139], v161 offset:57856
    v_mfma_f32_32x32x16_bf16 v[96:111], v[140:143], v[232:235], v[96:111]
    ds_read_b64_tr_b16 v[140:141], v162 offset:57344
    ds_read_b64_tr_b16 v[142:143], v162 offset:57856
    s_add_u32 s70, s66, 1634304
    s_add_u32 m0, s69, 117760
    s_nop 0
    buffer_load_dwordx4 v31, s[36:39], s70 offen lds
    s_waitcnt vmcnt(16) lgkmcnt(10)
    v_mfma_f32_32x32x16_bf16 v[64:79], v[144:147], v[236:239], v[64:79]
    ds_read_b64_tr_b16 v[144:145], v163 offset:57344
    ds_read_b64_tr_b16 v[146:147], v163 offset:57856
    s_add_u32 s64, s64, 4096
    buffer_load_dwordx4 v[220:223], v1, s[16:19], s64 offen offset:0 sc1
    v_mfma_f32_32x32x16_bf16 v[80:95], v[148:151], v[236:239], v[80:95]
    ds_read_b64_tr_b16 v[148:149], v161 offset:61440
    ds_read_b64_tr_b16 v[150:151], v161 offset:61952
    v_mfma_f32_32x32x16_bf16 v[96:111], v[152:155], v[236:239], v[96:111]
    ds_read_b64_tr_b16 v[152:153], v162 offset:61440
    ds_read_b64_tr_b16 v[154:155], v162 offset:61952
    s_waitcnt vmcnt(16) lgkmcnt(10)
    v_mfma_f32_32x32x16_bf16 v[64:79], v[156:159], v[240:243], v[64:79]
    ds_read_b64_tr_b16 v[156:157], v163 offset:61440
    ds_read_b64_tr_b16 v[158:159], v163 offset:61952
    buffer_load_dwordx4 v[224:227], v1, s[16:19], s64 offen offset:1024 sc1
    v_mfma_f32_32x32x16_bf16 v[80:95], v[128:131], v[240:243], v[80:95]
    v_add_u32 v161, 0x10000, v161
    ds_read_b64_tr_b16 v[128:129], v161 offset:0
    ds_read_b64_tr_b16 v[130:131], v161 offset:512
    v_mfma_f32_32x32x16_bf16 v[96:111], v[132:135], v[240:243], v[96:111]
    v_add_u32 v162, 0x10000, v162
    ds_read_b64_tr_b16 v[132:133], v162 offset:0
    ds_read_b64_tr_b16 v[134:135], v162 offset:512
    s_waitcnt vmcnt(16) lgkmcnt(10)
    v_mfma_f32_32x32x16_bf16 v[64:79], v[136:139], v[244:247], v[64:79]
    v_add_u32 v163, 0x10000, v163
    ds_read_b64_tr_b16 v[136:137], v163 offset:0
    ds_read_b64_tr_b16 v[138:139], v163 offset:512
    buffer_load_dwordx4 v[228:231], v1, s[16:19], s64 offen offset:2048 sc1
    v_mfma_f32_32x32x16_bf16 v[80:95], v[140:143], v[244:247], v[80:95]
    ds_read_b64_tr_b16 v[140:141], v161 offset:4096
    ds_read_b64_tr_b16 v[142:143], v161 offset:4608
    v_mfma_f32_32x32x16_bf16 v[96:111], v[144:147], v[244:247], v[96:111]
    ds_read_b64_tr_b16 v[144:145], v162 offset:4096
    ds_read_b64_tr_b16 v[146:147], v162 offset:4608
    s_waitcnt vmcnt(16) lgkmcnt(10)
    v_mfma_f32_32x32x16_bf16 v[64:79], v[148:151], v[248:251], v[64:79]
    ds_read_b64_tr_b16 v[148:149], v163 offset:4096
    ds_read_b64_tr_b16 v[150:151], v163 offset:4608
    buffer_load_dwordx4 v[232:235], v1, s[16:19], s64 offen offset:3072 sc1
    v_mfma_f32_32x32x16_bf16 v[80:95], v[152:155], v[248:251], v[80:95]
    ds_read_b64_tr_b16 v[152:153], v161 offset:8192
    ds_read_b64_tr_b16 v[154:155], v161 offset:8704
    v_mfma_f32_32x32x16_bf16 v[96:111], v[156:159], v[248:251], v[96:111]
    ds_read_b64_tr_b16 v[156:157], v162 offset:8192
    ds_read_b64_tr_b16 v[158:159], v162 offset:8704
    s_waitcnt vmcnt(15) lgkmcnt(10)
    v_mfma_f32_32x32x16_bf16 v[64:79], v[128:131], v[188:191], v[64:79]
    ds_read_b64_tr_b16 v[128:129], v163 offset:8192
    ds_read_b64_tr_b16 v[130:131], v163 offset:8704
    s_add_u32 s64, s64, 4096
    buffer_load_dwordx4 v[236:239], v1, s[16:19], s64 offen offset:0 sc1
    v_mfma_f32_32x32x16_bf16 v[80:95], v[132:135], v[188:191], v[80:95]
    ds_read_b64_tr_b16 v[132:133], v161 offset:12288
    ds_read_b64_tr_b16 v[134:135], v161 offset:12800
    v_mfma_f32_32x32x16_bf16 v[96:111], v[136:139], v[188:191], v[96:111]
    ds_read_b64_tr_b16 v[136:137], v162 offset:12288
    ds_read_b64_tr_b16 v[138:139], v162 offset:12800
    s_waitcnt vmcnt(15) lgkmcnt(10)
    v_mfma_f32_32x32x16_bf16 v[64:79], v[140:143], v[192:195], v[64:79]
    ds_read_b64_tr_b16 v[140:141], v163 offset:12288
    ds_read_b64_tr_b16 v[142:143], v163 offset:12800
    buffer_load_dwordx4 v[240:243], v1, s[16:19], s64 offen offset:1024 sc1
    v_mfma_f32_32x32x16_bf16 v[80:95], v[144:147], v[192:195], v[80:95]
    ds_read_b64_tr_b16 v[144:145], v161 offset:16384
    ds_read_b64_tr_b16 v[146:147], v161 offset:16896
    v_mfma_f32_32x32x16_bf16 v[96:111], v[148:151], v[192:195], v[96:111]
    ds_read_b64_tr_b16 v[148:149], v162 offset:16384
    ds_read_b64_tr_b16 v[150:151], v162 offset:16896
    s_waitcnt vmcnt(15) lgkmcnt(10)
    v_mfma_f32_32x32x16_bf16 v[64:79], v[152:155], v[196:199], v[64:79]
    ds_read_b64_tr_b16 v[152:153], v163 offset:16384
    ds_read_b64_tr_b16 v[154:155], v163 offset:16896
    buffer_load_dwordx4 v[244:247], v1, s[16:19], s64 offen offset:2048 sc1
    v_mfma_f32_32x32x16_bf16 v[80:95], v[156:159], v[196:199], v[80:95]
    ds_read_b64_tr_b16 v[156:157], v161 offset:20480
    ds_read_b64_tr_b16 v[158:159], v161 offset:20992
    v_mfma_f32_32x32x16_bf16 v[96:111], v[128:131], v[196:199], v[96:111]
    ds_read_b64_tr_b16 v[128:129], v162 offset:20480
    ds_read_b64_tr_b16 v[130:131], v162 offset:20992
    s_waitcnt vmcnt(15) lgkmcnt(10)
    v_mfma_f32_32x32x16_bf16 v[64:79], v[132:135], v[200:203], v[64:79]
    ds_read_b64_tr_b16 v[132:133], v163 offset:20480
    ds_read_b64_tr_b16 v[134:135], v163 offset:20992
    buffer_load_dwordx4 v[248:251], v1, s[16:19], s64 offen offset:3072 sc1
    v_mfma_f32_32x32x16_bf16 v[80:95], v[136:139], v[200:203], v[80:95]
    ds_read_b64_tr_b16 v[136:137], v161 offset:24576
    ds_read_b64_tr_b16 v[138:139], v161 offset:25088
    v_mfma_f32_32x32x16_bf16 v[96:111], v[140:143], v[200:203], v[96:111]
    ds_read_b64_tr_b16 v[140:141], v162 offset:24576
    ds_read_b64_tr_b16 v[142:143], v162 offset:25088
    s_waitcnt vmcnt(15) lgkmcnt(10)
    v_mfma_f32_32x32x16_bf16 v[64:79], v[144:147], v[204:207], v[64:79]
    ds_read_b64_tr_b16 v[144:145], v163 offset:24576
    ds_read_b64_tr_b16 v[146:147], v163 offset:25088
    v_mfma_f32_32x32x16_bf16 v[80:95], v[148:151], v[204:207], v[80:95]
    ds_read_b64_tr_b16 v[148:149], v161 offset:28672
    ds_read_b64_tr_b16 v[150:151], v161 offset:29184
    v_mov_b32 v173, 0
    v_mov_b32 v174, 0
    v_mfma_f32_32x32x16_bf16 v[96:111], v[152:155], v[204:207], v[96:111]
    ds_read_b64_tr_b16 v[152:153], v162 offset:28672
    ds_read_b64_tr_b16 v[154:155], v162 offset:29184
    buffer_load_dword v184, v21, s[16:19], s53 offen sc1
    s_waitcnt vmcnt(14) lgkmcnt(10)
    v_mfma_f32_32x32x16_bf16 v[64:79], v[156:159], v[208:211], v[64:79]
    ds_read_b64_tr_b16 v[156:157], v163 offset:28672
    ds_read_b64_tr_b16 v[158:159], v163 offset:29184
    v_mfma_f32_32x32x16_bf16 v[80:95], v[128:131], v[208:211], v[80:95]
    ds_read_b64_tr_b16 v[128:129], v161 offset:32768
    ds_read_b64_tr_b16 v[130:131], v161 offset:33280
    v_mov_b32 v175, 0
    v_mov_b32 v177, 0
    v_mfma_f32_32x32x16_bf16 v[96:111], v[132:135], v[208:211], v[96:111]
    ds_read_b64_tr_b16 v[132:133], v162 offset:32768
    ds_read_b64_tr_b16 v[134:135], v162 offset:33280
    s_waitcnt vmcnt(12) lgkmcnt(10)
    v_mfma_f32_32x32x16_bf16 v[64:79], v[136:139], v[212:215], v[64:79]
    ds_read_b64_tr_b16 v[136:137], v163 offset:32768
    ds_read_b64_tr_b16 v[138:139], v163 offset:33280
    v_mfma_f32_32x32x16_bf16 v[80:95], v[140:143], v[212:215], v[80:95]
    ds_read_b64_tr_b16 v[140:141], v161 offset:36864
    ds_read_b64_tr_b16 v[142:143], v161 offset:37376
    v_mov_b32 v178, 0
    v_mov_b32 v179, 0
    v_mfma_f32_32x32x16_bf16 v[96:111], v[144:147], v[212:215], v[96:111]
    ds_read_b64_tr_b16 v[144:145], v162 offset:36864
    ds_read_b64_tr_b16 v[146:147], v162 offset:37376
    s_waitcnt vmcnt(10) lgkmcnt(10)
    v_mfma_f32_32x32x16_bf16 v[64:79], v[148:151], v[216:219], v[64:79]
    ds_read_b64_tr_b16 v[148:149], v163 offset:36864
    ds_read_b64_tr_b16 v[150:151], v163 offset:37376
    v_mfma_f32_32x32x16_bf16 v[80:95], v[152:155], v[216:219], v[80:95]
    ds_read_b64_tr_b16 v[152:153], v161 offset:40960
    ds_read_b64_tr_b16 v[154:155], v161 offset:41472
    v_mfma_f32_32x32x16_bf16 v[96:111], v[156:159], v[216:219], v[96:111]
    ds_read_b64_tr_b16 v[156:157], v162 offset:40960
    ds_read_b64_tr_b16 v[158:159], v162 offset:41472
    s_waitcnt vmcnt(8) lgkmcnt(10)
    v_mfma_f32_32x32x16_bf16 v[64:79], v[128:131], v[220:223], v[64:79]
    ds_read_b64_tr_b16 v[128:129], v163 offset:40960
    ds_read_b64_tr_b16 v[130:131], v163 offset:41472
    s_waitcnt vmcnt(0)
    v_cmp_gt_u32 vcc, 16, v184
    s_nop 1
    s_cbranch_vccnz L_poll_173
L_ok_174:
    s_cmp_lg_u32 s50, 0
    s_cbranch_scc1 L_acq_175
L_acr_176:
    s_mov_b32 s64, s60
    buffer_load_dwordx4 v[188:191], v1, s[16:19], s64 offen offset:0 sc1
    v_mfma_f32_32x32x16_bf16 v[80:95], v[132:135], v[220:223], v[80:95]
    ds_read_b64_tr_b16 v[132:133], v161 offset:45056
    ds_read_b64_tr_b16 v[134:135], v161 offset:45568
    buffer_load_dwordx4 v[192:195], v1, s[16:19], s64 offen offset:1024 sc1
    v_mfma_f32_32x32x16_bf16 v[96:111], v[136:139], v[220:223], v[96:111]
    ds_read_b64_tr_b16 v[136:137], v162 offset:45056
    ds_read_b64_tr_b16 v[138:139], v162 offset:45568
    s_waitcnt lgkmcnt(10)
    v_mfma_f32_32x32x16_bf16 v[64:79], v[140:143], v[224:227], v[64:79]
    ds_read_b64_tr_b16 v[140:141], v163 offset:45056
    ds_read_b64_tr_b16 v[142:143], v163 offset:45568
    buffer_load_dwordx4 v[196:199], v1, s[16:19], s64 offen offset:2048 sc1
    v_mfma_f32_32x32x16_bf16 v[80:95], v[144:147], v[224:227], v[80:95]
    s_barrier
    ds_read_b64_tr_b16 v[144:145], v161 offset:49152
    ds_read_b64_tr_b16 v[146:147], v161 offset:49664
    buffer_load_dwordx4 v[200:203], v1, s[16:19], s64 offen offset:3072 sc1
    v_mfma_f32_32x32x16_bf16 v[96:111], v[148:151], v[224:227], v[96:111]
    ds_read_b64_tr_b16 v[148:149], v162 offset:49152
    ds_read_b64_tr_b16 v[150:151], v162 offset:49664
    s_waitcnt lgkmcnt(10)
    v_mfma_f32_32x32x16_bf16 v[64:79], v[152:155], v[228:231], v[64:79]
    ds_read_b64_tr_b16 v[152:153], v163 offset:49152
    ds_read_b64_tr_b16 v[154:155], v163 offset:49664
    s_add_u32 s64, s64, 4096
    buffer_load_dwordx4 v[204:207], v1, s[16:19], s64 offen offset:0 sc1
    v_mfma_f32_32x32x16_bf16 v[80:95], v[156:159], v[228:231], v[80:95]
    ds_read_b64_tr_b16 v[156:157], v161 offset:53248
    ds_read_b64_tr_b16 v[158:159], v161 offset:53760
    buffer_load_dwordx4 v[208:211], v1, s[16:19], s64 offen offset:1024 sc1
    v_mfma_f32_32x32x16_bf16 v[96:111], v[128:131], v[228:231], v[96:111]
    ds_read_b64_tr_b16 v[128:129], v161 offset:57344
    ds_read_b64_tr_b16 v[130:131], v161 offset:57856
    s_waitcnt lgkmcnt(10)
    v_mfma_f32_32x32x16_bf16 v[64:79], v[132:135], v[232:235], v[64:79]
    ds_read_b64_tr_b16 v[132:133], v161 offset:61440
    ds_read_b64_tr_b16 v[134:135], v161 offset:61952
    buffer_load_dwordx4 v[212:215], v1, s[16:19], s64 offen offset:2048 sc1
    v_mfma_f32_32x32x16_bf16 v[80:95], v[136:139], v[232:235], v[80:95]
    ds_read_b64_tr_b16 v[136:137], v162 offset:53248
    ds_read_b64_tr_b16 v[138:139], v162 offset:53760
    buffer_load_dwordx4 v[216:219], v1, s[16:19], s64 offen offset:3072 sc1
    v_mfma_f32_32x32x16_bf16 v[96:111], v[140:143], v[232:235], v[96:111]
    ds_read_b64_tr_b16 v[140:141], v162 offset:57344
    ds_read_b64_tr_b16 v[142:143], v162 offset:57856
    s_add_u32 s88, s60, 149504
    buffer_load_dwordx4 v[164:167], v19, s[16:19], s88 offen sc1
    buffer_load_dwordx4 v[168:171], v19, s[16:19], s88 offen offset:16 sc1
    s_add_u32 s87, s57, s59
    s_add_u32 s89, s57, s60
    s_waitcnt lgkmcnt(10)
    v_mfma_f32_32x32x16_bf16 v[64:79], v[144:147], v[236:239], v[64:79]
    ds_read_b64_tr_b16 v[144:145], v162 offset:61440
    ds_read_b64_tr_b16 v[146:147], v162 offset:61952
    s_add_u32 s64, s64, 4096
    buffer_load_dwordx4 v[220:223], v1, s[16:19], s64 offen offset:0 sc1
    v_mfma_f32_32x32x16_bf16 v[80:95], v[148:151], v[236:239], v[80:95]
    ds_read_b64_tr_b16 v[148:149], v163 offset:53248
    ds_read_b64_tr_b16 v[150:151], v163 offset:53760
    buffer_load_dwordx4 v[224:227], v1, s[16:19], s64 offen offset:1024 sc1
    v_mfma_f32_32x32x16_bf16 v[96:111], v[152:155], v[236:239], v[96:111]
    ds_read_b64_tr_b16 v[152:153], v163 offset:57344
    ds_read_b64_tr_b16 v[154:155], v163 offset:57856
    s_waitcnt lgkmcnt(10)
    v_mfma_f32_32x32x16_bf16 v[64:79], v[156:159], v[240:243], v[64:79]
    ds_read_b64_tr_b16 v[156:157], v163 offset:61440
    ds_read_b64_tr_b16 v[158:159], v163 offset:61952
    buffer_load_dwordx4 v[228:231], v1, s[16:19], s64 offen offset:2048 sc1
    v_mfma_f32_32x32x16_bf16 v[64:79], v[128:131], v[244:247], v[64:79]
    ds_read_b64_tr_b16 v[128:129], v160 offset:0
    ds_read_b64_tr_b16 v[130:131], v160 offset:512
    v_mov_b32 v172, v25
    buffer_load_dwordx4 v[232:235], v1, s[16:19], s64 offen offset:3072 sc1
    v_mfma_f32_32x32x16_bf16 v[64:79], v[132:135], v[248:251], v[64:79]
    ds_read_b64_tr_b16 v[132:133], v160 offset:4096
    ds_read_b64_tr_b16 v[134:135], v160 offset:4608
    s_waitcnt lgkmcnt(12)
    v_mfma_f32_32x32x16_bf16 v[64:79], v[172:175], v[180:183], v[64:79]
    s_add_u32 s64, s64, 4096
    buffer_load_dwordx4 v[236:239], v1, s[16:19], s64 offen offset:0 sc1
    v_mfma_f32_32x32x16_bf16 v[80:95], v[136:139], v[240:243], v[80:95]
    ds_read_b64_tr_b16 v[136:137], v160 offset:8192
    ds_read_b64_tr_b16 v[138:139], v160 offset:8704
    v_mfma_f32_32x32x16_bf16 v[80:95], v[140:143], v[244:247], v[80:95]
    ds_read_b64_tr_b16 v[140:141], v160 offset:12288
    ds_read_b64_tr_b16 v[142:143], v160 offset:12800
    v_mov_b32 v176, v26
    v_max_f32 v64, 0, v64
    v_max_f32 v65, 0, v65
    v_max_f32 v66, 0, v66
    v_max_f32 v67, 0, v67
    s_waitcnt lgkmcnt(12)
    v_mfma_f32_32x32x16_bf16 v[80:95], v[144:147], v[248:251], v[80:95]
    v_subrev_u32 v161, 0x10000, v161
    ds_read_b64_tr_b16 v[144:145], v161 offset:0
    ds_read_b64_tr_b16 v[146:147], v161 offset:512
    v_max_f32 v68, 0, v68
    v_max_f32 v69, 0, v69
    v_max_f32 v70, 0, v70
    v_max_f32 v71, 0, v71
    v_mul_f32 v64, v64, v72
    v_mfma_f32_32x32x16_bf16 v[80:95], v[176:179], v[180:183], v[80:95]
    v_mul_f32 v65, v65, v73
    v_mul_f32 v66, v66, v74
    v_mul_f32 v67, v67, v75
    v_mul_f32 v68, v68, v76
    v_mul_f32 v69, v69, v77
    v_mul_f32 v70, v70, v78
    v_mul_f32 v71, v71, v79
    v_mfma_f32_32x32x16_bf16 v[96:111], v[148:151], v[240:243], v[96:111]
    ds_read_b64_tr_b16 v[148:149], v161 offset:4096
    ds_read_b64_tr_b16 v[150:151], v161 offset:4608
    v_cvt_pk_bf16_f32 v64, v64, v65
    v_cvt_pk_bf16_f32 v65, v66, v67
    v_cvt_pk_bf16_f32 v66, v68, v69
    v_cvt_pk_bf16_f32 v67, v70, v71
    buffer_store_dwordx4 v[64:67], v1, s[16:19], s87 offen offset:1024
    s_waitcnt lgkmcnt(12)
    v_mfma_f32_32x32x16_bf16 v[96:111], v[152:155], v[244:247], v[96:111]
    ds_read_b64_tr_b16 v[152:153], v161 offset:8192
    ds_read_b64_tr_b16 v[154:155], v161 offset:8704
    v_mov_b32 v172, v27
    buffer_load_dwordx4 v[240:243], v1, s[16:19], s64 offen offset:1024 sc1
    v_max_f32 v80, 0, v80
    v_max_f32 v81, 0, v81
    v_max_f32 v82, 0, v82
    v_mfma_f32_32x32x16_bf16 v[96:111], v[156:159], v[248:251], v[96:111]
    ds_read_b64_tr_b16 v[156:157], v161 offset:12288
    ds_read_b64_tr_b16 v[158:159], v161 offset:12800
    buffer_load_dwordx4 v[244:247], v1, s[16:19], s64 offen offset:2048 sc1
    v_max_f32 v83, 0, v83
    v_max_f32 v84, 0, v84
    v_max_f32 v85, 0, v85
    v_max_f32 v86, 0, v86
    v_mfma_f32_32x32x16_bf16 v[96:111], v[172:175], v[180:183], v[96:111]
    v_max_f32 v87, 0, v87
    v_mul_f32 v80, v80, v88
    v_mul_f32 v81, v81, v89
    v_mul_f32 v82, v82, v90
    v_mul_f32 v83, v83, v91
    v_mul_f32 v84, v84, v92
    v_mul_f32 v85, v85, v93
    s_waitcnt vmcnt(14) lgkmcnt(8)
    v_mfma_f32_32x32x16_bf16 v[112:127], v[128:131], v[188:191], 0
    v_subrev_u32 v162, 0x10000, v162
    ds_read_b64_tr_b16 v[128:129], v162 offset:0
    ds_read_b64_tr_b16 v[130:131], v162 offset:512
    buffer_load_dwordx4 v[248:251], v1, s[16:19], s64 offen offset:3072 sc1
    v_mul_f32 v86, v86, v94
    v_mul_f32 v87, v87, v95
    v_cvt_pk_bf16_f32 v80, v80, v81
    v_cvt_pk_bf16_f32 v81, v82, v83
    v_mfma_f32_32x32x16_bf16 v[112:127], v[132:135], v[192:195], v[112:127]
    ds_read_b64_tr_b16 v[132:133], v162 offset:4096
    ds_read_b64_tr_b16 v[134:135], v162 offset:4608
    v_cvt_pk_bf16_f32 v82, v84, v85
    v_cvt_pk_bf16_f32 v83, v86, v87
    buffer_store_dwordx4 v[80:83], v1, s[16:19], s87 offen offset:2048
    v_max_f32 v96, 0, v96
    v_max_f32 v97, 0, v97
    v_mfma_f32_32x32x16_bf16 v[112:127], v[136:139], v[196:199], v[112:127]
    ds_read_b64_tr_b16 v[136:137], v162 offset:8192
    ds_read_b64_tr_b16 v[138:139], v162 offset:8704
    v_max_f32 v98, 0, v98
    v_max_f32 v99, 0, v99
    v_max_f32 v100, 0, v100
    v_max_f32 v101, 0, v101
    v_max_f32 v102, 0, v102
    v_mfma_f32_32x32x16_bf16 v[112:127], v[140:143], v[200:203], v[112:127]
    ds_read_b64_tr_b16 v[140:141], v162 offset:12288
    ds_read_b64_tr_b16 v[142:143], v162 offset:12800
    v_max_f32 v103, 0, v103
    v_mul_f32 v96, v96, v104
    v_mul_f32 v97, v97, v105
    v_mul_f32 v98, v98, v106
    v_mul_f32 v99, v99, v107
    s_waitcnt lgkmcnt(8)
    v_mfma_f32_32x32x16_bf16 v[64:79], v[144:147], v[188:191], 0
    v_subrev_u32 v163, 0x10000, v163
    ds_read_b64_tr_b16 v[144:145], v163 offset:0
    ds_read_b64_tr_b16 v[146:147], v163 offset:512
    v_mul_f32 v100, v100, v108
    v_mul_f32 v101, v101, v109
    v_mul_f32 v102, v102, v110
    v_mul_f32 v103, v103, v111
    v_cvt_pk_bf16_f32 v96, v96, v97
    v_mfma_f32_32x32x16_bf16 v[64:79], v[148:151], v[192:195], v[64:79]
    ds_read_b64_tr_b16 v[148:149], v163 offset:4096
    ds_read_b64_tr_b16 v[150:151], v163 offset:4608
    v_cvt_pk_bf16_f32 v97, v98, v99
    v_cvt_pk_bf16_f32 v98, v100, v101
    v_cvt_pk_bf16_f32 v99, v102, v103
    buffer_store_dwordx4 v[96:99], v1, s[16:19], s87 offen offset:3072
    v_mfma_f32_32x32x16_bf16 v[64:79], v[152:155], v[196:199], v[64:79]
    ds_read_b64_tr_b16 v[152:153], v163 offset:8192
    ds_read_b64_tr_b16 v[154:155], v163 offset:8704
    v_mfma_f32_32x32x16_bf16 v[64:79], v[156:159], v[200:203], v[64:79]
    ds_read_b64_tr_b16 v[156:157], v163 offset:12288
    ds_read_b64_tr_b16 v[158:159], v163 offset:12800
    s_waitcnt lgkmcnt(8)
    v_mfma_f32_32x32x16_bf16 v[80:95], v[128:131], v[188:191], 0
    ds_read_b64_tr_b16 v[128:129], v160 offset:16384
    ds_read_b64_tr_b16 v[130:131], v160 offset:16896
    v_mfma_f32_32x32x16_bf16 v[80:95], v[132:135], v[192:195], v[80:95]
    ds_read_b64_tr_b16 v[132:133], v161 offset:16384
    ds_read_b64_tr_b16 v[134:135], v161 offset:16896
    v_mfma_f32_32x32x16_bf16 v[80:95], v[136:139], v[196:199], v[80:95]
    ds_read_b64_tr_b16 v[136:137], v162 offset:16384
    ds_read_b64_tr_b16 v[138:139], v162 offset:16896
    v_mfma_f32_32x32x16_bf16 v[80:95], v[140:143], v[200:203], v[80:95]
    ds_read_b64_tr_b16 v[140:141], v163 offset:16384
    ds_read_b64_tr_b16 v[142:143], v163 offset:16896
    s_waitcnt lgkmcnt(8)
    v_mfma_f32_32x32x16_bf16 v[96:111], v[144:147], v[188:191], 0
    ds_read_b64_tr_b16 v[144:145], v160 offset:20480
    ds_read_b64_tr_b16 v[146:147], v160 offset:20992
    s_add_u32 s64, s64, 4096
    buffer_load_dwordx4 v[188:191], v1, s[16:19], s64 offen offset:0 sc1
    v_mfma_f32_32x32x16_bf16 v[96:111], v[148:151], v[192:195], v[96:111]
    ds_read_b64_tr_b16 v[148:149], v161 offset:20480
    ds_read_b64_tr_b16 v[150:151], v161 offset:20992
    buffer_load_dwordx4 v[192:195], v1, s[16:19], s64 offen offset:1024 sc1
    s_waitcnt vmcnt(14)
    v_add_f32 v164, v164, v165
    v_add_f32 v166, v166, v167
    v_mfma_f32_32x32x16_bf16 v[96:111], v[152:155], v[196:199], v[96:111]
    ds_read_b64_tr_b16 v[152:153], v162 offset:20480
    ds_read_b64_tr_b16 v[154:155], v162 offset:20992
    v_mfma_f32_32x32x16_bf16 v[96:111], v[156:159], v[200:203], v[96:111]
    ds_read_b64_tr_b16 v[156:157], v163 offset:20480
    ds_read_b64_tr_b16 v[158:159], v163 offset:20992
    s_waitcnt lgkmcnt(8)
    v_mfma_f32_32x32x16_bf16 v[112:127], v[128:131], v[204:207], v[112:127]
    ds_read_b64_tr_b16 v[128:129], v160 offset:24576
    ds_read_b64_tr_b16 v[130:131], v160 offset:25088
    buffer_load_dwordx4 v[196:199], v1, s[16:19], s64 offen offset:2048 sc1
    v_mfma_f32_32x32x16_bf16 v[64:79], v[132:135], v[204:207], v[64:79]
    ds_read_b64_tr_b16 v[132:133], v161 offset:24576
    ds_read_b64_tr_b16 v[134:135], v161 offset:25088
    buffer_load_dwordx4 v[200:203], v1, s[16:19], s64 offen offset:3072 sc1
    s_waitcnt vmcnt(15)
    v_add_f32 v168, v168, v169
    v_add_f32 v170, v170, v171
    v_mfma_f32_32x32x16_bf16 v[80:95], v[136:139], v[204:207], v[80:95]
    ds_read_b64_tr_b16 v[136:137], v162 offset:24576
    ds_read_b64_tr_b16 v[138:139], v162 offset:25088
    v_mfma_f32_32x32x16_bf16 v[96:111], v[140:143], v[204:207], v[96:111]
    ds_read_b64_tr_b16 v[140:141], v163 offset:24576
    ds_read_b64_tr_b16 v[142:143], v163 offset:25088
    s_waitcnt lgkmcnt(8)
    v_mfma_f32_32x32x16_bf16 v[112:127], v[144:147], v[208:211], v[112:127]
    ds_read_b64_tr_b16 v[144:145], v160 offset:28672
    ds_read_b64_tr_b16 v[146:147], v160 offset:29184
    s_add_u32 s64, s64, 4096
    buffer_load_dwordx4 v[204:207], v1, s[16:19], s64 offen offset:0 sc1
    v_mfma_f32_32x32x16_bf16 v[64:79], v[148:151], v[208:211], v[64:79]
    ds_read_b64_tr_b16 v[148:149], v161 offset:28672
    ds_read_b64_tr_b16 v[150:151], v161 offset:29184
    v_add_f32 v164, v164, v166
    v_add_f32 v168, v168, v170
    v_mfma_f32_32x32x16_bf16 v[80:95], v[152:155], v[208:211], v[80:95]
    ds_read_b64_tr_b16 v[152:153], v162 offset:28672
    ds_read_b64_tr_b16 v[154:155], v162 offset:29184
    v_mfma_f32_32x32x16_bf16 v[96:111], v[156:159], v[208:211], v[96:111]
    ds_read_b64_tr_b16 v[156:157], v163 offset:28672
    ds_read_b64_tr_b16 v[158:159], v163 offset:29184
    s_waitcnt lgkmcnt(8)
    v_mfma_f32_32x32x16_bf16 v[112:127], v[128:131], v[212:215], v[112:127]
    ds_read_b64_tr_b16 v[128:129], v160 offset:32768
    ds_read_b64_tr_b16 v[130:131], v160 offset:33280
    buffer_load_dwordx4 v[208:211], v1, s[16:19], s64 offen offset:1024 sc1
    v_mfma_f32_32x32x16_bf16 v[64:79], v[132:135], v[212:215], v[64:79]
    ds_read_b64_tr_b16 v[132:133], v161 offset:32768
    ds_read_b64_tr_b16 v[134:135], v161 offset:33280
    v_add_f32 v164, v164, v168
    v_mov_b32 v165, v164
    v_mfma_f32_32x32x16_bf16 v[80:95], v[136:139], v[212:215], v[80:95]
    ds_read_b64_tr_b16 v[136:137], v162 offset:32768
    ds_read_b64_tr_b16 v[138:139], v162 offset:33280
    v_mfma_f32_32x32x16_bf16 v[96:111], v[140:143], v[212:215], v[96:111]
    ds_read_b64_tr_b16 v[140:141], v163 offset:32768
    ds_read_b64_tr_b16 v[142:143], v163 offset:33280
    s_waitcnt lgkmcnt(8)
    v_mfma_f32_32x32x16_bf16 v[112:127], v[144:147], v[216:219], v[112:127]
    ds_read_b64_tr_b16 v[144:145], v160 offset:36864
    ds_read_b64_tr_b16 v[146:147], v160 offset:37376
    buffer_load_dwordx4 v[212:215], v1, s[16:19], s64 offen offset:2048 sc1
    v_mfma_f32_32x32x16_bf16 v[64:79], v[148:151], v[216:219], v[64:79]
    ds_read_b64_tr_b16 v[148:149], v161 offset:36864
    ds_read_b64_tr_b16 v[150:151], v161 offset:37376
    v_permlane32_swap_b32 v164, v165
    v_mul_f32 v164, 0x3b000000, v164
    v_mfma_f32_32x32x16_bf16 v[80:95], v[152:155], v[216:219], v[80:95]
    ds_read_b64_tr_b16 v[152:153], v162 offset:36864
    ds_read_b64_tr_b16 v[154:155], v162 offset:37376
    v_mfma_f32_32x32x16_bf16 v[96:111], v[156:159], v[216:219], v[96:111]
    ds_read_b64_tr_b16 v[156:157], v163 offset:36864
    ds_read_b64_tr_b16 v[158:159], v163 offset:37376
    s_waitcnt vmcnt(17) lgkmcnt(8)
    v_mfma_f32_32x32x16_bf16 v[112:127], v[128:131], v[220:223], v[112:127]
    ds_read_b64_tr_b16 v[128:129], v160 offset:40960
    ds_read_b64_tr_b16 v[130:131], v160 offset:41472
    buffer_load_dwordx4 v[216:219], v1, s[16:19], s64 offen offset:3072 sc1
    v_mfma_f32_32x32x16_bf16 v[64:79], v[132:135], v[220:223], v[64:79]
    ds_read_b64_tr_b16 v[132:133], v161 offset:40960
    ds_read_b64_tr_b16 v[134:135], v161 offset:41472
    v_cvt_pk_bf16_f32 v180, -v164, -v164
    v_mov_b32 v181, v180
    v_mfma_f32_32x32x16_bf16 v[80:95], v[136:139], v[220:223], v[80:95]
    ds_read_b64_tr_b16 v[136:137], v162 offset:40960
    ds_read_b64_tr_b16 v[138:139], v162 offset:41472
    v_mfma_f32_32x32x16_bf16 v[96:111], v[140:143], v[220:223], v[96:111]
    ds_read_b64_tr_b16 v[140:141], v163 offset:40960
    ds_read_b64_tr_b16 v[142:143], v163 offset:41472
    v_mov_b32 v252, 17
    s_waitcnt vmcnt(8)
    s_mov_b64 exec, 1
    s_cmp_lg_u32 s50, 0
    s_cbranch_scc1 L_pub_177
    buffer_store_dword v252, off, s[16:19], s52
L_pur_178:
    s_mov_b64 exec, -1
    s_waitcnt lgkmcnt(8)
    v_mfma_f32_32x32x16_bf16 v[112:127], v[144:147], v[224:227], v[112:127]
    ds_read_b64_tr_b16 v[144:145], v160 offset:45056
    ds_read_b64_tr_b16 v[146:147], v160 offset:45568
    s_add_u32 s64, s64, 4096
    buffer_load_dwordx4 v[220:223], v1, s[16:19], s64 offen offset:0 sc1
    v_mfma_f32_32x32x16_bf16 v[64:79], v[148:151], v[224:227], v[64:79]
    ds_read_b64_tr_b16 v[148:149], v161 offset:45056
    ds_read_b64_tr_b16 v[150:151], v161 offset:45568
    v_mov_b32 v182, v180
    v_mov_b32 v183, v180
    v_mfma_f32_32x32x16_bf16 v[80:95], v[152:155], v[224:227], v[80:95]
    ds_read_b64_tr_b16 v[152:153], v162 offset:45056
    ds_read_b64_tr_b16 v[154:155], v162 offset:45568
    v_mfma_f32_32x32x16_bf16 v[96:111], v[156:159], v[224:227], v[96:111]
    ds_read_b64_tr_b16 v[156:157], v163 offset:45056
    ds_read_b64_tr_b16 v[158:159], v163 offset:45568
    s_waitcnt lgkmcnt(8)
    v_mfma_f32_32x32x16_bf16 v[112:127], v[128:131], v[228:231], v[112:127]
    ds_read_b64_tr_b16 v[128:129], v160 offset:49152
    ds_read_b64_tr_b16 v[130:131], v160 offset:49664
    buffer_load_dwordx4 v[224:227], v1, s[16:19], s64 offen offset:1024 sc1
    v_mfma_f32_32x32x16_bf16 v[64:79], v[132:135], v[228:231], v[64:79]
    ds_read_b64_tr_b16 v[132:133], v161 offset:49152
    ds_read_b64_tr_b16 v[134:135], v161 offset:49664
    v_mfma_f32_32x32x16_bf16 v[80:95], v[136:139], v[228:231], v[80:95]
    ds_read_b64_tr_b16 v[136:137], v162 offset:49152
    ds_read_b64_tr_b16 v[138:139], v162 offset:49664
    v_mfma_f32_32x32x16_bf16 v[96:111], v[140:143], v[228:231], v[96:111]
    ds_read_b64_tr_b16 v[140:141], v163 offset:49152
    ds_read_b64_tr_b16 v[142:143], v163 offset:49664
    s_waitcnt lgkmcnt(8)
    v_mfma_f32_32x32x16_bf16 v[112:127], v[144:147], v[232:235], v[112:127]
    ds_read_b64_tr_b16 v[144:145], v160 offset:53248
    ds_read_b64_tr_b16 v[146:147], v160 offset:53760
    buffer_load_dwordx4 v[228:231], v1, s[16:19], s64 offen offset:2048 sc1
    v_mfma_f32_32x32x16_bf16 v[64:79], v[148:151], v[232:235], v[64:79]
    ds_read_b64_tr_b16 v[148:149], v161 offset:53248
    ds_read_b64_tr_b16 v[150:151], v161 offset:53760
    v_mfma_f32_32x32x16_bf16 v[80:95], v[152:155], v[232:235], v[80:95]
    ds_read_b64_tr_b16 v[152:153], v162 offset:53248
    ds_read_b64_tr_b16 v[154:155], v162 offset:53760
    v_mfma_f32_32x32x16_bf16 v[96:111], v[156:159], v[232:235], v[96:111]
    ds_read_b64_tr_b16 v[156:157], v163 offset:53248
    ds_read_b64_tr_b16 v[158:159], v163 offset:53760
    s_waitcnt lgkmcnt(8)
    v_mfma_f32_32x32x16_bf16 v[112:127], v[128:131], v[236:239], v[112:127]
    ds_read_b64_tr_b16 v[128:129], v160 offset:57344
    ds_read_b64_tr_b16 v[130:131], v160 offset:57856
    buffer_load_dwordx4 v[232:235], v1, s[16:19], s64 offen offset:3072 sc1
    v_mfma_f32_32x32x16_bf16 v[64:79], v[132:135], v[236:239], v[64:79]
    ds_read_b64_tr_b16 v[132:133], v161 offset:57344
    ds_read_b64_tr_b16 v[134:135], v161 offset:57856
    v_mfma_f32_32x32x16_bf16 v[80:95], v[136:139], v[236:239], v[80:95]
    ds_read_b64_tr_b16 v[136:137], v162 offset:57344
    ds_read_b64_tr_b16 v[138:139], v162 offset:57856
    v_mfma_f32_32x32x16_bf16 v[96:111], v[140:143], v[236:239], v[96:111]
    ds_read_b64_tr_b16 v[140:141], v163 offset:57344
    ds_read_b64_tr_b16 v[142:143], v163 offset:57856
    s_waitcnt lgkmcnt(8)
    v_mfma_f32_32x32x16_bf16 v[112:127], v[144:147], v[240:243], v[112:127]
    ds_read_b64_tr_b16 v[144:145], v160 offset:61440
    ds_read_b64_tr_b16 v[146:147], v160 offset:61952
    s_add_u32 s64, s64, 4096
    buffer_load_dwordx4 v[236:239], v1, s[16:19], s64 offen offset:0 sc1
    v_mfma_f32_32x32x16_bf16 v[64:79], v[148:151], v[240:243], v[64:79]
    ds_read_b64_tr_b16 v[148:149], v161 offset:61440
    ds_read_b64_tr_b16 v[150:151], v161 offset:61952
    v_mfma_f32_32x32x16_bf16 v[80:95], v[152:155], v[240:243], v[80:95]
    ds_read_b64_tr_b16 v[152:153], v162 offset:61440
    ds_read_b64_tr_b16 v[154:155], v162 offset:61952
    v_mfma_f32_32x32x16_bf16 v[96:111], v[156:159], v[240:243], v[96:111]
    ds_read_b64_tr_b16 v[156:157], v163 offset:61440
    ds_read_b64_tr_b16 v[158:159], v163 offset:61952
    s_waitcnt lgkmcnt(8)
    v_mfma_f32_32x32x16_bf16 v[112:127], v[128:131], v[244:247], v[112:127]
    v_add_u32 v160, 0x10000, v160
    ds_read_b64_tr_b16 v[128:129], v160 offset:0
    ds_read_b64_tr_b16 v[130:131], v160 offset:512
    buffer_load_dwordx4 v[240:243], v1, s[16:19], s64 offen offset:1024 sc1
    v_mfma_f32_32x32x16_bf16 v[64:79], v[132:135], v[244:247], v[64:79]
    v_add_u32 v161, 0x10000, v161
    ds_read_b64_tr_b16 v[132:133], v161 offset:0
    ds_read_b64_tr_b16 v[134:135], v161 offset:512
    v_mfma_f32_32x32x16_bf16 v[80:95], v[136:139], v[244:247], v[80:95]
    v_add_u32 v162, 0x10000, v162
    ds_read_b64_tr_b16 v[136:137], v162 offset:0
    ds_read_b64_tr_b16 v[138:139], v162 offset:512
    v_mfma_f32_32x32x16_bf16 v[96:111], v[140:143], v[244:247], v[96:111]
    v_add_u32 v163, 0x10000, v163
    ds_read_b64_tr_b16 v[140:141], v163 offset:0
    ds_read_b64_tr_b16 v[142:143], v163 offset:512
    s_waitcnt lgkmcnt(8)
    v_mfma_f32_32x32x16_bf16 v[112:127], v[144:147], v[248:251], v[112:127]
    ds_read_b64_tr_b16 v[144:145], v160 offset:4096
    ds_read_b64_tr_b16 v[146:147], v160 offset:4608
    buffer_load_dwordx4 v[244:247], v1, s[16:19], s64 offen offset:2048 sc1
    v_mfma_f32_32x32x16_bf16 v[64:79], v[148:151], v[248:251], v[64:79]
    ds_read_b64_tr_b16 v[148:149], v161 offset:4096
    ds_read_b64_tr_b16 v[150:151], v161 offset:4608
    v_mfma_f32_32x32x16_bf16 v[80:95], v[152:155], v[248:251], v[80:95]
    ds_read_b64_tr_b16 v[152:153], v162 offset:4096
    ds_read_b64_tr_b16 v[154:155], v162 offset:4608
    v_mfma_f32_32x32x16_bf16 v[96:111], v[156:159], v[248:251], v[96:111]
    ds_read_b64_tr_b16 v[156:157], v163 offset:4096
    ds_read_b64_tr_b16 v[158:159], v163 offset:4608
    s_waitcnt vmcnt(15) lgkmcnt(8)
    v_mfma_f32_32x32x16_bf16 v[112:127], v[128:131], v[188:191], v[112:127]
    ds_read_b64_tr_b16 v[128:129], v160 offset:8192
    ds_read_b64_tr_b16 v[130:131], v160 offset:8704
    buffer_load_dwordx4 v[248:251], v1, s[16:19], s64 offen offset:3072 sc1
    v_mfma_f32_32x32x16_bf16 v[64:79], v[132:135], v[188:191], v[64:79]
    ds_read_b64_tr_b16 v[132:133], v161 offset:8192
    ds_read_b64_tr_b16 v[134:135], v161 offset:8704
    v_mfma_f32_32x32x16_bf16 v[80:95], v[136:139], v[188:191], v[80:95]
    ds_read_b64_tr_b16 v[136:137], v162 offset:8192
    ds_read_b64_tr_b16 v[138:139], v162 offset:8704
    v_mfma_f32_32x32x16_bf16 v[96:111], v[140:143], v[188:191], v[96:111]
    ds_read_b64_tr_b16 v[140:141], v163 offset:8192
    ds_read_b64_tr_b16 v[142:143], v163 offset:8704
    s_lshl_b32 s90, s45, 2
    s_add_u32 s90, s90, s46
    s_and_b32 s90, s90, 127
    s_cbranch_scc0 L_wb_179
    buffer_load_dword v185, off, s[16:19], s52
L_wr_180:
    s_waitcnt vmcnt(16) lgkmcnt(8)
    v_mfma_f32_32x32x16_bf16 v[112:127], v[144:147], v[192:195], v[112:127]
    ds_read_b64_tr_b16 v[144:145], v160 offset:12288
    ds_read_b64_tr_b16 v[146:147], v160 offset:12800
    v_mfma_f32_32x32x16_bf16 v[64:79], v[148:151], v[192:195], v[64:79]
    ds_read_b64_tr_b16 v[148:149], v161 offset:12288
    ds_read_b64_tr_b16 v[150:151], v161 offset:12800
    v_mfma_f32_32x32x16_bf16 v[80:95], v[152:155], v[192:195], v[80:95]
    ds_read_b64_tr_b16 v[152:153], v162 offset:12288
    ds_read_b64_tr_b16 v[154:155], v162 offset:12800
    v_mfma_f32_32x32x16_bf16 v[96:111], v[156:159], v[192:195], v[96:111]
    ds_read_b64_tr_b16 v[156:157], v163 offset:12288
    ds_read_b64_tr_b16 v[158:159], v163 offset:12800
    s_waitcnt vmcnt(15) lgkmcnt(8)
    v_mfma_f32_32x32x16_bf16 v[112:127], v[128:131], v[196:199], v[112:127]
    ds_read_b64_tr_b16 v[128:129], v160 offset:16384
    ds_read_b64_tr_b16 v[130:131], v160 offset:16896
    v_mfma_f32_32x32x16_bf16 v[64:79], v[132:135], v[196:199], v[64:79]
    ds_read_b64_tr_b16 v[132:133], v161 offset:16384
    ds_read_b64_tr_b16 v[134:135], v161 offset:16896
    v_mfma_f32_32x32x16_bf16 v[80:95], v[136:139], v[196:199], v[80:95]
    ds_read_b64_tr_b16 v[136:137], v162 offset:16384
    ds_read_b64_tr_b16 v[138:139], v162 offset:16896
    v_mfma_f32_32x32x16_bf16 v[96:111], v[140:143], v[196:199], v[96:111]
    ds_read_b64_tr_b16 v[140:141], v163 offset:16384
    ds_read_b64_tr_b16 v[142:143], v163 offset:16896
    s_waitcnt vmcnt(14) lgkmcnt(8)
    v_mfma_f32_32x32x16_bf16 v[112:127], v[144:147], v[200:203], v[112:127]
    ds_read_b64_tr_b16 v[144:145], v160 offset:20480
    ds_read_b64_tr_b16 v[146:147], v160 offset:20992
    v_mfma_f32_32x32x16_bf16 v[64:79], v[148:151], v[200:203], v[64:79]
    ds_read_b64_tr_b16 v[148:149], v161 offset:20480
    ds_read_b64_tr_b16 v[150:151], v161 offset:20992
    v_mfma_f32_32x32x16_bf16 v[80:95], v[152:155], v[200:203], v[80:95]
    ds_read_b64_tr_b16 v[152:153], v162 offset:20480
    ds_read_b64_tr_b16 v[154:155], v162 offset:20992
    v_mfma_f32_32x32x16_bf16 v[96:111], v[156:159], v[200:203], v[96:111]
    ds_read_b64_tr_b16 v[156:157], v163 offset:20480
    ds_read_b64_tr_b16 v[158:159], v163 offset:20992
    s_waitcnt vmcnt(13) lgkmcnt(8)
    v_mfma_f32_32x32x16_bf16 v[112:127], v[128:131], v[204:207], v[112:127]
    ds_read_b64_tr_b16 v[128:129], v160 offset:24576
    ds_read_b64_tr_b16 v[130:131], v160 offset:25088
    v_mfma_f32_32x32x16_bf16 v[64:79], v[132:135], v[204:207], v[64:79]
    ds_read_b64_tr_b16 v[132:133], v161 offset:24576
    ds_read_b64_tr_b16 v[134:135], v161 offset:25088
    v_mfma_f32_32x32x16_bf16 v[80:95], v[136:139], v[204:207], v[80:95]
    ds_read_b64_tr_b16 v[136:137], v162 offset:24576
    ds_read_b64_tr_b16 v[138:139], v162 offset:25088
    v_mfma_f32_32x32x16_bf16 v[96:111], v[140:143], v[204:207], v[96:111]
    ds_read_b64_tr_b16 v[140:141], v163 offset:24576
    ds_read_b64_tr_b16 v[142:143], v163 offset:25088
    s_waitcnt vmcnt(12) lgkmcnt(8)
    v_mfma_f32_32x32x16_bf16 v[112:127], v[144:147], v[208:211], v[112:127]
    ds_read_b64_tr_b16 v[144:145], v160 offset:28672
    ds_read_b64_tr_b16 v[146:147], v160 offset:29184
    v_mfma_f32_32x32x16_bf16 v[64:79], v[148:151], v[208:211], v[64:79]
    ds_read_b64_tr_b16 v[148:149], v161 offset:28672
    ds_read_b64_tr_b16 v[150:151], v161 offset:29184
    v_mfma_f32_32x32x16_bf16 v[80:95], v[152:155], v[208:211], v[80:95]
    ds_read_b64_tr_b16 v[152:153], v162 offset:28672
    ds_read_b64_tr_b16 v[154:155], v162 offset:29184
    v_mfma_f32_32x32x16_bf16 v[96:111], v[156:159], v[208:211], v[96:111]
    ds_read_b64_tr_b16 v[156:157], v163 offset:28672
    ds_read_b64_tr_b16 v[158:159], v163 offset:29184
    s_waitcnt vmcnt(11) lgkmcnt(8)
    v_mfma_f32_32x32x16_bf16 v[112:127], v[128:131], v[212:215], v[112:127]
    ds_read_b64_tr_b16 v[128:129], v160 offset:32768
    ds_read_b64_tr_b16 v[130:131], v160 offset:33280
    v_mfma_f32_32x32x16_bf16 v[64:79], v[132:135], v[212:215], v[64:79]
    ds_read_b64_tr_b16 v[132:133], v161 offset:32768
    ds_read_b64_tr_b16 v[134:135], v161 offset:33280
    v_mfma_f32_32x32x16_bf16 v[80:95], v[136:139], v[212:215], v[80:95]
    ds_read_b64_tr_b16 v[136:137], v162 offset:32768
    ds_read_b64_tr_b16 v[138:139], v162 offset:33280
    v_mfma_f32_32x32x16_bf16 v[96:111], v[140:143], v[212:215], v[96:111]
    ds_read_b64_tr_b16 v[140:141], v163 offset:32768
    ds_read_b64_tr_b16 v[142:143], v163 offset:33280
    s_waitcnt vmcnt(10) lgkmcnt(8)
    v_mfma_f32_32x32x16_bf16 v[112:127], v[144:147], v[216:219], v[112:127]
    ds_read_b64_tr_b16 v[144:145], v160 offset:36864
    ds_read_b64_tr_b16 v[146:147], v160 offset:37376
    v_mfma_f32_32x32x16_bf16 v[64:79], v[148:151], v[216:219], v[64:79]
    ds_read_b64_tr_b16 v[148:149], v161 offset:36864
    ds_read_b64_tr_b16 v[150:151], v161 offset:37376
    v_mfma_f32_32x32x16_bf16 v[80:95], v[152:155], v[216:219], v[80:95]
    ds_read_b64_tr_b16 v[152:153], v162 offset:36864
    ds_read_b64_tr_b16 v[154:155], v162 offset:37376
    v_mfma_f32_32x32x16_bf16 v[96:111], v[156:159], v[216:219], v[96:111]
    ds_read_b64_tr_b16 v[156:157], v163 offset:36864
    ds_read_b64_tr_b16 v[158:159], v163 offset:37376
    s_waitcnt vmcnt(8) lgkmcnt(8)
    v_mfma_f32_32x32x16_bf16 v[112:127], v[128:131], v[220:223], v[112:127]
    ds_read_b64_tr_b16 v[128:129], v160 offset:40960
    ds_read_b64_tr_b16 v[130:131], v160 offset:41472
    v_mfma_f32_32x32x16_bf16 v[64:79], v[132:135], v[220:223], v[64:79]
    ds_read_b64_tr_b16 v[132:133], v161 offset:40960
    ds_read_b64_tr_b16 v[134:135], v161 offset:41472
    v_mfma_f32_32x32x16_bf16 v[80:95], v[136:139], v[220:223], v[80:95]
    ds_read_b64_tr_b16 v[136:137], v162 offset:40960
    ds_read_b64_tr_b16 v[138:139], v162 offset:41472
    v_mfma_f32_32x32x16_bf16 v[96:111], v[140:143], v[220:223], v[96:111]
    ds_read_b64_tr_b16 v[140:141], v163 offset:40960
    ds_read_b64_tr_b16 v[142:143], v163 offset:41472
    s_waitcnt vmcnt(7) lgkmcnt(8)
    v_mfma_f32_32x32x16_bf16 v[112:127], v[144:147], v[224:227], v[112:127]
    ds_read_b64_tr_b16 v[144:145], v160 offset:45056
    ds_read_b64_tr_b16 v[146:147], v160 offset:45568
    v_mfma_f32_32x32x16_bf16 v[64:79], v[148:151], v[224:227], v[64:79]
    ds_read_b64_tr_b16 v[148:149], v161 offset:45056
    ds_read_b64_tr_b16 v[150:151], v161 offset:45568
    v_mfma_f32_32x32x16_bf16 v[80:95], v[152:155], v[224:227], v[80:95]
    ds_read_b64_tr_b16 v[152:153], v162 offset:45056
    ds_read_b64_tr_b16 v[154:155], v162 offset:45568
    v_mfma_f32_32x32x16_bf16 v[96:111], v[156:159], v[224:227], v[96:111]
    ds_read_b64_tr_b16 v[156:157], v163 offset:45056
    ds_read_b64_tr_b16 v[158:159], v163 offset:45568
    s_waitcnt vmcnt(6) lgkmcnt(8)
    v_mfma_f32_32x32x16_bf16 v[112:127], v[128:131], v[228:231], v[112:127]
    ds_read_b64_tr_b16 v[128:129], v160 offset:49152
    ds_read_b64_tr_b16 v[130:131], v160 offset:49664
    v_mfma_f32_32x32x16_bf16 v[64:79], v[132:135], v[228:231], v[64:79]
    ds_read_b64_tr_b16 v[132:133], v161 offset:49152
    ds_read_b64_tr_b16 v[134:135], v161 offset:49664
    v_mfma_f32_32x32x16_bf16 v[80:95], v[136:139], v[228:231], v[80:95]
    ds_read_b64_tr_b16 v[136:137], v162 offset:49152
    ds_read_b64_tr_b16 v[138:139], v162 offset:49664
    v_mfma_f32_32x32x16_bf16 v[96:111], v[140:143], v[228:231], v[96:111]
    ds_read_b64_tr_b16 v[140:141], v163 offset:49152
    ds_read_b64_tr_b16 v[142:143], v163 offset:49664
    buffer_load_dword v184, v22, s[16:19], s53 offen sc1
    s_waitcnt vmcnt(6) lgkmcnt(8)
    v_mfma_f32_32x32x16_bf16 v[112:127], v[144:147], v[232:235], v[112:127]
    ds_read_b64_tr_b16 v[144:145], v160 offset:53248
    ds_read_b64_tr_b16 v[146:147], v160 offset:53760
    v_mfma_f32_32x32x16_bf16 v[64:79], v[148:151], v[232:235], v[64:79]
    ds_read_b64_tr_b16 v[148:149], v160 offset:57344
    ds_read_b64_tr_b16 v[150:151], v160 offset:57856
    v_mfma_f32_32x32x16_bf16 v[80:95], v[152:155], v[232:235], v[80:95]
    ds_read_b64_tr_b16 v[152:153], v160 offset:61440
    ds_read_b64_tr_b16 v[154:155], v160 offset:61952
    v_mfma_f32_32x32x16_bf16 v[96:111], v[156:159], v[232:235], v[96:111]
    ds_read_b64_tr_b16 v[156:157], v161 offset:53248
    ds_read_b64_tr_b16 v[158:159], v161 offset:53760
    s_waitcnt vmcnt(5) lgkmcnt(8)
    v_mfma_f32_32x32x16_bf16 v[112:127], v[128:131], v[236:239], v[112:127]
    ds_read_b64_tr_b16 v[128:129], v161 offset:57344
    ds_read_b64_tr_b16 v[130:131], v161 offset:57856
    s_waitcnt vmcnt(0)
    v_cmp_gt_u32 vcc, 17, v184
    s_nop 1
    s_cbranch_vccnz L_poll_181
L_ok_182:
    s_cmp_lg_u32 s50, 0
    s_cbranch_scc1 L_acq_183
L_acr_184:
    s_add_u32 s80, s75, s61
    s_add_u32 s81, s80, 28672
    s_add_u32 s64, s82, 0
    s_and_b32 s64, s64, 3
    s_mul_i32 s64, s64, 7168
    s_add_u32 s64, s64, s80
    s_add_u32 s64, s64, s83
    buffer_load_dwordx4 v[188:191], v1, s[16:19], s64 offen offset:0 sc1
    v_mfma_f32_32x32x16_bf16 v[64:79], v[132:135], v[236:239], v[64:79]
    ds_read_b64_tr_b16 v[132:133], v161 offset:61440
    ds_read_b64_tr_b16 v[134:135], v161 offset:61952
    buffer_load_dwordx4 v[192:195], v1, s[16:19], s64 offen offset:1024 sc1
    v_mfma_f32_32x32x16_bf16 v[80:95], v[136:139], v[236:239], v[80:95]
    ds_read_b64_tr_b16 v[136:137], v162 offset:53248
    ds_read_b64_tr_b16 v[138:139], v162 offset:53760
    v_mfma_f32_32x32x16_bf16 v[96:111], v[140:143], v[236:239], v[96:111]
    ds_read_b64_tr_b16 v[140:141], v162 offset:57344
    ds_read_b64_tr_b16 v[142:143], v162 offset:57856
    s_waitcnt lgkmcnt(10)
    v_mfma_f32_32x32x16_bf16 v[112:127], v[144:147], v[240:243], v[112:127]
    ds_read_b64_tr_b16 v[144:145], v162 offset:61440
    ds_read_b64_tr_b16 v[146:147], v162 offset:61952
    buffer_load_dwordx4 v[196:199], v1, s[16:19], s64 offen offset:2048 sc1
    v_mfma_f32_32x32x16_bf16 v[112:127], v[148:151], v[244:247], v[112:127]
    ds_read_b64_tr_b16 v[148:149], v163 offset:53248
    ds_read_b64_tr_b16 v[150:151], v163 offset:53760
    v_mov_b32 v176, v24
    buffer_load_dwordx4 v[200:203], v1, s[16:19], s64 offen offset:3072 sc1
    v_mfma_f32_32x32x16_bf16 v[112:127], v[152:155], v[248:251], v[112:127]
    ds_read_b64_tr_b16 v[152:153], v163 offset:57344
    ds_read_b64_tr_b16 v[154:155], v163 offset:57856
    v_mfma_f32_32x32x16_bf16 v[112:127], v[176:179], v[180:183], v[112:127]
    s_waitcnt lgkmcnt(10)
    v_mfma_f32_32x32x16_bf16 v[64:79], v[156:159], v[240:243], v[64:79]
    ds_read_b64_tr_b16 v[156:157], v163 offset:61440
    ds_read_b64_tr_b16 v[158:159], v163 offset:61952
    s_add_u32 s64, s64, 4096
    s_cmp_eq_u32 s64, s81
    s_cmov_b32 s64, s80
    buffer_load_dwordx4 v[204:207], v1, s[16:19], s64 offen offset:0 sc1
    v_mfma_f32_32x32x16_bf16 v[64:79], v[128:131], v[244:247], v[64:79]
    v_mov_b32 v172, v25
    buffer_load_dwordx4 v[208:211], v1, s[16:19], s64 offen offset:1024 sc1
    v_max_f32 v112, 0, v112
    v_max_f32 v113, 0, v113
    v_max_f32 v114, 0, v114
    v_max_f32 v115, 0, v115
    v_max_f32 v116, 0, v116
    v_mfma_f32_32x32x16_bf16 v[64:79], v[132:135], v[248:251], v[64:79]
    v_max_f32 v117, 0, v117
    v_max_f32 v118, 0, v118
    v_max_f32 v119, 0, v119
    v_mul_f32 v112, v112, v120
    v_mul_f32 v113, v113, v121
    v_mul_f32 v114, v114, v122
    v_mul_f32 v115, v115, v123
    v_mfma_f32_32x32x16_bf16 v[64:79], v[172:175], v[180:183], v[64:79]
    v_mul_f32 v116, v116, v124
    v_mul_f32 v117, v117, v125
    v_mul_f32 v118, v118, v126
    v_mul_f32 v119, v119, v127
    v_cvt_pk_bf16_f32 v112, v112, v113
    v_cvt_pk_bf16_f32 v113, v114, v115
    v_cvt_pk_bf16_f32 v114, v116, v117
    s_waitcnt lgkmcnt(6)
    v_mfma_f32_32x32x16_bf16 v[80:95], v[136:139], v[240:243], v[80:95]
    buffer_load_dwordx4 v[212:215], v1, s[16:19], s64 offen offset:2048 sc1
    v_cvt_pk_bf16_f32 v115, v118, v119
    buffer_store_dwordx4 v[112:115], v1, s[16:19], s89 offen offset:0
    v_mfma_f32_32x32x16_bf16 v[80:95], v[140:143], v[244:247], v[80:95]
    v_mov_b32 v176, v26
    s_add_u32 s64, s64, 3072
    s_cmp_eq_u32 s64, s81
    s_cmov_b32 s64, s80
    buffer_load_dwordx4 v[216:219], v1, s[16:19], s64 offen offset:0 sc1
    v_max_f32 v64, 0, v64
    v_max_f32 v65, 0, v65
    v_max_f32 v66, 0, v66
    v_max_f32 v67, 0, v67
    v_max_f32 v68, 0, v68
    v_mfma_f32_32x32x16_bf16 v[80:95], v[144:147], v[248:251], v[80:95]
    v_max_f32 v69, 0, v69
    v_max_f32 v70, 0, v70
    v_max_f32 v71, 0, v71
    v_mul_f32 v64, v64, v72
    v_mul_f32 v65, v65, v73
    v_mul_f32 v66, v66, v74
    v_mul_f32 v67, v67, v75
    v_mfma_f32_32x32x16_bf16 v[80:95], v[176:179], v[180:183], v[80:95]
    v_mul_f32 v68, v68, v76
    v_mul_f32 v69, v69, v77
    v_mul_f32 v70, v70, v78
    v_mul_f32 v71, v71, v79
    v_cvt_pk_bf16_f32 v64, v64, v65
    v_cvt_pk_bf16_f32 v65, v66, v67
    v_cvt_pk_bf16_f32 v66, v68, v69
    s_waitcnt lgkmcnt(0)
    v_mfma_f32_32x32x16_bf16 v[96:111], v[148:151], v[240:243], v[96:111]
    buffer_load_dwordx4 v[220:223], v1, s[16:19], s64 offen offset:1024 sc1
    v_cvt_pk_bf16_f32 v67, v70, v71
    buffer_store_dwordx4 v[64:67], v1, s[16:19], s89 offen offset:1024
    v_mfma_f32_32x32x16_bf16 v[96:111], v[152:155], v[244:247], v[96:111]
    v_mov_b32 v172, v27
    buffer_load_dwordx4 v[224:227], v1, s[16:19], s64 offen offset:2048 sc1
    v_max_f32 v80, 0, v80
    v_max_f32 v81, 0, v81
    v_max_f32 v82, 0, v82
    v_max_f32 v83, 0, v83
    v_max_f32 v84, 0, v84
    v_mfma_f32_32x32x16_bf16 v[96:111], v[156:159], v[248:251], v[96:111]
    v_max_f32 v85, 0, v85
    v_max_f32 v86, 0, v86
    v_max_f32 v87, 0, v87
    v_mul_f32 v80, v80, v88
    v_mul_f32 v81, v81, v89
    v_mul_f32 v82, v82, v90
    v_mul_f32 v83, v83, v91
    v_mfma_f32_32x32x16_bf16 v[96:111], v[172:175], v[180:183], v[96:111]
    v_mul_f32 v84, v84, v92
    v_mul_f32 v85, v85, v93
    v_mul_f32 v86, v86, v94
    v_mul_f32 v87, v87, v95
    v_cvt_pk_bf16_f32 v80, v80, v81
    v_cvt_pk_bf16_f32 v81, v82, v83
    v_cvt_pk_bf16_f32 v82, v84, v85
    v_cvt_pk_bf16_f32 v83, v86, v87
    buffer_store_dwordx4 v[80:83], v1, s[16:19], s89 offen offset:2048
    s_nop 2
    v_max_f32 v96, 0, v96
    v_max_f32 v97, 0, v97
    v_max_f32 v98, 0, v98
    v_max_f32 v99, 0, v99
    v_max_f32 v100, 0, v100
    v_max_f32 v101, 0, v101
    v_max_f32 v102, 0, v102
    v_max_f32 v103, 0, v103
    v_mul_f32 v96, v96, v104
    v_mul_f32 v97, v97, v105
    v_mul_f32 v98, v98, v106
    v_mul_f32 v99, v99, v107
    v_mul_f32 v100, v100, v108
    v_mul_f32 v101, v101, v109
    v_mul_f32 v102, v102, v110
    v_mul_f32 v103, v103, v111
    v_cvt_pk_bf16_f32 v96, v96, v97
    v_cvt_pk_bf16_f32 v97, v98, v99
    v_cvt_pk_bf16_f32 v98, v100, v101
    v_cvt_pk_bf16_f32 v99, v102, v103
    buffer_store_dwordx4 v[96:99], v1, s[16:19], s89 offen offset:3072
    s_waitcnt lgkmcnt(0)
    s_nop 2
L_dn1:
    buffer_load_dwordx4 v[228:231], v1, s[16:19], s64 offen offset:3072 sc1
    s_add_u32 s64, s64, 4096
    s_cmp_eq_u32 s64, s81
    s_cmov_b32 s64, s80
    buffer_load_dwordx4 v[232:235], v1, s[16:19], s64 offen offset:0 sc1
    s_add_u32 s86, s61, 149504
    buffer_load_dwordx4 v[96:99], v20, s[16:19], s86 offen sc1
    buffer_load_dwordx4 v[100:103], v20, s[16:19], s86 offen offset:16 sc1
    s_waitcnt vmcnt(15)
    v_mfma_f32_32x32x16_bf16 v[64:79], a[0:3], v[188:191], 0
    buffer_load_dwordx4 v[236:239], v1, s[16:19], s64 offen offset:1024 sc1
    v_mfma_f32_32x32x16_bf16 v[80:95], a[4:7], v[188:191], 0
    s_waitcnt vmcnt(15)
    v_mfma_f32_32x32x16_bf16 v[64:79], a[8:11], v[192:195], v[64:79]
    buffer_load_dwordx4 v[240:243], v1, s[16:19], s64 offen offset:2048 sc1
    v_mfma_f32_32x32x16_bf16 v[80:95], a[12:15], v[192:195], v[80:95]
    s_waitcnt vmcnt(15)
    v_mfma_f32_32x32x16_bf16 v[64:79], a[16:19], v[196:199], v[64:79]
    s_add_u32 s64, s64, 3072
    s_cmp_eq_u32 s64, s81
    s_cmov_b32 s64, s80
    buffer_load_dwordx4 v[244:247], v1, s[16:19], s64 offen offset:0 sc1
    v_mfma_f32_32x32x16_bf16 v[80:95], a[20:23], v[196:199], v[80:95]
    s_waitcnt vmcnt(15)
    v_mfma_f32_32x32x16_bf16 v[64:79], a[24:27], v[200:203], v[64:79]
    buffer_load_dwordx4 v[248:251], v1, s[16:19], s64 offen offset:1024 sc1
    v_mfma_f32_32x32x16_bf16 v[80:95], a[28:31], v[200:203], v[80:95]
    v_mov_b32 v252, 18
    s_waitcnt vmcnt(8)
    s_mov_b64 exec, 1
    s_cmp_lg_u32 s50, 0
    s_cbranch_scc1 L_pub_185
    buffer_store_dword v252, off, s[16:19], s52
L_pur_186:
    s_mov_b64 exec, -1
    v_mfma_f32_32x32x16_bf16 v[64:79], a[32:35], v[204:207], v[64:79]
    buffer_load_dwordx4 v[112:115], v1, s[16:19], s64 offen offset:2048 sc1
    v_mfma_f32_32x32x16_bf16 v[80:95], a[36:39], v[204:207], v[80:95]
    v_mfma_f32_32x32x16_bf16 v[64:79], a[40:43], v[208:211], v[64:79]
    buffer_load_dwordx4 v[116:119], v1, s[16:19], s64 offen offset:3072 sc1
    v_mfma_f32_32x32x16_bf16 v[80:95], a[44:47], v[208:211], v[80:95]
    v_mfma_f32_32x32x16_bf16 v[64:79], a[48:51], v[212:215], v[64:79]
    s_add_u32 s64, s64, 4096
    s_cmp_eq_u32 s64, s81
    s_cmov_b32 s64, s80
    buffer_load_dwordx4 v[120:123], v1, s[16:19], s64 offen offset:0 sc1
    v_mfma_f32_32x32x16_bf16 v[80:95], a[52:55], v[212:215], v[80:95]
    v_mfma_f32_32x32x16_bf16 v[64:79], a[56:59], v[216:219], v[64:79]
    buffer_load_dwordx4 v[124:127], v1, s[16:19], s64 offen offset:1024 sc1
    v_mfma_f32_32x32x16_bf16 v[80:95], a[60:63], v[216:219], v[80:95]
    v_mfma_f32_32x32x16_bf16 v[64:79], a[64:67], v[220:223], v[64:79]
    s_waitcnt vmcnt(10)
    v_add_f32 v96, v96, v97
    v_add_f32 v98, v98, v99
    buffer_load_dwordx4 v[128:131], v1, s[16:19], s64 offen offset:2048 sc1
    v_mfma_f32_32x32x16_bf16 v[80:95], a[68:71], v[220:223], v[80:95]
    s_waitcnt vmcnt(10)
    v_add_f32 v100, v100, v101
    v_add_f32 v102, v102, v103
    v_mfma_f32_32x32x16_bf16 v[64:79], a[72:75], v[224:227], v[64:79]
    v_add_f32 v96, v96, v98
    v_add_f32 v100, v100, v102
    s_add_u32 s64, s64, 3072
    s_cmp_eq_u32 s64, s81
    s_cmov_b32 s64, s80
    buffer_load_dwordx4 v[132:135], v1, s[16:19], s64 offen offset:0 sc1
    v_mfma_f32_32x32x16_bf16 v[80:95], a[76:79], v[224:227], v[80:95]
    v_add_f32 v96, v96, v100
    v_and_b32 v100, 8, v0
    v_mfma_f32_32x32x16_bf16 v[64:79], a[80:83], v[228:231], v[64:79]
    v_mov_b32_dpp v97, v96 row_ror:8 row_mask:0xf bank_mask:0xf
    v_cmp_ne_u32 vcc, 0, v100
    s_nop 1
    v_cndmask_b32 v98, v96, v97, vcc
    v_cndmask_b32 v99, v97, v96, vcc
    buffer_load_dwordx4 v[136:139], v1, s[16:19], s64 offen offset:1024 sc1
    v_mfma_f32_32x32x16_bf16 v[80:95], a[84:87], v[228:231], v[80:95]
    v_mul_f32 v98, 0x3b000000, v98
    v_mul_f32 v99, 0x3b000000, v99
    buffer_load_dword v106, v22, s[16:19], s53 offen sc1
    v_mfma_f32_32x32x16_bf16 v[64:79], a[88:91], v[232:235], v[64:79]
    v_fma_f32 v99, -v98, v98, v99
    v_max_f32 v99, 0, v99
    buffer_load_dwordx4 v[140:143], v1, s[16:19], s64 offen offset:2048 sc1
    v_mfma_f32_32x32x16_bf16 v[80:95], a[92:95], v[232:235], v[80:95]
    v_cvt_pk_bf16_f32 v100, v99, v99
    v_and_b32 v100, 0xffff0000, v100
    s_waitcnt vmcnt(13)
    v_mfma_f32_32x32x16_bf16 v[64:79], a[96:99], v[236:239], v[64:79]
    v_add_f32 v100, 0x3727c5ac, v100
    v_cvt_pk_bf16_f32 v100, v100, v100
    buffer_load_dwordx4 v[144:147], v1, s[16:19], s64 offen offset:3072 sc1
    v_mfma_f32_32x32x16_bf16 v[80:95], a[100:103], v[236:239], v[80:95]
    v_and_b32 v100, 0xffff0000, v100
    v_sqrt_f32 v100, v100
    s_waitcnt vmcnt(13)
    v_mfma_f32_32x32x16_bf16 v[64:79], a[104:107], v[240:243], v[64:79]
    v_cvt_pk_bf16_f32 v100, v100, v100
    v_and_b32 v100, 0xffff0000, v100
    s_add_u32 s64, s64, 4096
    s_cmp_eq_u32 s64, s81
    s_cmov_b32 s64, s80
    buffer_load_dwordx4 v[148:151], v1, s[16:19], s64 offen offset:0 sc1
    v_mfma_f32_32x32x16_bf16 v[80:95], a[108:111], v[240:243], v[80:95]
    v_rcp_f32 v104, v100
    s_nop 0
    v_mul_f32 v104, v104, v104
    s_waitcnt vmcnt(13)
    v_mfma_f32_32x32x16_bf16 v[64:79], a[112:115], v[244:247], v[64:79]
    buffer_load_dwordx4 v[188:191], v1, s[16:19], s64 offen offset:1024 sc1
    v_mfma_f32_32x32x16_bf16 v[80:95], a[116:119], v[244:247], v[80:95]
    s_waitcnt vmcnt(13)
    v_mfma_f32_32x32x16_bf16 v[64:79], a[120:123], v[248:251], v[64:79]
    buffer_load_dwordx4 v[192:195], v1, s[16:19], s64 offen offset:2048 sc1
    v_mfma_f32_32x32x16_bf16 v[80:95], a[124:127], v[248:251], v[80:95]
    s_waitcnt vmcnt(12)
    v_mfma_f32_32x32x16_bf16 v[64:79], a[128:131], v[112:115], v[64:79]
    v_mfma_f32_32x32x16_bf16 v[80:95], a[132:135], v[112:115], v[80:95]
    s_waitcnt vmcnt(5)
    v_cmp_gt_u32 vcc, 18, v106
    s_nop 1
    s_cbranch_vccnz L_poll_187
L_ok_188:
    s_cmp_lg_u32 s50, 0
    s_cbranch_scc1 L_acq_189
L_acr_190:
    s_add_u32 s86, s62, 149504
    buffer_load_dwordx4 v[96:99], v20, s[16:19], s86 offen sc1
    buffer_load_dwordx4 v[100:103], v20, s[16:19], s86 offen offset:16 sc1
    v_mfma_f32_32x32x16_bf16 v[64:79], a[136:139], v[116:119], v[64:79]
    s_add_u32 s80, s75, s62
    s_add_u32 s81, s80, 28672
    s_add_u32 s64, s82, 0
    s_and_b32 s64, s64, 3
    s_mul_i32 s64, s64, 7168
    s_add_u32 s64, s64, s80
    s_add_u32 s64, s64, s83
    buffer_load_dwordx4 v[196:199], v1, s[16:19], s64 offen offset:0 sc1
    buffer_load_dwordx4 v[200:203], v1, s[16:19], s64 offen offset:1024 sc1
    v_mfma_f32_32x32x16_bf16 v[80:95], a[140:143], v[116:119], v[80:95]
    v_mfma_f32_32x32x16_bf16 v[64:79], a[144:147], v[120:123], v[64:79]
    buffer_load_dwordx4 v[204:207], v1, s[16:19], s64 offen offset:2048 sc1
    buffer_load_dwordx4 v[208:211], v1, s[16:19], s64 offen offset:3072 sc1
    v_mfma_f32_32x32x16_bf16 v[80:95], a[148:151], v[120:123], v[80:95]
    v_mfma_f32_32x32x16_bf16 v[64:79], a[152:155], v[124:127], v[64:79]
    s_add_u32 s64, s64, 4096
    s_cmp_eq_u32 s64, s81
    s_cmov_b32 s64, s80
    buffer_load_dwordx4 v[212:215], v1, s[16:19], s64 offen offset:0 sc1
    v_mfma_f32_32x32x16_bf16 v[80:95], a[156:159], v[124:127], v[80:95]
    v_mfma_f32_32x32x16_bf16 v[64:79], a[160:163], v[128:131], v[64:79]
    buffer_load_dwordx4 v[216:219], v1, s[16:19], s64 offen offset:1024 sc1
    buffer_load_dwordx4 v[220:223], v1, s[16:19], s64 offen offset:2048 sc1
    v_mfma_f32_32x32x16_bf16 v[80:95], a[164:167], v[128:131], v[80:95]
    v_mfma_f32_32x32x16_bf16 v[64:79], a[168:171], v[132:135], v[64:79]
    s_add_u32 s64, s64, 3072
    s_cmp_eq_u32 s64, s81
    s_cmov_b32 s64, s80
    buffer_load_dwordx4 v[224:227], v1, s[16:19], s64 offen offset:0 sc1
    v_mfma_f32_32x32x16_bf16 v[80:95], a[172:175], v[132:135], v[80:95]
    v_mfma_f32_32x32x16_bf16 v[64:79], a[176:179], v[136:139], v[64:79]
    buffer_load_dwordx4 v[228:231], v1, s[16:19], s64 offen offset:1024 sc1
    buffer_load_dwordx4 v[232:235], v1, s[16:19], s64 offen offset:2048 sc1
    v_mfma_f32_32x32x16_bf16 v[80:95], a[180:183], v[136:139], v[80:95]
    s_waitcnt vmcnt(16)
    v_mfma_f32_32x32x16_bf16 v[64:79], a[184:187], v[140:143], v[64:79]
    buffer_load_dwordx4 v[236:239], v1, s[16:19], s64 offen offset:3072 sc1
    v_mfma_f32_32x32x16_bf16 v[80:95], a[188:191], v[140:143], v[80:95]
    s_waitcnt vmcnt(16)
    v_mfma_f32_32x32x16_bf16 v[64:79], a[192:195], v[144:147], v[64:79]
    s_add_u32 s64, s64, 4096
    s_cmp_eq_u32 s64, s81
    s_cmov_b32 s64, s80
    buffer_load_dwordx4 v[240:243], v1, s[16:19], s64 offen offset:0 sc1
    buffer_load_dwordx4 v[244:247], v1, s[16:19], s64 offen offset:1024 sc1
    v_mfma_f32_32x32x16_bf16 v[80:95], a[196:199], v[144:147], v[80:95]
    s_waitcnt vmcnt(17)
    v_mfma_f32_32x32x16_bf16 v[64:79], a[200:203], v[148:151], v[64:79]
    buffer_load_dwordx4 v[248:251], v1, s[16:19], s64 offen offset:2048 sc1
    v_mfma_f32_32x32x16_bf16 v[80:95], a[204:207], v[148:151], v[80:95]
    s_waitcnt vmcnt(17)
    v_mfma_f32_32x32x16_bf16 v[64:79], a[208:211], v[188:191], v[64:79]
    s_add_u32 s64, s64, 3072
    s_cmp_eq_u32 s64, s81
    s_cmov_b32 s64, s80
    buffer_load_dwordx4 v[112:115], v1, s[16:19], s64 offen offset:0 sc1
    buffer_load_dwordx4 v[116:119], v1, s[16:19], s64 offen offset:1024 sc1
    v_mfma_f32_32x32x16_bf16 v[80:95], a[212:215], v[188:191], v[80:95]
    s_waitcnt vmcnt(18)
    v_mfma_f32_32x32x16_bf16 v[64:79], a[216:219], v[192:195], v[64:79]
    buffer_load_dwordx4 v[120:123], v1, s[16:19], s64 offen offset:2048 sc1
    v_mfma_f32_32x32x16_bf16 v[80:95], a[220:223], v[192:195], v[80:95]
    s_waitcnt vmcnt(16)
    v_mfma_f32_32x32x16_bf16 v[152:167], a[0:3], v[196:199], 0
    buffer_load_dwordx4 v[124:127], v1, s[16:19], s64 offen offset:3072 sc1
    s_add_u32 s64, s64, 4096
    s_cmp_eq_u32 s64, s81
    s_cmov_b32 s64, s80
    buffer_load_dwordx4 v[128:131], v1, s[16:19], s64 offen offset:0 sc1
    v_mfma_f32_32x32x16_bf16 v[168:183], a[4:7], v[196:199], 0
    s_waitcnt vmcnt(17)
    v_mfma_f32_32x32x16_bf16 v[152:167], a[8:11], v[200:203], v[152:167]
    ds_write_b128 v14, v[64:67] offset:0
    v_add_f32 v96, v96, v97
    v_add_f32 v98, v98, v99
    buffer_load_dwordx4 v[132:135], v1, s[16:19], s64 offen offset:1024 sc1
    v_mfma_f32_32x32x16_bf16 v[168:183], a[12:15], v[200:203], v[168:183]
    ds_write_b128 v15, v[68:71] offset:1024
    v_add_f32 v100, v100, v101
    v_add_f32 v102, v102, v103
    s_waitcnt vmcnt(17)
    v_mfma_f32_32x32x16_bf16 v[152:167], a[16:19], v[204:207], v[152:167]
    ds_write_b128 v14, v[72:75] offset:2048
    v_add_f32 v96, v96, v98
    v_add_f32 v100, v100, v102
    buffer_load_dwordx4 v[136:139], v1, s[16:19], s64 offen offset:2048 sc1
    s_add_u32 s64, s64, 3072
    s_cmp_eq_u32 s64, s81
    s_cmov_b32 s64, s80
    buffer_load_dwordx4 v[140:143], v1, s[16:19], s64 offen offset:0 sc1
    v_mfma_f32_32x32x16_bf16 v[168:183], a[20:23], v[204:207], v[168:183]
    ds_write_b128 v15, v[76:79] offset:3072
    v_add_f32 v96, v96, v100
    v_and_b32 v100, 8, v0
    s_waitcnt vmcnt(18)
    v_mfma_f32_32x32x16_bf16 v[152:167], a[24:27], v[208:211], v[152:167]
    ds_write_b128 v14, v[80:83] offset:4096
    v_mov_b32_dpp v97, v96 row_ror:8 row_mask:0xf bank_mask:0xf
    v_cmp_ne_u32 vcc, 0, v100
    s_nop 1
    v_cndmask_b32 v98, v96, v97, vcc
    v_cndmask_b32 v99, v97, v96, vcc
    buffer_load_dwordx4 v[144:147], v1, s[16:19], s64 offen offset:1024 sc1
    v_mfma_f32_32x32x16_bf16 v[168:183], a[28:31], v[208:211], v[168:183]
    ds_write_b128 v15, v[84:87] offset:5120
    v_mul_f32 v98, 0x3b000000, v98
    v_mul_f32 v99, 0x3b000000, v99
    s_waitcnt vmcnt(18)
    v_mfma_f32_32x32x16_bf16 v[152:167], a[32:35], v[212:215], v[152:167]
    ds_write_b128 v14, v[88:91] offset:6144
    v_fma_f32 v99, -v98, v98, v99
    v_max_f32 v99, 0, v99
    buffer_load_dwordx4 v[148:151], v1, s[16:19], s64 offen offset:2048 sc1
    buffer_load_dwordx4 v[188:191], v1, s[16:19], s64 offen offset:3072 sc1
    v_mfma_f32_32x32x16_bf16 v[168:183], a[36:39], v[212:215], v[168:183]
    ds_write_b128 v15, v[92:95] offset:7168
    v_cvt_pk_bf16_f32 v100, v99, v99
    v_and_b32 v100, 0xffff0000, v100
    s_waitcnt vmcnt(19)
    v_mfma_f32_32x32x16_bf16 v[152:167], a[40:43], v[216:219], v[152:167]
    v_add_f32 v100, 0x3727c5ac, v100
    v_cvt_pk_bf16_f32 v100, v100, v100
    s_add_u32 s64, s64, 4096
    s_cmp_eq_u32 s64, s81
    s_cmov_b32 s64, s80
    buffer_load_dwordx4 v[192:195], v1, s[16:19], s64 offen offset:0 sc1
    v_mfma_f32_32x32x16_bf16 v[168:183], a[44:47], v[216:219], v[168:183]
    v_and_b32 v100, 0xffff0000, v100
    v_sqrt_f32 v100, v100
    s_waitcnt vmcnt(19)
    v_mfma_f32_32x32x16_bf16 v[152:167], a[48:51], v[220:223], v[152:167]
    v_cvt_pk_bf16_f32 v100, v100, v100
    v_and_b32 v100, 0xffff0000, v100
    buffer_load_dwordx4 v[196:199], v1, s[16:19], s64 offen offset:1024 sc1
    buffer_load_dwordx4 v[200:203], v1, s[16:19], s64 offen offset:2048 sc1
    v_mfma_f32_32x32x16_bf16 v[168:183], a[52:55], v[220:223], v[168:183]
    v_rcp_f32 v105, v100
    s_nop 0
    v_mul_f32 v105, v105, v105
    s_waitcnt lgkmcnt(0)
    s_barrier
    s_waitcnt vmcnt(20)
    v_mfma_f32_32x32x16_bf16 v[152:167], a[56:59], v[224:227], v[152:167]
    ds_read_b128 v[64:67], v13 offset:0
    v_mfma_f32_32x32x16_bf16 v[168:183], a[60:63], v[224:227], v[168:183]
    ds_read_b128 v[68:71], v13 offset:512
    s_waitcnt vmcnt(19)
    v_mfma_f32_32x32x16_bf16 v[152:167], a[64:67], v[228:231], v[152:167]
    ds_read_b128 v[72:75], v13 offset:8192
    v_mfma_f32_32x32x16_bf16 v[168:183], a[68:71], v[228:231], v[168:183]
    ds_read_b128 v[76:79], v13 offset:8704
    s_waitcnt vmcnt(18)
    v_mfma_f32_32x32x16_bf16 v[152:167], a[72:75], v[232:235], v[152:167]
    ds_read_b128 v[80:83], v13 offset:16384
    v_mfma_f32_32x32x16_bf16 v[168:183], a[76:79], v[232:235], v[168:183]
    ds_read_b128 v[84:87], v13 offset:16896
    s_waitcnt vmcnt(17)
    v_mfma_f32_32x32x16_bf16 v[152:167], a[80:83], v[236:239], v[152:167]
    ds_read_b128 v[88:91], v13 offset:24576
    s_waitcnt lgkmcnt(4)
    v_add_f32 v64, v64, v72
    v_add_f32 v65, v65, v73
    v_add_f32 v66, v66, v74
    v_mfma_f32_32x32x16_bf16 v[168:183], a[84:87], v[236:239], v[168:183]
    ds_read_b128 v[92:95], v13 offset:25088
    v_add_f32 v67, v67, v75
    s_waitcnt lgkmcnt(4)
    v_add_f32 v68, v68, v76
    v_add_f32 v69, v69, v77
    s_waitcnt vmcnt(16)
    v_mfma_f32_32x32x16_bf16 v[152:167], a[88:91], v[240:243], v[152:167]
    v_add_f32 v70, v70, v78
    v_add_f32 v71, v71, v79
    s_waitcnt lgkmcnt(1)
    v_add_f32 v80, v80, v88
    v_mfma_f32_32x32x16_bf16 v[168:183], a[92:95], v[240:243], v[168:183]
    v_add_f32 v81, v81, v89
    v_add_f32 v82, v82, v90
    v_add_f32 v83, v83, v91
    s_waitcnt vmcnt(15)
    v_mfma_f32_32x32x16_bf16 v[152:167], a[96:99], v[244:247], v[152:167]
    s_waitcnt lgkmcnt(0)
    v_add_f32 v84, v84, v92
    v_add_f32 v85, v85, v93
    v_add_f32 v86, v86, v94
    v_mfma_f32_32x32x16_bf16 v[168:183], a[100:103], v[244:247], v[168:183]
    v_add_f32 v87, v87, v95
    v_lshlrev_b32 v72, 16, v2
    v_and_b32 v73, 0xffff0000, v2
    s_waitcnt vmcnt(14)
    v_mfma_f32_32x32x16_bf16 v[152:167], a[104:107], v[248:251], v[152:167]
    v_lshlrev_b32 v74, 16, v3
    v_and_b32 v75, 0xffff0000, v3
    v_lshlrev_b32 v76, 16, v4
    v_mfma_f32_32x32x16_bf16 v[168:183], a[108:111], v[248:251], v[168:183]
    v_and_b32 v77, 0xffff0000, v4
    v_lshlrev_b32 v78, 16, v5
    v_and_b32 v79, 0xffff0000, v5
    s_waitcnt vmcnt(13)
    v_mfma_f32_32x32x16_bf16 v[152:167], a[112:115], v[112:115], v[152:167]
    v_add_f32 v64, v64, v80
    v_add_f32 v65, v65, v81
    v_add_f32 v66, v66, v82
    v_mfma_f32_32x32x16_bf16 v[168:183], a[116:119], v[112:115], v[168:183]
    v_add_f32 v67, v67, v83
    v_add_f32 v68, v68, v84
    v_add_f32 v69, v69, v85
    s_waitcnt vmcnt(12)
    v_mfma_f32_32x32x16_bf16 v[152:167], a[120:123], v[116:119], v[152:167]
    v_add_f32 v70, v70, v86
    v_add_f32 v71, v71, v87
    v_fma_f32 v64, v64, v104, v72
    v_mfma_f32_32x32x16_bf16 v[168:183], a[124:127], v[116:119], v[168:183]
    v_fma_f32 v65, v65, v104, v73
    v_fma_f32 v66, v66, v104, v74
    v_fma_f32 v67, v67, v104, v75
    s_waitcnt vmcnt(11)
    v_mfma_f32_32x32x16_bf16 v[152:167], a[128:131], v[120:123], v[152:167]
    v_fma_f32 v68, v68, v104, v76
    v_fma_f32 v69, v69, v104, v77
    v_fma_f32 v70, v70, v104, v78
    v_mfma_f32_32x32x16_bf16 v[168:183], a[132:135], v[120:123], v[168:183]
    v_fma_f32 v71, v71, v104, v79
    v_cvt_pk_bf16_f32 v2, v64, v65
    v_cvt_pk_bf16_f32 v3, v66, v67
    s_lshl_b32 s90, s45, 2
    s_add_u32 s90, s90, s46
    s_and_b32 s90, s90, 127
    s_cbranch_scc0 L_wb_191
    buffer_load_dword v107, off, s[16:19], s52
L_wr_192:
    s_waitcnt vmcnt(11)
    v_mfma_f32_32x32x16_bf16 v[152:167], a[136:139], v[124:127], v[152:167]
    v_cvt_pk_bf16_f32 v4, v68, v69
    v_cvt_pk_bf16_f32 v5, v70, v71
    s_lshl_b32 s86, s44, 3
    v_mfma_f32_32x32x16_bf16 v[168:183], a[140:143], v[124:127], v[168:183]
    s_sub_u32 s86, s86, s47
    s_add_u32 s86, s86, 7
    s_lshl_b32 s86, s86, 15
    s_waitcnt vmcnt(10)
    v_mfma_f32_32x32x16_bf16 v[152:167], a[144:147], v[128:131], v[152:167]
    s_lshl_b32 s87, s48, 7
    s_add_u32 s86, s86, s87
    buffer_store_dwordx4 v[2:5], v17, s[20:23], s86 offen sc1
    v_mfma_f32_32x32x16_bf16 v[168:183], a[148:151], v[128:131], v[168:183]
    s_waitcnt vmcnt(10)
    v_mfma_f32_32x32x16_bf16 v[152:167], a[152:155], v[132:135], v[152:167]
    v_mfma_f32_32x32x16_bf16 v[168:183], a[156:159], v[132:135], v[168:183]
    s_barrier
    s_waitcnt vmcnt(9)
    v_mfma_f32_32x32x16_bf16 v[152:167], a[160:163], v[136:139], v[152:167]
    s_waitcnt vmcnt(8)
    v_mfma_f32_32x32x16_bf16 v[152:167], a[168:171], v[140:143], v[152:167]
    s_waitcnt vmcnt(7)
    v_mfma_f32_32x32x16_bf16 v[152:167], a[176:179], v[144:147], v[152:167]
    s_waitcnt vmcnt(6)
    v_mfma_f32_32x32x16_bf16 v[152:167], a[184:187], v[148:151], v[152:167]
    s_waitcnt vmcnt(5)
    v_mfma_f32_32x32x16_bf16 v[152:167], a[192:195], v[188:191], v[152:167]
    s_waitcnt vmcnt(4)
    v_mfma_f32_32x32x16_bf16 v[152:167], a[200:203], v[192:195], v[152:167]
    s_waitcnt vmcnt(3)
    v_mfma_f32_32x32x16_bf16 v[152:167], a[208:211], v[196:199], v[152:167]
    s_waitcnt vmcnt(2)
    v_mfma_f32_32x32x16_bf16 v[152:167], a[216:219], v[200:203], v[152:167]
    v_mfma_f32_32x32x16_bf16 v[168:183], a[164:167], v[136:139], v[168:183]
    s_nop 3
    ds_write_b128 v14, v[152:155] offset:0
    v_mfma_f32_32x32x16_bf16 v[168:183], a[172:175], v[140:143], v[168:183]
    ds_write_b128 v15, v[156:159] offset:1024
    v_mfma_f32_32x32x16_bf16 v[168:183], a[180:183], v[144:147], v[168:183]
    ds_write_b128 v14, v[160:163] offset:2048
    v_mfma_f32_32x32x16_bf16 v[168:183], a[188:191], v[148:151], v[168:183]
    ds_write_b128 v15, v[164:167] offset:3072
    v_mfma_f32_32x32x16_bf16 v[168:183], a[196:199], v[188:191], v[168:183]
    v_mfma_f32_32x32x16_bf16 v[168:183], a[204:207], v[192:195], v[168:183]
    v_mfma_f32_32x32x16_bf16 v[168:183], a[212:215], v[196:199], v[168:183]
    v_mfma_f32_32x32x16_bf16 v[168:183], a[220:223], v[200:203], v[168:183]
    s_nop 11
    ds_write_b128 v14, v[168:171] offset:4096
    ds_write_b128 v15, v[172:175] offset:5120
    ds_write_b128 v14, v[176:179] offset:6144
    ds_write_b128 v15, v[180:183] offset:7168
    s_waitcnt lgkmcnt(0)
    s_barrier
    ds_read_b128 v[152:155], v13 offset:0
    ds_read_b128 v[156:159], v13 offset:512
    ds_read_b128 v[160:163], v13 offset:8192
    ds_read_b128 v[164:167], v13 offset:8704
    ds_read_b128 v[168:171], v13 offset:16384
    ds_read_b128 v[172:175], v13 offset:16896
    ds_read_b128 v[176:179], v13 offset:24576
    ds_read_b128 v[180:183], v13 offset:25088
    s_waitcnt lgkmcnt(5)
    v_pk_add_f32 v[152:153], v[152:153], v[160:161]
    v_pk_add_f32 v[154:155], v[154:155], v[162:163]
    s_waitcnt lgkmcnt(4)
    v_pk_add_f32 v[156:157], v[156:157], v[164:165]
    v_pk_add_f32 v[158:159], v[158:159], v[166:167]
    s_waitcnt lgkmcnt(1)
    v_pk_add_f32 v[168:169], v[168:169], v[176:177]
    v_pk_add_f32 v[170:171], v[170:171], v[178:179]
    s_waitcnt lgkmcnt(0)
    v_pk_add_f32 v[172:173], v[172:173], v[180:181]
    v_pk_add_f32 v[174:175], v[174:175], v[182:183]
    v_lshlrev_b32 v160, 16, v6
    v_and_b32 v161, 0xffff0000, v6
    v_lshlrev_b32 v162, 16, v7
    v_and_b32 v163, 0xffff0000, v7
    v_lshlrev_b32 v164, 16, v8
    v_and_b32 v165, 0xffff0000, v8
    v_lshlrev_b32 v166, 16, v9
    v_and_b32 v167, 0xffff0000, v9
    v_pk_add_f32 v[152:153], v[152:153], v[168:169]
    v_pk_add_f32 v[154:155], v[154:155], v[170:171]
    v_pk_add_f32 v[156:157], v[156:157], v[172:173]
    v_pk_add_f32 v[158:159], v[158:159], v[174:175]
    v_pk_fma_f32 v[152:153], v[152:153], v[104:105], v[160:161] op_sel:[0,1,0] op_sel_hi:[1,1,1]
    v_pk_fma_f32 v[154:155], v[154:155], v[104:105], v[162:163] op_sel:[0,1,0] op_sel_hi:[1,1,1]
    v_pk_fma_f32 v[156:157], v[156:157], v[104:105], v[164:165] op_sel:[0,1,0] op_sel_hi:[1,1,1]
    v_pk_fma_f32 v[158:159], v[158:159], v[104:105], v[166:167] op_sel:[0,1,0] op_sel_hi:[1,1,1]
    v_cvt_pk_bf16_f32 v6, v152, v153
    v_cvt_pk_bf16_f32 v7, v154, v155
    v_cvt_pk_bf16_f32 v8, v156, v157
    v_cvt_pk_bf16_f32 v9, v158, v159
    s_lshl_b32 s86, s44, 3
    s_add_u32 s86, s86, s47
    s_add_u32 s86, s86, 0
    s_lshl_b32 s86, s86, 15
    s_lshl_b32 s87, s48, 7
    s_add_u32 s86, s86, s87
    buffer_store_dwordx4 v[6:9], v17, s[20:23], s86 offen sc1
    s_nop 0
    s_endpgm
L_exit:
    s_endpgm
L_poll_11:
    s_nop 4
    buffer_load_dword v99, v98, s[24:27], 0 offen sc1
    s_waitcnt vmcnt(0)
    v_and_b32 v254, s93, v99
    v_cmp_ne_u32 vcc, s93, v254
    s_nop 1
    s_cbranch_vccz L_ok_12
    s_sub_u32 s54, s54, 1
    s_cbranch_scc0 L_poll_11
    s_endpgm
L_pub_15:
    buffer_wbl2 sc1
    s_waitcnt vmcnt(0)
    buffer_store_dword v252, off, s[16:19], s52 sc1
    s_branch L_pur_16
L_poll_17:
    s_nop 4
    buffer_load_dword v215, v214, s[16:19], s53 offen sc1
    s_waitcnt vmcnt(0)
    v_cmp_gt_u32 vcc, 1, v215
    s_nop 1
    s_cbranch_vccz L_ok_18
    s_sub_u32 s54, s54, 1
    s_cbranch_scc0 L_poll_17
    s_endpgm
L_acq_19:
    buffer_inv sc1
    s_waitcnt vmcnt(0)
    s_branch L_acr_20
L_poll_22:
    s_nop 4
    buffer_load_dword v215, v214, s[16:19], s97 offen sc1
    s_waitcnt vmcnt(0)
    v_cmp_gt_u32 vcc, 2, v215
    s_nop 1
    s_cbranch_vccz L_ok_23
    s_sub_u32 s54, s54, 1
    s_cbranch_scc0 L_poll_22
    s_endpgm
L_acq_24:
    buffer_inv sc1
    s_waitcnt vmcnt(0)
    s_branch L_acr_25
L_pub_28:
    buffer_wbl2 sc1
    s_waitcnt vmcnt(0)
    buffer_store_dword v252, off, s[16:19], s52 sc1
    s_branch L_pur_29
L_poll_31:
    s_nop 4
    buffer_load_dword v120, v22, s[16:19], s53 offen sc1
    s_waitcnt vmcnt(0)
    v_cmp_gt_u32 vcc, 4, v120
    s_nop 1
    s_cbranch_vccz L_ok_32
    s_sub_u32 s54, s54, 1
    s_cbranch_scc0 L_poll_31
    s_endpgm
L_acq_33:
    buffer_inv sc1
    s_waitcnt vmcnt(0)
    s_branch L_acr_34
L_fb0:
    s_nop 7
    s_nop 7
    s_nop 7
    s_sub_u32 s90, 7, s46
    s_cmp_eq_u32 s44, 0
    s_cselect_b32 s90, s90, 8
    s_mov_b32 s89, 0
    v_mov_b32 v80, 0xff800000
    v_add_u32 v81, 8192, v217
    s_nop 4
L_fa_90001:
    ds_read_b128 v[112:115], v81
    s_waitcnt lgkmcnt(0)
    s_cmp_eq_u32 s89, 0
    s_cbranch_scc1 L_f0_90002
    s_cmp_eq_u32 s89, 8
    s_cbranch_scc1 L_f8_90003
    v_mfma_f32_32x32x16_bf16 v[64:79], v[112:115], v[128:131], 0
    s_branch L_fe_90004
L_f0_90002:
    s_nop 10
    v_mfma_f32_32x32x16_bf16 v[64:79], v[112:115], v[128:131], v[220:235]
    s_branch L_fe_90004
L_f8_90003:
    s_nop 10
    v_mfma_f32_32x32x16_bf16 v[64:79], v[112:115], v[128:131], v[236:251]
L_fe_90004:
    s_nop 7
    s_nop 7
    v_max3_f32 v80, v64, v65, v80
    v_max3_f32 v80, v66, v67, v80
    v_max3_f32 v80, v68, v69, v80
    v_max3_f32 v80, v70, v71, v80
    v_max3_f32 v80, v72, v73, v80
    v_max3_f32 v80, v74, v75, v80
    v_max3_f32 v80, v76, v77, v80
    v_max3_f32 v80, v78, v79, v80
    v_subrev_u32 v81, 1024, v81
    s_add_u32 s89, s89, 1
    s_cmp_le_u32 s89, s90
    s_nop 2
    s_cbranch_scc1 L_fa_90001
    v_mov_b32 v83, v80
    s_nop 1
    v_permlane32_swap_b32 v80, v83
    v_max_f32 v80, v80, v83
    s_mov_b32 s89, 0
    v_add_u32 v81, 8192, v217
    v_add_u32 v82, 8192, v219
    v_mov_b32 v192, 0
    v_mov_b32 v193, 0
    v_mov_b32 v194, 0
    v_mov_b32 v195, 0
    v_mov_b32 v196, 0
    v_mov_b32 v197, 0
    v_mov_b32 v198, 0
    v_mov_b32 v199, 0
    v_mov_b32 v200, 0
    v_mov_b32 v201, 0
    v_mov_b32 v202, 0
    v_mov_b32 v203, 0
    v_mov_b32 v204, 0
    v_mov_b32 v205, 0
    v_mov_b32 v206, 0
    v_mov_b32 v207, 0
    s_nop 4
L_fc_90005:
    ds_read_b128 v[112:115], v81
    ds_read_b128 v[144:147], v82
    ds_read_b128 v[148:151], v82 offset:256
    s_waitcnt lgkmcnt(0)
    s_cmp_eq_u32 s89, 0
    s_cbranch_scc1 L_f0_90006
    s_cmp_eq_u32 s89, 8
    s_cbranch_scc1 L_f8_90007
    v_mfma_f32_32x32x16_bf16 v[64:79], v[112:115], v[128:131], 0
    s_branch L_fe_90008
L_f0_90006:
    s_nop 10
    v_mfma_f32_32x32x16_bf16 v[64:79], v[112:115], v[128:131], v[220:235]
    s_branch L_fe_90008
L_f8_90007:
    s_nop 10
    v_mfma_f32_32x32x16_bf16 v[64:79], v[112:115], v[128:131], v[236:251]
L_fe_90008:
    s_nop 7
    s_nop 7
    v_sub_f32 v64, v64, v80
    v_sub_f32 v65, v65, v80
    v_sub_f32 v66, v66, v80
    v_sub_f32 v67, v67, v80
    v_sub_f32 v68, v68, v80
    v_sub_f32 v69, v69, v80
    v_sub_f32 v70, v70, v80
    v_sub_f32 v71, v71, v80
    v_sub_f32 v72, v72, v80
    v_sub_f32 v73, v73, v80
    v_sub_f32 v74, v74, v80
    v_sub_f32 v75, v75, v80
    v_sub_f32 v76, v76, v80
    v_sub_f32 v77, v77, v80
    v_sub_f32 v78, v78, v80
    v_sub_f32 v79, v79, v80
    v_exp_f32 v64, v64
    v_exp_f32 v65, v65
    v_exp_f32 v66, v66
    v_exp_f32 v67, v67
    v_exp_f32 v68, v68
    v_exp_f32 v69, v69
    v_exp_f32 v70, v70
    v_exp_f32 v71, v71
    v_exp_f32 v72, v72
    v_exp_f32 v73, v73
    v_exp_f32 v74, v74
    v_exp_f32 v75, v75
    v_exp_f32 v76, v76
    v_exp_f32 v77, v77
    v_exp_f32 v78, v78
    v_exp_f32 v79, v79
    v_cvt_pk_bf16_f32 v96, v64, v65
    v_cvt_pk_bf16_f32 v97, v66, v67
    v_cvt_pk_bf16_f32 v98, v68, v69
    v_cvt_pk_bf16_f32 v99, v70, v71
    v_cvt_pk_bf16_f32 v100, v72, v73
    v_cvt_pk_bf16_f32 v101, v74, v75
    v_cvt_pk_bf16_f32 v102, v76, v77
    v_cvt_pk_bf16_f32 v103, v78, v79
    v_mfma_f32_32x32x16_bf16 v[192:207], v[144:147], v[96:99], v[192:207]
    s_nop 0
    v_mfma_f32_32x32x16_bf16 v[192:207], v[148:151], v[100:103], v[192:207]
    v_subrev_u32 v81, 1024, v81
    v_subrev_u32 v82, 1024, v82
    s_add_u32 s89, s89, 1
    s_cmp_le_u32 s89, s90
    s_nop 7
    s_cbranch_scc1 L_fc_90005
    v_rcp_f32 v201, v200
    s_nop 0
    v_mul_f32 v192, v192, v201
    v_mul_f32 v193, v193, v201
    v_mul_f32 v194, v194, v201
    v_mul_f32 v195, v195, v201
    v_mul_f32 v196, v196, v201
    v_mul_f32 v197, v197, v201
    v_mul_f32 v198, v198, v201
    v_mul_f32 v199, v199, v201
    v_cvt_pk_bf16_f32 v204, v192, v193
    v_cvt_pk_bf16_f32 v205, v194, v195
    v_cvt_pk_bf16_f32 v206, v196, v197
    v_cvt_pk_bf16_f32 v207, v198, v199
    s_waitcnt vmcnt(0)
    buffer_store_dwordx4 v[204:207], v1, s[16:19], s86 offen
    s_waitcnt vmcnt(0)
    s_mov_b32 s90, s46
    s_cmp_eq_u32 s44, 0
    s_cselect_b32 s90, s90, 8
    s_mov_b32 s89, 0
    v_mov_b32 v80, 0xff800000
    v_add_u32 v81, 8192, v216
    s_nop 4
L_fa_90009:
    ds_read_b128 v[112:115], v81
    s_waitcnt lgkmcnt(0)
    s_cmp_eq_u32 s89, 0
    s_cbranch_scc1 L_f0_90010
    s_cmp_eq_u32 s89, 8
    s_cbranch_scc1 L_f8_90011
    v_mfma_f32_32x32x16_bf16 v[64:79], v[112:115], v[160:163], 0
    s_branch L_fe_90012
L_f0_90010:
    s_nop 10
    v_mfma_f32_32x32x16_bf16 v[64:79], v[112:115], v[160:163], v[220:235]
    s_branch L_fe_90012
L_f8_90011:
    s_nop 10
    v_mfma_f32_32x32x16_bf16 v[64:79], v[112:115], v[160:163], v[236:251]
L_fe_90012:
    s_nop 7
    s_nop 7
    v_max3_f32 v80, v64, v65, v80
    v_max3_f32 v80, v66, v67, v80
    v_max3_f32 v80, v68, v69, v80
    v_max3_f32 v80, v70, v71, v80
    v_max3_f32 v80, v72, v73, v80
    v_max3_f32 v80, v74, v75, v80
    v_max3_f32 v80, v76, v77, v80
    v_max3_f32 v80, v78, v79, v80
    v_subrev_u32 v81, 1024, v81
    s_add_u32 s89, s89, 1
    s_cmp_le_u32 s89, s90
    s_nop 2
    s_cbranch_scc1 L_fa_90009
    v_mov_b32 v83, v80
    s_nop 1
    v_permlane32_swap_b32 v80, v83
    v_max_f32 v80, v80, v83
    s_mov_b32 s89, 0
    v_add_u32 v81, 8192, v216
    v_add_u32 v82, 8192, v218
    v_mov_b32 v192, 0
    v_mov_b32 v193, 0
    v_mov_b32 v194, 0
    v_mov_b32 v195, 0
    v_mov_b32 v196, 0
    v_mov_b32 v197, 0
    v_mov_b32 v198, 0
    v_mov_b32 v199, 0
    v_mov_b32 v200, 0
    v_mov_b32 v201, 0
    v_mov_b32 v202, 0
    v_mov_b32 v203, 0
    v_mov_b32 v204, 0
    v_mov_b32 v205, 0
    v_mov_b32 v206, 0
    v_mov_b32 v207, 0
    s_nop 4
L_fc_90013:
    ds_read_b128 v[112:115], v81
    ds_read_b128 v[144:147], v82
    ds_read_b128 v[148:151], v82 offset:256
    s_waitcnt lgkmcnt(0)
    s_cmp_eq_u32 s89, 0
    s_cbranch_scc1 L_f0_90014
    s_cmp_eq_u32 s89, 8
    s_cbranch_scc1 L_f8_90015
    v_mfma_f32_32x32x16_bf16 v[64:79], v[112:115], v[160:163], 0
    s_branch L_fe_90016
L_f0_90014:
    s_nop 10
    v_mfma_f32_32x32x16_bf16 v[64:79], v[112:115], v[160:163], v[220:235]
    s_branch L_fe_90016
L_f8_90015:
    s_nop 10
    v_mfma_f32_32x32x16_bf16 v[64:79], v[112:115], v[160:163], v[236:251]
L_fe_90016:
    s_nop 7
    s_nop 7
    v_sub_f32 v64, v64, v80
    v_sub_f32 v65, v65, v80
    v_sub_f32 v66, v66, v80
    v_sub_f32 v67, v67, v80
    v_sub_f32 v68, v68, v80
    v_sub_f32 v69, v69, v80
    v_sub_f32 v70, v70, v80
    v_sub_f32 v71, v71, v80
    v_sub_f32 v72, v72, v80
    v_sub_f32 v73, v73, v80
    v_sub_f32 v74, v74, v80
    v_sub_f32 v75, v75, v80
    v_sub_f32 v76, v76, v80
    v_sub_f32 v77, v77, v80
    v_sub_f32 v78, v78, v80
    v_sub_f32 v79, v79, v80
    v_exp_f32 v64, v64
    v_exp_f32 v65, v65
    v_exp_f32 v66, v66
    v_exp_f32 v67, v67
    v_exp_f32 v68, v68
    v_exp_f32 v69, v69
    v_exp_f32 v70, v70
    v_exp_f32 v71, v71
    v_exp_f32 v72, v72
    v_exp_f32 v73, v73
    v_exp_f32 v74, v74
    v_exp_f32 v75, v75
    v_exp_f32 v76, v76
    v_exp_f32 v77, v77
    v_exp_f32 v78, v78
    v_exp_f32 v79, v79
    v_cvt_pk_bf16_f32 v96, v64, v65
    v_cvt_pk_bf16_f32 v97, v66, v67
    v_cvt_pk_bf16_f32 v98, v68, v69
    v_cvt_pk_bf16_f32 v99, v70, v71
    v_cvt_pk_bf16_f32 v100, v72, v73
    v_cvt_pk_bf16_f32 v101, v74, v75
    v_cvt_pk_bf16_f32 v102, v76, v77
    v_cvt_pk_bf16_f32 v103, v78, v79
    v_mfma_f32_32x32x16_bf16 v[192:207], v[144:147], v[96:99], v[192:207]
    s_nop 0
    v_mfma_f32_32x32x16_bf16 v[192:207], v[148:151], v[100:103], v[192:207]
    v_subrev_u32 v81, 1024, v81
    v_subrev_u32 v82, 1024, v82
    s_add_u32 s89, s89, 1
    s_cmp_le_u32 s89, s90
    s_nop 7
    s_cbranch_scc1 L_fc_90013
    v_rcp_f32 v201, v200
    s_nop 0
    v_mul_f32 v192, v192, v201
    v_mul_f32 v193, v193, v201
    v_mul_f32 v194, v194, v201
    v_mul_f32 v195, v195, v201
    v_mul_f32 v196, v196, v201
    v_mul_f32 v197, v197, v201
    v_mul_f32 v198, v198, v201
    v_mul_f32 v199, v199, v201
    v_cvt_pk_bf16_f32 v204, v192, v193
    v_cvt_pk_bf16_f32 v205, v194, v195
    v_cvt_pk_bf16_f32 v206, v196, v197
    v_cvt_pk_bf16_f32 v207, v198, v199
    s_waitcnt vmcnt(0)
    buffer_store_dwordx4 v[204:207], v1, s[16:19], s87 offen
    s_waitcnt vmcnt(0)
    v_mov_b32 v252, 5
    buffer_wbl2 sc1
    s_waitcnt vmcnt(0)
    s_mov_b64 exec, 1
    s_cmp_lg_u32 s50, 0
    s_cbranch_scc1 L_fp_90017
    buffer_store_dword v252, off, s[16:19], s52
    s_branch L_fp_90018
L_fp_90017:
    buffer_store_dword v252, off, s[16:19], s52 sc1
L_fp_90018:
    s_mov_b64 exec, -1
    s_cmp_eq_u32 s91, 0
    s_cbranch_scc1 L_fp_90021
L_fp_90019:
    buffer_load_dword v120, v22, s[16:19], s53 offen sc1
    s_waitcnt vmcnt(0)
    v_cmp_gt_u32 vcc, 4, v120
    s_nop 1
    s_cbranch_vccz L_fp_90020
    s_sub_u32 s54, s54, 1
    s_cbranch_scc0 L_fp_90019
    s_endpgm
L_fp_90020:
    buffer_inv sc1
    s_waitcnt vmcnt(0)
    s_add_u32 s92, s61, s76
    buffer_load_dwordx4 v[132:135], v1, s[16:19], s92 offen offset:0 sc1
    buffer_load_dwordx4 v[136:139], v1, s[16:19], s92 offen offset:1024 sc1
    s_add_u32 s92, s61, s77
    buffer_load_dwordx4 v[140:143], v1, s[16:19], s92 offen offset:0 sc1
    buffer_load_dwordx4 v[164:167], v1, s[16:19], s92 offen offset:1024 sc1
    s_add_u32 s92, s61, s78
    buffer_load_dwordx4 v[168:171], v1, s[16:19], s92 offen offset:0 sc1
    buffer_load_dwordx4 v[172:175], v1, s[16:19], s92 offen offset:1024 sc1
    s_add_u32 s92, s61, s79
    buffer_load_dwordx4 v[208:211], v1, s[16:19], s92 offen offset:0 sc1
    buffer_load_dwordx4 v[212:215], v1, s[16:19], s92 offen offset:1024 sc1
    s_nop 1
L_fp_90021:
    s_waitcnt vmcnt(0)
    s_nop 7
    s_nop 7
    s_nop 7
    s_nop 7
    s_branch L_fbr0
L_pub_36:
    buffer_wbl2 sc1
    s_waitcnt vmcnt(0)
    buffer_store_dword v252, off, s[16:19], s52 sc1
    s_branch L_pur_37
L_poll_38:
    s_nop 4
    buffer_load_dword v128, v22, s[16:19], s53 offen sc1
    s_waitcnt vmcnt(0)
    v_cmp_gt_u32 vcc, 5, v128
    s_nop 1
    s_cbranch_vccz L_ok_39
    s_sub_u32 s54, s54, 1
    s_cbranch_scc0 L_poll_38
    s_endpgm
L_acq_40:
    buffer_inv sc1
    s_waitcnt vmcnt(0)
    s_branch L_acr_41
L_pub_42:
    buffer_wbl2 sc1
    s_waitcnt vmcnt(0)
    buffer_store_dword v252, off, s[16:19], s52 sc1
    s_branch L_pur_43
L_poll_44:
    s_nop 4
    buffer_load_dword v128, v21, s[16:19], s53 offen sc1
    s_waitcnt vmcnt(0)
    v_cmp_gt_u32 vcc, 6, v128
    s_nop 1
    s_cbranch_vccz L_ok_45
    s_sub_u32 s54, s54, 1
    s_cbranch_scc0 L_poll_44
    s_endpgm
L_acq_46:
    buffer_inv sc1
    s_waitcnt vmcnt(0)
    s_branch L_acr_47
L_poll_48:
    s_nop 4
    buffer_load_dword v143, v142, s[24:27], s51 offen sc1
    s_waitcnt vmcnt(0)
    v_and_b32 v254, s91, v143
    v_cmp_ne_u32 vcc, s91, v254
    s_nop 1
    s_cbranch_vccz L_ok_49
    s_sub_u32 s54, s54, 1
    s_cbranch_scc0 L_poll_48
    s_endpgm
L_acq_50:
    buffer_inv sc1
    s_waitcnt vmcnt(0)
    s_branch L_acr_51
L_pub_52:
    buffer_wbl2 sc1
    s_waitcnt vmcnt(0)
    buffer_store_dword v252, off, s[16:19], s52 sc1
    s_branch L_pur_53
L_poll_54:
    s_nop 4
    buffer_load_dword v184, v21, s[16:19], s53 offen sc1
    s_waitcnt vmcnt(0)
    v_cmp_gt_u32 vcc, 7, v184
    s_nop 1
    s_cbranch_vccz L_ok_55
    s_sub_u32 s54, s54, 1
    s_cbranch_scc0 L_poll_54
    s_endpgm
L_acq_56:
    buffer_inv sc1
    s_waitcnt vmcnt(0)
    s_branch L_acr_57
L_hs_58:
    buffer_store_dwordx4 v[64:67], v1, s[16:19], s87 offen offset:0 sc1
    s_branch L_hr_59
L_hs_60:
    buffer_store_dwordx4 v[80:83], v1, s[16:19], s87 offen offset:1024 sc1
    s_branch L_hr_61
L_hs_62:
    buffer_store_dwordx4 v[96:99], v1, s[16:19], s87 offen offset:2048 sc1
    s_branch L_hr_63
L_hs_64:
    buffer_store_dwordx4 v[112:115], v1, s[16:19], s87 offen offset:3072 sc1
    s_branch L_hr_65
L_pub_66:
    buffer_wbl2 sc1
    s_waitcnt vmcnt(0)
    buffer_store_dword v252, off, s[16:19], s52 sc1
    s_branch L_pur_67
L_poll_68:
    s_nop 4
    buffer_load_dword v184, v22, s[16:19], s53 offen sc1
    s_waitcnt vmcnt(0)
    v_cmp_gt_u32 vcc, 8, v184
    s_nop 1
    s_cbranch_vccz L_ok_69
    s_sub_u32 s54, s54, 1
    s_cbranch_scc0 L_poll_68
    s_endpgm
L_acq_70:
    buffer_inv sc1
    s_waitcnt vmcnt(0)
    s_branch L_acr_71
L_hs_72:
    buffer_store_dwordx4 v[64:67], v1, s[16:19], s89 offen offset:0 sc1
    s_branch L_hr_73
L_hs_74:
    buffer_store_dwordx4 v[80:83], v1, s[16:19], s89 offen offset:1024 sc1
    s_branch L_hr_75
L_hs_76:
    buffer_store_dwordx4 v[96:99], v1, s[16:19], s89 offen offset:2048 sc1
    s_branch L_hr_77
L_poll_78:
    s_nop 4
    buffer_load_dword v184, v21, s[16:19], s53 offen sc1
    s_waitcnt vmcnt(0)
    v_cmp_gt_u32 vcc, 7, v184
    s_nop 1
    s_cbranch_vccz L_ok_79
    s_sub_u32 s54, s54, 1
    s_cbranch_scc0 L_poll_78
    s_endpgm
L_acq_80:
    buffer_inv sc1
    s_waitcnt vmcnt(0)
    s_branch L_acr_81
L_hs_82:
    buffer_store_dwordx4 v[64:67], v1, s[16:19], s87 offen offset:1024 sc1
    s_branch L_hr_83
L_hs_84:
    buffer_store_dwordx4 v[80:83], v1, s[16:19], s87 offen offset:2048 sc1
    s_branch L_hr_85
L_hs_86:
    buffer_store_dwordx4 v[96:99], v1, s[16:19], s87 offen offset:3072 sc1
    s_branch L_hr_87
L_pub_88:
    buffer_wbl2 sc1
    s_waitcnt vmcnt(0)
    buffer_store_dword v252, off, s[16:19], s52 sc1
    s_branch L_pur_89
L_poll_90:
    s_nop 4
    buffer_load_dword v184, v22, s[16:19], s53 offen sc1
    s_waitcnt vmcnt(0)
    v_cmp_gt_u32 vcc, 8, v184
    s_nop 1
    s_cbranch_vccz L_ok_91
    s_sub_u32 s54, s54, 1
    s_cbranch_scc0 L_poll_90
    s_endpgm
L_acq_92:
    buffer_inv sc1
    s_waitcnt vmcnt(0)
    s_branch L_acr_93
L_hs_94:
    buffer_store_dwordx4 v[112:115], v1, s[16:19], s89 offen offset:0 sc1
    s_branch L_hr_95
L_hs_96:
    buffer_store_dwordx4 v[64:67], v1, s[16:19], s89 offen offset:1024 sc1
    s_branch L_hr_97
L_hs_98:
    buffer_store_dwordx4 v[80:83], v1, s[16:19], s89 offen offset:2048 sc1
    s_branch L_hr_99
L_hs_100:
    buffer_store_dwordx4 v[96:99], v1, s[16:19], s89 offen offset:3072 sc1
    s_branch L_hr_101
L_pub_102:
    buffer_wbl2 sc1
    s_waitcnt vmcnt(0)
    buffer_store_dword v252, off, s[16:19], s52 sc1
    s_branch L_pur_103
L_poll_104:
    s_nop 4
    buffer_load_dword v106, v22, s[16:19], s53 offen sc1
    s_waitcnt vmcnt(0)
    v_cmp_gt_u32 vcc, 9, v106
    s_nop 1
    s_cbranch_vccz L_ok_105
    s_sub_u32 s54, s54, 1
    s_cbranch_scc0 L_poll_104
    s_endpgm
L_acq_106:
    buffer_inv sc1
    s_waitcnt vmcnt(0)
    s_branch L_acr_107
L_pub_108:
    buffer_wbl2 sc1
    s_waitcnt vmcnt(0)
    buffer_store_dword v252, off, s[16:19], s52 sc1
    s_branch L_pur_109
L_poll_110:
    s_nop 4
    buffer_load_dword v106, v21, s[16:19], s53 offen sc1
    s_waitcnt vmcnt(0)
    v_cmp_gt_u32 vcc, 10, v106
    s_nop 1
    s_cbranch_vccz L_ok_111
    s_sub_u32 s54, s54, 1
    s_cbranch_scc0 L_poll_110
    s_endpgm
L_acq_112:
    buffer_inv sc1
    s_waitcnt vmcnt(0)
    s_branch L_acr_113
L_pub_114:
    buffer_wbl2 sc1
    s_waitcnt vmcnt(0)
    buffer_store_dword v252, off, s[16:19], s52 sc1
    s_branch L_pur_115
L_poll_116:
    s_nop 4
    buffer_load_dword v111, v21, s[16:19], s53 offen sc1
    s_waitcnt vmcnt(0)
    v_cmp_gt_u32 vcc, 11, v111
    s_nop 1
    s_cbranch_vccz L_ok_117
    s_sub_u32 s54, s54, 1
    s_cbranch_scc0 L_poll_116
    s_endpgm
L_acq_118:
    buffer_inv sc1
    s_waitcnt vmcnt(0)
    s_branch L_acr_119
L_poll_124:
    s_nop 4
    buffer_load_dword v215, v214, s[16:19], s71 offen sc1
    s_waitcnt vmcnt(0)
    v_cmp_gt_u32 vcc, 3, v215
    s_nop 1
    s_cbranch_vccz L_ok_125
    s_sub_u32 s54, s54, 1
    s_cbranch_scc0 L_poll_124
    s_endpgm
L_acq_126:
    buffer_inv sc1
    s_waitcnt vmcnt(0)
    s_branch L_acr_127
L_hx_122:
    buffer_load_dword v215, off, s[16:19], s52
    buffer_load_dword v215, off, s[16:19], s52
    s_branch L_hy_123
L_poll_131:
    s_nop 4
    buffer_load_dword v215, v214, s[16:19], s71 offen sc1
    s_waitcnt vmcnt(0)
    v_cmp_gt_u32 vcc, 4, v215
    s_nop 1
    s_cbranch_vccz L_ok_132
    s_sub_u32 s54, s54, 1
    s_cbranch_scc0 L_poll_131
    s_endpgm
L_acq_133:
    buffer_inv sc1
    s_waitcnt vmcnt(0)
    s_branch L_acr_134
L_hx_129:
    buffer_load_dword v215, off, s[16:19], s52
    buffer_load_dword v215, off, s[16:19], s52
    s_branch L_hy_130
L_pub_136:
    buffer_wbl2 sc1
    s_waitcnt vmcnt(0)
    buffer_store_dword v252, off, s[16:19], s52 sc1
    s_branch L_pur_137
L_poll_139:
    s_nop 4
    buffer_load_dword v120, v22, s[16:19], s53 offen sc1
    s_waitcnt vmcnt(0)
    v_cmp_gt_u32 vcc, 13, v120
    s_nop 1
    s_cbranch_vccz L_ok_140
    s_sub_u32 s54, s54, 1
    s_cbranch_scc0 L_poll_139
    s_endpgm
L_acq_141:
    buffer_inv sc1
    s_waitcnt vmcnt(0)
    s_branch L_acr_142
L_fb1:
    s_nop 7
    s_nop 7
    s_nop 7
    v_and_b32 v253, 31, v0
    v_lshrrev_b32 v254, 5, v0
    v_lshlrev_b32 v235, 2, v254
    v_sub_u32 v235, v253, v235
    v_mov_b32 v11, 0xf149f2ca
    v_cmp_le_i32_e64 s[94:95], 0, v235
    v_cmp_le_i32_e64 s[96:97], 1, v235
    s_nop 0
    v_cndmask_b32_e64 v220, v11, 0, s[94:95]
    v_cmp_le_i32_e64 s[94:95], 2, v235
    v_cndmask_b32_e64 v221, v11, 0, s[96:97]
    v_cmp_le_i32_e64 s[96:97], 3, v235
    v_cndmask_b32_e64 v222, v11, 0, s[94:95]
    v_cmp_le_i32_e64 s[94:95], 8, v235
    v_cndmask_b32_e64 v223, v11, 0, s[96:97]
    v_cmp_le_i32_e64 s[96:97], 9, v235
    v_cndmask_b32_e64 v224, v11, 0, s[94:95]
    v_cmp_le_i32_e64 s[94:95], 10, v235
    v_cndmask_b32_e64 v225, v11, 0, s[96:97]
    v_cmp_le_i32_e64 s[96:97], 11, v235
    v_cndmask_b32_e64 v226, v11, 0, s[94:95]
    v_cmp_le_i32_e64 s[94:95], 16, v235
    v_cndmask_b32_e64 v227, v11, 0, s[96:97]
    v_cmp_le_i32_e64 s[96:97], 17, v235
    v_cndmask_b32_e64 v228, v11, 0, s[94:95]
    v_cmp_le_i32_e64 s[94:95], 18, v235
    v_cndmask_b32_e64 v229, v11, 0, s[96:97]
    v_cmp_le_i32_e64 s[96:97], 19, v235
    v_cndmask_b32_e64 v230, v11, 0, s[94:95]
    v_cmp_le_i32_e64 s[94:95], 24, v235
    v_cndmask_b32_e64 v231, v11, 0, s[96:97]
    v_cmp_le_i32_e64 s[96:97], 25, v235
    v_cndmask_b32_e64 v232, v11, 0, s[94:95]
    v_cmp_le_i32_e64 s[94:95], 26, v235
    v_cndmask_b32_e64 v233, v11, 0, s[96:97]
    v_cmp_le_i32_e64 s[96:97], 27, v235
    v_cndmask_b32_e64 v234, v11, 0, s[94:95]
    s_nop 0
    v_cndmask_b32_e64 v235, v11, 0, s[96:97]
    s_sub_u32 s90, 7, s46
    s_cmp_eq_u32 s44, 0
    s_cselect_b32 s90, s90, 8
    s_mov_b32 s89, 0
    v_mov_b32 v80, 0xff800000
    v_add_u32 v81, 8192, v217
    s_nop 4
L_fa_91001:
    ds_read_b128 v[112:115], v81
    s_waitcnt lgkmcnt(0)
    s_cmp_eq_u32 s89, 0
    s_cbranch_scc1 L_f0_91002
    s_cmp_eq_u32 s89, 8
    s_cbranch_scc1 L_f8_91003
    v_mfma_f32_32x32x16_bf16 v[64:79], v[112:115], v[128:131], 0
    s_branch L_fe_91004
L_f0_91002:
    s_nop 10
    v_mfma_f32_32x32x16_bf16 v[64:79], v[112:115], v[128:131], v[220:235]
    s_branch L_fe_91004
L_f8_91003:
    s_nop 10
    v_mfma_f32_32x32x16_bf16 v[64:79], v[112:115], v[128:131], v[236:251]
L_fe_91004:
    s_nop 7
    s_nop 7
    v_max3_f32 v80, v64, v65, v80
    v_max3_f32 v80, v66, v67, v80
    v_max3_f32 v80, v68, v69, v80
    v_max3_f32 v80, v70, v71, v80
    v_max3_f32 v80, v72, v73, v80
    v_max3_f32 v80, v74, v75, v80
    v_max3_f32 v80, v76, v77, v80
    v_max3_f32 v80, v78, v79, v80
    v_subrev_u32 v81, 1024, v81
    s_add_u32 s89, s89, 1
    s_cmp_le_u32 s89, s90
    s_nop 2
    s_cbranch_scc1 L_fa_91001
    v_mov_b32 v83, v80
    s_nop 1
    v_permlane32_swap_b32 v80, v83
    v_max_f32 v80, v80, v83
    s_mov_b32 s89, 0
    v_add_u32 v81, 8192, v217
    v_add_u32 v82, 8192, v219
    v_mov_b32 v192, 0
    v_mov_b32 v193, 0
    v_mov_b32 v194, 0
    v_mov_b32 v195, 0
    v_mov_b32 v196, 0
    v_mov_b32 v197, 0
    v_mov_b32 v198, 0
    v_mov_b32 v199, 0
    v_mov_b32 v200, 0
    v_mov_b32 v201, 0
    v_mov_b32 v202, 0
    v_mov_b32 v203, 0
    v_mov_b32 v204, 0
    v_mov_b32 v205, 0
    v_mov_b32 v206, 0
    v_mov_b32 v207, 0
    s_nop 4
L_fc_91005:
    ds_read_b128 v[112:115], v81
    ds_read_b128 v[144:147], v82
    ds_read_b128 v[148:151], v82 offset:256
    s_waitcnt lgkmcnt(0)
    s_cmp_eq_u32 s89, 0
    s_cbranch_scc1 L_f0_91006
    s_cmp_eq_u32 s89, 8
    s_cbranch_scc1 L_f8_91007
    v_mfma_f32_32x32x16_bf16 v[64:79], v[112:115], v[128:131], 0
    s_branch L_fe_91008
L_f0_91006:
    s_nop 10
    v_mfma_f32_32x32x16_bf16 v[64:79], v[112:115], v[128:131], v[220:235]
    s_branch L_fe_91008
L_f8_91007:
    s_nop 10
    v_mfma_f32_32x32x16_bf16 v[64:79], v[112:115], v[128:131], v[236:251]
L_fe_91008:
    s_nop 7
    s_nop 7
    v_sub_f32 v64, v64, v80
    v_sub_f32 v65, v65, v80
    v_sub_f32 v66, v66, v80
    v_sub_f32 v67, v67, v80
    v_sub_f32 v68, v68, v80
    v_sub_f32 v69, v69, v80
    v_sub_f32 v70, v70, v80
    v_sub_f32 v71, v71, v80
    v_sub_f32 v72, v72, v80
    v_sub_f32 v73, v73, v80
    v_sub_f32 v74, v74, v80
    v_sub_f32 v75, v75, v80
    v_sub_f32 v76, v76, v80
    v_sub_f32 v77, v77, v80
    v_sub_f32 v78, v78, v80
    v_sub_f32 v79, v79, v80
    v_exp_f32 v64, v64
    v_exp_f32 v65, v65
    v_exp_f32 v66, v66
    v_exp_f32 v67, v67
    v_exp_f32 v68, v68
    v_exp_f32 v69, v69
    v_exp_f32 v70, v70
    v_exp_f32 v71, v71
    v_exp_f32 v72, v72
    v_exp_f32 v73, v73
    v_exp_f32 v74, v74
    v_exp_f32 v75, v75
    v_exp_f32 v76, v76
    v_exp_f32 v77, v77
    v_exp_f32 v78, v78
    v_exp_f32 v79, v79
    v_cvt_pk_bf16_f32 v96, v64, v65
    v_cvt_pk_bf16_f32 v97, v66, v67
    v_cvt_pk_bf16_f32 v98, v68, v69
    v_cvt_pk_bf16_f32 v99, v70, v71
    v_cvt_pk_bf16_f32 v100, v72, v73
    v_cvt_pk_bf16_f32 v101, v74, v75
    v_cvt_pk_bf16_f32 v102, v76, v77
    v_cvt_pk_bf16_f32 v103, v78, v79
    v_mfma_f32_32x32x16_bf16 v[192:207], v[144:147], v[96:99], v[192:207]
    s_nop 0
    v_mfma_f32_32x32x16_bf16 v[192:207], v[148:151], v[100:103], v[192:207]
    v_subrev_u32 v81, 1024, v81
    v_subrev_u32 v82, 1024, v82
    s_add_u32 s89, s89, 1
    s_cmp_le_u32 s89, s90
    s_nop 7
    s_cbranch_scc1 L_fc_91005
    v_rcp_f32 v201, v200
    s_nop 0
    v_mul_f32 v192, v192, v201
    v_mul_f32 v193, v193, v201
    v_mul_f32 v194, v194, v201
    v_mul_f32 v195, v195, v201
    v_mul_f32 v196, v196, v201
    v_mul_f32 v197, v197, v201
    v_mul_f32 v198, v198, v201
    v_mul_f32 v199, v199, v201
    v_cvt_pk_bf16_f32 v204, v192, v193
    v_cvt_pk_bf16_f32 v205, v194, v195
    v_cvt_pk_bf16_f32 v206, v196, v197
    v_cvt_pk_bf16_f32 v207, v198, v199
    s_waitcnt vmcnt(0)
    buffer_store_dwordx4 v[204:207], v1, s[16:19], s86 offen
    s_waitcnt vmcnt(0)
    s_mov_b32 s90, s46
    s_cmp_eq_u32 s44, 0
    s_cselect_b32 s90, s90, 8
    s_mov_b32 s89, 0
    v_mov_b32 v80, 0xff800000
    v_add_u32 v81, 8192, v216
    s_nop 4
L_fa_91009:
    ds_read_b128 v[112:115], v81
    s_waitcnt lgkmcnt(0)
    s_cmp_eq_u32 s89, 0
    s_cbranch_scc1 L_f0_91010
    s_cmp_eq_u32 s89, 8
    s_cbranch_scc1 L_f8_91011
    v_mfma_f32_32x32x16_bf16 v[64:79], v[112:115], v[160:163], 0
    s_branch L_fe_91012
L_f0_91010:
    s_nop 10
    v_mfma_f32_32x32x16_bf16 v[64:79], v[112:115], v[160:163], v[220:235]
    s_branch L_fe_91012
L_f8_91011:
    s_nop 10
    v_mfma_f32_32x32x16_bf16 v[64:79], v[112:115], v[160:163], v[236:251]
L_fe_91012:
    s_nop 7
    s_nop 7
    v_max3_f32 v80, v64, v65, v80
    v_max3_f32 v80, v66, v67, v80
    v_max3_f32 v80, v68, v69, v80
    v_max3_f32 v80, v70, v71, v80
    v_max3_f32 v80, v72, v73, v80
    v_max3_f32 v80, v74, v75, v80
    v_max3_f32 v80, v76, v77, v80
    v_max3_f32 v80, v78, v79, v80
    v_subrev_u32 v81, 1024, v81
    s_add_u32 s89, s89, 1
    s_cmp_le_u32 s89, s90
    s_nop 2
    s_cbranch_scc1 L_fa_91009
    v_mov_b32 v83, v80
    s_nop 1
    v_permlane32_swap_b32 v80, v83
    v_max_f32 v80, v80, v83
    s_mov_b32 s89, 0
    v_add_u32 v81, 8192, v216
    v_add_u32 v82, 8192, v218
    v_mov_b32 v192, 0
    v_mov_b32 v193, 0
    v_mov_b32 v194, 0
    v_mov_b32 v195, 0
    v_mov_b32 v196, 0
    v_mov_b32 v197, 0
    v_mov_b32 v198, 0
    v_mov_b32 v199, 0
    v_mov_b32 v200, 0
    v_mov_b32 v201, 0
    v_mov_b32 v202, 0
    v_mov_b32 v203, 0
    v_mov_b32 v204, 0
    v_mov_b32 v205, 0
    v_mov_b32 v206, 0
    v_mov_b32 v207, 0
    s_nop 4
L_fc_91013:
    ds_read_b128 v[112:115], v81
    ds_read_b128 v[144:147], v82
    ds_read_b128 v[148:151], v82 offset:256
    s_waitcnt lgkmcnt(0)
    s_cmp_eq_u32 s89, 0
    s_cbranch_scc1 L_f0_91014
    s_cmp_eq_u32 s89, 8
    s_cbranch_scc1 L_f8_91015
    v_mfma_f32_32x32x16_bf16 v[64:79], v[112:115], v[160:163], 0
    s_branch L_fe_91016
L_f0_91014:
    s_nop 10
    v_mfma_f32_32x32x16_bf16 v[64:79], v[112:115], v[160:163], v[220:235]
    s_branch L_fe_91016
L_f8_91015:
    s_nop 10
    v_mfma_f32_32x32x16_bf16 v[64:79], v[112:115], v[160:163], v[236:251]
L_fe_91016:
    s_nop 7
    s_nop 7
    v_sub_f32 v64, v64, v80
    v_sub_f32 v65, v65, v80
    v_sub_f32 v66, v66, v80
    v_sub_f32 v67, v67, v80
    v_sub_f32 v68, v68, v80
    v_sub_f32 v69, v69, v80
    v_sub_f32 v70, v70, v80
    v_sub_f32 v71, v71, v80
    v_sub_f32 v72, v72, v80
    v_sub_f32 v73, v73, v80
    v_sub_f32 v74, v74, v80
    v_sub_f32 v75, v75, v80
    v_sub_f32 v76, v76, v80
    v_sub_f32 v77, v77, v80
    v_sub_f32 v78, v78, v80
    v_sub_f32 v79, v79, v80
    v_exp_f32 v64, v64
    v_exp_f32 v65, v65
    v_exp_f32 v66, v66
    v_exp_f32 v67, v67
    v_exp_f32 v68, v68
    v_exp_f32 v69, v69
    v_exp_f32 v70, v70
    v_exp_f32 v71, v71
    v_exp_f32 v72, v72
    v_exp_f32 v73, v73
    v_exp_f32 v74, v74
    v_exp_f32 v75, v75
    v_exp_f32 v76, v76
    v_exp_f32 v77, v77
    v_exp_f32 v78, v78
    v_exp_f32 v79, v79
    v_cvt_pk_bf16_f32 v96, v64, v65
    v_cvt_pk_bf16_f32 v97, v66, v67
    v_cvt_pk_bf16_f32 v98, v68, v69
    v_cvt_pk_bf16_f32 v99, v70, v71
    v_cvt_pk_bf16_f32 v100, v72, v73
    v_cvt_pk_bf16_f32 v101, v74, v75
    v_cvt_pk_bf16_f32 v102, v76, v77
    v_cvt_pk_bf16_f32 v103, v78, v79
    v_mfma_f32_32x32x16_bf16 v[192:207], v[144:147], v[96:99], v[192:207]
    s_nop 0
    v_mfma_f32_32x32x16_bf16 v[192:207], v[148:151], v[100:103], v[192:207]
    v_subrev_u32 v81, 1024, v81
    v_subrev_u32 v82, 1024, v82
    s_add_u32 s89, s89, 1
    s_cmp_le_u32 s89, s90
    s_nop 7
    s_cbranch_scc1 L_fc_91013
    v_rcp_f32 v201, v200
    s_nop 0
    v_mul_f32 v192, v192, v201
    v_mul_f32 v193, v193, v201
    v_mul_f32 v194, v194, v201
    v_mul_f32 v195, v195, v201
    v_mul_f32 v196, v196, v201
    v_mul_f32 v197, v197, v201
    v_mul_f32 v198, v198, v201
    v_mul_f32 v199, v199, v201
    v_cvt_pk_bf16_f32 v204, v192, v193
    v_cvt_pk_bf16_f32 v205, v194, v195
    v_cvt_pk_bf16_f32 v206, v196, v197
    v_cvt_pk_bf16_f32 v207, v198, v199
    s_waitcnt vmcnt(0)
    buffer_store_dwordx4 v[204:207], v1, s[16:19], s87 offen
    s_waitcnt vmcnt(0)
    v_mov_b32 v252, 14
    buffer_wbl2 sc1
    s_waitcnt vmcnt(0)
    s_mov_b64 exec, 1
    s_cmp_lg_u32 s50, 0
    s_cbranch_scc1 L_fp_91017
    buffer_store_dword v252, off, s[16:19], s52
    s_branch L_fp_91018
L_fp_91017:
    buffer_store_dword v252, off, s[16:19], s52 sc1
L_fp_91018:
    s_mov_b64 exec, -1
    s_cmp_eq_u32 s91, 0
    s_cbranch_scc1 L_fp_91021
L_fp_91019:
    buffer_load_dword v120, v22, s[16:19], s53 offen sc1
    s_waitcnt vmcnt(0)
    v_cmp_gt_u32 vcc, 13, v120
    s_nop 1
    s_cbranch_vccz L_fp_91020
    s_sub_u32 s54, s54, 1
    s_cbranch_scc0 L_fp_91019
    s_endpgm
L_fp_91020:
    buffer_inv sc1
    s_waitcnt vmcnt(0)
    s_add_u32 s92, s61, s76
    buffer_load_dwordx4 v[132:135], v1, s[16:19], s92 offen offset:0 sc1
    buffer_load_dwordx4 v[136:139], v1, s[16:19], s92 offen offset:1024 sc1
    s_add_u32 s92, s61, s77
    buffer_load_dwordx4 v[140:143], v1, s[16:19], s92 offen offset:0 sc1
    buffer_load_dwordx4 v[164:167], v1, s[16:19], s92 offen offset:1024 sc1
    s_add_u32 s92, s61, s78
    buffer_load_dwordx4 v[168:171], v1, s[16:19], s92 offen offset:0 sc1
    buffer_load_dwordx4 v[172:175], v1, s[16:19], s92 offen offset:1024 sc1
    s_add_u32 s92, s61, s79
    buffer_load_dwordx4 v[208:211], v1, s[16:19], s92 offen offset:0 sc1
    buffer_load_dwordx4 v[212:215], v1, s[16:19], s92 offen offset:1024 sc1
    s_nop 1
L_fp_91021:
    s_waitcnt vmcnt(0)
    s_nop 7
    s_nop 7
    v_mfma_f32_32x32x16_bf16 v[176:191], v[32:35], v[132:135], 0
    v_mfma_f32_32x32x16_bf16 v[220:235], v[36:39], v[132:135], 0
    v_mfma_f32_32x32x16_bf16 v[176:191], v[40:43], v[136:139], v[176:191]
    v_mfma_f32_32x32x16_bf16 v[220:235], v[44:47], v[136:139], v[220:235]
    v_mfma_f32_32x32x16_bf16 v[176:191], v[48:51], v[140:143], v[176:191]
    v_mfma_f32_32x32x16_bf16 v[220:235], v[52:55], v[140:143], v[220:235]
    v_mfma_f32_32x32x16_bf16 v[176:191], v[56:59], v[164:167], v[176:191]
    v_mfma_f32_32x32x16_bf16 v[220:235], v[60:63], v[164:167], v[220:235]
    v_mfma_f32_32x32x16_bf16 v[176:191], a[224:227], v[168:171], v[176:191]
    v_mfma_f32_32x32x16_bf16 v[220:235], a[228:231], v[168:171], v[220:235]
    v_mfma_f32_32x32x16_bf16 v[176:191], a[232:235], v[172:175], v[176:191]
    v_mfma_f32_32x32x16_bf16 v[220:235], a[236:239], v[172:175], v[220:235]
    v_mfma_f32_32x32x16_bf16 v[176:191], a[240:243], v[208:211], v[176:191]
    v_mfma_f32_32x32x16_bf16 v[220:235], a[244:247], v[208:211], v[220:235]
    s_nop 7
    s_nop 7
    s_branch L_fbr1
L_pub_143:
    buffer_wbl2 sc1
    s_waitcnt vmcnt(0)
    buffer_store_dword v252, off, s[16:19], s52 sc1
    s_branch L_pur_144
L_pub_145:
    buffer_wbl2 sc1
    s_waitcnt vmcnt(0)
    buffer_store_dword v252, off, s[16:19], s52 sc1
    s_branch L_pur_146
L_wx_147:
    s_nop 7
    s_nop 7
    s_mov_b32 s94, 0
    s_cmp_eq_u32 s50, 0
    s_cbranch_scc1 L_rt_149
L_sp_151:
    buffer_load_dword v128, v22, s[16:19], s53 offen sc1
    s_waitcnt vmcnt(0)
    v_cmp_gt_u32 vcc, 14, v128
    s_nop 4
    s_cbranch_vccz L_sq_152
    s_sub_u32 s54, s54, 1
    s_cbranch_scc0 L_sp_151
    s_endpgm
L_sq_152:
    s_cmp_eq_u32 s50, 0
    s_cbranch_scc1 L_sq_152x
    buffer_inv sc1
    s_waitcnt vmcnt(0)
L_sq_152x:
    s_mov_b32 s94, 1
L_rt_149:

    buffer_load_dword v128, v22, s[16:19], s53 offen sc1
    s_add_u32 s92, s62, s76
    buffer_load_dwordx4 v[144:147], v1, s[16:19], s92 offen offset:0 sc1
    buffer_load_dwordx4 v[148:151], v1, s[16:19], s92 offen offset:1024 sc1
    s_add_u32 s92, s62, s77
    buffer_load_dwordx4 v[152:155], v1, s[16:19], s92 offen offset:0 sc1
    buffer_load_dwordx4 v[156:159], v1, s[16:19], s92 offen offset:1024 sc1
    s_add_u32 s92, s62, s78
    buffer_load_dwordx4 v[176:179], v1, s[16:19], s92 offen offset:0 sc1
    buffer_load_dwordx4 v[180:183], v1, s[16:19], s92 offen offset:1024 sc1
    s_add_u32 s92, s62, s79
    buffer_load_dwordx4 v[184:187], v1, s[16:19], s92 offen offset:0 sc1
    buffer_load_dwordx4 v[220:223], v1, s[16:19], s92 offen offset:1024 sc1
    s_waitcnt vmcnt(0)
    v_mfma_f32_32x32x16_bf16 v[96:111], v[32:35], v[144:147], 0
    v_mfma_f32_32x32x16_bf16 v[96:111], v[40:43], v[148:151], v[96:111]
    v_mfma_f32_32x32x16_bf16 v[96:111], v[48:51], v[152:155], v[96:111]
    v_mfma_f32_32x32x16_bf16 v[96:111], v[56:59], v[156:159], v[96:111]
    v_mfma_f32_32x32x16_bf16 v[96:111], a[224:227], v[176:179], v[96:111]
    v_mfma_f32_32x32x16_bf16 v[96:111], a[232:235], v[180:183], v[96:111]
    v_mfma_f32_32x32x16_bf16 v[96:111], a[240:243], v[184:187], v[96:111]
    v_mfma_f32_32x32x16_bf16 v[96:111], a[248:251], v[220:223], v[96:111]
    v_mfma_f32_32x32x16_bf16 v[112:127], v[36:39], v[144:147], 0
    v_mfma_f32_32x32x16_bf16 v[112:127], v[44:47], v[148:151], v[112:127]
    s_nop 7
    s_nop 7
    v_cmp_class_f32 vcc, v96, s93
    s_nop 4
    s_cbranch_vccz L_wy_148
    s_cmp_lg_u32 s94, 0
    s_cbranch_scc1 L_wy_148
    v_cmp_gt_u32 vcc, 14, v128
    s_nop 4
    s_cmp_eq_u64 vcc, 0
    s_cselect_b32 s94, 1, 0
    s_sub_u32 s54, s54, 1
    s_cbranch_scc0 L_rt_149
    s_endpgm
L_poll_153:
    s_nop 4
    buffer_load_dword v129, v21, s[16:19], s53 offen sc1
    s_waitcnt vmcnt(0)
    v_cmp_gt_u32 vcc, 15, v129
    s_nop 1
    s_cbranch_vccz L_ok_154
    s_sub_u32 s54, s54, 1
    s_cbranch_scc0 L_poll_153
    s_endpgm
L_acq_155:
    buffer_inv sc1
    s_waitcnt vmcnt(0)
    s_branch L_acr_156
L_pub_157:
    buffer_wbl2 sc1
    s_waitcnt vmcnt(0)
    buffer_store_dword v252, off, s[16:19], s52 sc1
    s_branch L_pur_158
L_poll_159:
    s_nop 4
    buffer_load_dword v184, v21, s[16:19], s53 offen sc1
    s_waitcnt vmcnt(0)
    v_cmp_gt_u32 vcc, 16, v184
    s_nop 1
    s_cbranch_vccz L_ok_160
    s_sub_u32 s54, s54, 1
    s_cbranch_scc0 L_poll_159
    s_endpgm
L_acq_161:
    buffer_inv sc1
    s_waitcnt vmcnt(0)
    s_branch L_acr_162
L_pub_163:
    buffer_wbl2 sc1
    s_waitcnt vmcnt(0)
    buffer_store_dword v252, off, s[16:19], s52 sc1
    s_branch L_pur_164
L_wb_165:
    buffer_wbl2 sc1
    s_branch L_wr_166
L_poll_167:
    s_nop 4
    buffer_load_dword v184, v22, s[16:19], s53 offen sc1
    s_waitcnt vmcnt(0)
    v_cmp_gt_u32 vcc, 17, v184
    s_nop 1
    s_cbranch_vccz L_ok_168
    s_sub_u32 s54, s54, 1
    s_cbranch_scc0 L_poll_167
    s_endpgm
L_acq_169:
    buffer_inv sc1
    s_waitcnt vmcnt(0)
    s_branch L_acr_170
L_pub_171:
    buffer_wbl2 sc1
    s_waitcnt vmcnt(0)
    buffer_store_dword v252, off, s[16:19], s52 sc1
    s_branch L_pur_172
L_poll_173:
    s_nop 4
    buffer_load_dword v184, v21, s[16:19], s53 offen sc1
    s_waitcnt vmcnt(0)
    v_cmp_gt_u32 vcc, 16, v184
    s_nop 1
    s_cbranch_vccz L_ok_174
    s_sub_u32 s54, s54, 1
    s_cbranch_scc0 L_poll_173
    s_endpgm
L_acq_175:
    buffer_inv sc1
    s_waitcnt vmcnt(0)
    s_branch L_acr_176
L_pub_177:
    buffer_wbl2 sc1
    s_waitcnt vmcnt(0)
    buffer_store_dword v252, off, s[16:19], s52 sc1
    s_branch L_pur_178
L_wb_179:
    buffer_wbl2 sc1
    s_branch L_wr_180
L_poll_181:
    s_nop 4
    buffer_load_dword v184, v22, s[16:19], s53 offen sc1
    s_waitcnt vmcnt(0)
    v_cmp_gt_u32 vcc, 17, v184
    s_nop 1
    s_cbranch_vccz L_ok_182
    s_sub_u32 s54, s54, 1
    s_cbranch_scc0 L_poll_181
    s_endpgm
L_acq_183:
    buffer_inv sc1
    s_waitcnt vmcnt(0)
    s_branch L_acr_184
L_pub_185:
    buffer_wbl2 sc1
    s_waitcnt vmcnt(0)
    buffer_store_dword v252, off, s[16:19], s52 sc1
    s_branch L_pur_186
L_poll_187:
    s_nop 4
    buffer_load_dword v106, v22, s[16:19], s53 offen sc1
    s_waitcnt vmcnt(0)
    v_cmp_gt_u32 vcc, 18, v106
    s_nop 1
    s_cbranch_vccz L_ok_188
    s_sub_u32 s54, s54, 1
    s_cbranch_scc0 L_poll_187
    s_endpgm
L_acq_189:
    buffer_inv sc1
    s_waitcnt vmcnt(0)
    s_branch L_acr_190
L_wb_191:
    buffer_wbl2 sc1
    s_branch L_wr_192
L_end:
.section .rodata,"a"
.p2align 6
.amdhsa_kernel interleave_layers__sliding_block__glu_gated_reglu__prompt_kernel
  .amdhsa_next_free_vgpr 512
  .amdhsa_next_free_sgpr 102
  .amdhsa_accum_offset 256
  .amdhsa_group_segment_fixed_size 0
  .amdhsa_kernarg_size 80
  .amdhsa_user_sgpr_count 2
  .amdhsa_user_sgpr_kernarg_segment_ptr 1
  .amdhsa_system_sgpr_workgroup_id_x 1
.end_amdhsa_kernel
```
